```python
import torch

def _softmax(x, axis=-1):
    return torch.softmax(x, dim=axis)
def _gelu(x):
    return torch.nn.functional.gelu(x, approximate="tanh")
def _silu(x):
    return torch.nn.functional.silu(x)
def _sigmoid(x):
    return torch.sigmoid(x)
def _layernorm(x, axis=-1, eps=1e-5):
    m = x.mean(dim=axis, keepdim=True)
    v = x.var(dim=axis, keepdim=True, unbiased=False)
    return (x - m) / torch.sqrt(v + eps)
def _scatter_add(tgt, idx, src, axis=0):
    return tgt.clone().index_add_(axis, idx, src)
def _segment_sum(src, seg, n):
    out = torch.zeros((n,) + src.shape[1:], dtype=src.dtype)
    return out.index_add_(0, seg, src)
def _pad(x, pw):
    flat = tuple(v for pair in reversed(pw) for v in pair)
    return torch.nn.functional.pad(x, flat)

kernel_name = 'sequential_preLN__softmax_full_mha__glu_gated_swiglu__prompt'

def setup_inputs():

    _w = (lambda a: (lambda t: t.to(torch.bfloat16) if t.is_floating_point() else t)(torch.as_tensor(a)))
    def _A_setup():
        B, S, D = 1, 2048, 1024
        return {
            "x": _w((lambda *s: torch.randn(*s, dtype=torch.bfloat16) * 0.05)(B, S, D)),
            "wqkv": _w((lambda *s: torch.randn(*s, dtype=torch.bfloat16) * 0.05)(D, 3 * D)),
            "wo": _w((lambda *s: torch.randn(*s, dtype=torch.bfloat16) * 0.05)(D, D)),
        }
    _A_in = _A_setup()

    def _B_setup():
        B, S, D, F = 1, 2048, 1024, 3584
        return {
            "x": _w((lambda *s: torch.randn(*s, dtype=torch.bfloat16) * 0.05)(B, S, D)),
            "w1": _w((lambda *s: torch.randn(*s, dtype=torch.bfloat16) * 0.8)(D, F) * (2.0 / D) ** 0.5),
            "w3": _w((lambda *s: torch.randn(*s, dtype=torch.bfloat16) * 0.8)(D, F) * (2.0 / D) ** 0.5),
            "w2": _w((lambda *s: torch.randn(*s, dtype=torch.bfloat16) * 0.8)(F, D) * (2.0 / F) ** 0.5),
        }
    _B_in = _B_setup()

    return {
        "A_x": _A_in["x"],
        "A_wqkv": _A_in["wqkv"],
        "A_wo": _A_in["wo"],
        "B_x": _B_in["x"],
        "B_w1": _B_in["w1"],
        "B_w3": _B_in["w3"],
        "B_w2": _B_in["w2"],
    }

def reference(A_x, A_wqkv, A_wo, B_x, B_w1, B_w3, B_w2):
    def _A_ref(x, wqkv, wo):
        B, S, D = x.shape
        H = 32; Dh = D // H
        qkv = (lambda x, *d: x.permute(*d))((x @ wqkv).reshape(B, S, 3, H, Dh), 2, 0, 3, 1, 4)
        q, k, v = qkv[0], qkv[1], qkv[2]
        scale = Dh ** -0.5
        scores = torch.einsum("bhqd,bhkd->bhqk", q, k) * scale
        p = _softmax(scores, axis=-1)
        o = torch.einsum("bhqk,bhkd->bhqd", p, v)
        return (lambda x, *d: x.permute(*d))(o, 0, 2, 1, 3).reshape(B, S, D) @ wo

    def _B_ref(x, w1, w3, w2):
        gate = torch.einsum("bsd,df->bsf", x, w1)
        up = torch.einsum("bsd,df->bsf", x, w3)
        h = _silu(gate) * up
        out = torch.einsum("bsf,fd->bsd", h, w2)
        return out

    x = A_x
    h = x + _A_ref(_layernorm(x, axis=-1), A_wqkv, A_wo)
    h2 = h + _B_ref(_layernorm(h, axis=-1), B_w1, B_w3, B_w2)
    return h2
```

```asm
; @launch grid=(256,1,1) block=(256,1,1) lds=163840
.amdgcn_target "amdgcn-amd-amdhsa--gfx950"
.text
.globl sequential_preLN__softmax_full_mha__glu_gated_swiglu__prompt_kernel
.p2align 12
.p2align 8
.type sequential_preLN__softmax_full_mha__glu_gated_swiglu__prompt_kernel,@function
sequential_preLN__softmax_full_mha__glu_gated_swiglu__prompt_kernel:
 s_cmp_ge_u32 s2, 256
 s_cbranch_scc1 L_end_1
 s_load_dwordx16 s[36:51], s[0:1], 0
 s_load_dwordx4 s[52:55], s[0:1], 64
 s_branch L_main
.p2align 12
L_main:
 v_lshrrev_b32 v2, 6, v0
 v_and_b32 v0, 63, v0
 v_readfirstlane_b32 s16, v2
 v_lshlrev_b32 v1, 4, v0
 s_and_b32 s28, s2, 1
 s_bfe_u32 s29, s2, 0x20001
 s_lshr_b32 s30, s2, 3
 s_and_b32 s31, s30, 3
 s_lshr_b32 s32, s30, 2
 s_and_b32 s3, s30, 7
 s_lshl3_add_u32 s17, s28, s3
 s_lshr_b32 s3, s30, 3
 s_lshl2_add_u32 s18, s29, s3
 s_lshl2_add_u32 s60, s29, s31
 s_lshl3_add_u32 s61, s28, s32
 s_lshl2_add_u32 s62, s28, s31
 s_lshl3_add_u32 s63, s29, s32
 s_lshl_b32 s19, s16, 12
 s_mov_b32 s64, 0xffff0000
 s_lshl1_add_u32 s61, s32, s28
 s_bfe_u32 s33, s2, 0x10002
 s_xor_b32 s33, s33, 1
 s_lshl2_add_u32 s62, s33, s31
 s_and_b32 s33, s2, 3
 s_lshl3_add_u32 s63, s33, s32
 s_and_b32 s17, s30, 15
 s_and_b32 s28, s2, 7
 s_lshr_b32 s3, s30, 4
 s_lshl1_add_u32 s18, s28, s3
 s_xor_b32 s33, s17, 0
 s_lshl_b32 s33, s33, 4
 s_add_u32 s33, s33, s18
 s_lshl_b32 s34, s16, 1
 s_lshl3_add_u32 s35, s33, s34
 v_lshrrev_b32 v98, 5, v0
 v_add_u32 v99, s35, v98
 v_and_b32 v100, 31, v0
 v_lshlrev_b32 v101, 11, v99
 v_lshl_add_u32 v101, v100, 4, v101
 s_lshl2_add_u32 s66, s2, s16
 v_mov_b32 v85, 1
 v_mov_b32 v86, 0
 v_lshlrev_b32 v87, 8, v0
 v_and_b32 v95, 1, v0
 v_lshlrev_b32 v95, 7, v95
 s_lshl_b32 s3, s2, 15
 s_add_u32 s3, s3, 40108032
 v_add_u32 v92, s3, v87
 v_add_u32 v93, 0x4000, v92
 s_cmp_eq_u32 s16, 3
 s_cselect_b32 s67, s2, 8
 s_waitcnt lgkmcnt(0)
 s_cmp_ge_u32 s67, 5
 s_cbranch_scc1 L_nz_2
 global_store_dword v92, v86, s[54:55] sc1
 global_store_dword v93, v86, s[54:55] sc1
L_nz_2:
 global_load_dwordx4 v[112:115], v101, s[36:37] nt
 global_load_dwordx4 v[116:119], v101, s[36:37] offset:512 nt
 global_load_dwordx4 v[120:123], v101, s[36:37] offset:1024 nt
 global_load_dwordx4 v[124:127], v101, s[36:37] offset:1536 nt
 s_mov_b32 s4, s54
 s_mov_b32 s5, s55
 s_mov_b32 s6, 0x4000000
 s_mov_b32 s7, 0x20000
 s_and_b32 s0, s2, 7
 s_lshl_b32 s0, s0, 8
 s_cmp_eq_u32 s16, 0
 s_cselect_b32 s1, -1, 0
 s_mov_b32 s12, s38
 s_mov_b32 s13, s39
 s_mov_b32 s14, 0x600000
 s_mov_b32 s15, 0x20000
 s_mov_b32 s56, s52
 s_mov_b32 s57, s53
 s_mov_b32 s58, 0x100
 s_mov_b32 s59, 0x20000
 s_getpc_b64 s[28:29]
L_pc:
 s_lshl2_add_u32 s3, s30, s16
 s_mul_i32 s3, s3, 896
 v_min_u32 v88, 6, v0
 v_lshl_add_u32 v88, v88, 7, s3
 v_min_u32 v88, L_codeend-L_pc-4, v88
 s_lshl2_add_u32 s3, s30, s16
 s_mul_i32 s31, s3, 24576
 s_mul_i32 s3, s3, 49152
 s_and_b32 s32, s2, 7
 s_lshl_b32 s32, s32, 8
 s_add_u32 s31, s31, s32
 s_add_u32 s3, s3, s32
 v_and_b32 v89, 1, v0
 v_lshlrev_b32 v89, 7, v89
 v_bfe_u32 v90, v0, 2, 2
 v_mul_u32_u24 v90, 6144, v90
 v_bfe_u32 v111, v0, 1, 1
 v_lshl_add_u32 v111, v111, 11, v90
 v_add3_u32 v111, v111, v89, s31
 v_add_u32 v111, 2048, v111
 v_bfe_u32 v90, v0, 1, 3
 v_mul_u32_u24 v90, 6144, v90
 v_add3_u32 v89, v90, v89, s3
 v_add_u32 v90, 3145728, v111
 v_mov_b32 v94, v111
 s_lshl_b32 s3, s66, 11
 v_add_u32 v91, s3, v1
 global_load_dword v74, v88, s[28:29]
 global_load_dword v72, v94, s[38:39]
 v_add_u32 v103, s34, v98
 v_and_b32 v104, 7, v0
 v_xor_b32 v103, v103, v104
 v_lshlrev_b32 v103, 4, v103
 v_lshl_add_u32 v103, v100, 7, v103
 v_add_u32 v103, 131072, v103
 s_lshl_b32 s3, s16, 3
 v_lshrrev_b32 v105, 3, v0
 v_xor_b32 v106, v105, v104
 v_add_u32 v105, s3, v105
 v_lshlrev_b32 v106, 4, v106
 v_lshl_add_u32 v106, v105, 7, v106
 v_add_u32 v106, 131072, v106
 v_lshlrev_b32 v107, 4, v104
 v_lshl_add_u32 v107, v105, 9, v107
 s_lshr_b32 s65, s33, 1
 s_lshl_b32 s65, s65, 15
 s_and_b32 s3, s33, 1
 s_lshl_b32 s3, s3, 7
 s_add_u32 s65, s65, s3
 s_lshl_b32 s65, s65, 1
 v_lshlrev_b32 v99, 2, v99
 s_mul_i32 s3, s16, 98304
 s_lshl_b32 s33, s18, 7
 s_add_u32 s3, s3, s33
 v_lshrrev_b32 v108, 3, v0
 v_and_b32 v109, 2, v108
 v_lshlrev_b32 v109, 1, v109
 v_and_b32 v110, 7, v0
 v_xor_b32 v109, v109, v110
 v_mul_u32_u24 v108, 6144, v108
 v_add_u32 v108, s3, v108
 v_xor_b32 v110, 2, v109
 v_lshl_add_u32 v109, v109, 4, v108
 v_lshl_add_u32 v110, v110, 4, v108
 v_add_u32 v76, 2048, v109
 v_add_u32 v77, 50176, v110
 v_add_u32 v78, 2048, v109
 v_add_u32 v79, 50176, v110
 s_lshl_b32 s29, s17, 11
 s_add_u32 s29, s29, s0
 s_add_u32 s29, s29, 40108032
 s_xor_b32 s26, s17, 0
 s_lshl_b32 s26, s26, 11
 s_add_u32 s26, s26, s0
 s_add_u32 s26, s26, 40108032
 s_cmp_ge_u32 s67, 2
 s_cbranch_scc1 L_nr_3
 s_lshl_b32 s3, s67, 7
 s_waitcnt vmcnt(6)
 s_mov_b64 exec, 1
 buffer_store_dword v85, v86, s[56:59], s3 offen sc1
 s_mov_b64 exec, -1
 s_waitcnt vmcnt(3)
 s_branch L_havex_4
L_nr_3:
 s_waitcnt vmcnt(2)
L_havex_4:
 global_load_dword v72, v90, s[38:39]
 v_lshlrev_b32 v128, 16, v112
 v_and_b32 v129, s64, v112
 v_lshlrev_b32 v130, 16, v113
 v_and_b32 v131, s64, v113
 v_lshlrev_b32 v132, 16, v114
 v_and_b32 v133, s64, v114
 v_lshlrev_b32 v134, 16, v115
 v_and_b32 v135, s64, v115
 v_lshlrev_b32 v136, 16, v116
 v_and_b32 v137, s64, v116
 v_lshlrev_b32 v138, 16, v117
 v_and_b32 v139, s64, v117
 v_lshlrev_b32 v140, 16, v118
 v_and_b32 v141, s64, v118
 v_lshlrev_b32 v142, 16, v119
 v_and_b32 v143, s64, v119
 v_lshlrev_b32 v144, 16, v120
 v_and_b32 v145, s64, v120
 v_lshlrev_b32 v146, 16, v121
 v_and_b32 v147, s64, v121
 v_lshlrev_b32 v148, 16, v122
 v_and_b32 v149, s64, v122
 v_lshlrev_b32 v150, 16, v123
 v_and_b32 v151, s64, v123
 v_lshlrev_b32 v152, 16, v124
 v_and_b32 v153, s64, v124
 v_lshlrev_b32 v154, 16, v125
 v_and_b32 v155, s64, v125
 v_lshlrev_b32 v156, 16, v126
 v_and_b32 v157, s64, v126
 v_lshlrev_b32 v158, 16, v127
 v_and_b32 v159, s64, v127
 v_pk_add_f32 v[108:109], v[128:129], v[130:131]
 v_pk_add_f32 v[110:111], v[132:133], v[134:135]
 v_pk_add_f32 v[108:109], v[108:109], v[136:137]
 v_pk_add_f32 v[110:111], v[110:111], v[138:139]
 v_pk_add_f32 v[108:109], v[108:109], v[140:141]
 v_pk_add_f32 v[110:111], v[110:111], v[142:143]
 v_pk_add_f32 v[108:109], v[108:109], v[144:145]
 v_pk_add_f32 v[110:111], v[110:111], v[146:147]
 v_pk_add_f32 v[108:109], v[108:109], v[148:149]
 v_pk_add_f32 v[110:111], v[110:111], v[150:151]
 v_pk_add_f32 v[108:109], v[108:109], v[152:153]
 v_pk_add_f32 v[110:111], v[110:111], v[154:155]
 v_pk_add_f32 v[108:109], v[108:109], v[156:157]
 v_pk_add_f32 v[110:111], v[110:111], v[158:159]
 v_pk_add_f32 v[108:109], v[108:109], v[110:111]
 v_add_f32 v108, v108, v109
 s_nop 1
 v_add_f32_dpp v108, v108, v108 quad_perm:[1,0,3,2] row_mask:0xf bank_mask:0xf
 s_nop 1
 v_add_f32_dpp v108, v108, v108 quad_perm:[2,3,0,1] row_mask:0xf bank_mask:0xf
 s_nop 1
 v_add_f32_dpp v108, v108, v108 row_half_mirror row_mask:0xf bank_mask:0xf
 s_nop 1
 v_add_f32_dpp v108, v108, v108 row_mirror row_mask:0xf bank_mask:0xf
 v_mov_b32 v109, v108
 s_nop 1
 v_permlane16_swap_b32 v108, v109
 v_add_f32 v108, v108, v109
 v_mul_f32 v108, 0x3a800000, v108
 v_pk_add_f32 v[128:129], v[128:129], v[108:109] op_sel_hi:[1,0] neg_lo:[0,1] neg_hi:[0,1]
 v_pk_add_f32 v[130:131], v[130:131], v[108:109] op_sel_hi:[1,0] neg_lo:[0,1] neg_hi:[0,1]
 v_pk_add_f32 v[132:133], v[132:133], v[108:109] op_sel_hi:[1,0] neg_lo:[0,1] neg_hi:[0,1]
 v_pk_add_f32 v[134:135], v[134:135], v[108:109] op_sel_hi:[1,0] neg_lo:[0,1] neg_hi:[0,1]
 v_pk_add_f32 v[136:137], v[136:137], v[108:109] op_sel_hi:[1,0] neg_lo:[0,1] neg_hi:[0,1]
 v_pk_add_f32 v[138:139], v[138:139], v[108:109] op_sel_hi:[1,0] neg_lo:[0,1] neg_hi:[0,1]
 v_pk_add_f32 v[140:141], v[140:141], v[108:109] op_sel_hi:[1,0] neg_lo:[0,1] neg_hi:[0,1]
 v_pk_add_f32 v[142:143], v[142:143], v[108:109] op_sel_hi:[1,0] neg_lo:[0,1] neg_hi:[0,1]
 v_pk_add_f32 v[144:145], v[144:145], v[108:109] op_sel_hi:[1,0] neg_lo:[0,1] neg_hi:[0,1]
 v_pk_add_f32 v[146:147], v[146:147], v[108:109] op_sel_hi:[1,0] neg_lo:[0,1] neg_hi:[0,1]
 v_pk_add_f32 v[148:149], v[148:149], v[108:109] op_sel_hi:[1,0] neg_lo:[0,1] neg_hi:[0,1]
 v_pk_add_f32 v[150:151], v[150:151], v[108:109] op_sel_hi:[1,0] neg_lo:[0,1] neg_hi:[0,1]
 v_pk_add_f32 v[152:153], v[152:153], v[108:109] op_sel_hi:[1,0] neg_lo:[0,1] neg_hi:[0,1]
 v_pk_add_f32 v[154:155], v[154:155], v[108:109] op_sel_hi:[1,0] neg_lo:[0,1] neg_hi:[0,1]
 v_pk_add_f32 v[156:157], v[156:157], v[108:109] op_sel_hi:[1,0] neg_lo:[0,1] neg_hi:[0,1]
 v_pk_add_f32 v[158:159], v[158:159], v[108:109] op_sel_hi:[1,0] neg_lo:[0,1] neg_hi:[0,1]
 v_pk_mul_f32 v[110:111], v[128:129], v[128:129]
 v_pk_mul_f32 v[112:113], v[130:131], v[130:131]
 v_pk_fma_f32 v[110:111], v[132:133], v[132:133], v[110:111]
 v_pk_fma_f32 v[112:113], v[134:135], v[134:135], v[112:113]
 v_pk_fma_f32 v[110:111], v[136:137], v[136:137], v[110:111]
 v_pk_fma_f32 v[112:113], v[138:139], v[138:139], v[112:113]
 v_pk_fma_f32 v[110:111], v[140:141], v[140:141], v[110:111]
 v_pk_fma_f32 v[112:113], v[142:143], v[142:143], v[112:113]
 v_pk_fma_f32 v[110:111], v[144:145], v[144:145], v[110:111]
 v_pk_fma_f32 v[112:113], v[146:147], v[146:147], v[112:113]
 v_pk_fma_f32 v[110:111], v[148:149], v[148:149], v[110:111]
 v_pk_fma_f32 v[112:113], v[150:151], v[150:151], v[112:113]
 v_pk_fma_f32 v[110:111], v[152:153], v[152:153], v[110:111]
 v_pk_fma_f32 v[112:113], v[154:155], v[154:155], v[112:113]
 v_pk_fma_f32 v[110:111], v[156:157], v[156:157], v[110:111]
 v_pk_fma_f32 v[112:113], v[158:159], v[158:159], v[112:113]
 v_pk_add_f32 v[110:111], v[110:111], v[112:113]
 v_add_f32 v109, v110, v111
 s_nop 1
 v_add_f32_dpp v109, v109, v109 quad_perm:[1,0,3,2] row_mask:0xf bank_mask:0xf
 s_nop 1
 v_add_f32_dpp v109, v109, v109 quad_perm:[2,3,0,1] row_mask:0xf bank_mask:0xf
 s_nop 1
 v_add_f32_dpp v109, v109, v109 row_half_mirror row_mask:0xf bank_mask:0xf
 s_nop 1
 v_add_f32_dpp v109, v109, v109 row_mirror row_mask:0xf bank_mask:0xf
 v_mov_b32 v110, v109
 s_nop 1
 v_permlane16_swap_b32 v109, v110
 v_add_f32 v109, v109, v110
 v_mov_b32 v110, 0x3727c5ac
 v_fmac_f32 v110, 0x3a800000, v109
 v_rsq_f32 v110, v110
 s_nop 0
 v_pk_mul_f32 v[128:129], v[128:129], v[110:111] op_sel_hi:[1,0]
 v_pk_mul_f32 v[130:131], v[130:131], v[110:111] op_sel_hi:[1,0]
 v_pk_mul_f32 v[132:133], v[132:133], v[110:111] op_sel_hi:[1,0]
 v_pk_mul_f32 v[134:135], v[134:135], v[110:111] op_sel_hi:[1,0]
 v_cvt_pk_bf16_f32 v112, v128, v129
 v_cvt_pk_bf16_f32 v113, v130, v131
 v_cvt_pk_bf16_f32 v114, v132, v133
 v_cvt_pk_bf16_f32 v115, v134, v135
 ds_write_b128 v103, v[112:115]
 v_pk_mul_f32 v[136:137], v[136:137], v[110:111] op_sel_hi:[1,0]
 v_pk_mul_f32 v[138:139], v[138:139], v[110:111] op_sel_hi:[1,0]
 v_pk_mul_f32 v[140:141], v[140:141], v[110:111] op_sel_hi:[1,0]
 v_pk_mul_f32 v[142:143], v[142:143], v[110:111] op_sel_hi:[1,0]
 v_cvt_pk_bf16_f32 v116, v136, v137
 v_cvt_pk_bf16_f32 v117, v138, v139
 v_cvt_pk_bf16_f32 v118, v140, v141
 v_cvt_pk_bf16_f32 v119, v142, v143
 ds_write_b128 v103, v[116:119] offset:4096
 v_pk_mul_f32 v[144:145], v[144:145], v[110:111] op_sel_hi:[1,0]
 v_pk_mul_f32 v[146:147], v[146:147], v[110:111] op_sel_hi:[1,0]
 v_pk_mul_f32 v[148:149], v[148:149], v[110:111] op_sel_hi:[1,0]
 v_pk_mul_f32 v[150:151], v[150:151], v[110:111] op_sel_hi:[1,0]
 v_cvt_pk_bf16_f32 v120, v144, v145
 v_cvt_pk_bf16_f32 v121, v146, v147
 v_cvt_pk_bf16_f32 v122, v148, v149
 v_cvt_pk_bf16_f32 v123, v150, v151
 ds_write_b128 v103, v[120:123] offset:8192
 v_pk_mul_f32 v[152:153], v[152:153], v[110:111] op_sel_hi:[1,0]
 v_pk_mul_f32 v[154:155], v[154:155], v[110:111] op_sel_hi:[1,0]
 v_pk_mul_f32 v[156:157], v[156:157], v[110:111] op_sel_hi:[1,0]
 v_pk_mul_f32 v[158:159], v[158:159], v[110:111] op_sel_hi:[1,0]
 v_cvt_pk_bf16_f32 v124, v152, v153
 v_cvt_pk_bf16_f32 v125, v154, v155
 v_cvt_pk_bf16_f32 v126, v156, v157
 v_cvt_pk_bf16_f32 v127, v158, v159
 ds_write_b128 v103, v[124:127] offset:12288
 s_mov_b32 s3, 39845888
 s_mov_b32 exec_lo, 1
 s_mov_b32 exec_hi, 1
 buffer_store_dword v108, v99, s[4:7], s3 offen sc1
 s_mov_b64 exec, -1
 s_waitcnt lgkmcnt(0)
 s_barrier
 ds_read_b128 v[112:115], v106
 ds_read_b128 v[116:119], v106 offset:4096
 ds_read_b128 v[120:123], v106 offset:8192
 ds_read_b128 v[124:127], v106 offset:12288
 s_waitcnt lgkmcnt(3)
 buffer_store_dwordx4 v[112:115], v107, s[4:7], s65 offen sc1
 s_add_u32 s65, s65, 16384
 s_waitcnt lgkmcnt(2)
 buffer_store_dwordx4 v[116:119], v107, s[4:7], s65 offen sc1
 s_add_u32 s65, s65, 16384
 s_waitcnt lgkmcnt(1)
 buffer_store_dwordx4 v[120:123], v107, s[4:7], s65 offen sc1
 s_add_u32 s65, s65, 16384
 s_waitcnt lgkmcnt(0)
 buffer_store_dwordx4 v[124:127], v107, s[4:7], s65 offen sc1
 s_cmp_lg_u32 s16, 0
 s_cbranch_scc1 L_look_5
 buffer_load_dword v84, v95, s[56:59], 0 offen sc1
L_look_5:
 s_mov_b32 s21, 0
 s_mov_b32 m0, s19
 s_nop 0
 buffer_load_dwordx4 v76, s[12:15], s21 offen lds
 buffer_load_dwordx4 v77, s[12:15], s21 offen offset:1024 lds
 buffer_load_dwordx4 v78, s[12:15], s21 offen offset:2048 lds
 buffer_load_dwordx4 v79, s[12:15], s21 offen offset:3072 lds
 s_add_u32 s21, s21, 393216
 s_add_u32 m0, s19, 16384
 s_nop 0
 buffer_load_dwordx4 v76, s[12:15], s21 offen lds
 buffer_load_dwordx4 v77, s[12:15], s21 offen offset:1024 lds
 buffer_load_dwordx4 v78, s[12:15], s21 offen offset:2048 lds
 buffer_load_dwordx4 v79, s[12:15], s21 offen offset:3072 lds
 s_add_u32 s21, s21, 393216
 s_mov_b64 exec, 0
 s_cmp_eq_u32 s16, 0
 s_cbranch_scc1 L_hop_2
 s_cmp_eq_u32 s16, 1
 s_cbranch_scc1 L_hop_3
 s_cmp_eq_u32 s16, 2
 s_cbranch_scc1 L_hop_4
 s_branch L_hop_5
L_ret_0:
 s_mov_b64 exec, -1
 s_waitcnt vmcnt(8)
 v_cmp_gt_u32 vcc, 1, v84
 s_nop 1
 s_and_b32 s67, s1, vcc_lo
 s_cbranch_scc1 L_poll_6
L_polled_7:
 s_barrier
 s_cmp_lg_u32 s16, 0
 s_cbranch_scc1 L_arrived_8
 s_sub_u32 s67, s26, s0
 s_mov_b64 exec, 0xff
 buffer_atomic_add v85, v87, s[4:7], s67 offen sc1
 s_mov_b64 exec, -1
L_arrived_8:
 global_load_dword v72, v89, s[38:39]
 global_load_dwordx4 v[64:67], v91, s[40:41]
 global_load_dwordx4 v[68:71], v91, s[40:41] offset:1024
 s_add_u32 m0, s19, 32768
 s_nop 0
 buffer_load_dwordx4 v76, s[12:15], s21 offen lds
 buffer_load_dwordx4 v77, s[12:15], s21 offen offset:1024 lds
 buffer_load_dwordx4 v78, s[12:15], s21 offen offset:2048 lds
 buffer_load_dwordx4 v79, s[12:15], s21 offen offset:3072 lds
 s_add_u32 s21, s21, 393216
 s_add_u32 m0, s19, 49152
 s_nop 0
 buffer_load_dwordx4 v76, s[12:15], s21 offen lds
 buffer_load_dwordx4 v77, s[12:15], s21 offen offset:1024 lds
 buffer_load_dwordx4 v78, s[12:15], s21 offen offset:2048 lds
 buffer_load_dwordx4 v79, s[12:15], s21 offen offset:3072 lds
 s_add_u32 s21, s21, 393216
 s_mul_i32 s3, s16, 196608
 s_lshl_b32 s28, s18, 7
 s_add_u32 s3, s3, s28
 v_lshrrev_b32 v29, 3, v0
 v_and_b32 v30, 2, v29
 v_lshlrev_b32 v30, 1, v30
 v_and_b32 v31, 7, v0
 v_xor_b32 v30, v30, v31
 v_mul_u32_u24 v29, 6144, v29
 v_add_u32 v29, s3, v29
 v_xor_b32 v31, 2, v30
 v_lshl_add_u32 v30, v30, 4, v29
 v_lshl_add_u32 v31, v31, 4, v29
 v_add_u32 v80, 0, v30
 v_add_u32 v81, 48128, v31
 v_add_u32 v82, 96256, v30
 v_add_u32 v83, 144384, v31
 s_lshl_b32 s3, s17, 2
 s_add_u32 s33, s3, s16
 s_lshl_b32 s3, s33, 16
 v_add_u32 v2, s3, v1
 v_and_b32 v3, 4294967168, v2
 v_add_u32 v2, v2, v3
 v_add_u32 v3, 65536, v2
 s_mov_b32 s23, 0
 v_bfe_u32 v20, v0, 2, 2
 v_lshrrev_b32 v21, 4, v0
 v_and_b32 v22, 2, v20
 v_and_or_b32 v22, v21, 1, v22
 v_lshlrev_b32 v21, 10, v21
 v_lshl_add_u32 v21, v20, 7, v21
 v_and_b32 v20, 3, v0
 v_lshl_add_u32 v21, v20, 3, v21
 v_xor_b32 v20, 0, v22
 v_lshl_add_u32 v12, v20, 5, v21
 v_xor_b32 v20, 1, v22
 v_lshl_add_u32 v13, v20, 5, v21
 v_xor_b32 v20, 2, v22
 v_lshl_add_u32 v14, v20, 5, v21
 v_xor_b32 v20, 3, v22
 v_lshl_add_u32 v15, v20, 5, v21
 v_lshrrev_b32 v20, 5, v0
 v_lshlrev_b32 v20, 11, v20
 v_add_u32 v4, v20, v12
 v_add_u32 v16, 0x10000, v12
 v_add_u32 v8, 0x10000, v4
 v_add_u32 v5, v20, v13
 v_add_u32 v17, 0x10000, v13
 v_add_u32 v9, 0x10000, v5
 v_add_u32 v6, v20, v14
 v_add_u32 v18, 0x10000, v14
 v_add_u32 v10, 0x10000, v6
 v_add_u32 v7, v20, v15
 v_add_u32 v19, 0x10000, v15
 v_add_u32 v11, 0x10000, v7
 v_lshrrev_b32 v20, 4, v0
 v_lshlrev_b32 v20, 5, v20
 v_and_or_b32 v27, v0, 3, v20
 v_and_or_b32 v28, v0, 15, v20
 v_bfe_u32 v20, v0, 3, 1
 v_lshl_or_b32 v27, v20, 2, v27
 v_bfe_u32 v20, v0, 2, 1
 v_lshl_or_b32 v27, v20, 3, v27
 v_lshlrev_b32 v21, 4, v28
 v_lshlrev_b32 v27, 4, v27
 s_lshl_b32 s3, s18, 7
 s_add_u32 s33, s33, s3
 s_lshl_b32 s33, s33, 12
 s_add_u32 s33, s33, 8388608
 s_add_u32 s34, s33, 262144
 s_lshr_b32 s3, s16, 1
 s_lshl1_add_u32 s35, s18, s3
 s_lshl_b32 s31, s35, 18
 s_and_b32 s3, s16, 1
 s_lshl_b32 s3, s3, 12
 s_add_u32 s31, s31, s3
 s_add_u32 s31, s31, 8388608
 s_lshl_b32 s30, s17, 14
 s_add_u32 s8, s54, s31
 s_addc_u32 s9, s55, 0
 s_mov_b32 s10, 0x40000
 s_mov_b32 s11, 0x20000
 s_lshl_b32 s3, s16, 16
 s_lshl_b32 s28, s61, 7
 s_add_u32 s3, s3, s28
 v_lshrrev_b32 v22, 3, v0
 v_and_b32 v23, 2, v22
 v_lshlrev_b32 v23, 1, v23
 v_and_b32 v24, 7, v0
 v_xor_b32 v23, v23, v24
 v_mul_u32_u24 v22, 2048, v22
 v_add_u32 v22, s3, v22
 v_xor_b32 v24, 2, v23
 v_lshl_add_u32 v23, v23, 4, v22
 v_lshl_add_u32 v24, v24, 4, v22
 v_add_u32 v192, 0, v23
 v_add_u32 v193, 15360, v24
 v_add_u32 v194, 30720, v23
 v_add_u32 v195, 46080, v24
 v_bfe_u32 v200, v0, 4, 1
 v_mul_u32_u24 v200, 32768, v200
 v_lshrrev_b32 v22, 5, v0
 v_lshl_add_u32 v200, v22, 8, v200
 v_and_b32 v22, 15, v0
 v_lshl_add_u32 v200, v22, 4, v200
 v_min_u32 v201, 27, v0
 s_mul_i32 s3, s66, 7168
 s_add_u32 s3, s3, 0
 v_lshl_add_u32 v201, v201, 7, s3
 s_lshr_b32 s28, s16, 1
 s_lshl_b32 s3, s28, 13
 v_add_u32 v202, s3, v1
 s_lshl_b32 s28, s28, 11
 s_and_b32 s3, s16, 1
 s_lshl_b32 s3, s3, 13
 s_add_u32 s3, s3, s28
 s_add_u32 s3, s3, 131072
 v_add_u32 v203, s3, v1
 v_lshl_add_u32 v22, v28, 4, s19
 v_add_u32 v22, 131072, v22
 v_mov_b32 v23, 0x3f803f80
 v_and_b32 v24, 7, v0
 v_cmp_eq_u32 vcc, 0, v24
 s_nop 1
 v_cndmask_b32 v204, 0, v23, vcc
 v_cmp_eq_u32 vcc, 4, v24
 s_nop 1
 v_cndmask_b32 v205, 0, v23, vcc
 v_and_b32 v206, 0x23, v0
 v_bfe_u32 v24, v0, 2, 1
 v_lshl_or_b32 v206, v24, 4, v206
 v_bfe_u32 v24, v0, 3, 2
 v_lshl_or_b32 v206, v24, 2, v206
 v_lshlrev_b32 v206, 4, v206
 s_lshl_b32 s24, s16, 10
 s_add_u32 s24, s24, 151552
 v_bfe_u32 v196, v0, 2, 2
 v_lshlrev_b32 v196, 7, v196
 v_lshrrev_b32 v23, 4, v0
 v_lshl_add_u32 v196, v23, 5, v196
 v_and_b32 v24, 3, v0
 v_lshl_add_u32 v196, v24, 3, v196
 v_add_u32 v196, s24, v196
 v_and_b32 v24, 15, v0
 v_lshlrev_b32 v25, 11, v24
 v_lshlrev_b32 v26, 2, v24
 v_lshlrev_b32 v24, 4, v24
 v_lshl_add_u32 v197, v23, 10, v24
 v_lshrrev_b32 v23, 3, v0
 v_and_b32 v24, 7, v0
 v_lshlrev_b32 v24, 4, v24
 v_lshl_add_u32 v198, v23, 11, v24
 s_lshr_b32 s3, s66, 4
 s_and_b32 s28, s66, 15
 s_lshl_b32 s20, s3, 14
 s_lshl_b32 s27, s28, 7
 s_add_u32 s20, s20, s27
 s_lshr_b32 s27, s3, 2
 s_lshl4_add_u32 s27, s27, s28
 s_lshl_b32 s27, s27, 12
 s_and_b32 s3, s3, 3
 s_lshl_b32 s3, s3, 8
 s_add_u32 s27, s27, s3
 s_add_u32 s27, s27, 50331648
 v_and_b32 v199, 31, v0
 v_lshlrev_b32 v199, 11, v199
 v_lshrrev_b32 v23, 5, v0
 v_lshl_add_u32 v199, v23, 4, v199
 s_lshl2_add_u32 s3, s60, s16
 s_lshl_b32 s28, s3, 7
 s_add_u32 s28, s28, 39845888
 v_add_u32 v212, s28, v26
 v_mov_b32 v213, v25
 v_mov_b32 v214, 0
 s_lshl_b32 s3, s3, 16
 s_lshl_b32 s28, s61, 7
 s_add_u32 s3, s3, s28
 v_add_u32 v199, s3, v199
 s_and_b32 s3, s16, 1
 s_lshl_b32 s3, s3, 13
 s_lshr_b32 s28, s16, 1
 s_lshl4_add_u32 s3, s28, s3
 s_add_u32 s3, s3, 39854080
 v_lshl_add_u32 v215, v0, 7, s3
 s_xor_b32 s25, s61, 1
 s_lshl4_add_u32 s25, s60, s25
 s_lshl2_add_u32 s25, s25, s16
 s_lshl_b32 s25, s25, 13
 s_add_u32 s25, s25, 41943040
 v_mov_b32 v208, -1
 v_mov_b32 v209, -1
 v_mov_b32 v210, -1
 v_mov_b32 v211, -1
 s_bfe_u32 s0, s2, 0x30003
 s_lshl_b32 s0, s0, 8
 s_lshl_b32 s32, s18, 11
 s_add_u32 s32, s32, s0
 s_add_u32 s32, s32, 40140800
 s_waitcnt vmcnt(11)
 s_cmp_lg_u32 s16, 0
 s_cbranch_scc1 L_other_10
 s_mov_b32 s67, 400000
 s_mov_b64 exec, 1
L_spin_9:
 buffer_load_dword v20, v86, s[4:7], s29 offen sc1
 s_waitcnt vmcnt(0)
 v_cmp_gt_u32 vcc, 16, v20
 s_sub_u32 s67, s67, 1
 s_cmp_lg_u32 s67, 0
 s_cbranch_vccz L_join_11
 s_sleep 2
 s_cbranch_scc1 L_spin_9
 s_branch L_join_11
L_other_10:
 s_mov_b64 exec, 0
 s_cmp_eq_u32 s16, 1
 s_cbranch_scc1 L_hop_6
 s_cmp_eq_u32 s16, 2
 s_cbranch_scc1 L_hop_0
 s_branch L_hop_1
L_ret_1:
 s_mov_b64 exec, -1
L_join_11:
 s_mov_b64 exec, -1
 s_barrier
 buffer_load_dwordx4 a[0:3], v2, s[4:7], s23 offen sc1
 buffer_load_dwordx4 a[4:7], v3, s[4:7], s23 offen sc1
 buffer_load_dwordx4 a[8:11], v2, s[4:7], s23 offen offset:2048 sc1
 buffer_load_dwordx4 a[12:15], v3, s[4:7], s23 offen offset:2048 sc1
 s_add_u32 s23, s23, 4096
 buffer_load_dwordx4 a[16:19], v2, s[4:7], s23 offen sc1
 buffer_load_dwordx4 a[20:23], v3, s[4:7], s23 offen sc1
 buffer_load_dwordx4 a[24:27], v2, s[4:7], s23 offen offset:2048 sc1
 buffer_load_dwordx4 a[28:31], v3, s[4:7], s23 offen offset:2048 sc1
 s_add_u32 s23, s23, 4096
 ds_read_b64_tr_b16 a[216:217], v4
 ds_read_b64_tr_b16 a[218:219], v4 offset:512
 ds_read_b64_tr_b16 a[220:221], v5
 ds_read_b64_tr_b16 a[222:223], v5 offset:512
 ds_read_b64_tr_b16 a[224:225], v6
 ds_read_b64_tr_b16 a[226:227], v6 offset:512
 ds_read_b64_tr_b16 a[228:229], v7
 ds_read_b64_tr_b16 a[230:231], v7 offset:512
 ds_read_b64_tr_b16 a[232:233], v4 offset:2048
 ds_read_b64_tr_b16 a[234:235], v4 offset:2560
 ds_read_b64_tr_b16 a[236:237], v5 offset:2048
 ds_read_b64_tr_b16 a[238:239], v5 offset:2560
 s_waitcnt vmcnt(7) lgkmcnt(10)
 v_mfma_f32_16x16x32_bf16 v[96:99], a[216:219], a[0:3], 0
 ds_read_b64_tr_b16 a[240:241], v6 offset:2048
 buffer_load_dwordx4 a[32:35], v2, s[4:7], s23 offen sc1
 s_waitcnt vmcnt(7)
 v_mfma_f32_16x16x32_bf16 v[128:131], a[216:219], a[4:7], 0
 ds_read_b64_tr_b16 a[242:243], v6 offset:2560
 s_mov_b32 s21, 0
 s_waitcnt lgkmcnt(10)
 v_mfma_f32_16x16x32_bf16 v[132:135], a[220:223], a[4:7], 0
 ds_read_b64_tr_b16 a[244:245], v7 offset:2048
 v_mfma_f32_16x16x32_bf16 v[100:103], a[220:223], a[0:3], 0
 ds_read_b64_tr_b16 a[246:247], v7 offset:2560
 s_waitcnt lgkmcnt(8)
 v_mfma_f32_16x16x32_bf16 v[104:107], a[224:227], a[0:3], 0
 ds_read_b64_tr_b16 a[248:249], v4 offset:8192
 buffer_load_dwordx4 a[36:39], v3, s[4:7], s23 offen sc1
 v_mfma_f32_16x16x32_bf16 v[136:139], a[224:227], a[4:7], 0
 ds_read_b64_tr_b16 a[250:251], v4 offset:8704
 s_add_u32 m0, s19, 65536
 v_mfma_f32_16x16x32_bf16 v[140:143], a[228:231], a[4:7], 0
 ds_read_b64_tr_b16 a[252:253], v5 offset:8192
 v_mfma_f32_16x16x32_bf16 v[108:111], a[228:231], a[0:3], 0
 ds_read_b64_tr_b16 a[254:255], v5 offset:8704
 s_waitcnt lgkmcnt(8)
 v_mfma_f32_16x16x32_bf16 v[112:115], a[0:3], a[232:235], 0
 ds_read_b64_tr_b16 a[216:217], v6 offset:8192
 buffer_load_dwordx4 a[40:43], v2, s[4:7], s23 offen offset:2048 sc1
 v_mfma_f32_16x16x32_bf16 v[144:147], a[4:7], a[232:235], 0
 ds_read_b64_tr_b16 a[218:219], v6 offset:8704
 v_mfma_f32_16x16x32_bf16 v[148:151], a[4:7], a[236:239], 0
 ds_read_b64_tr_b16 a[220:221], v7 offset:8192
 v_mfma_f32_16x16x32_bf16 v[116:119], a[0:3], a[236:239], 0
 ds_read_b64_tr_b16 a[222:223], v7 offset:8704
 s_waitcnt lgkmcnt(8)
 v_mfma_f32_16x16x32_bf16 v[120:123], a[0:3], a[240:243], 0
 ds_read_b64_tr_b16 a[224:225], v4 offset:10240
 buffer_load_dwordx4 v80, s[12:15], s21 offen lds
 v_mfma_f32_16x16x32_bf16 v[152:155], a[4:7], a[240:243], 0
 ds_read_b64_tr_b16 a[226:227], v4 offset:10752
 v_mfma_f32_16x16x32_bf16 v[156:159], a[4:7], a[244:247], 0
 ds_read_b64_tr_b16 a[228:229], v5 offset:10240
 v_mfma_f32_16x16x32_bf16 v[124:127], a[0:3], a[244:247], 0
 ds_read_b64_tr_b16 a[230:231], v5 offset:10752
 s_waitcnt vmcnt(8) lgkmcnt(8)
 v_mfma_f32_16x16x32_bf16 v[96:99], a[248:251], a[8:11], v[96:99]
 ds_read_b64_tr_b16 a[232:233], v6 offset:10240
 buffer_load_dwordx4 a[44:47], v3, s[4:7], s23 offen offset:2048 sc1
 v_mfma_f32_16x16x32_bf16 v[128:131], a[248:251], a[12:15], v[128:131]
 ds_read_b64_tr_b16 a[234:235], v6 offset:10752
 v_mfma_f32_16x16x32_bf16 v[132:135], a[252:255], a[12:15], v[132:135]
 ds_read_b64_tr_b16 a[236:237], v7 offset:10240
 v_mfma_f32_16x16x32_bf16 v[100:103], a[252:255], a[8:11], v[100:103]
 ds_read_b64_tr_b16 a[238:239], v7 offset:10752
 s_waitcnt lgkmcnt(8)
 v_mfma_f32_16x16x32_bf16 v[104:107], a[216:219], a[8:11], v[104:107]
 s_barrier
 ds_read_b64_tr_b16 a[240:241], v4 offset:16384
 v_mfma_f32_16x16x32_bf16 v[136:139], a[216:219], a[12:15], v[136:139]
 ds_read_b64_tr_b16 a[242:243], v4 offset:16896
 buffer_load_dwordx4 v81, s[12:15], s21 offen offset:1024 lds
 v_mfma_f32_16x16x32_bf16 v[140:143], a[220:223], a[12:15], v[140:143]
L_hop_0:
 s_cbranch_execz L_hop_7
 ds_read_b64_tr_b16 a[244:245], v4 offset:24576
 s_add_u32 s23, s23, 4096
 v_mfma_f32_16x16x32_bf16 v[108:111], a[220:223], a[8:11], v[108:111]
 ds_read_b64_tr_b16 a[246:247], v4 offset:25088
 s_waitcnt lgkmcnt(8)
 v_mfma_f32_16x16x32_bf16 v[112:115], a[8:11], a[224:227], v[112:115]
 ds_read_b64_tr_b16 a[248:249], v5 offset:16384
 buffer_load_dwordx4 v82, s[12:15], s21 offen offset:2048 lds
 v_mfma_f32_16x16x32_bf16 v[144:147], a[12:15], a[224:227], v[144:147]
 ds_read_b64_tr_b16 a[250:251], v5 offset:16896
 v_mfma_f32_16x16x32_bf16 v[148:151], a[12:15], a[228:231], v[148:151]
 ds_read_b64_tr_b16 a[252:253], v5 offset:24576
 v_mfma_f32_16x16x32_bf16 v[116:119], a[8:11], a[228:231], v[116:119]
 ds_read_b64_tr_b16 a[254:255], v5 offset:25088
 s_waitcnt lgkmcnt(8)
 v_mfma_f32_16x16x32_bf16 v[120:123], a[8:11], a[232:235], v[120:123]
 ds_read_b64_tr_b16 a[216:217], v6 offset:16384
 buffer_load_dwordx4 v83, s[12:15], s21 offen offset:3072 lds
 v_mfma_f32_16x16x32_bf16 v[152:155], a[12:15], a[232:235], v[152:155]
 ds_read_b64_tr_b16 a[218:219], v6 offset:16896
 s_mov_b32 s21, 1572864
 v_mfma_f32_16x16x32_bf16 v[156:159], a[12:15], a[236:239], v[156:159]
 ds_read_b64_tr_b16 a[220:221], v6 offset:24576
 s_add_u32 m0, s19, 81920
 v_mfma_f32_16x16x32_bf16 v[124:127], a[8:11], a[236:239], v[124:127]
 ds_read_b64_tr_b16 a[222:223], v6 offset:25088
 s_waitcnt vmcnt(8) lgkmcnt(8)
 v_mfma_f32_16x16x32_bf16 v[128:131], a[240:243], a[20:23], v[128:131]
 ds_read_b64_tr_b16 a[224:225], v7 offset:16384
 buffer_load_dwordx4 a[48:51], v2, s[4:7], s23 offen sc1
 v_mfma_f32_16x16x32_bf16 v[128:131], a[244:247], a[28:31], v[128:131]
 ds_read_b64_tr_b16 a[226:227], v7 offset:16896
 v_mfma_f32_16x16x32_bf16 v[96:99], a[244:247], a[24:27], v[96:99]
 ds_read_b64_tr_b16 a[228:229], v7 offset:24576
 v_mfma_f32_16x16x32_bf16 v[96:99], a[240:243], a[16:19], v[96:99]
 ds_read_b64_tr_b16 a[230:231], v7 offset:25088
 s_waitcnt lgkmcnt(8)
 v_mfma_f32_16x16x32_bf16 v[100:103], a[248:251], a[16:19], v[100:103]
 ds_read_b64_tr_b16 a[232:233], v4 offset:18432
 buffer_load_dwordx4 v76, s[12:15], s21 offen lds
 v_mfma_f32_16x16x32_bf16 v[100:103], a[252:255], a[24:27], v[100:103]
 ds_read_b64_tr_b16 a[234:235], v4 offset:18944
 v_mfma_f32_16x16x32_bf16 v[132:135], a[252:255], a[28:31], v[132:135]
 ds_read_b64_tr_b16 a[236:237], v4 offset:26624
 v_mfma_f32_16x16x32_bf16 v[132:135], a[248:251], a[20:23], v[132:135]
 ds_read_b64_tr_b16 a[238:239], v4 offset:27136
 s_waitcnt lgkmcnt(8)
 v_mfma_f32_16x16x32_bf16 v[136:139], a[216:219], a[20:23], v[136:139]
 ds_read_b64_tr_b16 a[240:241], v5 offset:18432
 buffer_load_dwordx4 a[52:55], v3, s[4:7], s23 offen sc1
 v_mfma_f32_16x16x32_bf16 v[136:139], a[220:223], a[28:31], v[136:139]
 ds_read_b64_tr_b16 a[242:243], v5 offset:18944
 v_mfma_f32_16x16x32_bf16 v[104:107], a[220:223], a[24:27], v[104:107]
 ds_read_b64_tr_b16 a[244:245], v5 offset:26624
 v_mfma_f32_16x16x32_bf16 v[104:107], a[216:219], a[16:19], v[104:107]
 ds_read_b64_tr_b16 a[246:247], v5 offset:27136
 s_waitcnt lgkmcnt(8)
 v_mfma_f32_16x16x32_bf16 v[108:111], a[224:227], a[16:19], v[108:111]
 ds_read_b64_tr_b16 a[248:249], v6 offset:18432
 buffer_load_dwordx4 v77, s[12:15], s21 offen offset:1024 lds
 v_mfma_f32_16x16x32_bf16 v[108:111], a[228:231], a[24:27], v[108:111]
 ds_read_b64_tr_b16 a[250:251], v6 offset:18944
 v_mfma_f32_16x16x32_bf16 v[140:143], a[228:231], a[28:31], v[140:143]
 ds_read_b64_tr_b16 a[252:253], v6 offset:26624
 v_mfma_f32_16x16x32_bf16 v[140:143], a[224:227], a[20:23], v[140:143]
 ds_read_b64_tr_b16 a[254:255], v6 offset:27136
 s_waitcnt lgkmcnt(8)
 v_mfma_f32_16x16x32_bf16 v[144:147], a[20:23], a[232:235], v[144:147]
 ds_read_b64_tr_b16 a[216:217], v7 offset:18432
 buffer_load_dwordx4 a[56:59], v2, s[4:7], s23 offen offset:2048 sc1
 v_mfma_f32_16x16x32_bf16 v[144:147], a[28:31], a[236:239], v[144:147]
 ds_read_b64_tr_b16 a[218:219], v7 offset:18944
 v_mfma_f32_16x16x32_bf16 v[112:115], a[24:27], a[236:239], v[112:115]
 ds_read_b64_tr_b16 a[220:221], v7 offset:26624
 v_mfma_f32_16x16x32_bf16 v[112:115], a[16:19], a[232:235], v[112:115]
 ds_read_b64_tr_b16 a[222:223], v7 offset:27136
 s_waitcnt lgkmcnt(8)
 v_mfma_f32_16x16x32_bf16 v[116:119], a[16:19], a[240:243], v[116:119]
 s_barrier
 ds_read_b64_tr_b16 a[224:225], v4 offset:32768
 v_mfma_f32_16x16x32_bf16 v[116:119], a[24:27], a[244:247], v[116:119]
 ds_read_b64_tr_b16 a[226:227], v4 offset:33280
 buffer_load_dwordx4 v78, s[12:15], s21 offen offset:2048 lds
 v_mfma_f32_16x16x32_bf16 v[148:151], a[28:31], a[244:247], v[148:151]
 ds_read_b64_tr_b16 a[228:229], v4 offset:40960
 v_mfma_f32_16x16x32_bf16 v[148:151], a[20:23], a[240:243], v[148:151]
 ds_read_b64_tr_b16 a[230:231], v4 offset:41472
 s_waitcnt lgkmcnt(8)
 v_mfma_f32_16x16x32_bf16 v[152:155], a[20:23], a[248:251], v[152:155]
 ds_read_b64_tr_b16 a[232:233], v5 offset:32768
 buffer_load_dwordx4 a[60:63], v3, s[4:7], s23 offen offset:2048 sc1
 v_mfma_f32_16x16x32_bf16 v[152:155], a[28:31], a[252:255], v[152:155]
 ds_read_b64_tr_b16 a[234:235], v5 offset:33280
 v_mfma_f32_16x16x32_bf16 v[120:123], a[24:27], a[252:255], v[120:123]
 ds_read_b64_tr_b16 a[236:237], v5 offset:40960
 v_mfma_f32_16x16x32_bf16 v[120:123], a[16:19], a[248:251], v[120:123]
 ds_read_b64_tr_b16 a[238:239], v5 offset:41472
 s_waitcnt lgkmcnt(8)
 v_mfma_f32_16x16x32_bf16 v[124:127], a[16:19], a[216:219], v[124:127]
 ds_read_b64_tr_b16 a[240:241], v6 offset:32768
 buffer_load_dwordx4 v79, s[12:15], s21 offen offset:3072 lds
 v_mfma_f32_16x16x32_bf16 v[124:127], a[24:27], a[220:223], v[124:127]
 ds_read_b64_tr_b16 a[242:243], v6 offset:33280
 s_add_u32 s23, s23, 4096
 v_mfma_f32_16x16x32_bf16 v[156:159], a[28:31], a[220:223], v[156:159]
 ds_read_b64_tr_b16 a[244:245], v6 offset:40960
 s_mov_b32 s21, 1966080
 v_mfma_f32_16x16x32_bf16 v[156:159], a[20:23], a[216:219], v[156:159]
 ds_read_b64_tr_b16 a[246:247], v6 offset:41472
 s_waitcnt vmcnt(11) lgkmcnt(8)
 v_mfma_f32_16x16x32_bf16 v[128:131], a[224:227], a[36:39], v[128:131]
 ds_read_b64_tr_b16 a[248:249], v7 offset:32768
 s_add_u32 m0, s19, 98304
 v_mfma_f32_16x16x32_bf16 v[128:131], a[228:231], a[44:47], v[128:131]
 ds_read_b64_tr_b16 a[250:251], v7 offset:33280
 buffer_load_dwordx4 a[64:67], v2, s[4:7], s23 offen sc1
 v_mfma_f32_16x16x32_bf16 v[96:99], a[228:231], a[40:43], v[96:99]
 ds_read_b64_tr_b16 a[252:253], v7 offset:40960
 v_mfma_f32_16x16x32_bf16 v[96:99], a[224:227], a[32:35], v[96:99]
 ds_read_b64_tr_b16 a[254:255], v7 offset:41472
 s_waitcnt lgkmcnt(8)
 v_mfma_f32_16x16x32_bf16 v[100:103], a[232:235], a[32:35], v[100:103]
 ds_read_b64_tr_b16 a[216:217], v4 offset:34816
 buffer_load_dwordx4 v76, s[12:15], s21 offen lds
 v_mfma_f32_16x16x32_bf16 v[100:103], a[236:239], a[40:43], v[100:103]
 ds_read_b64_tr_b16 a[218:219], v4 offset:35328
 v_mfma_f32_16x16x32_bf16 v[132:135], a[236:239], a[44:47], v[132:135]
 ds_read_b64_tr_b16 a[220:221], v4 offset:43008
 v_mfma_f32_16x16x32_bf16 v[132:135], a[232:235], a[36:39], v[132:135]
 ds_read_b64_tr_b16 a[222:223], v4 offset:43520
 s_waitcnt lgkmcnt(8)
 v_mfma_f32_16x16x32_bf16 v[136:139], a[240:243], a[36:39], v[136:139]
 ds_read_b64_tr_b16 a[224:225], v5 offset:34816
 buffer_load_dwordx4 a[68:71], v3, s[4:7], s23 offen sc1
 v_mfma_f32_16x16x32_bf16 v[136:139], a[244:247], a[44:47], v[136:139]
 ds_read_b64_tr_b16 a[226:227], v5 offset:35328
 v_mfma_f32_16x16x32_bf16 v[104:107], a[244:247], a[40:43], v[104:107]
 ds_read_b64_tr_b16 a[228:229], v5 offset:43008
 v_mfma_f32_16x16x32_bf16 v[104:107], a[240:243], a[32:35], v[104:107]
 ds_read_b64_tr_b16 a[230:231], v5 offset:43520
 s_waitcnt lgkmcnt(8)
 v_mfma_f32_16x16x32_bf16 v[108:111], a[248:251], a[32:35], v[108:111]
 ds_read_b64_tr_b16 a[232:233], v6 offset:34816
 buffer_load_dwordx4 v77, s[12:15], s21 offen offset:1024 lds
 v_mfma_f32_16x16x32_bf16 v[108:111], a[252:255], a[40:43], v[108:111]
 ds_read_b64_tr_b16 a[234:235], v6 offset:35328
 v_mfma_f32_16x16x32_bf16 v[140:143], a[252:255], a[44:47], v[140:143]
 ds_read_b64_tr_b16 a[236:237], v6 offset:43008
 v_mfma_f32_16x16x32_bf16 v[140:143], a[248:251], a[36:39], v[140:143]
 ds_read_b64_tr_b16 a[238:239], v6 offset:43520
 s_waitcnt lgkmcnt(8)
 v_mfma_f32_16x16x32_bf16 v[144:147], a[36:39], a[216:219], v[144:147]
 ds_read_b64_tr_b16 a[240:241], v7 offset:34816
 buffer_load_dwordx4 a[72:75], v2, s[4:7], s23 offen offset:2048 sc1
 v_mfma_f32_16x16x32_bf16 v[144:147], a[44:47], a[220:223], v[144:147]
 ds_read_b64_tr_b16 a[242:243], v7 offset:35328
 v_mfma_f32_16x16x32_bf16 v[112:115], a[40:43], a[220:223], v[112:115]
 ds_read_b64_tr_b16 a[244:245], v7 offset:43008
 v_mfma_f32_16x16x32_bf16 v[112:115], a[32:35], a[216:219], v[112:115]
 ds_read_b64_tr_b16 a[246:247], v7 offset:43520
 s_waitcnt lgkmcnt(8)
 v_mfma_f32_16x16x32_bf16 v[116:119], a[32:35], a[224:227], v[116:119]
 s_barrier
 ds_read_b64_tr_b16 a[248:249], v4 offset:49152
 v_mfma_f32_16x16x32_bf16 v[116:119], a[40:43], a[228:231], v[116:119]
 ds_read_b64_tr_b16 a[250:251], v4 offset:49664
 buffer_load_dwordx4 v78, s[12:15], s21 offen offset:2048 lds
 v_mfma_f32_16x16x32_bf16 v[148:151], a[44:47], a[228:231], v[148:151]
 ds_read_b64_tr_b16 a[252:253], v4 offset:57344
 v_mfma_f32_16x16x32_bf16 v[148:151], a[36:39], a[224:227], v[148:151]
 ds_read_b64_tr_b16 a[254:255], v4 offset:57856
 s_waitcnt lgkmcnt(8)
 v_mfma_f32_16x16x32_bf16 v[152:155], a[36:39], a[232:235], v[152:155]
 ds_read_b64_tr_b16 a[216:217], v5 offset:49152
 buffer_load_dwordx4 a[76:79], v3, s[4:7], s23 offen offset:2048 sc1
 v_mfma_f32_16x16x32_bf16 v[152:155], a[44:47], a[236:239], v[152:155]
 ds_read_b64_tr_b16 a[218:219], v5 offset:49664
 v_mfma_f32_16x16x32_bf16 v[120:123], a[40:43], a[236:239], v[120:123]
 ds_read_b64_tr_b16 a[220:221], v5 offset:57344
 v_mfma_f32_16x16x32_bf16 v[120:123], a[32:35], a[232:235], v[120:123]
 ds_read_b64_tr_b16 a[222:223], v5 offset:57856
 s_waitcnt lgkmcnt(8)
 v_mfma_f32_16x16x32_bf16 v[124:127], a[32:35], a[240:243], v[124:127]
 ds_read_b64_tr_b16 a[224:225], v6 offset:49152
 buffer_load_dwordx4 v79, s[12:15], s21 offen offset:3072 lds
 v_mfma_f32_16x16x32_bf16 v[124:127], a[40:43], a[244:247], v[124:127]
 ds_read_b64_tr_b16 a[226:227], v6 offset:49664
 s_add_u32 s23, s23, 4096
 v_mfma_f32_16x16x32_bf16 v[156:159], a[44:47], a[244:247], v[156:159]
 ds_read_b64_tr_b16 a[228:229], v6 offset:57344
 s_mov_b32 s21, 2359296
 v_mfma_f32_16x16x32_bf16 v[156:159], a[36:39], a[240:243], v[156:159]
 ds_read_b64_tr_b16 a[230:231], v6 offset:57856
 s_waitcnt vmcnt(9) lgkmcnt(8)
 v_mfma_f32_16x16x32_bf16 v[128:131], a[248:251], a[52:55], v[128:131]
 ds_read_b64_tr_b16 a[232:233], v7 offset:49152
 s_add_u32 m0, s19, 114688
 v_mfma_f32_16x16x32_bf16 v[128:131], a[252:255], a[60:63], v[128:131]
 ds_read_b64_tr_b16 a[234:235], v7 offset:49664
 buffer_load_dwordx4 a[80:83], v2, s[4:7], s23 offen sc1
 v_mfma_f32_16x16x32_bf16 v[96:99], a[252:255], a[56:59], v[96:99]
 ds_read_b64_tr_b16 a[236:237], v7 offset:57344
 v_mfma_f32_16x16x32_bf16 v[96:99], a[248:251], a[48:51], v[96:99]
 ds_read_b64_tr_b16 a[238:239], v7 offset:57856
 s_waitcnt lgkmcnt(8)
 v_mfma_f32_16x16x32_bf16 v[100:103], a[216:219], a[48:51], v[100:103]
 ds_read_b64_tr_b16 a[240:241], v4 offset:51200
 buffer_load_dwordx4 v76, s[12:15], s21 offen lds
 v_mfma_f32_16x16x32_bf16 v[100:103], a[220:223], a[56:59], v[100:103]
 ds_read_b64_tr_b16 a[242:243], v4 offset:51712
 v_mfma_f32_16x16x32_bf16 v[132:135], a[220:223], a[60:63], v[132:135]
 ds_read_b64_tr_b16 a[244:245], v4 offset:59392
 v_mfma_f32_16x16x32_bf16 v[132:135], a[216:219], a[52:55], v[132:135]
 ds_read_b64_tr_b16 a[246:247], v4 offset:59904
 s_waitcnt lgkmcnt(8)
 v_mfma_f32_16x16x32_bf16 v[136:139], a[224:227], a[52:55], v[136:139]
 ds_read_b64_tr_b16 a[248:249], v5 offset:51200
 buffer_load_dwordx4 a[84:87], v3, s[4:7], s23 offen sc1
 v_mfma_f32_16x16x32_bf16 v[136:139], a[228:231], a[60:63], v[136:139]
 ds_read_b64_tr_b16 a[250:251], v5 offset:51712
 v_mfma_f32_16x16x32_bf16 v[104:107], a[228:231], a[56:59], v[104:107]
 ds_read_b64_tr_b16 a[252:253], v5 offset:59392
 v_mfma_f32_16x16x32_bf16 v[104:107], a[224:227], a[48:51], v[104:107]
 ds_read_b64_tr_b16 a[254:255], v5 offset:59904
 s_waitcnt lgkmcnt(8)
 v_mfma_f32_16x16x32_bf16 v[108:111], a[232:235], a[48:51], v[108:111]
 ds_read_b64_tr_b16 a[216:217], v6 offset:51200
 buffer_load_dwordx4 v77, s[12:15], s21 offen offset:1024 lds
 v_mfma_f32_16x16x32_bf16 v[108:111], a[236:239], a[56:59], v[108:111]
 ds_read_b64_tr_b16 a[218:219], v6 offset:51712
 v_mfma_f32_16x16x32_bf16 v[140:143], a[236:239], a[60:63], v[140:143]
 ds_read_b64_tr_b16 a[220:221], v6 offset:59392
 v_mfma_f32_16x16x32_bf16 v[140:143], a[232:235], a[52:55], v[140:143]
 ds_read_b64_tr_b16 a[222:223], v6 offset:59904
 s_waitcnt lgkmcnt(8)
 v_mfma_f32_16x16x32_bf16 v[144:147], a[52:55], a[240:243], v[144:147]
 ds_read_b64_tr_b16 a[224:225], v7 offset:51200
 buffer_load_dwordx4 a[88:91], v2, s[4:7], s23 offen offset:2048 sc1
 v_mfma_f32_16x16x32_bf16 v[144:147], a[60:63], a[244:247], v[144:147]
 ds_read_b64_tr_b16 a[226:227], v7 offset:51712
 v_mfma_f32_16x16x32_bf16 v[112:115], a[56:59], a[244:247], v[112:115]
 ds_read_b64_tr_b16 a[228:229], v7 offset:59392
 v_mfma_f32_16x16x32_bf16 v[112:115], a[48:51], a[240:243], v[112:115]
 ds_read_b64_tr_b16 a[230:231], v7 offset:59904
 s_waitcnt lgkmcnt(8)
 v_mfma_f32_16x16x32_bf16 v[116:119], a[48:51], a[248:251], v[116:119]
 s_barrier
 ds_read_b64_tr_b16 a[232:233], v16
 v_mfma_f32_16x16x32_bf16 v[116:119], a[56:59], a[252:255], v[116:119]
 ds_read_b64_tr_b16 a[234:235], v16 offset:512
 buffer_load_dwordx4 v78, s[12:15], s21 offen offset:2048 lds
 v_mfma_f32_16x16x32_bf16 v[148:151], a[60:63], a[252:255], v[148:151]
 ds_read_b64_tr_b16 a[236:237], v16 offset:4096
 v_mfma_f32_16x16x32_bf16 v[148:151], a[52:55], a[248:251], v[148:151]
 ds_read_b64_tr_b16 a[238:239], v16 offset:4608
 s_waitcnt lgkmcnt(8)
 v_mfma_f32_16x16x32_bf16 v[152:155], a[52:55], a[216:219], v[152:155]
 ds_read_b64_tr_b16 a[240:241], v17
 buffer_load_dwordx4 v79, s[12:15], s21 offen offset:3072 lds
 v_mfma_f32_16x16x32_bf16 v[152:155], a[60:63], a[220:223], v[152:155]
 ds_read_b64_tr_b16 a[242:243], v17 offset:512
 s_mov_b32 s21, 2752512
 v_mfma_f32_16x16x32_bf16 v[120:123], a[56:59], a[220:223], v[120:123]
 ds_read_b64_tr_b16 a[244:245], v17 offset:4096
 s_mov_b32 m0, s19
 v_mfma_f32_16x16x32_bf16 v[120:123], a[48:51], a[216:219], v[120:123]
 ds_read_b64_tr_b16 a[246:247], v17 offset:4608
 s_waitcnt lgkmcnt(8)
 v_mfma_f32_16x16x32_bf16 v[124:127], a[48:51], a[224:227], v[124:127]
 ds_read_b64_tr_b16 a[248:249], v18
 buffer_load_dwordx4 v76, s[12:15], s21 offen lds
 v_mfma_f32_16x16x32_bf16 v[124:127], a[56:59], a[228:231], v[124:127]
 ds_read_b64_tr_b16 a[250:251], v18 offset:512
 v_mfma_f32_16x16x32_bf16 v[156:159], a[60:63], a[228:231], v[156:159]
 ds_read_b64_tr_b16 a[252:253], v18 offset:4096
 v_mfma_f32_16x16x32_bf16 v[156:159], a[52:55], a[224:227], v[156:159]
 ds_read_b64_tr_b16 a[254:255], v18 offset:4608
 s_waitcnt lgkmcnt(8)
 v_mfma_f32_16x16x32_bf16 v[176:179], a[232:235], a[4:7], 0
 ds_read_b64_tr_b16 a[216:217], v19
 buffer_load_dwordx4 a[92:95], v3, s[4:7], s23 offen offset:2048 sc1
 v_mfma_f32_16x16x32_bf16 v[176:179], a[236:239], a[12:15], v[176:179]
 ds_read_b64_tr_b16 a[218:219], v19 offset:512
 v_mfma_f32_16x16x32_bf16 v[160:163], a[236:239], a[8:11], 0
 ds_read_b64_tr_b16 a[220:221], v19 offset:4096
 v_mfma_f32_16x16x32_bf16 v[160:163], a[232:235], a[0:3], v[160:163]
 ds_read_b64_tr_b16 a[222:223], v19 offset:4608
 s_waitcnt lgkmcnt(8)
 v_mfma_f32_16x16x32_bf16 v[164:167], a[240:243], a[0:3], 0
 ds_read_b64_tr_b16 a[224:225], v16 offset:8192
 buffer_load_dwordx4 v77, s[12:15], s21 offen offset:1024 lds
 v_mfma_f32_16x16x32_bf16 v[164:167], a[244:247], a[8:11], v[164:167]
 ds_read_b64_tr_b16 a[226:227], v16 offset:8704
 s_add_u32 s23, s23, 4096
 v_mfma_f32_16x16x32_bf16 v[180:183], a[244:247], a[12:15], 0
 ds_read_b64_tr_b16 a[228:229], v16 offset:12288
 v_mfma_f32_16x16x32_bf16 v[180:183], a[240:243], a[4:7], v[180:183]
 ds_read_b64_tr_b16 a[230:231], v16 offset:12800
 s_waitcnt lgkmcnt(8)
 v_mfma_f32_16x16x32_bf16 v[184:187], a[248:251], a[4:7], 0
 ds_read_b64_tr_b16 a[232:233], v17 offset:8192
 buffer_load_dwordx4 v78, s[12:15], s21 offen offset:2048 lds
 v_mfma_f32_16x16x32_bf16 v[184:187], a[252:255], a[12:15], v[184:187]
 ds_read_b64_tr_b16 a[234:235], v17 offset:8704
 v_mfma_f32_16x16x32_bf16 v[168:171], a[252:255], a[8:11], 0
 ds_read_b64_tr_b16 a[236:237], v17 offset:12288
 v_mfma_f32_16x16x32_bf16 v[168:171], a[248:251], a[0:3], v[168:171]
 ds_read_b64_tr_b16 a[238:239], v17 offset:12800
 s_waitcnt lgkmcnt(8)
 v_mfma_f32_16x16x32_bf16 v[172:175], a[216:219], a[0:3], 0
 ds_read_b64_tr_b16 a[240:241], v18 offset:8192
 buffer_load_dwordx4 a[96:99], v2, s[4:7], s23 offen sc1
 v_mfma_f32_16x16x32_bf16 v[172:175], a[220:223], a[8:11], v[172:175]
 ds_read_b64_tr_b16 a[242:243], v18 offset:8704
 v_mfma_f32_16x16x32_bf16 v[188:191], a[220:223], a[12:15], 0
 ds_read_b64_tr_b16 a[244:245], v18 offset:12288
 v_mfma_f32_16x16x32_bf16 v[188:191], a[216:219], a[4:7], v[188:191]
 ds_read_b64_tr_b16 a[246:247], v18 offset:12800
 s_waitcnt lgkmcnt(8)
 v_mfma_f32_16x16x32_bf16 v[176:179], a[224:227], a[20:23], v[176:179]
 ds_read_b64_tr_b16 a[248:249], v19 offset:8192
 buffer_load_dwordx4 v79, s[12:15], s21 offen offset:3072 lds
 v_mfma_f32_16x16x32_bf16 v[176:179], a[228:231], a[28:31], v[176:179]
 ds_read_b64_tr_b16 a[250:251], v19 offset:8704
 v_mfma_f32_16x16x32_bf16 v[160:163], a[228:231], a[24:27], v[160:163]
 ds_read_b64_tr_b16 a[252:253], v19 offset:12288
 v_mfma_f32_16x16x32_bf16 v[160:163], a[224:227], a[16:19], v[160:163]
 ds_read_b64_tr_b16 a[254:255], v19 offset:12800
 s_waitcnt lgkmcnt(8)
 v_mfma_f32_16x16x32_bf16 v[164:167], a[232:235], a[16:19], v[164:167]
 s_waitcnt vmcnt(21)
 s_barrier
 ds_read_b64_tr_b16 a[216:217], v8 offset:16384
 v_mfma_f32_16x16x32_bf16 v[164:167], a[236:239], a[24:27], v[164:167]
 ds_read_b64_tr_b16 a[218:219], v8 offset:16896
 buffer_load_dwordx4 a[100:103], v3, s[4:7], s23 offen sc1
 v_mfma_f32_16x16x32_bf16 v[180:183], a[236:239], a[28:31], v[180:183]
 ds_read_b64_tr_b16 a[220:221], v8 offset:24576
 s_mov_b32 s21, 3145728
 v_mfma_f32_16x16x32_bf16 v[180:183], a[232:235], a[20:23], v[180:183]
 ds_read_b64_tr_b16 a[222:223], v8 offset:25088
 s_waitcnt lgkmcnt(8)
 v_mfma_f32_16x16x32_bf16 v[184:187], a[240:243], a[20:23], v[184:187]
 ds_read_b64_tr_b16 a[224:225], v9 offset:16384
 buffer_load_dwordx4 a[104:107], v2, s[4:7], s23 offen offset:2048 sc1
 v_mfma_f32_16x16x32_bf16 v[184:187], a[244:247], a[28:31], v[184:187]
 ds_read_b64_tr_b16 a[226:227], v9 offset:16896
 s_add_u32 m0, s19, 16384
 v_mfma_f32_16x16x32_bf16 v[168:171], a[244:247], a[24:27], v[168:171]
 ds_read_b64_tr_b16 a[228:229], v9 offset:24576
 v_mfma_f32_16x16x32_bf16 v[168:171], a[240:243], a[16:19], v[168:171]
 ds_read_b64_tr_b16 a[230:231], v9 offset:25088
 s_waitcnt lgkmcnt(8)
 v_mfma_f32_16x16x32_bf16 v[172:175], a[248:251], a[16:19], v[172:175]
 ds_read_b64_tr_b16 a[232:233], v10 offset:16384
 buffer_load_dwordx4 v76, s[12:15], s21 offen lds
 v_mfma_f32_16x16x32_bf16 v[172:175], a[252:255], a[24:27], v[172:175]
 ds_read_b64_tr_b16 a[234:235], v10 offset:16896
 v_mfma_f32_16x16x32_bf16 v[188:191], a[252:255], a[28:31], v[188:191]
 ds_read_b64_tr_b16 a[236:237], v10 offset:24576
 v_mfma_f32_16x16x32_bf16 v[188:191], a[248:251], a[20:23], v[188:191]
 ds_read_b64_tr_b16 a[238:239], v10 offset:25088
 s_waitcnt vmcnt(17) lgkmcnt(8)
 v_mfma_f32_16x16x32_bf16 v[128:131], a[216:219], a[68:71], v[128:131]
 ds_read_b64_tr_b16 a[240:241], v11 offset:16384
 buffer_load_dwordx4 a[108:111], v3, s[4:7], s23 offen offset:2048 sc1
 v_mfma_f32_16x16x32_bf16 v[128:131], a[220:223], a[76:79], v[128:131]
 ds_read_b64_tr_b16 a[242:243], v11 offset:16896
 v_mfma_f32_16x16x32_bf16 v[96:99], a[220:223], a[72:75], v[96:99]
 ds_read_b64_tr_b16 a[244:245], v11 offset:24576
 v_mfma_f32_16x16x32_bf16 v[96:99], a[216:219], a[64:67], v[96:99]
 ds_read_b64_tr_b16 a[246:247], v11 offset:25088
 s_waitcnt lgkmcnt(8)
 v_mfma_f32_16x16x32_bf16 v[100:103], a[224:227], a[64:67], v[100:103]
 ds_read_b64_tr_b16 a[248:249], v8 offset:18432
 buffer_load_dwordx4 v77, s[12:15], s21 offen offset:1024 lds
 v_mfma_f32_16x16x32_bf16 v[100:103], a[228:231], a[72:75], v[100:103]
 ds_read_b64_tr_b16 a[250:251], v8 offset:18944
 s_add_u32 s23, s23, 4096
 v_mfma_f32_16x16x32_bf16 v[132:135], a[228:231], a[76:79], v[132:135]
 ds_read_b64_tr_b16 a[252:253], v8 offset:26624
 v_mfma_f32_16x16x32_bf16 v[132:135], a[224:227], a[68:71], v[132:135]
 ds_read_b64_tr_b16 a[254:255], v8 offset:27136
 s_waitcnt lgkmcnt(8)
 v_mfma_f32_16x16x32_bf16 v[136:139], a[232:235], a[68:71], v[136:139]
 ds_read_b64_tr_b16 a[216:217], v9 offset:18432
 buffer_load_dwordx4 v78, s[12:15], s21 offen offset:2048 lds
 v_mfma_f32_16x16x32_bf16 v[136:139], a[236:239], a[76:79], v[136:139]
 ds_read_b64_tr_b16 a[218:219], v9 offset:18944
 v_mfma_f32_16x16x32_bf16 v[104:107], a[236:239], a[72:75], v[104:107]
 ds_read_b64_tr_b16 a[220:221], v9 offset:26624
 v_mfma_f32_16x16x32_bf16 v[104:107], a[232:235], a[64:67], v[104:107]
 ds_read_b64_tr_b16 a[222:223], v9 offset:27136
 s_waitcnt lgkmcnt(8)
 v_mfma_f32_16x16x32_bf16 v[108:111], a[240:243], a[64:67], v[108:111]
 ds_read_b64_tr_b16 a[224:225], v10 offset:18432
 buffer_load_dwordx4 a[112:115], v2, s[4:7], s23 offen sc1
 v_mfma_f32_16x16x32_bf16 v[108:111], a[244:247], a[72:75], v[108:111]
 ds_read_b64_tr_b16 a[226:227], v10 offset:18944
 v_mfma_f32_16x16x32_bf16 v[140:143], a[244:247], a[76:79], v[140:143]
 ds_read_b64_tr_b16 a[228:229], v10 offset:26624
 v_mfma_f32_16x16x32_bf16 v[140:143], a[240:243], a[68:71], v[140:143]
 ds_read_b64_tr_b16 a[230:231], v10 offset:27136
 s_waitcnt lgkmcnt(8)
 v_mfma_f32_16x16x32_bf16 v[144:147], a[68:71], a[248:251], v[144:147]
 ds_read_b64_tr_b16 a[232:233], v11 offset:18432
 buffer_load_dwordx4 v79, s[12:15], s21 offen offset:3072 lds
 v_mfma_f32_16x16x32_bf16 v[144:147], a[76:79], a[252:255], v[144:147]
 ds_read_b64_tr_b16 a[234:235], v11 offset:18944
 v_mfma_f32_16x16x32_bf16 v[112:115], a[72:75], a[252:255], v[112:115]
 ds_read_b64_tr_b16 a[236:237], v11 offset:26624
 v_mfma_f32_16x16x32_bf16 v[112:115], a[64:67], a[248:251], v[112:115]
 ds_read_b64_tr_b16 a[238:239], v11 offset:27136
 s_waitcnt lgkmcnt(8)
 v_mfma_f32_16x16x32_bf16 v[116:119], a[64:67], a[216:219], v[116:119]
 s_waitcnt vmcnt(21)
 s_barrier
 ds_read_b64_tr_b16 a[240:241], v8 offset:32768
 v_mfma_f32_16x16x32_bf16 v[116:119], a[72:75], a[220:223], v[116:119]
 ds_read_b64_tr_b16 a[242:243], v8 offset:33280
 buffer_load_dwordx4 a[116:119], v3, s[4:7], s23 offen sc1
 v_mfma_f32_16x16x32_bf16 v[148:151], a[76:79], a[220:223], v[148:151]
 ds_read_b64_tr_b16 a[244:245], v8 offset:40960
 s_mov_b32 s21, 3538944
 v_mfma_f32_16x16x32_bf16 v[148:151], a[68:71], a[216:219], v[148:151]
 ds_read_b64_tr_b16 a[246:247], v8 offset:41472
 s_waitcnt lgkmcnt(8)
 v_mfma_f32_16x16x32_bf16 v[152:155], a[68:71], a[224:227], v[152:155]
 ds_read_b64_tr_b16 a[248:249], v9 offset:32768
 buffer_load_dwordx4 a[120:123], v2, s[4:7], s23 offen offset:2048 sc1
 v_mfma_f32_16x16x32_bf16 v[152:155], a[76:79], a[228:231], v[152:155]
 ds_read_b64_tr_b16 a[250:251], v9 offset:33280
 s_add_u32 m0, s19, 32768
 v_mfma_f32_16x16x32_bf16 v[120:123], a[72:75], a[228:231], v[120:123]
 ds_read_b64_tr_b16 a[252:253], v9 offset:40960
 v_mfma_f32_16x16x32_bf16 v[120:123], a[64:67], a[224:227], v[120:123]
 ds_read_b64_tr_b16 a[254:255], v9 offset:41472
 s_waitcnt lgkmcnt(8)
 v_mfma_f32_16x16x32_bf16 v[124:127], a[64:67], a[232:235], v[124:127]
 ds_read_b64_tr_b16 a[216:217], v10 offset:32768
 buffer_load_dwordx4 v76, s[12:15], s21 offen lds
 v_mfma_f32_16x16x32_bf16 v[124:127], a[72:75], a[236:239], v[124:127]
 ds_read_b64_tr_b16 a[218:219], v10 offset:33280
 v_mfma_f32_16x16x32_bf16 v[156:159], a[76:79], a[236:239], v[156:159]
 ds_read_b64_tr_b16 a[220:221], v10 offset:40960
 v_mfma_f32_16x16x32_bf16 v[156:159], a[68:71], a[232:235], v[156:159]
 ds_read_b64_tr_b16 a[222:223], v10 offset:41472
 s_waitcnt vmcnt(15) lgkmcnt(8)
 v_mfma_f32_16x16x32_bf16 v[128:131], a[240:243], a[84:87], v[128:131]
 ds_read_b64_tr_b16 a[224:225], v11 offset:32768
 buffer_load_dwordx4 a[124:127], v3, s[4:7], s23 offen offset:2048 sc1
 v_mfma_f32_16x16x32_bf16 v[128:131], a[244:247], a[92:95], v[128:131]
 ds_read_b64_tr_b16 a[226:227], v11 offset:33280
 v_mfma_f32_16x16x32_bf16 v[96:99], a[244:247], a[88:91], v[96:99]
 ds_read_b64_tr_b16 a[228:229], v11 offset:40960
 v_mfma_f32_16x16x32_bf16 v[96:99], a[240:243], a[80:83], v[96:99]
 ds_read_b64_tr_b16 a[230:231], v11 offset:41472
 s_waitcnt lgkmcnt(8)
 v_mfma_f32_16x16x32_bf16 v[100:103], a[248:251], a[80:83], v[100:103]
 ds_read_b64_tr_b16 a[232:233], v8 offset:34816
 buffer_load_dwordx4 v77, s[12:15], s21 offen offset:1024 lds
 v_mfma_f32_16x16x32_bf16 v[100:103], a[252:255], a[88:91], v[100:103]
 ds_read_b64_tr_b16 a[234:235], v8 offset:35328
 s_add_u32 s23, s23, 4096
 v_mfma_f32_16x16x32_bf16 v[132:135], a[252:255], a[92:95], v[132:135]
 ds_read_b64_tr_b16 a[236:237], v8 offset:43008
 v_mfma_f32_16x16x32_bf16 v[132:135], a[248:251], a[84:87], v[132:135]
 ds_read_b64_tr_b16 a[238:239], v8 offset:43520
 s_waitcnt lgkmcnt(8)
 v_mfma_f32_16x16x32_bf16 v[136:139], a[216:219], a[84:87], v[136:139]
 ds_read_b64_tr_b16 a[240:241], v9 offset:34816
 buffer_load_dwordx4 v78, s[12:15], s21 offen offset:2048 lds
 v_mfma_f32_16x16x32_bf16 v[136:139], a[220:223], a[92:95], v[136:139]
 ds_read_b64_tr_b16 a[242:243], v9 offset:35328
 v_mfma_f32_16x16x32_bf16 v[104:107], a[220:223], a[88:91], v[104:107]
 ds_read_b64_tr_b16 a[244:245], v9 offset:43008
 v_mfma_f32_16x16x32_bf16 v[104:107], a[216:219], a[80:83], v[104:107]
 ds_read_b64_tr_b16 a[246:247], v9 offset:43520
 s_waitcnt lgkmcnt(8)
 v_mfma_f32_16x16x32_bf16 v[108:111], a[224:227], a[80:83], v[108:111]
 ds_read_b64_tr_b16 a[248:249], v10 offset:34816
 buffer_load_dwordx4 a[128:131], v2, s[4:7], s23 offen sc1
 v_mfma_f32_16x16x32_bf16 v[108:111], a[228:231], a[88:91], v[108:111]
 ds_read_b64_tr_b16 a[250:251], v10 offset:35328
 v_mfma_f32_16x16x32_bf16 v[140:143], a[228:231], a[92:95], v[140:143]
 ds_read_b64_tr_b16 a[252:253], v10 offset:43008
 v_mfma_f32_16x16x32_bf16 v[140:143], a[224:227], a[84:87], v[140:143]
 ds_read_b64_tr_b16 a[254:255], v10 offset:43520
 s_waitcnt lgkmcnt(8)
 v_mfma_f32_16x16x32_bf16 v[144:147], a[84:87], a[232:235], v[144:147]
 ds_read_b64_tr_b16 a[216:217], v11 offset:34816
 buffer_load_dwordx4 v79, s[12:15], s21 offen offset:3072 lds
 v_mfma_f32_16x16x32_bf16 v[144:147], a[92:95], a[236:239], v[144:147]
 ds_read_b64_tr_b16 a[218:219], v11 offset:35328
 v_mfma_f32_16x16x32_bf16 v[112:115], a[88:91], a[236:239], v[112:115]
 ds_read_b64_tr_b16 a[220:221], v11 offset:43008
 v_mfma_f32_16x16x32_bf16 v[112:115], a[80:83], a[232:235], v[112:115]
 ds_read_b64_tr_b16 a[222:223], v11 offset:43520
 s_waitcnt lgkmcnt(8)
 v_mfma_f32_16x16x32_bf16 v[116:119], a[80:83], a[240:243], v[116:119]
 s_barrier
 ds_read_b64_tr_b16 a[224:225], v8 offset:49152
 v_mfma_f32_16x16x32_bf16 v[116:119], a[88:91], a[244:247], v[116:119]
 ds_read_b64_tr_b16 a[226:227], v8 offset:49664
 buffer_load_dwordx4 a[132:135], v3, s[4:7], s23 offen sc1
 v_mfma_f32_16x16x32_bf16 v[148:151], a[92:95], a[244:247], v[148:151]
 ds_read_b64_tr_b16 a[228:229], v8 offset:57344
 s_mov_b32 s21, 3932160
 v_mfma_f32_16x16x32_bf16 v[148:151], a[84:87], a[240:243], v[148:151]
 ds_read_b64_tr_b16 a[230:231], v8 offset:57856
 s_waitcnt lgkmcnt(8)
 v_mfma_f32_16x16x32_bf16 v[152:155], a[84:87], a[248:251], v[152:155]
 ds_read_b64_tr_b16 a[232:233], v9 offset:49152
 buffer_load_dwordx4 a[136:139], v2, s[4:7], s23 offen offset:2048 sc1
 v_mfma_f32_16x16x32_bf16 v[152:155], a[92:95], a[252:255], v[152:155]
 ds_read_b64_tr_b16 a[234:235], v9 offset:49664
 s_add_u32 m0, s19, 49152
 v_mfma_f32_16x16x32_bf16 v[120:123], a[88:91], a[252:255], v[120:123]
 ds_read_b64_tr_b16 a[236:237], v9 offset:57344
 v_mfma_f32_16x16x32_bf16 v[120:123], a[80:83], a[248:251], v[120:123]
 ds_read_b64_tr_b16 a[238:239], v9 offset:57856
 s_waitcnt lgkmcnt(8)
 v_mfma_f32_16x16x32_bf16 v[124:127], a[80:83], a[216:219], v[124:127]
 ds_read_b64_tr_b16 a[240:241], v10 offset:49152
 buffer_load_dwordx4 v76, s[12:15], s21 offen lds
 v_mfma_f32_16x16x32_bf16 v[124:127], a[88:91], a[220:223], v[124:127]
 ds_read_b64_tr_b16 a[242:243], v10 offset:49664
 v_mfma_f32_16x16x32_bf16 v[156:159], a[92:95], a[220:223], v[156:159]
 ds_read_b64_tr_b16 a[244:245], v10 offset:57344
 v_mfma_f32_16x16x32_bf16 v[156:159], a[84:87], a[216:219], v[156:159]
 ds_read_b64_tr_b16 a[246:247], v10 offset:57856
 s_waitcnt vmcnt(15) lgkmcnt(8)
 v_mfma_f32_16x16x32_bf16 v[128:131], a[224:227], a[100:103], v[128:131]
 ds_read_b64_tr_b16 a[248:249], v11 offset:49152
 buffer_load_dwordx4 a[140:143], v3, s[4:7], s23 offen offset:2048 sc1
 v_mfma_f32_16x16x32_bf16 v[128:131], a[228:231], a[108:111], v[128:131]
 ds_read_b64_tr_b16 a[250:251], v11 offset:49664
 v_mfma_f32_16x16x32_bf16 v[96:99], a[228:231], a[104:107], v[96:99]
 ds_read_b64_tr_b16 a[252:253], v11 offset:57344
 v_mfma_f32_16x16x32_bf16 v[96:99], a[224:227], a[96:99], v[96:99]
L_hop_1:
 s_cbranch_execz L_hop_8
 ds_read_b64_tr_b16 a[254:255], v11 offset:57856
 s_waitcnt lgkmcnt(8)
 v_mfma_f32_16x16x32_bf16 v[100:103], a[232:235], a[96:99], v[100:103]
 ds_read_b64_tr_b16 a[216:217], v8 offset:51200
 buffer_load_dwordx4 v77, s[12:15], s21 offen offset:1024 lds
 v_mfma_f32_16x16x32_bf16 v[100:103], a[236:239], a[104:107], v[100:103]
 ds_read_b64_tr_b16 a[218:219], v8 offset:51712
 s_add_u32 s23, s23, 4096
 v_mfma_f32_16x16x32_bf16 v[132:135], a[236:239], a[108:111], v[132:135]
 ds_read_b64_tr_b16 a[220:221], v8 offset:59392
 v_mfma_f32_16x16x32_bf16 v[132:135], a[232:235], a[100:103], v[132:135]
 ds_read_b64_tr_b16 a[222:223], v8 offset:59904
 s_waitcnt lgkmcnt(8)
 v_mfma_f32_16x16x32_bf16 v[136:139], a[240:243], a[100:103], v[136:139]
 ds_read_b64_tr_b16 a[224:225], v9 offset:51200
 buffer_load_dwordx4 v78, s[12:15], s21 offen offset:2048 lds
 v_mfma_f32_16x16x32_bf16 v[136:139], a[244:247], a[108:111], v[136:139]
 ds_read_b64_tr_b16 a[226:227], v9 offset:51712
 v_mfma_f32_16x16x32_bf16 v[104:107], a[244:247], a[104:107], v[104:107]
 ds_read_b64_tr_b16 a[228:229], v9 offset:59392
 v_mfma_f32_16x16x32_bf16 v[104:107], a[240:243], a[96:99], v[104:107]
 ds_read_b64_tr_b16 a[230:231], v9 offset:59904
 s_waitcnt lgkmcnt(8)
 v_mfma_f32_16x16x32_bf16 v[108:111], a[248:251], a[96:99], v[108:111]
 ds_read_b64_tr_b16 a[232:233], v10 offset:51200
 buffer_load_dwordx4 a[144:147], v2, s[4:7], s23 offen sc1
 v_mfma_f32_16x16x32_bf16 v[108:111], a[252:255], a[104:107], v[108:111]
 ds_read_b64_tr_b16 a[234:235], v10 offset:51712
 v_mfma_f32_16x16x32_bf16 v[140:143], a[252:255], a[108:111], v[140:143]
 ds_read_b64_tr_b16 a[236:237], v10 offset:59392
 v_mfma_f32_16x16x32_bf16 v[140:143], a[248:251], a[100:103], v[140:143]
 ds_read_b64_tr_b16 a[238:239], v10 offset:59904
 s_waitcnt lgkmcnt(8)
 v_mfma_f32_16x16x32_bf16 v[144:147], a[100:103], a[216:219], v[144:147]
 ds_read_b64_tr_b16 a[240:241], v11 offset:51200
 buffer_load_dwordx4 v79, s[12:15], s21 offen offset:3072 lds
 v_mfma_f32_16x16x32_bf16 v[144:147], a[108:111], a[220:223], v[144:147]
 ds_read_b64_tr_b16 a[242:243], v11 offset:51712
 v_mfma_f32_16x16x32_bf16 v[112:115], a[104:107], a[220:223], v[112:115]
 ds_read_b64_tr_b16 a[244:245], v11 offset:59392
 v_mfma_f32_16x16x32_bf16 v[112:115], a[96:99], a[216:219], v[112:115]
 ds_read_b64_tr_b16 a[246:247], v11 offset:59904
 s_waitcnt lgkmcnt(8)
 v_mfma_f32_16x16x32_bf16 v[116:119], a[96:99], a[224:227], v[116:119]
 s_barrier
 ds_read_b64_tr_b16 a[248:249], v4
 v_mfma_f32_16x16x32_bf16 v[116:119], a[104:107], a[228:231], v[116:119]
 ds_read_b64_tr_b16 a[250:251], v4 offset:512
 buffer_load_dwordx4 a[148:151], v3, s[4:7], s23 offen sc1
 v_mfma_f32_16x16x32_bf16 v[148:151], a[108:111], a[228:231], v[148:151]
 ds_read_b64_tr_b16 a[252:253], v4 offset:8192
 s_mov_b32 s21, 4325376
 v_mfma_f32_16x16x32_bf16 v[148:151], a[100:103], a[224:227], v[148:151]
 ds_read_b64_tr_b16 a[254:255], v4 offset:8704
 s_waitcnt lgkmcnt(8)
 v_mfma_f32_16x16x32_bf16 v[152:155], a[100:103], a[232:235], v[152:155]
 ds_read_b64_tr_b16 a[216:217], v5
 s_add_u32 m0, s19, 65536
 v_mfma_f32_16x16x32_bf16 v[152:155], a[108:111], a[236:239], v[152:155]
 ds_read_b64_tr_b16 a[218:219], v5 offset:512
 buffer_load_dwordx4 v76, s[12:15], s21 offen lds
 v_mfma_f32_16x16x32_bf16 v[120:123], a[104:107], a[236:239], v[120:123]
 ds_read_b64_tr_b16 a[220:221], v5 offset:8192
 v_mfma_f32_16x16x32_bf16 v[120:123], a[96:99], a[232:235], v[120:123]
 ds_read_b64_tr_b16 a[222:223], v5 offset:8704
 s_waitcnt lgkmcnt(8)
 v_mfma_f32_16x16x32_bf16 v[124:127], a[96:99], a[240:243], v[124:127]
 ds_read_b64_tr_b16 a[224:225], v6
 buffer_load_dwordx4 v77, s[12:15], s21 offen offset:1024 lds
 v_mfma_f32_16x16x32_bf16 v[124:127], a[104:107], a[244:247], v[124:127]
 ds_read_b64_tr_b16 a[226:227], v6 offset:512
 v_mfma_f32_16x16x32_bf16 v[156:159], a[108:111], a[244:247], v[156:159]
 ds_read_b64_tr_b16 a[228:229], v6 offset:8192
 v_mfma_f32_16x16x32_bf16 v[156:159], a[100:103], a[240:243], v[156:159]
 ds_read_b64_tr_b16 a[230:231], v6 offset:8704
 s_waitcnt vmcnt(15) lgkmcnt(8)
 v_mfma_f32_16x16x32_bf16 v[128:131], a[248:251], a[116:119], v[128:131]
 ds_read_b64_tr_b16 a[232:233], v7
 buffer_load_dwordx4 a[152:155], v2, s[4:7], s23 offen offset:2048 sc1
 v_mfma_f32_16x16x32_bf16 v[128:131], a[252:255], a[124:127], v[128:131]
 ds_read_b64_tr_b16 a[234:235], v7 offset:512
 v_mfma_f32_16x16x32_bf16 v[96:99], a[252:255], a[120:123], v[96:99]
 ds_read_b64_tr_b16 a[236:237], v7 offset:8192
 v_mfma_f32_16x16x32_bf16 v[96:99], a[248:251], a[112:115], v[96:99]
 ds_read_b64_tr_b16 a[238:239], v7 offset:8704
 s_waitcnt lgkmcnt(8)
 v_mfma_f32_16x16x32_bf16 v[100:103], a[216:219], a[112:115], v[100:103]
 ds_read_b64_tr_b16 a[240:241], v4 offset:2048
 buffer_load_dwordx4 v78, s[12:15], s21 offen offset:2048 lds
 v_mfma_f32_16x16x32_bf16 v[100:103], a[220:223], a[120:123], v[100:103]
 ds_read_b64_tr_b16 a[242:243], v4 offset:2560
 v_mfma_f32_16x16x32_bf16 v[132:135], a[220:223], a[124:127], v[132:135]
 ds_read_b64_tr_b16 a[244:245], v4 offset:10240
 v_mfma_f32_16x16x32_bf16 v[132:135], a[216:219], a[116:119], v[132:135]
 ds_read_b64_tr_b16 a[246:247], v4 offset:10752
 s_waitcnt lgkmcnt(8)
 v_mfma_f32_16x16x32_bf16 v[136:139], a[224:227], a[116:119], v[136:139]
 ds_read_b64_tr_b16 a[248:249], v5 offset:2048
 buffer_load_dwordx4 a[156:159], v3, s[4:7], s23 offen offset:2048 sc1
 v_mfma_f32_16x16x32_bf16 v[136:139], a[228:231], a[124:127], v[136:139]
 ds_read_b64_tr_b16 a[250:251], v5 offset:2560
 v_mfma_f32_16x16x32_bf16 v[104:107], a[228:231], a[120:123], v[104:107]
 ds_read_b64_tr_b16 a[252:253], v5 offset:10240
 v_mfma_f32_16x16x32_bf16 v[104:107], a[224:227], a[112:115], v[104:107]
 ds_read_b64_tr_b16 a[254:255], v5 offset:10752
 s_waitcnt lgkmcnt(8)
 v_mfma_f32_16x16x32_bf16 v[108:111], a[232:235], a[112:115], v[108:111]
 ds_read_b64_tr_b16 a[216:217], v6 offset:2048
 buffer_load_dwordx4 v79, s[12:15], s21 offen offset:3072 lds
 v_mfma_f32_16x16x32_bf16 v[108:111], a[236:239], a[120:123], v[108:111]
 ds_read_b64_tr_b16 a[218:219], v6 offset:2560
 s_add_u32 s23, s23, 4096
 v_mfma_f32_16x16x32_bf16 v[140:143], a[236:239], a[124:127], v[140:143]
 ds_read_b64_tr_b16 a[220:221], v6 offset:10240
 s_mov_b32 s21, 4718592
 v_mfma_f32_16x16x32_bf16 v[140:143], a[232:235], a[116:119], v[140:143]
 ds_read_b64_tr_b16 a[222:223], v6 offset:10752
 s_waitcnt lgkmcnt(8)
 v_mfma_f32_16x16x32_bf16 v[144:147], a[116:119], a[240:243], v[144:147]
 ds_read_b64_tr_b16 a[224:225], v7 offset:2048
 buffer_load_dwordx4 a[160:163], v2, s[4:7], s23 offen sc1
 v_mfma_f32_16x16x32_bf16 v[144:147], a[124:127], a[244:247], v[144:147]
 ds_read_b64_tr_b16 a[226:227], v7 offset:2560
 s_add_u32 m0, s19, 81920
 v_mfma_f32_16x16x32_bf16 v[112:115], a[120:123], a[244:247], v[112:115]
 ds_read_b64_tr_b16 a[228:229], v7 offset:10240
 v_mfma_f32_16x16x32_bf16 v[112:115], a[112:115], a[240:243], v[112:115]
 ds_read_b64_tr_b16 a[230:231], v7 offset:10752
 s_waitcnt lgkmcnt(8)
 v_mfma_f32_16x16x32_bf16 v[116:119], a[112:115], a[248:251], v[116:119]
 s_barrier
 ds_read_b64_tr_b16 a[232:233], v4 offset:16384
 v_mfma_f32_16x16x32_bf16 v[116:119], a[120:123], a[252:255], v[116:119]
 ds_read_b64_tr_b16 a[234:235], v4 offset:16896
 buffer_load_dwordx4 a[164:167], v3, s[4:7], s23 offen sc1
 v_mfma_f32_16x16x32_bf16 v[148:151], a[124:127], a[252:255], v[148:151]
 ds_read_b64_tr_b16 a[236:237], v4 offset:24576
 v_mfma_f32_16x16x32_bf16 v[148:151], a[116:119], a[248:251], v[148:151]
 ds_read_b64_tr_b16 a[238:239], v4 offset:25088
 s_waitcnt lgkmcnt(8)
 v_mfma_f32_16x16x32_bf16 v[152:155], a[116:119], a[216:219], v[152:155]
 ds_read_b64_tr_b16 a[240:241], v5 offset:16384
 buffer_load_dwordx4 v76, s[12:15], s21 offen lds
 v_mfma_f32_16x16x32_bf16 v[152:155], a[124:127], a[220:223], v[152:155]
 ds_read_b64_tr_b16 a[242:243], v5 offset:16896
 v_mfma_f32_16x16x32_bf16 v[120:123], a[120:123], a[220:223], v[120:123]
 ds_read_b64_tr_b16 a[244:245], v5 offset:24576
 v_mfma_f32_16x16x32_bf16 v[120:123], a[112:115], a[216:219], v[120:123]
 ds_read_b64_tr_b16 a[246:247], v5 offset:25088
 s_waitcnt lgkmcnt(8)
 v_mfma_f32_16x16x32_bf16 v[124:127], a[112:115], a[224:227], v[124:127]
 ds_read_b64_tr_b16 a[248:249], v6 offset:16384
 buffer_load_dwordx4 v77, s[12:15], s21 offen offset:1024 lds
 v_mfma_f32_16x16x32_bf16 v[124:127], a[120:123], a[228:231], v[124:127]
 ds_read_b64_tr_b16 a[250:251], v6 offset:16896
 v_mfma_f32_16x16x32_bf16 v[156:159], a[124:127], a[228:231], v[156:159]
 ds_read_b64_tr_b16 a[252:253], v6 offset:24576
 v_mfma_f32_16x16x32_bf16 v[156:159], a[116:119], a[224:227], v[156:159]
 ds_read_b64_tr_b16 a[254:255], v6 offset:25088
 s_waitcnt vmcnt(15) lgkmcnt(8)
 v_mfma_f32_16x16x32_bf16 v[128:131], a[232:235], a[132:135], v[128:131]
 ds_read_b64_tr_b16 a[216:217], v7 offset:16384
 buffer_load_dwordx4 a[168:171], v2, s[4:7], s23 offen offset:2048 sc1
 v_mfma_f32_16x16x32_bf16 v[128:131], a[236:239], a[140:143], v[128:131]
 ds_read_b64_tr_b16 a[218:219], v7 offset:16896
 v_mfma_f32_16x16x32_bf16 v[96:99], a[236:239], a[136:139], v[96:99]
 ds_read_b64_tr_b16 a[220:221], v7 offset:24576
 v_mfma_f32_16x16x32_bf16 v[96:99], a[232:235], a[128:131], v[96:99]
 ds_read_b64_tr_b16 a[222:223], v7 offset:25088
 s_waitcnt lgkmcnt(8)
 v_mfma_f32_16x16x32_bf16 v[100:103], a[240:243], a[128:131], v[100:103]
 ds_read_b64_tr_b16 a[224:225], v4 offset:18432
 buffer_load_dwordx4 v78, s[12:15], s21 offen offset:2048 lds
 v_mfma_f32_16x16x32_bf16 v[100:103], a[244:247], a[136:139], v[100:103]
 ds_read_b64_tr_b16 a[226:227], v4 offset:18944
 v_mfma_f32_16x16x32_bf16 v[132:135], a[244:247], a[140:143], v[132:135]
 ds_read_b64_tr_b16 a[228:229], v4 offset:26624
 v_mfma_f32_16x16x32_bf16 v[132:135], a[240:243], a[132:135], v[132:135]
 ds_read_b64_tr_b16 a[230:231], v4 offset:27136
 s_waitcnt lgkmcnt(8)
 v_mfma_f32_16x16x32_bf16 v[136:139], a[248:251], a[132:135], v[136:139]
 ds_read_b64_tr_b16 a[232:233], v5 offset:18432
 buffer_load_dwordx4 a[172:175], v3, s[4:7], s23 offen offset:2048 sc1
 v_mfma_f32_16x16x32_bf16 v[136:139], a[252:255], a[140:143], v[136:139]
 ds_read_b64_tr_b16 a[234:235], v5 offset:18944
 v_mfma_f32_16x16x32_bf16 v[104:107], a[252:255], a[136:139], v[104:107]
 ds_read_b64_tr_b16 a[236:237], v5 offset:26624
 v_mfma_f32_16x16x32_bf16 v[104:107], a[248:251], a[128:131], v[104:107]
 ds_read_b64_tr_b16 a[238:239], v5 offset:27136
 s_waitcnt lgkmcnt(8)
 v_mfma_f32_16x16x32_bf16 v[108:111], a[216:219], a[128:131], v[108:111]
 ds_read_b64_tr_b16 a[240:241], v6 offset:18432
 buffer_load_dwordx4 v79, s[12:15], s21 offen offset:3072 lds
 v_mfma_f32_16x16x32_bf16 v[108:111], a[220:223], a[136:139], v[108:111]
 ds_read_b64_tr_b16 a[242:243], v6 offset:18944
 s_add_u32 s23, s23, 4096
 v_mfma_f32_16x16x32_bf16 v[140:143], a[220:223], a[140:143], v[140:143]
 ds_read_b64_tr_b16 a[244:245], v6 offset:26624
 s_mov_b32 s21, 5111808
 v_mfma_f32_16x16x32_bf16 v[140:143], a[216:219], a[132:135], v[140:143]
 ds_read_b64_tr_b16 a[246:247], v6 offset:27136
 s_waitcnt lgkmcnt(8)
 v_mfma_f32_16x16x32_bf16 v[144:147], a[132:135], a[224:227], v[144:147]
 ds_read_b64_tr_b16 a[248:249], v7 offset:18432
 buffer_load_dwordx4 a[176:179], v2, s[4:7], s23 offen sc1
 v_mfma_f32_16x16x32_bf16 v[144:147], a[140:143], a[228:231], v[144:147]
 ds_read_b64_tr_b16 a[250:251], v7 offset:18944
 s_add_u32 m0, s19, 98304
 v_mfma_f32_16x16x32_bf16 v[112:115], a[136:139], a[228:231], v[112:115]
 ds_read_b64_tr_b16 a[252:253], v7 offset:26624
 v_mfma_f32_16x16x32_bf16 v[112:115], a[128:131], a[224:227], v[112:115]
 ds_read_b64_tr_b16 a[254:255], v7 offset:27136
 s_waitcnt lgkmcnt(8)
 v_mfma_f32_16x16x32_bf16 v[116:119], a[128:131], a[232:235], v[116:119]
 s_barrier
 ds_read_b64_tr_b16 a[216:217], v4 offset:32768
 v_mfma_f32_16x16x32_bf16 v[116:119], a[136:139], a[236:239], v[116:119]
 ds_read_b64_tr_b16 a[218:219], v4 offset:33280
 buffer_load_dwordx4 a[180:183], v3, s[4:7], s23 offen sc1
 v_mfma_f32_16x16x32_bf16 v[148:151], a[140:143], a[236:239], v[148:151]
 ds_read_b64_tr_b16 a[220:221], v4 offset:40960
 v_mfma_f32_16x16x32_bf16 v[148:151], a[132:135], a[232:235], v[148:151]
 ds_read_b64_tr_b16 a[222:223], v4 offset:41472
 s_waitcnt lgkmcnt(8)
 v_mfma_f32_16x16x32_bf16 v[152:155], a[132:135], a[240:243], v[152:155]
 ds_read_b64_tr_b16 a[224:225], v5 offset:32768
 buffer_load_dwordx4 v76, s[12:15], s21 offen lds
 v_mfma_f32_16x16x32_bf16 v[152:155], a[140:143], a[244:247], v[152:155]
 ds_read_b64_tr_b16 a[226:227], v5 offset:33280
 v_mfma_f32_16x16x32_bf16 v[120:123], a[136:139], a[244:247], v[120:123]
 ds_read_b64_tr_b16 a[228:229], v5 offset:40960
 v_mfma_f32_16x16x32_bf16 v[120:123], a[128:131], a[240:243], v[120:123]
 ds_read_b64_tr_b16 a[230:231], v5 offset:41472
 s_waitcnt lgkmcnt(8)
 v_mfma_f32_16x16x32_bf16 v[124:127], a[128:131], a[248:251], v[124:127]
 ds_read_b64_tr_b16 a[232:233], v6 offset:32768
 buffer_load_dwordx4 v77, s[12:15], s21 offen offset:1024 lds
 v_mfma_f32_16x16x32_bf16 v[124:127], a[136:139], a[252:255], v[124:127]
 ds_read_b64_tr_b16 a[234:235], v6 offset:33280
 v_mfma_f32_16x16x32_bf16 v[156:159], a[140:143], a[252:255], v[156:159]
 ds_read_b64_tr_b16 a[236:237], v6 offset:40960
 v_mfma_f32_16x16x32_bf16 v[156:159], a[132:135], a[248:251], v[156:159]
 ds_read_b64_tr_b16 a[238:239], v6 offset:41472
 s_waitcnt vmcnt(13) lgkmcnt(8)
 v_mfma_f32_16x16x32_bf16 v[128:131], a[216:219], a[148:151], v[128:131]
 ds_read_b64_tr_b16 a[240:241], v7 offset:32768
 buffer_load_dwordx4 a[184:187], v2, s[4:7], s23 offen offset:2048 sc1
 v_mfma_f32_16x16x32_bf16 v[128:131], a[220:223], a[156:159], v[128:131]
 ds_read_b64_tr_b16 a[242:243], v7 offset:33280
 v_lshlrev_b32 v32, 16, v64
 v_mfma_f32_16x16x32_bf16 v[96:99], a[220:223], a[152:155], v[96:99]
 ds_read_b64_tr_b16 a[244:245], v7 offset:40960
 v_and_b32 v33, s64, v64
 v_mfma_f32_16x16x32_bf16 v[96:99], a[216:219], a[144:147], v[96:99]
 ds_read_b64_tr_b16 a[246:247], v7 offset:41472
 s_waitcnt lgkmcnt(8)
 v_mfma_f32_16x16x32_bf16 v[100:103], a[224:227], a[144:147], v[100:103]
 ds_read_b64_tr_b16 a[248:249], v4 offset:34816
 buffer_load_dwordx4 v78, s[12:15], s21 offen offset:2048 lds
 v_mfma_f32_16x16x32_bf16 v[100:103], a[228:231], a[152:155], v[100:103]
 ds_read_b64_tr_b16 a[250:251], v4 offset:35328
 v_lshlrev_b32 v34, 16, v65
 v_mfma_f32_16x16x32_bf16 v[132:135], a[228:231], a[156:159], v[132:135]
 ds_read_b64_tr_b16 a[252:253], v4 offset:43008
 v_and_b32 v35, s64, v65
 v_mfma_f32_16x16x32_bf16 v[132:135], a[224:227], a[148:151], v[132:135]
 ds_read_b64_tr_b16 a[254:255], v4 offset:43520
 s_waitcnt lgkmcnt(8)
 v_mfma_f32_16x16x32_bf16 v[136:139], a[232:235], a[148:151], v[136:139]
 ds_read_b64_tr_b16 a[216:217], v5 offset:34816
 buffer_load_dwordx4 a[188:191], v3, s[4:7], s23 offen offset:2048 sc1
 v_mfma_f32_16x16x32_bf16 v[136:139], a[236:239], a[156:159], v[136:139]
 ds_read_b64_tr_b16 a[218:219], v5 offset:35328
 v_lshlrev_b32 v36, 16, v66
 v_mfma_f32_16x16x32_bf16 v[104:107], a[236:239], a[152:155], v[104:107]
 ds_read_b64_tr_b16 a[220:221], v5 offset:43008
 v_and_b32 v37, s64, v66
 v_mfma_f32_16x16x32_bf16 v[104:107], a[232:235], a[144:147], v[104:107]
 ds_read_b64_tr_b16 a[222:223], v5 offset:43520
 s_waitcnt lgkmcnt(8)
 v_mfma_f32_16x16x32_bf16 v[108:111], a[240:243], a[144:147], v[108:111]
 ds_read_b64_tr_b16 a[224:225], v6 offset:34816
 buffer_load_dwordx4 v79, s[12:15], s21 offen offset:3072 lds
 v_mfma_f32_16x16x32_bf16 v[108:111], a[244:247], a[152:155], v[108:111]
 ds_read_b64_tr_b16 a[226:227], v6 offset:35328
 s_add_u32 s23, s23, 4096
 v_mfma_f32_16x16x32_bf16 v[140:143], a[244:247], a[156:159], v[140:143]
 ds_read_b64_tr_b16 a[228:229], v6 offset:43008
 s_mov_b32 s21, 5505024
 v_mfma_f32_16x16x32_bf16 v[140:143], a[240:243], a[148:151], v[140:143]
 ds_read_b64_tr_b16 a[230:231], v6 offset:43520
 s_waitcnt lgkmcnt(8)
 v_mfma_f32_16x16x32_bf16 v[144:147], a[148:151], a[248:251], v[144:147]
 ds_read_b64_tr_b16 a[232:233], v7 offset:34816
 buffer_load_dwordx4 a[192:195], v2, s[4:7], s23 offen sc1
 v_mfma_f32_16x16x32_bf16 v[144:147], a[156:159], a[252:255], v[144:147]
 ds_read_b64_tr_b16 a[234:235], v7 offset:35328
 s_add_u32 m0, s19, 114688
 v_mfma_f32_16x16x32_bf16 v[112:115], a[152:155], a[252:255], v[112:115]
 ds_read_b64_tr_b16 a[236:237], v7 offset:43008
 v_lshlrev_b32 v38, 16, v67
 v_mfma_f32_16x16x32_bf16 v[112:115], a[144:147], a[248:251], v[112:115]
 ds_read_b64_tr_b16 a[238:239], v7 offset:43520
 s_waitcnt lgkmcnt(8)
 v_mfma_f32_16x16x32_bf16 v[116:119], a[144:147], a[216:219], v[116:119]
 s_barrier
 ds_read_b64_tr_b16 a[240:241], v4 offset:49152
 v_mfma_f32_16x16x32_bf16 v[116:119], a[152:155], a[220:223], v[116:119]
 ds_read_b64_tr_b16 a[242:243], v4 offset:49664
 buffer_load_dwordx4 a[196:199], v3, s[4:7], s23 offen sc1
 v_mfma_f32_16x16x32_bf16 v[148:151], a[156:159], a[220:223], v[148:151]
 ds_read_b64_tr_b16 a[244:245], v4 offset:57344
 v_and_b32 v39, s64, v67
 v_mfma_f32_16x16x32_bf16 v[148:151], a[148:151], a[216:219], v[148:151]
 ds_read_b64_tr_b16 a[246:247], v4 offset:57856
 s_waitcnt lgkmcnt(8)
 v_mfma_f32_16x16x32_bf16 v[152:155], a[148:151], a[224:227], v[152:155]
 ds_read_b64_tr_b16 a[248:249], v5 offset:49152
 buffer_load_dwordx4 v76, s[12:15], s21 offen lds
 v_mfma_f32_16x16x32_bf16 v[152:155], a[156:159], a[228:231], v[152:155]
 ds_read_b64_tr_b16 a[250:251], v5 offset:49664
 v_lshlrev_b32 v40, 16, v68
 v_mfma_f32_16x16x32_bf16 v[120:123], a[152:155], a[228:231], v[120:123]
 ds_read_b64_tr_b16 a[252:253], v5 offset:57344
 v_and_b32 v41, s64, v68
 v_mfma_f32_16x16x32_bf16 v[120:123], a[144:147], a[224:227], v[120:123]
 ds_read_b64_tr_b16 a[254:255], v5 offset:57856
 s_waitcnt lgkmcnt(8)
 v_mfma_f32_16x16x32_bf16 v[124:127], a[144:147], a[232:235], v[124:127]
 ds_read_b64_tr_b16 a[216:217], v6 offset:49152
 buffer_load_dwordx4 v77, s[12:15], s21 offen offset:1024 lds
 v_mfma_f32_16x16x32_bf16 v[124:127], a[152:155], a[236:239], v[124:127]
 ds_read_b64_tr_b16 a[218:219], v6 offset:49664
 v_lshlrev_b32 v42, 16, v69
 v_mfma_f32_16x16x32_bf16 v[156:159], a[156:159], a[236:239], v[156:159]
 ds_read_b64_tr_b16 a[220:221], v6 offset:57344
 v_and_b32 v43, s64, v69
 v_mfma_f32_16x16x32_bf16 v[156:159], a[148:151], a[232:235], v[156:159]
 ds_read_b64_tr_b16 a[222:223], v6 offset:57856
 s_waitcnt vmcnt(13) lgkmcnt(8)
 v_mfma_f32_16x16x32_bf16 v[128:131], a[240:243], a[164:167], v[128:131]
 ds_read_b64_tr_b16 a[224:225], v7 offset:49152
 buffer_load_dwordx4 a[200:203], v2, s[4:7], s23 offen offset:2048 sc1
 v_mfma_f32_16x16x32_bf16 v[128:131], a[244:247], a[172:175], v[128:131]
 ds_read_b64_tr_b16 a[226:227], v7 offset:49664
 v_lshlrev_b32 v44, 16, v70
 v_mfma_f32_16x16x32_bf16 v[96:99], a[244:247], a[168:171], v[96:99]
 ds_read_b64_tr_b16 a[228:229], v7 offset:57344
 v_and_b32 v45, s64, v70
 v_mfma_f32_16x16x32_bf16 v[96:99], a[240:243], a[160:163], v[96:99]
 ds_read_b64_tr_b16 a[230:231], v7 offset:57856
 s_waitcnt lgkmcnt(8)
 v_mfma_f32_16x16x32_bf16 v[100:103], a[248:251], a[160:163], v[100:103]
 ds_read_b64_tr_b16 a[232:233], v4 offset:51200
 buffer_load_dwordx4 v78, s[12:15], s21 offen offset:2048 lds
 v_mfma_f32_16x16x32_bf16 v[100:103], a[252:255], a[168:171], v[100:103]
 ds_read_b64_tr_b16 a[234:235], v4 offset:51712
 v_lshlrev_b32 v46, 16, v71
 v_mfma_f32_16x16x32_bf16 v[132:135], a[252:255], a[172:175], v[132:135]
 ds_read_b64_tr_b16 a[236:237], v4 offset:59392
 v_and_b32 v47, s64, v71
 v_mfma_f32_16x16x32_bf16 v[132:135], a[248:251], a[164:167], v[132:135]
 ds_read_b64_tr_b16 a[238:239], v4 offset:59904
 s_waitcnt lgkmcnt(8)
 v_mfma_f32_16x16x32_bf16 v[136:139], a[216:219], a[164:167], v[136:139]
 ds_read_b64_tr_b16 a[240:241], v5 offset:51200
 buffer_load_dwordx4 a[204:207], v3, s[4:7], s23 offen offset:2048 sc1
 v_mfma_f32_16x16x32_bf16 v[136:139], a[220:223], a[172:175], v[136:139]
 ds_read_b64_tr_b16 a[242:243], v5 offset:51712
 v_add_f32 v32, v32, v33
 v_mfma_f32_16x16x32_bf16 v[104:107], a[220:223], a[168:171], v[104:107]
 ds_read_b64_tr_b16 a[244:245], v5 offset:59392
 v_add_f32 v32, v32, v34
 v_mfma_f32_16x16x32_bf16 v[104:107], a[216:219], a[160:163], v[104:107]
 ds_read_b64_tr_b16 a[246:247], v5 offset:59904
 s_waitcnt lgkmcnt(8)
 v_mfma_f32_16x16x32_bf16 v[108:111], a[224:227], a[160:163], v[108:111]
 ds_read_b64_tr_b16 a[248:249], v6 offset:51200
 buffer_load_dwordx4 v79, s[12:15], s21 offen offset:3072 lds
 v_mfma_f32_16x16x32_bf16 v[108:111], a[228:231], a[168:171], v[108:111]
 ds_read_b64_tr_b16 a[250:251], v6 offset:51712
 s_add_u32 s23, s23, 4096
 v_mfma_f32_16x16x32_bf16 v[140:143], a[228:231], a[172:175], v[140:143]
 ds_read_b64_tr_b16 a[252:253], v6 offset:59392
 s_mov_b32 s21, 5898240
 v_mfma_f32_16x16x32_bf16 v[140:143], a[224:227], a[164:167], v[140:143]
 ds_read_b64_tr_b16 a[254:255], v6 offset:59904
 s_waitcnt lgkmcnt(8)
 v_mfma_f32_16x16x32_bf16 v[144:147], a[164:167], a[232:235], v[144:147]
 ds_read_b64_tr_b16 a[216:217], v7 offset:51200
 buffer_load_dwordx4 a[208:211], v2, s[4:7], s23 offen sc1
 v_mfma_f32_16x16x32_bf16 v[144:147], a[172:175], a[236:239], v[144:147]
 ds_read_b64_tr_b16 a[218:219], v7 offset:51712
 s_mov_b32 m0, s19
 v_mfma_f32_16x16x32_bf16 v[112:115], a[168:171], a[236:239], v[112:115]
 ds_read_b64_tr_b16 a[220:221], v7 offset:59392
 v_add_f32 v32, v32, v35
 v_mfma_f32_16x16x32_bf16 v[112:115], a[160:163], a[232:235], v[112:115]
 ds_read_b64_tr_b16 a[222:223], v7 offset:59904
 s_waitcnt lgkmcnt(8)
 v_mfma_f32_16x16x32_bf16 v[116:119], a[160:163], a[240:243], v[116:119]
 s_barrier
 ds_read_b64_tr_b16 a[224:225], v8
 v_mfma_f32_16x16x32_bf16 v[116:119], a[168:171], a[244:247], v[116:119]
 ds_read_b64_tr_b16 a[226:227], v8 offset:512
 buffer_load_dwordx4 v76, s[12:15], s21 offen lds
 v_mfma_f32_16x16x32_bf16 v[148:151], a[172:175], a[244:247], v[148:151]
 ds_read_b64_tr_b16 a[228:229], v8 offset:8192
 v_add_f32 v32, v32, v36
 v_mfma_f32_16x16x32_bf16 v[148:151], a[164:167], a[240:243], v[148:151]
 ds_read_b64_tr_b16 a[230:231], v8 offset:8704
 s_waitcnt lgkmcnt(8)
 v_mfma_f32_16x16x32_bf16 v[152:155], a[164:167], a[248:251], v[152:155]
 ds_read_b64_tr_b16 a[232:233], v9
 buffer_load_dwordx4 v77, s[12:15], s21 offen offset:1024 lds
 v_mfma_f32_16x16x32_bf16 v[152:155], a[172:175], a[252:255], v[152:155]
 ds_read_b64_tr_b16 a[234:235], v9 offset:512
 v_add_f32 v32, v32, v37
 v_mfma_f32_16x16x32_bf16 v[120:123], a[168:171], a[252:255], v[120:123]
 ds_read_b64_tr_b16 a[236:237], v9 offset:8192
 v_add_f32 v32, v32, v38
 v_mfma_f32_16x16x32_bf16 v[120:123], a[160:163], a[248:251], v[120:123]
 ds_read_b64_tr_b16 a[238:239], v9 offset:8704
 s_waitcnt lgkmcnt(8)
 v_mfma_f32_16x16x32_bf16 v[124:127], a[160:163], a[216:219], v[124:127]
 ds_read_b64_tr_b16 a[240:241], v10
 buffer_load_dwordx4 v78, s[12:15], s21 offen offset:2048 lds
 v_mfma_f32_16x16x32_bf16 v[124:127], a[168:171], a[220:223], v[124:127]
 ds_read_b64_tr_b16 a[242:243], v10 offset:512
 v_add_f32 v32, v32, v39
 v_mfma_f32_16x16x32_bf16 v[156:159], a[172:175], a[220:223], v[156:159]
 ds_read_b64_tr_b16 a[244:245], v10 offset:8192
 v_add_f32 v32, v32, v40
 v_mfma_f32_16x16x32_bf16 v[156:159], a[164:167], a[216:219], v[156:159]
 ds_read_b64_tr_b16 a[246:247], v10 offset:8704
 s_waitcnt vmcnt(13) lgkmcnt(8)
 v_mfma_f32_16x16x32_bf16 v[128:131], a[224:227], a[180:183], v[128:131]
 ds_read_b64_tr_b16 a[248:249], v11
 buffer_load_dwordx4 a[212:215], v3, s[4:7], s23 offen sc1
 v_mfma_f32_16x16x32_bf16 v[128:131], a[228:231], a[188:191], v[128:131]
 ds_read_b64_tr_b16 a[250:251], v11 offset:512
 v_add_f32 v32, v32, v41
 v_mfma_f32_16x16x32_bf16 v[96:99], a[228:231], a[184:187], v[96:99]
 ds_read_b64_tr_b16 a[252:253], v11 offset:8192
 v_add_f32 v32, v32, v42
 v_mfma_f32_16x16x32_bf16 v[96:99], a[224:227], a[176:179], v[96:99]
 ds_read_b64_tr_b16 a[254:255], v11 offset:8704
 s_waitcnt lgkmcnt(8)
 v_mfma_f32_16x16x32_bf16 v[100:103], a[232:235], a[176:179], v[100:103]
 ds_read_b64_tr_b16 a[216:217], v8 offset:2048
 buffer_load_dwordx4 v79, s[12:15], s21 offen offset:3072 lds
 v_mfma_f32_16x16x32_bf16 v[100:103], a[236:239], a[184:187], v[100:103]
 ds_read_b64_tr_b16 a[218:219], v8 offset:2560
 v_add_f32 v32, v32, v43
 v_mfma_f32_16x16x32_bf16 v[132:135], a[236:239], a[188:191], v[132:135]
 ds_read_b64_tr_b16 a[220:221], v8 offset:10240
 v_add_f32 v32, v32, v44
 v_mfma_f32_16x16x32_bf16 v[132:135], a[232:235], a[180:183], v[132:135]
 ds_read_b64_tr_b16 a[222:223], v8 offset:10752
 s_waitcnt lgkmcnt(8)
 v_mfma_f32_16x16x32_bf16 v[136:139], a[240:243], a[180:183], v[136:139]
 ds_read_b64_tr_b16 a[224:225], v9 offset:2048
 buffer_load_dwordx4 v[216:219], v2, s[4:7], s23 offen offset:2048 sc1
 v_mfma_f32_16x16x32_bf16 v[136:139], a[244:247], a[188:191], v[136:139]
 ds_read_b64_tr_b16 a[226:227], v9 offset:2560
 s_mov_b32 s21, 786432
 v_mfma_f32_16x16x32_bf16 v[104:107], a[244:247], a[184:187], v[104:107]
 ds_read_b64_tr_b16 a[228:229], v9 offset:10240
 v_add_f32 v32, v32, v45
 v_mfma_f32_16x16x32_bf16 v[104:107], a[240:243], a[176:179], v[104:107]
 ds_read_b64_tr_b16 a[230:231], v9 offset:10752
 s_waitcnt lgkmcnt(8)
 v_mfma_f32_16x16x32_bf16 v[108:111], a[248:251], a[176:179], v[108:111]
 ds_read_b64_tr_b16 a[232:233], v10 offset:2048
 buffer_load_dwordx4 v[220:223], v3, s[4:7], s23 offen offset:2048 sc1
 v_mfma_f32_16x16x32_bf16 v[108:111], a[252:255], a[184:187], v[108:111]
 ds_read_b64_tr_b16 a[234:235], v10 offset:2560
 s_add_u32 m0, s19, 16384
 v_mfma_f32_16x16x32_bf16 v[140:143], a[252:255], a[188:191], v[140:143]
 ds_read_b64_tr_b16 a[236:237], v10 offset:10240
 s_add_u32 s23, s23, 4096
 v_mfma_f32_16x16x32_bf16 v[140:143], a[248:251], a[180:183], v[140:143]
 ds_read_b64_tr_b16 a[238:239], v10 offset:10752
 s_waitcnt lgkmcnt(8)
 v_mfma_f32_16x16x32_bf16 v[144:147], a[180:183], a[216:219], v[144:147]
 ds_read_b64_tr_b16 a[240:241], v11 offset:2048
 buffer_load_dwordx4 v80, s[12:15], s21 offen lds
 v_mfma_f32_16x16x32_bf16 v[144:147], a[188:191], a[220:223], v[144:147]
 ds_read_b64_tr_b16 a[242:243], v11 offset:2560
 v_add_f32 v32, v32, v46
 v_mfma_f32_16x16x32_bf16 v[112:115], a[184:187], a[220:223], v[112:115]
 ds_read_b64_tr_b16 a[244:245], v11 offset:10240
 v_add_f32 v32, v32, v47
 v_mfma_f32_16x16x32_bf16 v[112:115], a[176:179], a[216:219], v[112:115]
 ds_read_b64_tr_b16 a[246:247], v11 offset:10752
 s_waitcnt lgkmcnt(8)
 v_mfma_f32_16x16x32_bf16 v[116:119], a[176:179], a[224:227], v[116:119]
 s_barrier
 ds_read_b64_tr_b16 a[248:249], v8 offset:16384
 v_mfma_f32_16x16x32_bf16 v[116:119], a[184:187], a[228:231], v[116:119]
 ds_read_b64_tr_b16 a[250:251], v8 offset:16896
 buffer_load_dwordx4 v[224:227], v2, s[4:7], s23 offen sc1
 v_mfma_f32_16x16x32_bf16 v[148:151], a[188:191], a[228:231], v[148:151]
 ds_read_b64_tr_b16 a[252:253], v8 offset:24576
 v_add_f32_dpp v32, v32, v32 quad_perm:[1,0,3,2] row_mask:0xf bank_mask:0xf
 v_mfma_f32_16x16x32_bf16 v[148:151], a[180:183], a[224:227], v[148:151]
 ds_read_b64_tr_b16 a[254:255], v8 offset:25088
 s_waitcnt lgkmcnt(8)
 v_mfma_f32_16x16x32_bf16 v[152:155], a[180:183], a[232:235], v[152:155]
 ds_read_b64_tr_b16 a[216:217], v9 offset:16384
 buffer_load_dwordx4 v81, s[12:15], s21 offen offset:1024 lds
 v_mfma_f32_16x16x32_bf16 v[152:155], a[188:191], a[236:239], v[152:155]
 ds_read_b64_tr_b16 a[218:219], v9 offset:16896
 v_add_f32_dpp v32, v32, v32 quad_perm:[2,3,0,1] row_mask:0xf bank_mask:0xf
 v_mfma_f32_16x16x32_bf16 v[120:123], a[184:187], a[236:239], v[120:123]
 ds_read_b64_tr_b16 a[220:221], v9 offset:24576
 v_add_f32_dpp v32, v32, v32 row_half_mirror row_mask:0xf bank_mask:0xf
 v_mfma_f32_16x16x32_bf16 v[120:123], a[176:179], a[232:235], v[120:123]
 ds_read_b64_tr_b16 a[222:223], v9 offset:25088
 s_waitcnt lgkmcnt(8)
 v_mfma_f32_16x16x32_bf16 v[124:127], a[176:179], a[240:243], v[124:127]
 ds_read_b64_tr_b16 a[224:225], v10 offset:16384
 buffer_load_dwordx4 v82, s[12:15], s21 offen offset:2048 lds
 v_mfma_f32_16x16x32_bf16 v[124:127], a[184:187], a[244:247], v[124:127]
 ds_read_b64_tr_b16 a[226:227], v10 offset:16896
 v_add_f32_dpp v32, v32, v32 row_mirror row_mask:0xf bank_mask:0xf
 v_mfma_f32_16x16x32_bf16 v[156:159], a[188:191], a[244:247], v[156:159]
 ds_read_b64_tr_b16 a[228:229], v10 offset:24576
 v_mov_b32 v33, v32
 v_mfma_f32_16x16x32_bf16 v[156:159], a[180:183], a[240:243], v[156:159]
 ds_read_b64_tr_b16 a[230:231], v10 offset:25088
 s_waitcnt vmcnt(13) lgkmcnt(8)
 v_mfma_f32_16x16x32_bf16 v[128:131], a[248:251], a[196:199], v[128:131]
 ds_read_b64_tr_b16 a[232:233], v11 offset:16384
 buffer_load_dwordx4 v[228:231], v3, s[4:7], s23 offen sc1
 v_mfma_f32_16x16x32_bf16 v[128:131], a[252:255], a[204:207], v[128:131]
 ds_read_b64_tr_b16 a[234:235], v11 offset:16896
 v_permlane16_swap_b32 v32, v33
 v_mfma_f32_16x16x32_bf16 v[96:99], a[252:255], a[200:203], v[96:99]
 ds_read_b64_tr_b16 a[236:237], v11 offset:24576
 v_add_f32 v32, v32, v33
 v_mfma_f32_16x16x32_bf16 v[96:99], a[248:251], a[192:195], v[96:99]
 ds_read_b64_tr_b16 a[238:239], v11 offset:25088
 s_waitcnt lgkmcnt(8)
 v_mfma_f32_16x16x32_bf16 v[100:103], a[216:219], a[192:195], v[100:103]
 ds_read_b64_tr_b16 a[240:241], v8 offset:18432
 buffer_load_dwordx4 v83, s[12:15], s21 offen offset:3072 lds
 v_mfma_f32_16x16x32_bf16 v[100:103], a[220:223], a[200:203], v[100:103]
 ds_read_b64_tr_b16 a[242:243], v8 offset:18944
 v_mov_b32 v33, v32
 v_mfma_f32_16x16x32_bf16 v[132:135], a[220:223], a[204:207], v[132:135]
 ds_read_b64_tr_b16 a[244:245], v8 offset:26624
 v_permlane32_swap_b32 v32, v33
 v_mfma_f32_16x16x32_bf16 v[132:135], a[216:219], a[196:199], v[132:135]
 ds_read_b64_tr_b16 a[246:247], v8 offset:27136
 s_waitcnt lgkmcnt(8)
 v_mfma_f32_16x16x32_bf16 v[136:139], a[224:227], a[196:199], v[136:139]
 ds_read_b64_tr_b16 a[248:249], v9 offset:18432
 buffer_load_dwordx4 v[232:235], v2, s[4:7], s23 offen offset:2048 sc1
 v_mfma_f32_16x16x32_bf16 v[136:139], a[228:231], a[204:207], v[136:139]
L_hop_2:
 s_cbranch_execz L_ret_0
 ds_read_b64_tr_b16 a[250:251], v9 offset:18944
 s_mov_b32 s21, 1572864
 v_mfma_f32_16x16x32_bf16 v[104:107], a[228:231], a[200:203], v[104:107]
 ds_read_b64_tr_b16 a[252:253], v9 offset:26624
 v_add_f32 v32, v32, v33
 v_mfma_f32_16x16x32_bf16 v[104:107], a[224:227], a[192:195], v[104:107]
 ds_read_b64_tr_b16 a[254:255], v9 offset:27136
 s_waitcnt lgkmcnt(8)
 v_mfma_f32_16x16x32_bf16 v[108:111], a[232:235], a[192:195], v[108:111]
 ds_read_b64_tr_b16 a[216:217], v10 offset:18432
 buffer_load_dwordx4 v[236:239], v3, s[4:7], s23 offen offset:2048 sc1
 v_mfma_f32_16x16x32_bf16 v[108:111], a[236:239], a[200:203], v[108:111]
 ds_read_b64_tr_b16 a[218:219], v10 offset:18944
 s_add_u32 m0, s19, 32768
 v_mfma_f32_16x16x32_bf16 v[140:143], a[236:239], a[204:207], v[140:143]
 ds_read_b64_tr_b16 a[220:221], v10 offset:26624
 s_add_u32 s23, s23, 4096
 v_mfma_f32_16x16x32_bf16 v[140:143], a[232:235], a[196:199], v[140:143]
 ds_read_b64_tr_b16 a[222:223], v10 offset:27136
 s_waitcnt lgkmcnt(8)
 v_mfma_f32_16x16x32_bf16 v[144:147], a[196:199], a[240:243], v[144:147]
 ds_read_b64_tr_b16 a[224:225], v11 offset:18432
 buffer_load_dwordx4 v80, s[12:15], s21 offen lds
 v_mfma_f32_16x16x32_bf16 v[144:147], a[204:207], a[244:247], v[144:147]
 ds_read_b64_tr_b16 a[226:227], v11 offset:18944
 v_mul_f32 v32, 0x3a800000, v32
 v_mfma_f32_16x16x32_bf16 v[112:115], a[200:203], a[244:247], v[112:115]
 ds_read_b64_tr_b16 a[228:229], v11 offset:26624
 v_cvt_pk_bf16_f32 v74, v32, v32
 v_mfma_f32_16x16x32_bf16 v[112:115], a[192:195], a[240:243], v[112:115]
 ds_read_b64_tr_b16 a[230:231], v11 offset:27136
 s_waitcnt lgkmcnt(8)
 v_mfma_f32_16x16x32_bf16 v[116:119], a[192:195], a[248:251], v[116:119]
 s_barrier
 ds_read_b64_tr_b16 a[232:233], v8 offset:32768
 v_mfma_f32_16x16x32_bf16 v[116:119], a[200:203], a[252:255], v[116:119]
 ds_read_b64_tr_b16 a[234:235], v8 offset:33280
 buffer_load_dwordx4 v[240:243], v2, s[4:7], s23 offen sc1
 v_mfma_f32_16x16x32_bf16 v[148:151], a[204:207], a[252:255], v[148:151]
 ds_read_b64_tr_b16 a[236:237], v8 offset:40960
 v_and_b32 v34, s64, v74
 v_mfma_f32_16x16x32_bf16 v[148:151], a[196:199], a[248:251], v[148:151]
 ds_read_b64_tr_b16 a[238:239], v8 offset:41472
 s_waitcnt lgkmcnt(8)
 v_mfma_f32_16x16x32_bf16 v[152:155], a[196:199], a[216:219], v[152:155]
 ds_read_b64_tr_b16 a[240:241], v9 offset:32768
 buffer_load_dwordx4 v81, s[12:15], s21 offen offset:1024 lds
 v_mfma_f32_16x16x32_bf16 v[152:155], a[204:207], a[220:223], v[152:155]
 ds_read_b64_tr_b16 a[242:243], v9 offset:33280
 v_sub_f32 v34, v32, v34
 v_mfma_f32_16x16x32_bf16 v[120:123], a[200:203], a[220:223], v[120:123]
 ds_read_b64_tr_b16 a[244:245], v9 offset:40960
 v_cvt_pk_bf16_f32 v75, v34, v34
 v_mfma_f32_16x16x32_bf16 v[120:123], a[192:195], a[216:219], v[120:123]
 ds_read_b64_tr_b16 a[246:247], v9 offset:41472
 s_waitcnt lgkmcnt(8)
 v_mfma_f32_16x16x32_bf16 v[124:127], a[192:195], a[224:227], v[124:127]
 ds_read_b64_tr_b16 a[248:249], v10 offset:32768
 buffer_load_dwordx4 v82, s[12:15], s21 offen offset:2048 lds
 v_mfma_f32_16x16x32_bf16 v[124:127], a[200:203], a[228:231], v[124:127]
 ds_read_b64_tr_b16 a[250:251], v10 offset:33280
 s_lshr_b32 s28, s66, 3
 v_mfma_f32_16x16x32_bf16 v[156:159], a[204:207], a[228:231], v[156:159]
 ds_read_b64_tr_b16 a[252:253], v10 offset:40960
 s_lshl_b32 s28, s28, 6
 v_mfma_f32_16x16x32_bf16 v[156:159], a[196:199], a[224:227], v[156:159]
 ds_read_b64_tr_b16 a[254:255], v10 offset:41472
 s_waitcnt vmcnt(12) lgkmcnt(8)
 v_mfma_f32_16x16x32_bf16 v[128:131], a[232:235], a[212:215], v[128:131]
 ds_read_b64_tr_b16 a[216:217], v11 offset:32768
 buffer_load_dwordx4 v[244:247], v3, s[4:7], s23 offen sc1
 v_mfma_f32_16x16x32_bf16 v[128:131], a[236:239], v[220:223], v[128:131]
 ds_read_b64_tr_b16 a[218:219], v11 offset:33280
 s_and_b32 s3, s66, 7
 v_mfma_f32_16x16x32_bf16 v[96:99], a[236:239], v[216:219], v[96:99]
 ds_read_b64_tr_b16 a[220:221], v11 offset:40960
 s_add_u32 s28, s28, s3
 v_mfma_f32_16x16x32_bf16 v[96:99], a[232:235], a[208:211], v[96:99]
 ds_read_b64_tr_b16 a[222:223], v11 offset:41472
 s_waitcnt lgkmcnt(8)
 v_mfma_f32_16x16x32_bf16 v[100:103], a[240:243], a[208:211], v[100:103]
 ds_read_b64_tr_b16 a[224:225], v8 offset:34816
 buffer_load_dwordx4 v83, s[12:15], s21 offen offset:3072 lds
 v_mfma_f32_16x16x32_bf16 v[100:103], a[244:247], v[216:219], v[100:103]
 ds_read_b64_tr_b16 a[226:227], v8 offset:35328
 s_lshl_b32 s28, s28, 1
 v_mfma_f32_16x16x32_bf16 v[132:135], a[244:247], v[220:223], v[132:135]
 ds_read_b64_tr_b16 a[228:229], v8 offset:43008
 s_add_u32 s28, s28, 39854080
 v_mfma_f32_16x16x32_bf16 v[132:135], a[240:243], a[212:215], v[132:135]
 ds_read_b64_tr_b16 a[230:231], v8 offset:43520
 s_waitcnt lgkmcnt(8)
 v_mfma_f32_16x16x32_bf16 v[136:139], a[248:251], a[212:215], v[136:139]
 ds_read_b64_tr_b16 a[232:233], v9 offset:34816
 buffer_load_dwordx4 v[248:251], v2, s[4:7], s23 offen offset:2048 sc1
 v_mfma_f32_16x16x32_bf16 v[136:139], a[252:255], v[220:223], v[136:139]
 ds_read_b64_tr_b16 a[234:235], v9 offset:35328
 s_mov_b32 s21, 2359296
 v_mfma_f32_16x16x32_bf16 v[104:107], a[252:255], v[216:219], v[104:107]
 ds_read_b64_tr_b16 a[236:237], v9 offset:43008
 v_mfma_f32_16x16x32_bf16 v[104:107], a[248:251], a[208:211], v[104:107]
 ds_read_b64_tr_b16 a[238:239], v9 offset:43520
 s_waitcnt lgkmcnt(8)
 v_mfma_f32_16x16x32_bf16 v[108:111], a[216:219], a[208:211], v[108:111]
 ds_read_b64_tr_b16 a[240:241], v10 offset:34816
 buffer_load_dwordx4 v[252:255], v3, s[4:7], s23 offen offset:2048 sc1
 v_mfma_f32_16x16x32_bf16 v[108:111], a[220:223], v[216:219], v[108:111]
 ds_read_b64_tr_b16 a[242:243], v10 offset:35328
 s_add_u32 m0, s19, 49152
 v_mfma_f32_16x16x32_bf16 v[140:143], a[220:223], v[220:223], v[140:143]
 ds_read_b64_tr_b16 a[244:245], v10 offset:43008
 s_add_u32 s23, s23, 4096
 v_mfma_f32_16x16x32_bf16 v[140:143], a[216:219], a[212:215], v[140:143]
 ds_read_b64_tr_b16 a[246:247], v10 offset:43520
 s_waitcnt lgkmcnt(8)
 v_mfma_f32_16x16x32_bf16 v[144:147], a[212:215], a[224:227], v[144:147]
 ds_read_b64_tr_b16 a[248:249], v11 offset:34816
 buffer_load_dwordx4 v80, s[12:15], s21 offen lds
 v_mfma_f32_16x16x32_bf16 v[144:147], v[220:223], a[228:231], v[144:147]
 ds_read_b64_tr_b16 a[250:251], v11 offset:35328
 v_mfma_f32_16x16x32_bf16 v[112:115], v[216:219], a[228:231], v[112:115]
 ds_read_b64_tr_b16 a[252:253], v11 offset:43008
 v_mfma_f32_16x16x32_bf16 v[112:115], a[208:211], a[224:227], v[112:115]
 ds_read_b64_tr_b16 a[254:255], v11 offset:43520
 s_waitcnt lgkmcnt(8)
 v_mfma_f32_16x16x32_bf16 v[116:119], a[208:211], a[232:235], v[116:119]
 s_barrier
 ds_read_b64_tr_b16 a[216:217], v8 offset:49152
 v_mfma_f32_16x16x32_bf16 v[116:119], v[216:219], a[236:239], v[116:119]
 ds_read_b64_tr_b16 a[218:219], v8 offset:49664
 buffer_load_dwordx4 v81, s[12:15], s21 offen offset:1024 lds
 v_mfma_f32_16x16x32_bf16 v[148:151], v[220:223], a[236:239], v[148:151]
 ds_read_b64_tr_b16 a[220:221], v8 offset:57344
 v_mfma_f32_16x16x32_bf16 v[148:151], a[212:215], a[232:235], v[148:151]
 ds_read_b64_tr_b16 a[222:223], v8 offset:57856
 s_waitcnt lgkmcnt(8)
 v_mfma_f32_16x16x32_bf16 v[152:155], a[212:215], a[240:243], v[152:155]
 ds_read_b64_tr_b16 a[224:225], v9 offset:49152
 buffer_load_dwordx4 v82, s[12:15], s21 offen offset:2048 lds
 v_mfma_f32_16x16x32_bf16 v[152:155], v[220:223], a[244:247], v[152:155]
 ds_read_b64_tr_b16 a[226:227], v9 offset:49664
 v_mfma_f32_16x16x32_bf16 v[120:123], v[216:219], a[244:247], v[120:123]
 ds_read_b64_tr_b16 a[228:229], v9 offset:57344
 v_mfma_f32_16x16x32_bf16 v[120:123], a[208:211], a[240:243], v[120:123]
 ds_read_b64_tr_b16 a[230:231], v9 offset:57856
 s_waitcnt lgkmcnt(8)
 v_mfma_f32_16x16x32_bf16 v[124:127], a[208:211], a[248:251], v[124:127]
 ds_read_b64_tr_b16 a[232:233], v10 offset:49152
 buffer_load_dwordx4 v83, s[12:15], s21 offen offset:3072 lds
 v_mfma_f32_16x16x32_bf16 v[124:127], v[216:219], a[252:255], v[124:127]
 ds_read_b64_tr_b16 a[234:235], v10 offset:49664
 s_mov_b32 s21, 3145728
 v_mfma_f32_16x16x32_bf16 v[156:159], v[220:223], a[252:255], v[156:159]
 ds_read_b64_tr_b16 a[236:237], v10 offset:57344
 s_add_u32 m0, s19, 65536
 v_mfma_f32_16x16x32_bf16 v[156:159], a[212:215], a[248:251], v[156:159]
 ds_read_b64_tr_b16 a[238:239], v10 offset:57856
 s_waitcnt vmcnt(12) lgkmcnt(8)
 v_mfma_f32_16x16x32_bf16 v[128:131], a[216:219], v[228:231], v[128:131]
 ds_read_b64_tr_b16 a[240:241], v11 offset:49152
 buffer_load_dwordx4 v80, s[12:15], s21 offen lds
 v_mfma_f32_16x16x32_bf16 v[128:131], a[220:223], v[236:239], v[128:131]
 ds_read_b64_tr_b16 a[242:243], v11 offset:49664
 v_mfma_f32_16x16x32_bf16 v[96:99], a[220:223], v[232:235], v[96:99]
 ds_read_b64_tr_b16 a[244:245], v11 offset:57344
 v_mfma_f32_16x16x32_bf16 v[96:99], a[216:219], v[224:227], v[96:99]
 ds_read_b64_tr_b16 a[246:247], v11 offset:57856
 s_waitcnt lgkmcnt(8)
 v_mfma_f32_16x16x32_bf16 v[100:103], a[224:227], v[224:227], v[100:103]
 ds_read_b64_tr_b16 a[248:249], v8 offset:51200
 v_mfma_f32_16x16x32_bf16 v[100:103], a[228:231], v[232:235], v[100:103]
 ds_read_b64_tr_b16 a[250:251], v8 offset:51712
 v_mfma_f32_16x16x32_bf16 v[132:135], a[228:231], v[236:239], v[132:135]
 ds_read_b64_tr_b16 a[252:253], v8 offset:59392
 v_mfma_f32_16x16x32_bf16 v[132:135], a[224:227], v[228:231], v[132:135]
 ds_read_b64_tr_b16 a[254:255], v8 offset:59904
 s_waitcnt lgkmcnt(8)
 v_mfma_f32_16x16x32_bf16 v[136:139], a[232:235], v[228:231], v[136:139]
 ds_read_b64_tr_b16 a[216:217], v9 offset:51200
 buffer_load_dwordx4 v81, s[12:15], s21 offen offset:1024 lds
 v_mfma_f32_16x16x32_bf16 v[136:139], a[236:239], v[236:239], v[136:139]
 ds_read_b64_tr_b16 a[218:219], v9 offset:51712
 v_mfma_f32_16x16x32_bf16 v[104:107], a[236:239], v[232:235], v[104:107]
 ds_read_b64_tr_b16 a[220:221], v9 offset:59392
 v_mfma_f32_16x16x32_bf16 v[104:107], a[232:235], v[224:227], v[104:107]
 ds_read_b64_tr_b16 a[222:223], v9 offset:59904
 s_waitcnt lgkmcnt(8)
 v_mfma_f32_16x16x32_bf16 v[108:111], a[240:243], v[224:227], v[108:111]
 ds_read_b64_tr_b16 a[224:225], v10 offset:51200
 v_mfma_f32_16x16x32_bf16 v[108:111], a[244:247], v[232:235], v[108:111]
 ds_read_b64_tr_b16 a[226:227], v10 offset:51712
 v_mfma_f32_16x16x32_bf16 v[140:143], a[244:247], v[236:239], v[140:143]
 ds_read_b64_tr_b16 a[228:229], v10 offset:59392
 v_mfma_f32_16x16x32_bf16 v[140:143], a[240:243], v[228:231], v[140:143]
 ds_read_b64_tr_b16 a[230:231], v10 offset:59904
 s_waitcnt lgkmcnt(8)
 v_mfma_f32_16x16x32_bf16 v[144:147], v[228:231], a[248:251], v[144:147]
 ds_read_b64_tr_b16 a[232:233], v11 offset:51200
 buffer_load_dwordx4 v82, s[12:15], s21 offen offset:2048 lds
 v_mfma_f32_16x16x32_bf16 v[144:147], v[236:239], a[252:255], v[144:147]
 ds_read_b64_tr_b16 a[234:235], v11 offset:51712
 v_mfma_f32_16x16x32_bf16 v[112:115], v[232:235], a[252:255], v[112:115]
 ds_read_b64_tr_b16 a[236:237], v11 offset:59392
 v_mfma_f32_16x16x32_bf16 v[112:115], v[224:227], a[248:251], v[112:115]
 ds_read_b64_tr_b16 a[238:239], v11 offset:59904
 s_waitcnt lgkmcnt(8)
 v_mfma_f32_16x16x32_bf16 v[116:119], v[224:227], a[216:219], v[116:119]
 s_barrier
 ds_read_b64_tr_b16 a[240:241], v4
 v_mfma_f32_16x16x32_bf16 v[116:119], v[232:235], a[220:223], v[116:119]
 ds_read_b64_tr_b16 a[242:243], v4 offset:512
 v_mfma_f32_16x16x32_bf16 v[148:151], v[236:239], a[220:223], v[148:151]
 ds_read_b64_tr_b16 a[244:245], v4 offset:8192
 v_mfma_f32_16x16x32_bf16 v[148:151], v[228:231], a[216:219], v[148:151]
 ds_read_b64_tr_b16 a[246:247], v4 offset:8704
 s_waitcnt lgkmcnt(8)
 v_mfma_f32_16x16x32_bf16 v[152:155], v[228:231], a[224:227], v[152:155]
 ds_read_b64_tr_b16 a[248:249], v5
 buffer_load_dwordx4 v83, s[12:15], s21 offen offset:3072 lds
 v_mfma_f32_16x16x32_bf16 v[152:155], v[236:239], a[228:231], v[152:155]
 ds_read_b64_tr_b16 a[250:251], v5 offset:512
 s_mov_b32 s21, 3932160
 v_mfma_f32_16x16x32_bf16 v[120:123], v[232:235], a[228:231], v[120:123]
 ds_read_b64_tr_b16 a[252:253], v5 offset:8192
 s_add_u32 m0, s19, 81920
 v_mfma_f32_16x16x32_bf16 v[120:123], v[224:227], a[224:227], v[120:123]
 ds_read_b64_tr_b16 a[254:255], v5 offset:8704
 s_waitcnt lgkmcnt(8)
 v_mfma_f32_16x16x32_bf16 v[124:127], v[224:227], a[232:235], v[124:127]
 ds_read_b64_tr_b16 a[216:217], v6
 v_mfma_f32_16x16x32_bf16 v[124:127], v[232:235], a[236:239], v[124:127]
 ds_read_b64_tr_b16 a[218:219], v6 offset:512
 v_mfma_f32_16x16x32_bf16 v[156:159], v[236:239], a[236:239], v[156:159]
 ds_read_b64_tr_b16 a[220:221], v6 offset:8192
 v_mfma_f32_16x16x32_bf16 v[156:159], v[228:231], a[232:235], v[156:159]
 ds_read_b64_tr_b16 a[222:223], v6 offset:8704
 s_waitcnt vmcnt(8) lgkmcnt(8)
 v_mfma_f32_16x16x32_bf16 v[128:131], a[240:243], v[244:247], v[128:131]
 ds_read_b64_tr_b16 a[224:225], v7
 buffer_load_dwordx4 v80, s[12:15], s21 offen lds
 v_mfma_f32_16x16x32_bf16 v[128:131], a[244:247], v[252:255], v[128:131]
 ds_read_b64_tr_b16 a[226:227], v7 offset:512
 v_mfma_f32_16x16x32_bf16 v[96:99], a[244:247], v[248:251], v[96:99]
 ds_read_b64_tr_b16 a[228:229], v7 offset:8192
 v_mfma_f32_16x16x32_bf16 v[96:99], a[240:243], v[240:243], v[96:99]
 ds_read_b64_tr_b16 a[230:231], v7 offset:8704
 s_waitcnt lgkmcnt(8)
 v_mfma_f32_16x16x32_bf16 v[100:103], a[248:251], v[240:243], v[100:103]
 ds_read_b64_tr_b16 a[232:233], v4 offset:2048
 v_mfma_f32_16x16x32_bf16 v[100:103], a[252:255], v[248:251], v[100:103]
 ds_read_b64_tr_b16 a[234:235], v4 offset:2560
 v_mfma_f32_16x16x32_bf16 v[132:135], a[252:255], v[252:255], v[132:135]
 ds_read_b64_tr_b16 a[236:237], v4 offset:10240
 v_mfma_f32_16x16x32_bf16 v[132:135], a[248:251], v[244:247], v[132:135]
 ds_read_b64_tr_b16 a[238:239], v4 offset:10752
 s_waitcnt lgkmcnt(8)
 v_mfma_f32_16x16x32_bf16 v[136:139], a[216:219], v[244:247], v[136:139]
 ds_read_b64_tr_b16 a[240:241], v5 offset:2048
 buffer_load_dwordx4 v81, s[12:15], s21 offen offset:1024 lds
 v_mfma_f32_16x16x32_bf16 v[136:139], a[220:223], v[252:255], v[136:139]
 ds_read_b64_tr_b16 a[242:243], v5 offset:2560
 v_mfma_f32_16x16x32_bf16 v[104:107], a[220:223], v[248:251], v[104:107]
 ds_read_b64_tr_b16 a[244:245], v5 offset:10240
 v_mfma_f32_16x16x32_bf16 v[104:107], a[216:219], v[240:243], v[104:107]
 ds_read_b64_tr_b16 a[246:247], v5 offset:10752
 s_waitcnt lgkmcnt(8)
 v_mfma_f32_16x16x32_bf16 v[108:111], a[224:227], v[240:243], v[108:111]
 ds_read_b64_tr_b16 a[248:249], v6 offset:2048
 v_cvt_pk_bf16_f32 v32, v96, v97
 v_mfma_f32_16x16x32_bf16 v[108:111], a[228:231], v[248:251], v[108:111]
 ds_read_b64_tr_b16 a[250:251], v6 offset:2560
 v_cvt_pk_bf16_f32 v33, v98, v99
 v_mfma_f32_16x16x32_bf16 v[140:143], a[228:231], v[252:255], v[140:143]
 ds_read_b64_tr_b16 a[252:253], v6 offset:10240
 v_cvt_pk_bf16_f32 v34, v100, v101
 v_mfma_f32_16x16x32_bf16 v[140:143], a[224:227], v[244:247], v[140:143]
 ds_read_b64_tr_b16 a[254:255], v6 offset:10752
 s_waitcnt lgkmcnt(8)
 v_mfma_f32_16x16x32_bf16 v[144:147], v[244:247], a[232:235], v[144:147]
 ds_read_b64_tr_b16 a[216:217], v7 offset:2048
 buffer_load_dwordx4 v82, s[12:15], s21 offen offset:2048 lds
 v_mfma_f32_16x16x32_bf16 v[144:147], v[252:255], a[236:239], v[144:147]
 ds_read_b64_tr_b16 a[218:219], v7 offset:2560
 v_cvt_pk_bf16_f32 v35, v102, v103
 v_mfma_f32_16x16x32_bf16 v[112:115], v[248:251], a[236:239], v[112:115]
 ds_read_b64_tr_b16 a[220:221], v7 offset:10240
 buffer_store_dwordx4 v[32:35], v21, s[4:7], s33 offen sc1
 v_mfma_f32_16x16x32_bf16 v[112:115], v[240:243], a[232:235], v[112:115]
 ds_read_b64_tr_b16 a[222:223], v7 offset:10752
 s_waitcnt lgkmcnt(8)
 v_mfma_f32_16x16x32_bf16 v[116:119], v[240:243], a[240:243], v[116:119]
 s_barrier
 ds_read_b64_tr_b16 a[224:225], v12 offset:16384
 v_mfma_f32_16x16x32_bf16 v[116:119], v[248:251], a[244:247], v[116:119]
 ds_read_b64_tr_b16 a[226:227], v12 offset:16896
 v_cvt_pk_bf16_f32 v36, v128, v129
 v_mfma_f32_16x16x32_bf16 v[148:151], v[252:255], a[244:247], v[148:151]
 ds_read_b64_tr_b16 a[228:229], v12 offset:20480
 v_cvt_pk_bf16_f32 v37, v130, v131
 v_mfma_f32_16x16x32_bf16 v[148:151], v[244:247], a[240:243], v[148:151]
 ds_read_b64_tr_b16 a[230:231], v12 offset:20992
 s_waitcnt lgkmcnt(8)
 v_mfma_f32_16x16x32_bf16 v[152:155], v[244:247], a[248:251], v[152:155]
 ds_read_b64_tr_b16 a[232:233], v13 offset:16384
 buffer_load_dwordx4 v83, s[12:15], s21 offen offset:3072 lds
 v_mfma_f32_16x16x32_bf16 v[152:155], v[252:255], a[252:255], v[152:155]
 ds_read_b64_tr_b16 a[234:235], v13 offset:16896
 s_mov_b32 s21, 4718592
 v_mfma_f32_16x16x32_bf16 v[120:123], v[248:251], a[252:255], v[120:123]
 ds_read_b64_tr_b16 a[236:237], v13 offset:20480
 s_add_u32 m0, s19, 98304
 v_mfma_f32_16x16x32_bf16 v[120:123], v[240:243], a[248:251], v[120:123]
 ds_read_b64_tr_b16 a[238:239], v13 offset:20992
 s_waitcnt lgkmcnt(8)
 v_mfma_f32_16x16x32_bf16 v[124:127], v[240:243], a[216:219], v[124:127]
 ds_read_b64_tr_b16 a[240:241], v14 offset:16384
 v_cvt_pk_bf16_f32 v38, v132, v133
 v_mfma_f32_16x16x32_bf16 v[124:127], v[248:251], a[220:223], v[124:127]
 ds_read_b64_tr_b16 a[242:243], v14 offset:16896
 v_cvt_pk_bf16_f32 v39, v134, v135
 v_mfma_f32_16x16x32_bf16 v[156:159], v[252:255], a[220:223], v[156:159]
 ds_read_b64_tr_b16 a[244:245], v14 offset:20480
 buffer_store_dwordx4 v[36:39], v21, s[4:7], s33 offen offset:256 sc1
 v_mfma_f32_16x16x32_bf16 v[156:159], v[244:247], a[216:219], v[156:159]
 ds_read_b64_tr_b16 a[246:247], v14 offset:20992
 s_waitcnt lgkmcnt(8)
 v_mfma_f32_16x16x32_bf16 v[176:179], a[224:227], a[36:39], v[176:179]
 ds_read_b64_tr_b16 a[248:249], v15 offset:16384
 s_mov_b64 exec, 1
 buffer_store_short v74, v86, s[4:7], s28 offen sc1
 buffer_store_short v75, v86, s[4:7], s28 offen offset:16 sc1
 s_mov_b64 exec, -1
 v_mfma_f32_16x16x32_bf16 v[176:179], a[228:231], a[44:47], v[176:179]
 ds_read_b64_tr_b16 a[250:251], v15 offset:16896
 v_cvt_pk_bf16_f32 v40, v104, v105
 v_mfma_f32_16x16x32_bf16 v[160:163], a[228:231], a[40:43], v[160:163]
 ds_read_b64_tr_b16 a[252:253], v15 offset:20480
 v_cvt_pk_bf16_f32 v41, v106, v107
 v_mfma_f32_16x16x32_bf16 v[160:163], a[224:227], a[32:35], v[160:163]
 ds_read_b64_tr_b16 a[254:255], v15 offset:20992
 s_waitcnt lgkmcnt(8)
 v_mfma_f32_16x16x32_bf16 v[164:167], a[232:235], a[32:35], v[164:167]
 ds_read_b64_tr_b16 a[216:217], v12 offset:24576
 v_cvt_pk_bf16_f32 v42, v108, v109
 v_mfma_f32_16x16x32_bf16 v[164:167], a[236:239], a[40:43], v[164:167]
 ds_read_b64_tr_b16 a[218:219], v12 offset:25088
 v_cvt_pk_bf16_f32 v43, v110, v111
 v_mfma_f32_16x16x32_bf16 v[180:183], a[236:239], a[44:47], v[180:183]
 ds_read_b64_tr_b16 a[220:221], v12 offset:28672
 buffer_store_dwordx4 v[40:43], v21, s[4:7], s34 offen sc1
 v_mfma_f32_16x16x32_bf16 v[180:183], a[232:235], a[36:39], v[180:183]
 ds_read_b64_tr_b16 a[222:223], v12 offset:29184
 s_waitcnt lgkmcnt(8)
 v_mfma_f32_16x16x32_bf16 v[184:187], a[240:243], a[36:39], v[184:187]
 ds_read_b64_tr_b16 a[224:225], v13 offset:24576
 v_mfma_f32_16x16x32_bf16 v[184:187], a[244:247], a[44:47], v[184:187]
 ds_read_b64_tr_b16 a[226:227], v13 offset:25088
 v_cvt_pk_bf16_f32 v44, v136, v137
 v_mfma_f32_16x16x32_bf16 v[168:171], a[244:247], a[40:43], v[168:171]
 ds_read_b64_tr_b16 a[228:229], v13 offset:28672
 v_cvt_pk_bf16_f32 v45, v138, v139
 v_mfma_f32_16x16x32_bf16 v[168:171], a[240:243], a[32:35], v[168:171]
 ds_read_b64_tr_b16 a[230:231], v13 offset:29184
 s_waitcnt lgkmcnt(8)
 v_mfma_f32_16x16x32_bf16 v[172:175], a[248:251], a[32:35], v[172:175]
 ds_read_b64_tr_b16 a[232:233], v14 offset:24576
 v_cvt_pk_bf16_f32 v46, v140, v141
 v_mfma_f32_16x16x32_bf16 v[172:175], a[252:255], a[40:43], v[172:175]
 ds_read_b64_tr_b16 a[234:235], v14 offset:25088
 v_cvt_pk_bf16_f32 v47, v142, v143
 v_mfma_f32_16x16x32_bf16 v[188:191], a[252:255], a[44:47], v[188:191]
 ds_read_b64_tr_b16 a[236:237], v14 offset:28672
 buffer_store_dwordx4 v[44:47], v21, s[4:7], s34 offen offset:256 sc1
 v_mfma_f32_16x16x32_bf16 v[188:191], a[248:251], a[36:39], v[188:191]
 ds_read_b64_tr_b16 a[238:239], v14 offset:29184
 s_waitcnt lgkmcnt(8)
 v_mfma_f32_16x16x32_bf16 v[176:179], a[216:219], a[52:55], v[176:179]
 ds_read_b64_tr_b16 a[240:241], v15 offset:24576
 v_mfma_f32_16x16x32_bf16 v[176:179], a[220:223], a[60:63], v[176:179]
 ds_read_b64_tr_b16 a[242:243], v15 offset:25088
 v_cvt_pk_bf16_f32 v48, v112, v113
 v_mfma_f32_16x16x32_bf16 v[160:163], a[220:223], a[56:59], v[160:163]
 ds_read_b64_tr_b16 a[244:245], v15 offset:28672
 v_cvt_pk_bf16_f32 v49, v114, v115
 v_mfma_f32_16x16x32_bf16 v[160:163], a[216:219], a[48:51], v[160:163]
 ds_read_b64_tr_b16 a[246:247], v15 offset:29184
 s_waitcnt lgkmcnt(8)
 v_mfma_f32_16x16x32_bf16 v[164:167], a[224:227], a[48:51], v[164:167]
 s_barrier
 ds_read_b64_tr_b16 a[248:249], v12 offset:32768
 v_mfma_f32_16x16x32_bf16 v[164:167], a[228:231], a[56:59], v[164:167]
 ds_read_b64_tr_b16 a[250:251], v12 offset:33280
 v_cvt_pk_bf16_f32 v50, v144, v145
 v_mfma_f32_16x16x32_bf16 v[180:183], a[228:231], a[60:63], v[180:183]
 ds_read_b64_tr_b16 a[252:253], v12 offset:36864
 v_cvt_pk_bf16_f32 v51, v146, v147
 v_mfma_f32_16x16x32_bf16 v[180:183], a[224:227], a[52:55], v[180:183]
 ds_read_b64_tr_b16 a[254:255], v12 offset:37376
 s_waitcnt lgkmcnt(8)
 v_mfma_f32_16x16x32_bf16 v[184:187], a[232:235], a[52:55], v[184:187]
 ds_read_b64_tr_b16 a[216:217], v13 offset:32768
 buffer_store_dwordx4 v[48:51], v27, s[4:7], s33 offen offset:2048 sc1
 v_mfma_f32_16x16x32_bf16 v[184:187], a[236:239], a[60:63], v[184:187]
 ds_read_b64_tr_b16 a[218:219], v13 offset:33280
 v_mfma_f32_16x16x32_bf16 v[168:171], a[236:239], a[56:59], v[168:171]
 ds_read_b64_tr_b16 a[220:221], v13 offset:36864
 v_mfma_f32_16x16x32_bf16 v[168:171], a[232:235], a[48:51], v[168:171]
 ds_read_b64_tr_b16 a[222:223], v13 offset:37376
 s_waitcnt lgkmcnt(8)
 v_mfma_f32_16x16x32_bf16 v[172:175], a[240:243], a[48:51], v[172:175]
 ds_read_b64_tr_b16 a[224:225], v14 offset:32768
 v_cvt_pk_bf16_f32 v52, v116, v117
 v_mfma_f32_16x16x32_bf16 v[172:175], a[244:247], a[56:59], v[172:175]
 ds_read_b64_tr_b16 a[226:227], v14 offset:33280
 v_cvt_pk_bf16_f32 v53, v118, v119
 v_mfma_f32_16x16x32_bf16 v[188:191], a[244:247], a[60:63], v[188:191]
 ds_read_b64_tr_b16 a[228:229], v14 offset:36864
 v_cvt_pk_bf16_f32 v54, v148, v149
 v_mfma_f32_16x16x32_bf16 v[188:191], a[240:243], a[52:55], v[188:191]
 ds_read_b64_tr_b16 a[230:231], v14 offset:37376
 s_waitcnt lgkmcnt(8)
 v_mfma_f32_16x16x32_bf16 v[176:179], a[248:251], a[68:71], v[176:179]
 ds_read_b64_tr_b16 a[232:233], v15 offset:32768
 v_cvt_pk_bf16_f32 v55, v150, v151
 v_mfma_f32_16x16x32_bf16 v[176:179], a[252:255], a[76:79], v[176:179]
 ds_read_b64_tr_b16 a[234:235], v15 offset:33280
 buffer_store_dwordx4 v[52:55], v27, s[4:7], s33 offen offset:2304 sc1
 v_mfma_f32_16x16x32_bf16 v[160:163], a[252:255], a[72:75], v[160:163]
 ds_read_b64_tr_b16 a[236:237], v15 offset:36864
 v_mfma_f32_16x16x32_bf16 v[160:163], a[248:251], a[64:67], v[160:163]
 ds_read_b64_tr_b16 a[238:239], v15 offset:37376
 s_waitcnt lgkmcnt(8)
 v_mfma_f32_16x16x32_bf16 v[164:167], a[216:219], a[64:67], v[164:167]
 ds_read_b64_tr_b16 a[240:241], v12 offset:40960
 v_cvt_pk_bf16_f32 v56, v120, v121
 v_mfma_f32_16x16x32_bf16 v[164:167], a[220:223], a[72:75], v[164:167]
 ds_read_b64_tr_b16 a[242:243], v12 offset:41472
 v_cvt_pk_bf16_f32 v57, v122, v123
 v_mfma_f32_16x16x32_bf16 v[180:183], a[220:223], a[76:79], v[180:183]
 ds_read_b64_tr_b16 a[244:245], v12 offset:45056
 v_cvt_pk_bf16_f32 v58, v152, v153
 v_mfma_f32_16x16x32_bf16 v[180:183], a[216:219], a[68:71], v[180:183]
 ds_read_b64_tr_b16 a[246:247], v12 offset:45568
 s_waitcnt lgkmcnt(8)
 v_mfma_f32_16x16x32_bf16 v[184:187], a[224:227], a[68:71], v[184:187]
 ds_read_b64_tr_b16 a[248:249], v13 offset:40960
 v_cvt_pk_bf16_f32 v59, v154, v155
 v_mfma_f32_16x16x32_bf16 v[184:187], a[228:231], a[76:79], v[184:187]
 ds_read_b64_tr_b16 a[250:251], v13 offset:41472
 buffer_store_dwordx4 v[56:59], v27, s[4:7], s34 offen offset:2048 sc1
 v_mfma_f32_16x16x32_bf16 v[168:171], a[228:231], a[72:75], v[168:171]
 ds_read_b64_tr_b16 a[252:253], v13 offset:45056
 v_mfma_f32_16x16x32_bf16 v[168:171], a[224:227], a[64:67], v[168:171]
 ds_read_b64_tr_b16 a[254:255], v13 offset:45568
 s_waitcnt lgkmcnt(8)
 v_mfma_f32_16x16x32_bf16 v[172:175], a[232:235], a[64:67], v[172:175]
 ds_read_b64_tr_b16 a[216:217], v14 offset:40960
 v_cvt_pk_bf16_f32 v60, v124, v125
 v_mfma_f32_16x16x32_bf16 v[172:175], a[236:239], a[72:75], v[172:175]
 ds_read_b64_tr_b16 a[218:219], v14 offset:41472
 v_cvt_pk_bf16_f32 v61, v126, v127
 v_mfma_f32_16x16x32_bf16 v[188:191], a[236:239], a[76:79], v[188:191]
 ds_read_b64_tr_b16 a[220:221], v14 offset:45056
 v_cvt_pk_bf16_f32 v62, v156, v157
 v_mfma_f32_16x16x32_bf16 v[188:191], a[232:235], a[68:71], v[188:191]
 ds_read_b64_tr_b16 a[222:223], v14 offset:45568
 s_waitcnt lgkmcnt(8)
 v_mfma_f32_16x16x32_bf16 v[176:179], a[240:243], a[84:87], v[176:179]
 ds_read_b64_tr_b16 a[224:225], v15 offset:40960
 v_cvt_pk_bf16_f32 v63, v158, v159
 v_mfma_f32_16x16x32_bf16 v[176:179], a[244:247], a[92:95], v[176:179]
 ds_read_b64_tr_b16 a[226:227], v15 offset:41472
 buffer_store_dwordx4 v[60:63], v27, s[4:7], s34 offen offset:2304 sc1
 v_mfma_f32_16x16x32_bf16 v[160:163], a[244:247], a[88:91], v[160:163]
 ds_read_b64_tr_b16 a[228:229], v15 offset:45056
 v_mov_b32 v112, 0
 v_mfma_f32_16x16x32_bf16 v[160:163], a[240:243], a[80:83], v[160:163]
 ds_read_b64_tr_b16 a[230:231], v15 offset:45568
 s_waitcnt lgkmcnt(8)
 v_mfma_f32_16x16x32_bf16 v[164:167], a[248:251], a[80:83], v[164:167]
 s_waitcnt vmcnt(18)
 s_barrier
 ds_read_b64_tr_b16 a[232:233], v12 offset:49152
 v_mfma_f32_16x16x32_bf16 v[164:167], a[252:255], a[88:91], v[164:167]
 ds_read_b64_tr_b16 a[234:235], v12 offset:49664
 v_mov_b32 v113, 0
 v_mfma_f32_16x16x32_bf16 v[180:183], a[252:255], a[92:95], v[180:183]
 ds_read_b64_tr_b16 a[236:237], v12 offset:53248
 v_mov_b32 v114, 0
 v_mfma_f32_16x16x32_bf16 v[180:183], a[248:251], a[84:87], v[180:183]
 ds_read_b64_tr_b16 a[238:239], v12 offset:53760
 s_waitcnt lgkmcnt(8)
 v_mfma_f32_16x16x32_bf16 v[184:187], a[216:219], a[84:87], v[184:187]
 ds_read_b64_tr_b16 a[240:241], v13 offset:49152
 v_mov_b32 v115, 0
 v_mfma_f32_16x16x32_bf16 v[184:187], a[220:223], a[92:95], v[184:187]
 ds_read_b64_tr_b16 a[242:243], v13 offset:49664
 v_mov_b32 v116, 0
 v_mfma_f32_16x16x32_bf16 v[168:171], a[220:223], a[88:91], v[168:171]
 ds_read_b64_tr_b16 a[244:245], v13 offset:53248
 v_mov_b32 v117, 0
 v_mfma_f32_16x16x32_bf16 v[168:171], a[216:219], a[80:83], v[168:171]
 ds_read_b64_tr_b16 a[246:247], v13 offset:53760
 s_waitcnt lgkmcnt(8)
 v_mfma_f32_16x16x32_bf16 v[172:175], a[224:227], a[80:83], v[172:175]
 ds_read_b64_tr_b16 a[248:249], v14 offset:49152
 v_mov_b32 v118, 0
 v_mfma_f32_16x16x32_bf16 v[172:175], a[228:231], a[88:91], v[172:175]
 ds_read_b64_tr_b16 a[250:251], v14 offset:49664
 v_mov_b32 v119, 0
 v_mfma_f32_16x16x32_bf16 v[188:191], a[228:231], a[92:95], v[188:191]
 ds_read_b64_tr_b16 a[252:253], v14 offset:53248
 v_mov_b32 v120, 0
 v_mfma_f32_16x16x32_bf16 v[188:191], a[224:227], a[84:87], v[188:191]
 ds_read_b64_tr_b16 a[254:255], v14 offset:53760
 s_waitcnt lgkmcnt(8)
 v_mfma_f32_16x16x32_bf16 v[176:179], a[232:235], a[100:103], v[176:179]
 ds_read_b64_tr_b16 a[216:217], v15 offset:49152
 buffer_load_dwordx4 v80, s[12:15], s21 offen lds
 v_mfma_f32_16x16x32_bf16 v[176:179], a[236:239], a[108:111], v[176:179]
 ds_read_b64_tr_b16 a[218:219], v15 offset:49664
 v_mov_b32 v121, 0
 v_mfma_f32_16x16x32_bf16 v[160:163], a[236:239], a[104:107], v[160:163]
 ds_read_b64_tr_b16 a[220:221], v15 offset:53248
 v_mov_b32 v122, 0
 v_mfma_f32_16x16x32_bf16 v[160:163], a[232:235], a[96:99], v[160:163]
 ds_read_b64_tr_b16 a[222:223], v15 offset:53760
 s_waitcnt lgkmcnt(8)
 v_mfma_f32_16x16x32_bf16 v[164:167], a[240:243], a[96:99], v[164:167]
 ds_read_b64_tr_b16 a[224:225], v12 offset:57344
 v_mov_b32 v123, 0
 v_mfma_f32_16x16x32_bf16 v[164:167], a[244:247], a[104:107], v[164:167]
 ds_read_b64_tr_b16 a[226:227], v12 offset:57856
 v_mov_b32 v124, 0
 v_mfma_f32_16x16x32_bf16 v[180:183], a[244:247], a[108:111], v[180:183]
 ds_read_b64_tr_b16 a[228:229], v12 offset:61440
 v_mov_b32 v125, 0
 v_mfma_f32_16x16x32_bf16 v[180:183], a[240:243], a[100:103], v[180:183]
 ds_read_b64_tr_b16 a[230:231], v12 offset:61952
 s_waitcnt lgkmcnt(8)
 v_mfma_f32_16x16x32_bf16 v[184:187], a[248:251], a[100:103], v[184:187]
 ds_read_b64_tr_b16 a[232:233], v13 offset:57344
 buffer_load_dwordx4 v81, s[12:15], s21 offen offset:1024 lds
 v_mfma_f32_16x16x32_bf16 v[184:187], a[252:255], a[108:111], v[184:187]
 ds_read_b64_tr_b16 a[234:235], v13 offset:57856
 v_mov_b32 v126, 0
 v_mfma_f32_16x16x32_bf16 v[168:171], a[252:255], a[104:107], v[168:171]
 ds_read_b64_tr_b16 a[236:237], v13 offset:61440
 v_mov_b32 v127, 0
 v_mfma_f32_16x16x32_bf16 v[168:171], a[248:251], a[96:99], v[168:171]
L_hop_3:
 s_cbranch_execz L_ret_0
 ds_read_b64_tr_b16 a[238:239], v13 offset:61952
 s_waitcnt lgkmcnt(8)
 v_mfma_f32_16x16x32_bf16 v[172:175], a[216:219], a[96:99], v[172:175]
 ds_read_b64_tr_b16 a[240:241], v14 offset:57344
 v_mov_b32 v128, 0
 v_mfma_f32_16x16x32_bf16 v[172:175], a[220:223], a[104:107], v[172:175]
 ds_read_b64_tr_b16 a[242:243], v14 offset:57856
 v_mov_b32 v129, 0
 v_mfma_f32_16x16x32_bf16 v[188:191], a[220:223], a[108:111], v[188:191]
 ds_read_b64_tr_b16 a[244:245], v14 offset:61440
 v_mov_b32 v130, 0
 v_mfma_f32_16x16x32_bf16 v[188:191], a[216:219], a[100:103], v[188:191]
 ds_read_b64_tr_b16 a[246:247], v14 offset:61952
 s_waitcnt lgkmcnt(8)
 v_mfma_f32_16x16x32_bf16 v[176:179], a[224:227], a[116:119], v[176:179]
 ds_read_b64_tr_b16 a[248:249], v15 offset:57344
 buffer_load_dwordx4 v82, s[12:15], s21 offen offset:2048 lds
 v_mfma_f32_16x16x32_bf16 v[176:179], a[228:231], a[124:127], v[176:179]
 ds_read_b64_tr_b16 a[250:251], v15 offset:57856
 v_mov_b32 v131, 0
 v_mfma_f32_16x16x32_bf16 v[160:163], a[228:231], a[120:123], v[160:163]
 ds_read_b64_tr_b16 a[252:253], v15 offset:61440
 v_mov_b32 v132, 0
 v_mfma_f32_16x16x32_bf16 v[160:163], a[224:227], a[112:115], v[160:163]
 ds_read_b64_tr_b16 a[254:255], v15 offset:61952
 s_waitcnt lgkmcnt(8)
 v_mfma_f32_16x16x32_bf16 v[164:167], a[232:235], a[112:115], v[164:167]
 s_waitcnt vmcnt(17)
 s_barrier
 ds_read_b64_tr_b16 a[216:217], v16
 v_mfma_f32_16x16x32_bf16 v[164:167], a[236:239], a[120:123], v[164:167]
 ds_read_b64_tr_b16 a[218:219], v16 offset:512
 v_mov_b32 v133, 0
 v_mfma_f32_16x16x32_bf16 v[180:183], a[236:239], a[124:127], v[180:183]
 ds_read_b64_tr_b16 a[220:221], v16 offset:4096
 v_mov_b32 v134, 0
 v_mfma_f32_16x16x32_bf16 v[180:183], a[232:235], a[116:119], v[180:183]
 ds_read_b64_tr_b16 a[222:223], v16 offset:4608
 s_waitcnt lgkmcnt(8)
 v_mfma_f32_16x16x32_bf16 v[184:187], a[240:243], a[116:119], v[184:187]
 ds_read_b64_tr_b16 a[224:225], v17
 buffer_load_dwordx4 v83, s[12:15], s21 offen offset:3072 lds
 v_mfma_f32_16x16x32_bf16 v[184:187], a[244:247], a[124:127], v[184:187]
 ds_read_b64_tr_b16 a[226:227], v17 offset:512
 s_mov_b32 s21, 5505024
 v_mfma_f32_16x16x32_bf16 v[168:171], a[244:247], a[120:123], v[168:171]
 ds_read_b64_tr_b16 a[228:229], v17 offset:4096
 s_add_u32 m0, s19, 114688
 v_mfma_f32_16x16x32_bf16 v[168:171], a[240:243], a[112:115], v[168:171]
 ds_read_b64_tr_b16 a[230:231], v17 offset:4608
 s_waitcnt lgkmcnt(8)
 v_mfma_f32_16x16x32_bf16 v[172:175], a[248:251], a[112:115], v[172:175]
 ds_read_b64_tr_b16 a[232:233], v18
 v_mov_b32 v135, 0
 v_mfma_f32_16x16x32_bf16 v[172:175], a[252:255], a[120:123], v[172:175]
 ds_read_b64_tr_b16 a[234:235], v18 offset:512
 v_mov_b32 v136, 0
 v_mfma_f32_16x16x32_bf16 v[188:191], a[252:255], a[124:127], v[188:191]
 ds_read_b64_tr_b16 a[236:237], v18 offset:4096
 v_mov_b32 v137, 0
 v_mfma_f32_16x16x32_bf16 v[188:191], a[248:251], a[116:119], v[188:191]
 ds_read_b64_tr_b16 a[238:239], v18 offset:4608
 s_waitcnt lgkmcnt(8)
 v_mfma_f32_16x16x32_bf16 v[176:179], a[216:219], a[132:135], v[176:179]
 ds_read_b64_tr_b16 a[240:241], v19
 buffer_load_dwordx4 v80, s[12:15], s21 offen lds
 v_mfma_f32_16x16x32_bf16 v[176:179], a[220:223], a[140:143], v[176:179]
 ds_read_b64_tr_b16 a[242:243], v19 offset:512
 v_mov_b32 v138, 0
 v_mfma_f32_16x16x32_bf16 v[160:163], a[220:223], a[136:139], v[160:163]
 ds_read_b64_tr_b16 a[244:245], v19 offset:4096
 v_mov_b32 v139, 0
 v_mfma_f32_16x16x32_bf16 v[160:163], a[216:219], a[128:131], v[160:163]
 ds_read_b64_tr_b16 a[246:247], v19 offset:4608
 s_waitcnt lgkmcnt(8)
 v_mfma_f32_16x16x32_bf16 v[164:167], a[224:227], a[128:131], v[164:167]
 ds_read_b64_tr_b16 a[248:249], v16 offset:8192
 v_mov_b32 v140, 0
 v_mfma_f32_16x16x32_bf16 v[164:167], a[228:231], a[136:139], v[164:167]
 ds_read_b64_tr_b16 a[250:251], v16 offset:8704
 v_mov_b32 v141, 0
 v_mfma_f32_16x16x32_bf16 v[180:183], a[228:231], a[140:143], v[180:183]
 ds_read_b64_tr_b16 a[252:253], v16 offset:12288
 v_mov_b32 v142, 0
 v_mfma_f32_16x16x32_bf16 v[180:183], a[224:227], a[132:135], v[180:183]
 ds_read_b64_tr_b16 a[254:255], v16 offset:12800
 s_waitcnt lgkmcnt(8)
 v_mfma_f32_16x16x32_bf16 v[184:187], a[232:235], a[132:135], v[184:187]
 ds_read_b64_tr_b16 a[216:217], v17 offset:8192
 buffer_load_dwordx4 v81, s[12:15], s21 offen offset:1024 lds
 v_mfma_f32_16x16x32_bf16 v[184:187], a[236:239], a[140:143], v[184:187]
 ds_read_b64_tr_b16 a[218:219], v17 offset:8704
 v_mov_b32 v143, 0
 v_mfma_f32_16x16x32_bf16 v[168:171], a[236:239], a[136:139], v[168:171]
 ds_read_b64_tr_b16 a[220:221], v17 offset:12288
 v_mov_b32 v144, 0
 v_mfma_f32_16x16x32_bf16 v[168:171], a[232:235], a[128:131], v[168:171]
 ds_read_b64_tr_b16 a[222:223], v17 offset:12800
 s_waitcnt lgkmcnt(8)
 v_mfma_f32_16x16x32_bf16 v[172:175], a[240:243], a[128:131], v[172:175]
 ds_read_b64_tr_b16 a[224:225], v18 offset:8192
 v_mov_b32 v145, 0
 v_mfma_f32_16x16x32_bf16 v[172:175], a[244:247], a[136:139], v[172:175]
 ds_read_b64_tr_b16 a[226:227], v18 offset:8704
 v_mov_b32 v146, 0
 v_mfma_f32_16x16x32_bf16 v[188:191], a[244:247], a[140:143], v[188:191]
 ds_read_b64_tr_b16 a[228:229], v18 offset:12288
 v_mov_b32 v147, 0
 v_mfma_f32_16x16x32_bf16 v[188:191], a[240:243], a[132:135], v[188:191]
 ds_read_b64_tr_b16 a[230:231], v18 offset:12800
 s_waitcnt lgkmcnt(8)
 v_mfma_f32_16x16x32_bf16 v[176:179], a[248:251], a[148:151], v[176:179]
 ds_read_b64_tr_b16 a[232:233], v19 offset:8192
 buffer_load_dwordx4 v82, s[12:15], s21 offen offset:2048 lds
 v_mfma_f32_16x16x32_bf16 v[176:179], a[252:255], a[156:159], v[176:179]
 ds_read_b64_tr_b16 a[234:235], v19 offset:8704
 v_mov_b32 v148, 0
 v_mfma_f32_16x16x32_bf16 v[160:163], a[252:255], a[152:155], v[160:163]
 ds_read_b64_tr_b16 a[236:237], v19 offset:12288
 v_mov_b32 v149, 0
 v_mfma_f32_16x16x32_bf16 v[160:163], a[248:251], a[144:147], v[160:163]
 ds_read_b64_tr_b16 a[238:239], v19 offset:12800
 s_waitcnt lgkmcnt(8)
 v_mfma_f32_16x16x32_bf16 v[164:167], a[216:219], a[144:147], v[164:167]
 s_waitcnt vmcnt(7)
 s_barrier
 ds_read_b64_tr_b16 a[240:241], v16 offset:16384
 v_mfma_f32_16x16x32_bf16 v[164:167], a[220:223], a[152:155], v[164:167]
 ds_read_b64_tr_b16 a[242:243], v16 offset:16896
 s_cmp_lg_u32 s16, 0
 s_cbranch_scc1 L_arrived_12
 s_sub_u32 s67, s32, s0
 s_mov_b64 exec, 0xff
 buffer_atomic_add v85, v87, s[4:7], s67 offen sc1
 s_mov_b64 exec, -1
L_arrived_12:
 v_mfma_f32_16x16x32_bf16 v[180:183], a[220:223], a[156:159], v[180:183]
 ds_read_b64_tr_b16 a[244:245], v16 offset:20480
 v_mov_b32 v150, 0
 v_mfma_f32_16x16x32_bf16 v[180:183], a[216:219], a[148:151], v[180:183]
 ds_read_b64_tr_b16 a[246:247], v16 offset:20992
 s_waitcnt lgkmcnt(8)
 v_mfma_f32_16x16x32_bf16 v[184:187], a[224:227], a[148:151], v[184:187]
 ds_read_b64_tr_b16 a[248:249], v17 offset:16384
 buffer_load_dwordx4 v83, s[12:15], s21 offen offset:3072 lds
 v_mfma_f32_16x16x32_bf16 v[184:187], a[228:231], a[156:159], v[184:187]
 ds_read_b64_tr_b16 a[250:251], v17 offset:16896
 s_mov_b32 m0, s19
 v_mfma_f32_16x16x32_bf16 v[168:171], a[228:231], a[152:155], v[168:171]
 ds_read_b64_tr_b16 a[252:253], v17 offset:20480
 buffer_load_dwordx4 v206, s[8:11], s30 offen sc1 lds
 v_mfma_f32_16x16x32_bf16 v[168:171], a[224:227], a[144:147], v[168:171]
 ds_read_b64_tr_b16 a[254:255], v17 offset:20992
 s_waitcnt lgkmcnt(8)
 v_mfma_f32_16x16x32_bf16 v[172:175], a[232:235], a[144:147], v[172:175]
 ds_read_b64_tr_b16 a[216:217], v18 offset:16384
 s_add_u32 s22, s30, 8192
 v_mfma_f32_16x16x32_bf16 v[172:175], a[236:239], a[152:155], v[172:175]
 ds_read_b64_tr_b16 a[218:219], v18 offset:16896
 v_mov_b32 v151, 0
 v_mfma_f32_16x16x32_bf16 v[188:191], a[236:239], a[156:159], v[188:191]
 ds_read_b64_tr_b16 a[220:221], v18 offset:20480
 buffer_load_dwordx4 v206, s[8:11], s30 offen offset:1024 sc1 lds
 v_mfma_f32_16x16x32_bf16 v[188:191], a[232:235], a[148:151], v[188:191]
 ds_read_b64_tr_b16 a[222:223], v18 offset:20992
 s_waitcnt lgkmcnt(8)
 v_mfma_f32_16x16x32_bf16 v[176:179], a[240:243], a[164:167], v[176:179]
 ds_read_b64_tr_b16 a[224:225], v19 offset:16384
 s_and_b32 s22, s22, 0x3ffff
 v_mfma_f32_16x16x32_bf16 v[176:179], a[244:247], a[172:175], v[176:179]
 ds_read_b64_tr_b16 a[226:227], v19 offset:16896
 v_mov_b32 v152, v204
 v_mfma_f32_16x16x32_bf16 v[160:163], a[244:247], a[168:171], v[160:163]
 ds_read_b64_tr_b16 a[228:229], v19 offset:20480
 buffer_load_dwordx4 v1, s[8:11], s30 offen offset:2048 sc1 lds
 v_mfma_f32_16x16x32_bf16 v[160:163], a[240:243], a[160:163], v[160:163]
 ds_read_b64_tr_b16 a[230:231], v19 offset:20992
 s_waitcnt lgkmcnt(8)
 v_mfma_f32_16x16x32_bf16 v[164:167], a[248:251], a[160:163], v[164:167]
 ds_read_b64_tr_b16 a[232:233], v16 offset:24576
 v_mov_b32 v153, v204
 v_mfma_f32_16x16x32_bf16 v[164:167], a[252:255], a[168:171], v[164:167]
 ds_read_b64_tr_b16 a[234:235], v16 offset:25088
 v_mov_b32 v154, v205
 v_mfma_f32_16x16x32_bf16 v[180:183], a[252:255], a[172:175], v[180:183]
 ds_read_b64_tr_b16 a[236:237], v16 offset:28672
 buffer_load_dwordx4 v1, s[8:11], s30 offen offset:3072 sc1 lds
 v_mfma_f32_16x16x32_bf16 v[180:183], a[248:251], a[164:167], v[180:183]
 ds_read_b64_tr_b16 a[238:239], v16 offset:29184
 s_waitcnt lgkmcnt(8)
 v_mfma_f32_16x16x32_bf16 v[184:187], a[216:219], a[164:167], v[184:187]
 ds_read_b64_tr_b16 a[240:241], v17 offset:24576
 s_add_u32 m0, s19, 16384
 v_mfma_f32_16x16x32_bf16 v[184:187], a[220:223], a[172:175], v[184:187]
 ds_read_b64_tr_b16 a[242:243], v17 offset:25088
 v_mov_b32 v155, v205
 v_mfma_f32_16x16x32_bf16 v[168:171], a[220:223], a[168:171], v[168:171]
 ds_read_b64_tr_b16 a[244:245], v17 offset:28672
 buffer_load_dwordx4 v206, s[8:11], s22 offen sc1 lds
 v_mfma_f32_16x16x32_bf16 v[168:171], a[216:219], a[160:163], v[168:171]
 ds_read_b64_tr_b16 a[246:247], v17 offset:29184
 s_waitcnt lgkmcnt(8)
 v_mfma_f32_16x16x32_bf16 v[172:175], a[224:227], a[160:163], v[172:175]
 ds_read_b64_tr_b16 a[248:249], v18 offset:24576
 s_add_u32 s30, s22, 8192
 v_mfma_f32_16x16x32_bf16 v[172:175], a[228:231], a[168:171], v[172:175]
 ds_read_b64_tr_b16 a[250:251], v18 offset:25088
 v_mov_b32 v156, 0xdddd
 v_mfma_f32_16x16x32_bf16 v[188:191], a[228:231], a[172:175], v[188:191]
 ds_read_b64_tr_b16 a[252:253], v18 offset:28672
 buffer_load_dwordx4 v206, s[8:11], s22 offen offset:1024 sc1 lds
 v_mfma_f32_16x16x32_bf16 v[188:191], a[224:227], a[164:167], v[188:191]
 ds_read_b64_tr_b16 a[254:255], v18 offset:29184
 s_waitcnt lgkmcnt(8)
 v_mfma_f32_16x16x32_bf16 v[176:179], a[232:235], a[180:183], v[176:179]
 ds_read_b64_tr_b16 a[216:217], v19 offset:24576
 s_and_b32 s30, s30, 0x3ffff
 v_mfma_f32_16x16x32_bf16 v[176:179], a[236:239], a[188:191], v[176:179]
 ds_read_b64_tr_b16 a[218:219], v19 offset:25088
 v_mfma_f32_16x16x32_bf16 v[160:163], a[236:239], a[184:187], v[160:163]
 ds_read_b64_tr_b16 a[220:221], v19 offset:28672
 buffer_load_dwordx4 v1, s[8:11], s22 offen offset:2048 sc1 lds
 v_mfma_f32_16x16x32_bf16 v[160:163], a[232:235], a[176:179], v[160:163]
 ds_read_b64_tr_b16 a[222:223], v19 offset:29184
 s_waitcnt lgkmcnt(8)
 v_mfma_f32_16x16x32_bf16 v[164:167], a[240:243], a[176:179], v[164:167]
 s_waitcnt vmcnt(11)
 s_barrier
 ds_read_b64_tr_b16 a[224:225], v16 offset:32768
 v_mfma_f32_16x16x32_bf16 v[164:167], a[244:247], a[184:187], v[164:167]
 ds_read_b64_tr_b16 a[226:227], v16 offset:33280
 v_mfma_f32_16x16x32_bf16 v[180:183], a[244:247], a[188:191], v[180:183]
 ds_read_b64_tr_b16 a[228:229], v16 offset:36864
 buffer_load_dwordx4 v1, s[8:11], s22 offen offset:3072 sc1 lds
 v_mfma_f32_16x16x32_bf16 v[180:183], a[240:243], a[180:183], v[180:183]
 ds_read_b64_tr_b16 a[230:231], v16 offset:37376
 s_waitcnt lgkmcnt(8)
 v_mfma_f32_16x16x32_bf16 v[184:187], a[248:251], a[180:183], v[184:187]
 ds_read_b64_tr_b16 a[232:233], v17 offset:32768
 v_mfma_f32_16x16x32_bf16 v[184:187], a[252:255], a[188:191], v[184:187]
 ds_read_b64_tr_b16 a[234:235], v17 offset:33280
 v_mfma_f32_16x16x32_bf16 v[168:171], a[252:255], a[184:187], v[168:171]
 ds_read_b64_tr_b16 a[236:237], v17 offset:36864
 v_mfma_f32_16x16x32_bf16 v[168:171], a[248:251], a[176:179], v[168:171]
 ds_read_b64_tr_b16 a[238:239], v17 offset:37376
 s_waitcnt lgkmcnt(8)
 v_mfma_f32_16x16x32_bf16 v[172:175], a[216:219], a[176:179], v[172:175]
 ds_read_b64_tr_b16 a[240:241], v18 offset:32768
 v_mfma_f32_16x16x32_bf16 v[172:175], a[220:223], a[184:187], v[172:175]
 ds_read_b64_tr_b16 a[242:243], v18 offset:33280
 v_mfma_f32_16x16x32_bf16 v[188:191], a[220:223], a[188:191], v[188:191]
 ds_read_b64_tr_b16 a[244:245], v18 offset:36864
 v_mfma_f32_16x16x32_bf16 v[188:191], a[216:219], a[180:183], v[188:191]
 ds_read_b64_tr_b16 a[246:247], v18 offset:37376
 s_waitcnt lgkmcnt(8)
 v_mfma_f32_16x16x32_bf16 v[176:179], a[224:227], a[196:199], v[176:179]
 ds_read_b64_tr_b16 a[248:249], v19 offset:32768
 v_mfma_f32_16x16x32_bf16 v[176:179], a[228:231], a[204:207], v[176:179]
 ds_read_b64_tr_b16 a[250:251], v19 offset:33280
 v_mfma_f32_16x16x32_bf16 v[160:163], a[228:231], a[200:203], v[160:163]
 ds_read_b64_tr_b16 a[252:253], v19 offset:36864
 v_mfma_f32_16x16x32_bf16 v[160:163], a[224:227], a[192:195], v[160:163]
 ds_read_b64_tr_b16 a[254:255], v19 offset:37376
 s_waitcnt lgkmcnt(8)
 v_mfma_f32_16x16x32_bf16 v[164:167], a[232:235], a[192:195], v[164:167]
 ds_read_b64_tr_b16 a[216:217], v16 offset:40960
 v_mfma_f32_16x16x32_bf16 v[164:167], a[236:239], a[200:203], v[164:167]
 ds_read_b64_tr_b16 a[218:219], v16 offset:41472
 v_mfma_f32_16x16x32_bf16 v[180:183], a[236:239], a[204:207], v[180:183]
 ds_read_b64_tr_b16 a[220:221], v16 offset:45056
 v_mfma_f32_16x16x32_bf16 v[180:183], a[232:235], a[196:199], v[180:183]
 ds_read_b64_tr_b16 a[222:223], v16 offset:45568
 s_waitcnt lgkmcnt(8)
 v_mfma_f32_16x16x32_bf16 v[184:187], a[240:243], a[196:199], v[184:187]
 ds_read_b64_tr_b16 a[224:225], v17 offset:40960
 v_mfma_f32_16x16x32_bf16 v[184:187], a[244:247], a[204:207], v[184:187]
 ds_read_b64_tr_b16 a[226:227], v17 offset:41472
 v_mfma_f32_16x16x32_bf16 v[168:171], a[244:247], a[200:203], v[168:171]
 ds_read_b64_tr_b16 a[228:229], v17 offset:45056
 v_mfma_f32_16x16x32_bf16 v[168:171], a[240:243], a[192:195], v[168:171]
 ds_read_b64_tr_b16 a[230:231], v17 offset:45568
 s_waitcnt lgkmcnt(8)
 v_mfma_f32_16x16x32_bf16 v[172:175], a[248:251], a[192:195], v[172:175]
 ds_read_b64_tr_b16 a[232:233], v18 offset:40960
 v_mfma_f32_16x16x32_bf16 v[172:175], a[252:255], a[200:203], v[172:175]
 ds_read_b64_tr_b16 a[234:235], v18 offset:41472
 v_mfma_f32_16x16x32_bf16 v[188:191], a[252:255], a[204:207], v[188:191]
 ds_read_b64_tr_b16 a[236:237], v18 offset:45056
 v_mfma_f32_16x16x32_bf16 v[188:191], a[248:251], a[196:199], v[188:191]
 ds_read_b64_tr_b16 a[238:239], v18 offset:45568
 s_waitcnt lgkmcnt(8)
 v_mfma_f32_16x16x32_bf16 v[176:179], a[216:219], a[212:215], v[176:179]
 ds_read_b64_tr_b16 a[240:241], v19 offset:40960
 v_mfma_f32_16x16x32_bf16 v[176:179], a[220:223], v[220:223], v[176:179]
 ds_read_b64_tr_b16 a[242:243], v19 offset:41472
 v_mfma_f32_16x16x32_bf16 v[160:163], a[220:223], v[216:219], v[160:163]
 ds_read_b64_tr_b16 a[244:245], v19 offset:45056
 v_mfma_f32_16x16x32_bf16 v[160:163], a[216:219], a[208:211], v[160:163]
 ds_read_b64_tr_b16 a[246:247], v19 offset:45568
 s_waitcnt lgkmcnt(8)
 v_mfma_f32_16x16x32_bf16 v[164:167], a[224:227], a[208:211], v[164:167]
 s_waitcnt vmcnt(8)
 s_barrier
 ds_read_b64_tr_b16 a[248:249], v16 offset:49152
 v_mfma_f32_16x16x32_bf16 v[164:167], a[228:231], v[216:219], v[164:167]
 ds_read_b64_tr_b16 a[250:251], v16 offset:49664
 v_mfma_f32_16x16x32_bf16 v[180:183], a[228:231], v[220:223], v[180:183]
 ds_read_b64_tr_b16 a[252:253], v16 offset:53248
 v_mfma_f32_16x16x32_bf16 v[180:183], a[224:227], a[212:215], v[180:183]
 ds_read_b64_tr_b16 a[254:255], v16 offset:53760
 s_waitcnt lgkmcnt(8)
 v_mfma_f32_16x16x32_bf16 v[184:187], a[232:235], a[212:215], v[184:187]
 ds_read_b64_tr_b16 a[216:217], v17 offset:49152
 v_mfma_f32_16x16x32_bf16 v[184:187], a[236:239], v[220:223], v[184:187]
 ds_read_b64_tr_b16 a[218:219], v17 offset:49664
 v_mfma_f32_16x16x32_bf16 v[168:171], a[236:239], v[216:219], v[168:171]
 ds_read_b64_tr_b16 a[220:221], v17 offset:53248
 v_mfma_f32_16x16x32_bf16 v[168:171], a[232:235], a[208:211], v[168:171]
 ds_read_b64_tr_b16 a[222:223], v17 offset:53760
 s_waitcnt lgkmcnt(8)
 v_mfma_f32_16x16x32_bf16 v[172:175], a[240:243], a[208:211], v[172:175]
 ds_read_b64_tr_b16 a[224:225], v18 offset:49152
 v_mfma_f32_16x16x32_bf16 v[172:175], a[244:247], v[216:219], v[172:175]
 ds_read_b64_tr_b16 a[226:227], v18 offset:49664
 v_mfma_f32_16x16x32_bf16 v[188:191], a[244:247], v[220:223], v[188:191]
 ds_read_b64_tr_b16 a[228:229], v18 offset:53248
 v_mfma_f32_16x16x32_bf16 v[188:191], a[240:243], a[212:215], v[188:191]
 ds_read_b64_tr_b16 a[230:231], v18 offset:53760
 s_waitcnt lgkmcnt(8)
 v_mfma_f32_16x16x32_bf16 v[176:179], a[248:251], v[228:231], v[176:179]
 ds_read_b64_tr_b16 a[232:233], v19 offset:49152
 v_mfma_f32_16x16x32_bf16 v[176:179], a[252:255], v[236:239], v[176:179]
 ds_read_b64_tr_b16 a[234:235], v19 offset:49664
 v_mfma_f32_16x16x32_bf16 v[160:163], a[252:255], v[232:235], v[160:163]
 ds_read_b64_tr_b16 a[236:237], v19 offset:53248
 v_mfma_f32_16x16x32_bf16 v[160:163], a[248:251], v[224:227], v[160:163]
 ds_read_b64_tr_b16 a[238:239], v19 offset:53760
 s_waitcnt lgkmcnt(8)
 v_mfma_f32_16x16x32_bf16 v[164:167], a[216:219], v[224:227], v[164:167]
 ds_read_b64_tr_b16 a[240:241], v16 offset:57344
 v_mfma_f32_16x16x32_bf16 v[164:167], a[220:223], v[232:235], v[164:167]
 ds_read_b64_tr_b16 a[242:243], v16 offset:57856
 v_mfma_f32_16x16x32_bf16 v[180:183], a[220:223], v[236:239], v[180:183]
 ds_read_b64_tr_b16 a[244:245], v16 offset:61440
 v_mfma_f32_16x16x32_bf16 v[180:183], a[216:219], v[228:231], v[180:183]
 ds_read_b64_tr_b16 a[246:247], v16 offset:61952
 s_waitcnt lgkmcnt(8)
 v_mfma_f32_16x16x32_bf16 v[184:187], a[224:227], v[228:231], v[184:187]
 ds_read_b64_tr_b16 a[248:249], v17 offset:57344
 v_mfma_f32_16x16x32_bf16 v[184:187], a[228:231], v[236:239], v[184:187]
 ds_read_b64_tr_b16 a[250:251], v17 offset:57856
 v_mfma_f32_16x16x32_bf16 v[168:171], a[228:231], v[232:235], v[168:171]
 ds_read_b64_tr_b16 a[252:253], v17 offset:61440
 v_mfma_f32_16x16x32_bf16 v[168:171], a[224:227], v[224:227], v[168:171]
 ds_read_b64_tr_b16 a[254:255], v17 offset:61952
 s_waitcnt lgkmcnt(8)
 v_mfma_f32_16x16x32_bf16 v[172:175], a[232:235], v[224:227], v[172:175]
 ds_read_b64_tr_b16 a[216:217], v18 offset:57344
 v_mfma_f32_16x16x32_bf16 v[172:175], a[236:239], v[232:235], v[172:175]
 ds_read_b64_tr_b16 a[218:219], v18 offset:57856
 v_mfma_f32_16x16x32_bf16 v[188:191], a[236:239], v[236:239], v[188:191]
 ds_read_b64_tr_b16 a[220:221], v18 offset:61440
 v_mfma_f32_16x16x32_bf16 v[188:191], a[232:235], v[228:231], v[188:191]
 ds_read_b64_tr_b16 a[222:223], v18 offset:61952
 s_waitcnt lgkmcnt(8)
 v_mfma_f32_16x16x32_bf16 v[176:179], a[240:243], v[244:247], v[176:179]
 ds_read_b64_tr_b16 a[224:225], v19 offset:57344
 v_mfma_f32_16x16x32_bf16 v[176:179], a[244:247], v[252:255], v[176:179]
 ds_read_b64_tr_b16 a[226:227], v19 offset:57856
 v_mfma_f32_16x16x32_bf16 v[160:163], a[244:247], v[248:251], v[160:163]
 ds_read_b64_tr_b16 a[228:229], v19 offset:61440
 v_mfma_f32_16x16x32_bf16 v[160:163], a[240:243], v[240:243], v[160:163]
 ds_read_b64_tr_b16 a[230:231], v19 offset:61952
 s_waitcnt lgkmcnt(8)
 v_mfma_f32_16x16x32_bf16 v[164:167], a[248:251], v[240:243], v[164:167]
 v_mfma_f32_16x16x32_bf16 v[164:167], a[252:255], v[248:251], v[164:167]
 v_mfma_f32_16x16x32_bf16 v[180:183], a[252:255], v[252:255], v[180:183]
 v_mfma_f32_16x16x32_bf16 v[180:183], a[248:251], v[244:247], v[180:183]
 s_waitcnt lgkmcnt(4)
 v_mfma_f32_16x16x32_bf16 v[184:187], a[216:219], v[244:247], v[184:187]
 v_mfma_f32_16x16x32_bf16 v[184:187], a[220:223], v[252:255], v[184:187]
 v_mfma_f32_16x16x32_bf16 v[168:171], a[220:223], v[248:251], v[168:171]
 v_mfma_f32_16x16x32_bf16 v[168:171], a[216:219], v[240:243], v[168:171]
 s_waitcnt lgkmcnt(0)
 v_mfma_f32_16x16x32_bf16 v[172:175], a[224:227], v[240:243], v[172:175]
 v_mfma_f32_16x16x32_bf16 v[172:175], a[228:231], v[248:251], v[172:175]
 v_mfma_f32_16x16x32_bf16 v[188:191], a[228:231], v[252:255], v[188:191]
 v_mfma_f32_16x16x32_bf16 v[188:191], a[224:227], v[244:247], v[188:191]
 s_mov_b32 s28, 0x3e8293ee
 v_pk_mul_f32 v[160:161], v[160:161], s[28:29] op_sel_hi:[1,0]
 v_pk_mul_f32 v[162:163], v[162:163], s[28:29] op_sel_hi:[1,0]
 v_pk_mul_f32 v[164:165], v[164:165], s[28:29] op_sel_hi:[1,0]
 v_pk_mul_f32 v[166:167], v[166:167], s[28:29] op_sel_hi:[1,0]
 v_cvt_pk_bf16_f32 v64, v160, v161
 v_cvt_pk_bf16_f32 v65, v162, v163
 v_cvt_pk_bf16_f32 v66, v164, v165
 v_cvt_pk_bf16_f32 v67, v166, v167
 ds_write_b128 v22, v[64:67]
 v_pk_mul_f32 v[176:177], v[176:177], s[28:29] op_sel_hi:[1,0]
 v_pk_mul_f32 v[178:179], v[178:179], s[28:29] op_sel_hi:[1,0]
 v_pk_mul_f32 v[180:181], v[180:181], s[28:29] op_sel_hi:[1,0]
 v_pk_mul_f32 v[182:183], v[182:183], s[28:29] op_sel_hi:[1,0]
 v_cvt_pk_bf16_f32 v68, v176, v177
 v_cvt_pk_bf16_f32 v69, v178, v179
 v_cvt_pk_bf16_f32 v70, v180, v181
 v_cvt_pk_bf16_f32 v71, v182, v183
 ds_write_b128 v22, v[68:71] offset:256
 v_pk_mul_f32 v[168:169], v[168:169], s[28:29] op_sel_hi:[1,0]
 v_pk_mul_f32 v[170:171], v[170:171], s[28:29] op_sel_hi:[1,0]
 v_pk_mul_f32 v[172:173], v[172:173], s[28:29] op_sel_hi:[1,0]
 v_pk_mul_f32 v[174:175], v[174:175], s[28:29] op_sel_hi:[1,0]
 v_cvt_pk_bf16_f32 v72, v168, v169
 v_cvt_pk_bf16_f32 v73, v170, v171
 v_cvt_pk_bf16_f32 v74, v172, v173
 v_cvt_pk_bf16_f32 v75, v174, v175
 ds_write_b128 v22, v[72:75] offset:2048
 v_pk_mul_f32 v[184:185], v[184:185], s[28:29] op_sel_hi:[1,0]
 v_pk_mul_f32 v[186:187], v[186:187], s[28:29] op_sel_hi:[1,0]
 v_pk_mul_f32 v[188:189], v[188:189], s[28:29] op_sel_hi:[1,0]
 v_pk_mul_f32 v[190:191], v[190:191], s[28:29] op_sel_hi:[1,0]
 v_cvt_pk_bf16_f32 v76, v184, v185
 v_cvt_pk_bf16_f32 v77, v186, v187
 v_cvt_pk_bf16_f32 v78, v188, v189
 v_cvt_pk_bf16_f32 v79, v190, v191
 ds_write_b128 v22, v[76:79] offset:2304
 s_waitcnt vmcnt(0) lgkmcnt(0)
 s_barrier
 ds_read_b128 a[0:3], v202
 ds_read_b128 a[4:7], v202 offset:1024
 ds_read_b128 v[16:19], v203
 ds_read_b128 v[20:23], v203 offset:1024
 ds_read_b128 v[24:27], v203 offset:4096
 ds_read_b128 v[28:31], v203 offset:5120
 ds_read_b128 a[16:19], v202 offset:2048
 ds_read_b128 a[20:23], v202 offset:3072
 s_and_b32 s3, s16, 1
 s_lshl1_add_u32 s3, s17, s3
 s_lshl_b32 s33, s3, 17
 s_lshl_b32 s3, s35, 10
 s_add_u32 s33, s33, s3
 s_lshl_b32 s33, s33, 1
 s_add_u32 s33, s33, 58720256
 s_add_u32 s34, s33, 131072
 v_and_b32 v9, 4294967168, v200
 v_add_u32 v9, v9, v200
 v_add_u32 v8, 0x10000, v202
 s_add_u32 s28, s0, 40140800
 s_mov_b32 s12, s48
 s_mov_b32 s13, s49
 s_mov_b32 s14, 0x700000
 s_mov_b32 s15, 0x20000
 s_mov_b32 s56, s40
 s_mov_b32 s57, s41
 s_mov_b32 s58, 0x200000
 s_mov_b32 s59, 0x20000
 s_waitcnt lgkmcnt(5)
 v_mfma_f32_32x32x16_bf16 v[64:79], a[0:3], v[16:19], 0
 s_waitcnt lgkmcnt(4)
 v_mfma_f32_32x32x16_bf16 v[64:79], a[4:7], v[20:23], v[64:79]
 s_waitcnt lgkmcnt(3)
 v_mfma_f32_32x32x16_bf16 v[80:95], a[0:3], v[24:27], 0
 s_waitcnt lgkmcnt(2)
 v_mfma_f32_32x32x16_bf16 v[80:95], a[4:7], v[28:31], v[80:95]
 s_cmp_lg_u32 s16, 0
 s_cbranch_scc1 L_look_13
 buffer_load_dword v207, v214, s[4:7], s32 offen sc1
L_look_13:
 s_nop 4
 v_max3_f32 v6, v64, v65, v66
 v_max3_f32 v7, v67, v68, v69
 v_max3_f32 v6, v6, v70, v71
 v_max3_f32 v7, v7, v72, v73
 v_max3_f32 v6, v6, v74, v75
 v_max3_f32 v7, v7, v76, v77
 v_max3_f32 v6, v6, v78, v79
 v_max_f32 v6, v6, v7
 v_mov_b32 v7, v6
 s_nop 1
 v_permlane32_swap_b32 v6, v7
 v_max_f32 v6, v6, v7
 v_pk_mul_f32 v[32:33], v[6:7], -1.0 op_sel_hi:[0,0]
 v_pk_mul_f32 v[34:35], v[6:7], -1.0 op_sel_hi:[0,0]
 v_pk_mul_f32 v[36:37], v[6:7], -1.0 op_sel_hi:[0,0]
 v_pk_mul_f32 v[38:39], v[6:7], -1.0 op_sel_hi:[0,0]
 v_pk_mul_f32 v[40:41], v[6:7], -1.0 op_sel_hi:[0,0]
 v_pk_mul_f32 v[42:43], v[6:7], -1.0 op_sel_hi:[0,0]
 v_pk_mul_f32 v[44:45], v[6:7], -1.0 op_sel_hi:[0,0]
 v_pk_mul_f32 v[46:47], v[6:7], -1.0 op_sel_hi:[0,0]
 v_pk_add_f32 v[64:65], v[64:65], v[32:33]
 v_pk_add_f32 v[66:67], v[66:67], v[32:33]
 v_pk_add_f32 v[68:69], v[68:69], v[32:33]
 v_pk_add_f32 v[70:71], v[70:71], v[32:33]
 v_pk_add_f32 v[72:73], v[72:73], v[32:33]
 v_pk_add_f32 v[74:75], v[74:75], v[32:33]
 v_pk_add_f32 v[76:77], v[76:77], v[32:33]
 v_pk_add_f32 v[78:79], v[78:79], v[32:33]
 v_max3_f32 v6, v80, v81, v82
 v_max3_f32 v7, v83, v84, v85
 v_max3_f32 v6, v6, v86, v87
 v_max3_f32 v7, v7, v88, v89
 v_max3_f32 v6, v6, v90, v91
 v_max3_f32 v7, v7, v92, v93
 v_max3_f32 v6, v6, v94, v95
 v_max_f32 v6, v6, v7
 v_mov_b32 v7, v6
 s_nop 1
 v_permlane32_swap_b32 v6, v7
 v_max_f32 v6, v6, v7
 v_pk_mul_f32 v[48:49], v[6:7], -1.0 op_sel_hi:[0,0]
 v_pk_mul_f32 v[50:51], v[6:7], -1.0 op_sel_hi:[0,0]
 v_pk_mul_f32 v[52:53], v[6:7], -1.0 op_sel_hi:[0,0]
 v_pk_mul_f32 v[54:55], v[6:7], -1.0 op_sel_hi:[0,0]
 v_pk_mul_f32 v[56:57], v[6:7], -1.0 op_sel_hi:[0,0]
 v_pk_mul_f32 v[58:59], v[6:7], -1.0 op_sel_hi:[0,0]
 v_pk_mul_f32 v[60:61], v[6:7], -1.0 op_sel_hi:[0,0]
 v_pk_mul_f32 v[62:63], v[6:7], -1.0 op_sel_hi:[0,0]
 s_waitcnt lgkmcnt(0)
 s_nop 0
 v_mfma_f32_32x32x16_bf16 v[80:95], a[0:3], v[24:27], v[48:63]
 v_exp_f32 v96, v64
 v_exp_f32 v97, v65
 v_exp_f32 v98, v66
 v_mfma_f32_32x32x16_bf16 v[80:95], a[4:7], v[28:31], v[80:95]
 v_exp_f32 v99, v67
 v_exp_f32 v100, v68
 v_exp_f32 v101, v69
 ds_read_b128 a[8:11], v202 offset:4096
 v_exp_f32 v102, v70
 ds_read_b128 a[12:15], v202 offset:5120
 v_exp_f32 v103, v71
 v_exp_f32 v104, v72
 v_exp_f32 v105, v73
 v_exp_f32 v106, v74
 v_exp_f32 v107, v75
 s_waitcnt lgkmcnt(0)
 v_exp_f32 v108, v76
 v_exp_f32 v109, v77
 v_exp_f32 v110, v78
 v_exp_f32 v111, v79
 v_mfma_f32_32x32x16_bf16 v[64:79], a[8:11], v[16:19], v[32:47]
 s_waitcnt vmcnt(0)
 v_cmp_gt_u32 vcc, 16, v207
 v_exp_f32 v224, v80
 v_exp_f32 v225, v81
 v_exp_f32 v226, v82
 v_mfma_f32_32x32x16_bf16 v[64:79], a[12:15], v[20:23], v[64:79]
 s_and_b32 s67, s1, vcc_lo
 s_cbranch_scc1 L_poll_14
L_polled_15:
 s_barrier
 v_exp_f32 v227, v83
 v_exp_f32 v228, v84
 v_exp_f32 v229, v85
 v_smfmac_f32_16x16x64_bf16 v[144:147], v[152:155], v[96:103], v156
 ds_read_b128 a[24:27], v202 offset:6144
 v_exp_f32 v230, v86
 v_smfmac_f32_16x16x64_bf16 v[144:147], v[152:155], v[104:111], v156
 s_add_u32 m0, s19, 32768
 ds_read_b128 a[28:31], v202 offset:7168
 v_exp_f32 v231, v87
 v_exp_f32 v232, v88
 v_smfmac_f32_32x32x32_bf16 v[112:127], a[16:19], v[96:103], v156
 buffer_load_dwordx4 v206, s[8:11], s30 offen sc1 lds
 v_exp_f32 v233, v89
 v_exp_f32 v234, v90
 v_exp_f32 v235, v91
 v_smfmac_f32_32x32x32_bf16 v[112:127], a[20:23], v[104:111], v156
 s_add_u32 s22, s30, 8192
 buffer_load_dwordx4 v206, s[8:11], s30 offen offset:1024 sc1 lds
 v_exp_f32 v236, v92
 v_exp_f32 v237, v93
 v_exp_f32 v238, v94
 v_exp_f32 v239, v95
 v_mfma_f32_32x32x16_bf16 v[80:95], a[8:11], v[24:27], v[48:63]
 s_and_b32 s22, s22, 0x3ffff
 v_exp_f32 v96, v64
 v_exp_f32 v97, v65
 v_exp_f32 v98, v66
 v_mfma_f32_32x32x16_bf16 v[80:95], a[12:15], v[28:31], v[80:95]
 buffer_load_dwordx4 v1, s[8:11], s30 offen offset:2048 sc1 lds
 v_exp_f32 v99, v67
 v_exp_f32 v100, v68
 v_exp_f32 v101, v69
 v_smfmac_f32_16x16x64_bf16 v[148:151], v[152:155], v[224:231], v156
 ds_read_b128 a[0:3], v202 offset:16384
 v_exp_f32 v102, v70
 v_smfmac_f32_16x16x64_bf16 v[148:151], v[152:155], v[232:239], v156
 ds_read_b128 a[4:7], v202 offset:17408
 v_exp_f32 v103, v71
 v_exp_f32 v104, v72
 v_smfmac_f32_32x32x32_bf16 v[128:143], a[16:19], v[224:231], v156
 buffer_load_dwordx4 v1, s[8:11], s30 offen offset:3072 sc1 lds
 v_exp_f32 v105, v73
 v_exp_f32 v106, v74
 v_exp_f32 v107, v75
 v_smfmac_f32_32x32x32_bf16 v[128:143], a[20:23], v[232:239], v156
L_hop_4:
 s_cbranch_execz L_ret_0
 s_add_u32 m0, s19, 49152
 s_waitcnt lgkmcnt(0)
 buffer_load_dwordx4 v206, s[8:11], s22 offen sc1 lds
 v_exp_f32 v108, v76
 v_exp_f32 v109, v77
 v_exp_f32 v110, v78
 v_exp_f32 v111, v79
 v_mfma_f32_32x32x16_bf16 v[64:79], a[0:3], v[16:19], v[32:47]
 s_add_u32 s30, s22, 8192
 v_exp_f32 v224, v80
 v_exp_f32 v225, v81
 v_exp_f32 v226, v82
 v_mfma_f32_32x32x16_bf16 v[64:79], a[4:7], v[20:23], v[64:79]
 buffer_load_dwordx4 v206, s[8:11], s22 offen offset:1024 sc1 lds
 v_exp_f32 v227, v83
 v_exp_f32 v228, v84
 v_exp_f32 v229, v85
 v_smfmac_f32_16x16x64_bf16 v[144:147], v[152:155], v[96:103], v156
 ds_read_b128 a[16:19], v202 offset:18432
 v_exp_f32 v230, v86
 v_smfmac_f32_16x16x64_bf16 v[144:147], v[152:155], v[104:111], v156
 s_and_b32 s30, s30, 0x3ffff
 ds_read_b128 a[20:23], v202 offset:19456
 v_exp_f32 v231, v87
 v_exp_f32 v232, v88
 v_smfmac_f32_32x32x32_bf16 v[112:127], a[24:27], v[96:103], v156
 buffer_load_dwordx4 v1, s[8:11], s22 offen offset:2048 sc1 lds
 v_exp_f32 v233, v89
 v_exp_f32 v234, v90
 v_exp_f32 v235, v91
 v_smfmac_f32_32x32x32_bf16 v[112:127], a[28:31], v[104:111], v156
 buffer_load_dwordx4 v1, s[8:11], s22 offen offset:3072 sc1 lds
 v_exp_f32 v236, v92
 v_exp_f32 v237, v93
 v_exp_f32 v238, v94
 v_exp_f32 v239, v95
 v_mfma_f32_32x32x16_bf16 v[80:95], a[0:3], v[24:27], v[48:63]
 s_add_u32 m0, s19, 65536
 v_exp_f32 v96, v64
 v_exp_f32 v97, v65
 v_exp_f32 v98, v66
 v_mfma_f32_32x32x16_bf16 v[80:95], a[4:7], v[28:31], v[80:95]
 buffer_load_dwordx4 v206, s[8:11], s30 offen sc1 lds
 v_exp_f32 v99, v67
 v_exp_f32 v100, v68
 v_exp_f32 v101, v69
 v_smfmac_f32_16x16x64_bf16 v[148:151], v[152:155], v[224:231], v156
 ds_read_b128 a[8:11], v202 offset:20480
 v_exp_f32 v102, v70
 v_smfmac_f32_16x16x64_bf16 v[148:151], v[152:155], v[232:239], v156
 s_add_u32 s22, s30, 8192
 ds_read_b128 a[12:15], v202 offset:21504
 v_exp_f32 v103, v71
 v_exp_f32 v104, v72
 v_smfmac_f32_32x32x32_bf16 v[128:143], a[24:27], v[224:231], v156
 buffer_load_dwordx4 v206, s[8:11], s30 offen offset:1024 sc1 lds
 v_exp_f32 v105, v73
 v_exp_f32 v106, v74
 v_exp_f32 v107, v75
 v_smfmac_f32_32x32x32_bf16 v[128:143], a[28:31], v[232:239], v156
 s_and_b32 s22, s22, 0x3ffff
 s_waitcnt lgkmcnt(0)
 buffer_load_dwordx4 v1, s[8:11], s30 offen offset:2048 sc1 lds
 v_exp_f32 v108, v76
 v_exp_f32 v109, v77
 v_exp_f32 v110, v78
 v_exp_f32 v111, v79
 v_mfma_f32_32x32x16_bf16 v[64:79], a[8:11], v[16:19], v[32:47]
 v_exp_f32 v224, v80
 v_exp_f32 v225, v81
 v_exp_f32 v226, v82
 v_mfma_f32_32x32x16_bf16 v[64:79], a[12:15], v[20:23], v[64:79]
 buffer_load_dwordx4 v1, s[8:11], s30 offen offset:3072 sc1 lds
 v_exp_f32 v227, v83
 v_exp_f32 v228, v84
 v_exp_f32 v229, v85
 v_smfmac_f32_16x16x64_bf16 v[144:147], v[152:155], v[96:103], v156
 ds_read_b128 a[24:27], v202 offset:22528
 v_exp_f32 v230, v86
 v_smfmac_f32_16x16x64_bf16 v[144:147], v[152:155], v[104:111], v156
 s_add_u32 m0, s19, 81920
 ds_read_b128 a[28:31], v202 offset:23552
 v_exp_f32 v231, v87
 v_exp_f32 v232, v88
 v_smfmac_f32_32x32x32_bf16 v[112:127], a[16:19], v[96:103], v156
 buffer_load_dwordx4 v206, s[8:11], s22 offen sc1 lds
 v_exp_f32 v233, v89
 v_exp_f32 v234, v90
 v_exp_f32 v235, v91
 v_smfmac_f32_32x32x32_bf16 v[112:127], a[20:23], v[104:111], v156
 s_add_u32 s30, s22, 8192
 buffer_load_dwordx4 v206, s[8:11], s22 offen offset:1024 sc1 lds
 v_exp_f32 v236, v92
 v_exp_f32 v237, v93
 v_exp_f32 v238, v94
 v_exp_f32 v239, v95
 v_mfma_f32_32x32x16_bf16 v[80:95], a[8:11], v[24:27], v[48:63]
 s_waitcnt vmcnt(6) lgkmcnt(0)
 v_exp_f32 v96, v64
 v_exp_f32 v97, v65
 v_exp_f32 v98, v66
 v_mfma_f32_32x32x16_bf16 v[80:95], a[12:15], v[28:31], v[80:95]
 s_barrier
 v_exp_f32 v99, v67
 v_exp_f32 v100, v68
 v_exp_f32 v101, v69
 v_smfmac_f32_16x16x64_bf16 v[148:151], v[152:155], v[224:231], v156
 ds_read_b128 a[0:3], v202 offset:32768
 v_exp_f32 v102, v70
 v_smfmac_f32_16x16x64_bf16 v[148:151], v[152:155], v[232:239], v156
 ds_read_b128 a[4:7], v202 offset:33792
 v_exp_f32 v103, v71
 v_exp_f32 v104, v72
 v_smfmac_f32_32x32x32_bf16 v[128:143], a[16:19], v[224:231], v156
 s_and_b32 s30, s30, 0x3ffff
 buffer_load_dwordx4 v1, s[8:11], s22 offen offset:2048 sc1 lds
 v_exp_f32 v105, v73
 v_exp_f32 v106, v74
 v_exp_f32 v107, v75
 v_smfmac_f32_32x32x32_bf16 v[128:143], a[20:23], v[232:239], v156
 s_waitcnt lgkmcnt(0)
 buffer_load_dwordx4 v1, s[8:11], s22 offen offset:3072 sc1 lds
 v_exp_f32 v108, v76
 v_exp_f32 v109, v77
 v_exp_f32 v110, v78
 v_exp_f32 v111, v79
 v_mfma_f32_32x32x16_bf16 v[64:79], a[0:3], v[16:19], v[32:47]
 s_add_u32 m0, s19, 98304
 v_exp_f32 v224, v80
 v_exp_f32 v225, v81
 v_exp_f32 v226, v82
 v_mfma_f32_32x32x16_bf16 v[64:79], a[4:7], v[20:23], v[64:79]
 buffer_load_dwordx4 v206, s[8:11], s30 offen sc1 lds
 v_exp_f32 v227, v83
 v_exp_f32 v228, v84
 v_exp_f32 v229, v85
 v_smfmac_f32_16x16x64_bf16 v[144:147], v[152:155], v[96:103], v156
 ds_read_b128 a[16:19], v202 offset:34816
 v_exp_f32 v230, v86
 v_smfmac_f32_16x16x64_bf16 v[144:147], v[152:155], v[104:111], v156
 s_add_u32 s22, s30, 8192
 ds_read_b128 a[20:23], v202 offset:35840
 v_exp_f32 v231, v87
 v_exp_f32 v232, v88
 v_smfmac_f32_32x32x32_bf16 v[112:127], a[24:27], v[96:103], v156
 buffer_load_dwordx4 v206, s[8:11], s30 offen offset:1024 sc1 lds
 v_exp_f32 v233, v89
 v_exp_f32 v234, v90
 v_exp_f32 v235, v91
 v_smfmac_f32_32x32x32_bf16 v[112:127], a[28:31], v[104:111], v156
 s_and_b32 s22, s22, 0x3ffff
 buffer_load_dwordx4 v1, s[8:11], s30 offen offset:2048 sc1 lds
 v_exp_f32 v236, v92
 v_exp_f32 v237, v93
 v_exp_f32 v238, v94
 v_exp_f32 v239, v95
 v_mfma_f32_32x32x16_bf16 v[80:95], a[0:3], v[24:27], v[48:63]
 v_exp_f32 v96, v64
 v_exp_f32 v97, v65
 v_exp_f32 v98, v66
 v_mfma_f32_32x32x16_bf16 v[80:95], a[4:7], v[28:31], v[80:95]
 buffer_load_dwordx4 v1, s[8:11], s30 offen offset:3072 sc1 lds
 v_exp_f32 v99, v67
 v_exp_f32 v100, v68
 v_exp_f32 v101, v69
 v_smfmac_f32_16x16x64_bf16 v[148:151], v[152:155], v[224:231], v156
 ds_read_b128 a[8:11], v202 offset:36864
 v_exp_f32 v102, v70
 v_smfmac_f32_16x16x64_bf16 v[148:151], v[152:155], v[232:239], v156
 s_add_u32 m0, s19, 114688
 ds_read_b128 a[12:15], v202 offset:37888
 v_exp_f32 v103, v71
 v_exp_f32 v104, v72
 v_smfmac_f32_32x32x32_bf16 v[128:143], a[24:27], v[224:231], v156
 buffer_load_dwordx4 v206, s[8:11], s22 offen sc1 lds
 v_exp_f32 v105, v73
 v_exp_f32 v106, v74
 v_exp_f32 v107, v75
 v_smfmac_f32_32x32x32_bf16 v[128:143], a[28:31], v[232:239], v156
 s_add_u32 s30, s22, 8192
 s_waitcnt lgkmcnt(0)
 buffer_load_dwordx4 v206, s[8:11], s22 offen offset:1024 sc1 lds
 v_exp_f32 v108, v76
 v_exp_f32 v109, v77
 v_exp_f32 v110, v78
 v_exp_f32 v111, v79
 v_mfma_f32_32x32x16_bf16 v[64:79], a[8:11], v[16:19], v[32:47]
 s_and_b32 s30, s30, 0x3ffff
 v_exp_f32 v224, v80
 v_exp_f32 v225, v81
 v_exp_f32 v226, v82
 v_mfma_f32_32x32x16_bf16 v[64:79], a[12:15], v[20:23], v[64:79]
 buffer_load_dwordx4 v1, s[8:11], s22 offen offset:2048 sc1 lds
 v_exp_f32 v227, v83
 v_exp_f32 v228, v84
 v_exp_f32 v229, v85
 v_smfmac_f32_16x16x64_bf16 v[144:147], v[152:155], v[96:103], v156
 ds_read_b128 a[24:27], v202 offset:38912
 v_exp_f32 v230, v86
 v_smfmac_f32_16x16x64_bf16 v[144:147], v[152:155], v[104:111], v156
 ds_read_b128 a[28:31], v202 offset:39936
 v_exp_f32 v231, v87
 v_exp_f32 v232, v88
 v_smfmac_f32_32x32x32_bf16 v[112:127], a[16:19], v[96:103], v156
 buffer_load_dwordx4 v1, s[8:11], s22 offen offset:3072 sc1 lds
 v_exp_f32 v233, v89
 v_exp_f32 v234, v90
 v_exp_f32 v235, v91
 v_smfmac_f32_32x32x32_bf16 v[112:127], a[20:23], v[104:111], v156
 v_exp_f32 v236, v92
 v_exp_f32 v237, v93
 v_exp_f32 v238, v94
 v_exp_f32 v239, v95
 v_mfma_f32_32x32x16_bf16 v[80:95], a[8:11], v[24:27], v[48:63]
 v_exp_f32 v96, v64
 v_exp_f32 v97, v65
 v_exp_f32 v98, v66
 v_mfma_f32_32x32x16_bf16 v[80:95], a[12:15], v[28:31], v[80:95]
 v_exp_f32 v99, v67
 v_exp_f32 v100, v68
 v_exp_f32 v101, v69
 v_smfmac_f32_16x16x64_bf16 v[148:151], v[152:155], v[224:231], v156
 ds_read_b128 a[0:3], v202 offset:49152
 v_exp_f32 v102, v70
 v_smfmac_f32_16x16x64_bf16 v[148:151], v[152:155], v[232:239], v156
 ds_read_b128 a[4:7], v202 offset:50176
 v_exp_f32 v103, v71
 v_exp_f32 v104, v72
 v_smfmac_f32_32x32x32_bf16 v[128:143], a[16:19], v[224:231], v156
 v_exp_f32 v105, v73
 v_exp_f32 v106, v74
 v_exp_f32 v107, v75
 v_smfmac_f32_32x32x32_bf16 v[128:143], a[20:23], v[232:239], v156
 s_waitcnt lgkmcnt(0)
 v_exp_f32 v108, v76
 v_exp_f32 v109, v77
 v_exp_f32 v110, v78
 v_exp_f32 v111, v79
 v_mfma_f32_32x32x16_bf16 v[64:79], a[0:3], v[16:19], v[32:47]
 v_exp_f32 v224, v80
 v_exp_f32 v225, v81
 v_exp_f32 v226, v82
 v_mfma_f32_32x32x16_bf16 v[64:79], a[4:7], v[20:23], v[64:79]
 v_exp_f32 v227, v83
 v_exp_f32 v228, v84
 v_exp_f32 v229, v85
 v_smfmac_f32_16x16x64_bf16 v[144:147], v[152:155], v[96:103], v156
 ds_read_b128 a[16:19], v202 offset:51200
 v_exp_f32 v230, v86
 v_smfmac_f32_16x16x64_bf16 v[144:147], v[152:155], v[104:111], v156
 ds_read_b128 a[20:23], v202 offset:52224
 v_exp_f32 v231, v87
 v_exp_f32 v232, v88
 v_smfmac_f32_32x32x32_bf16 v[112:127], a[24:27], v[96:103], v156
 v_exp_f32 v233, v89
 v_exp_f32 v234, v90
 v_exp_f32 v235, v91
 v_smfmac_f32_32x32x32_bf16 v[112:127], a[28:31], v[104:111], v156
 v_exp_f32 v236, v92
 v_exp_f32 v237, v93
 v_exp_f32 v238, v94
 v_exp_f32 v239, v95
 v_mfma_f32_32x32x16_bf16 v[80:95], a[0:3], v[24:27], v[48:63]
 s_mov_b32 m0, s24
 v_exp_f32 v96, v64
 v_exp_f32 v97, v65
 v_exp_f32 v98, v66
 v_mfma_f32_32x32x16_bf16 v[80:95], a[4:7], v[28:31], v[80:95]
 buffer_load_dwordx4 v198, s[12:15], s20 offen nt lds
 v_exp_f32 v99, v67
 v_exp_f32 v100, v68
 v_exp_f32 v101, v69
 v_smfmac_f32_16x16x64_bf16 v[148:151], v[152:155], v[224:231], v156
 ds_read_b128 a[8:11], v202 offset:53248
 v_exp_f32 v102, v70
 v_smfmac_f32_16x16x64_bf16 v[148:151], v[152:155], v[232:239], v156
 s_add_u32 s20, s20, 1048576
 ds_read_b128 a[12:15], v202 offset:54272
 v_exp_f32 v103, v71
 v_exp_f32 v104, v72
 v_smfmac_f32_32x32x32_bf16 v[128:143], a[24:27], v[224:231], v156
 v_exp_f32 v105, v73
 v_exp_f32 v106, v74
 v_exp_f32 v107, v75
 v_smfmac_f32_32x32x32_bf16 v[128:143], a[28:31], v[232:239], v156
 s_waitcnt lgkmcnt(0)
 v_exp_f32 v108, v76
 v_exp_f32 v109, v77
 v_exp_f32 v110, v78
 v_exp_f32 v111, v79
 v_mfma_f32_32x32x16_bf16 v[64:79], a[8:11], v[16:19], v[32:47]
 v_exp_f32 v224, v80
 v_exp_f32 v225, v81
 v_exp_f32 v226, v82
 v_mfma_f32_32x32x16_bf16 v[64:79], a[12:15], v[20:23], v[64:79]
 v_exp_f32 v227, v83
 v_exp_f32 v228, v84
 v_exp_f32 v229, v85
 v_smfmac_f32_16x16x64_bf16 v[144:147], v[152:155], v[96:103], v156
 ds_read_b128 a[24:27], v202 offset:55296
 v_exp_f32 v230, v86
 v_smfmac_f32_16x16x64_bf16 v[144:147], v[152:155], v[104:111], v156
 ds_read_b128 a[28:31], v202 offset:56320
 v_exp_f32 v231, v87
 v_exp_f32 v232, v88
 v_smfmac_f32_32x32x32_bf16 v[112:127], a[16:19], v[96:103], v156
 v_exp_f32 v233, v89
 v_exp_f32 v234, v90
 v_exp_f32 v235, v91
 v_smfmac_f32_32x32x32_bf16 v[112:127], a[20:23], v[104:111], v156
 v_exp_f32 v236, v92
 v_exp_f32 v237, v93
 v_exp_f32 v238, v94
 v_exp_f32 v239, v95
 v_mfma_f32_32x32x16_bf16 v[80:95], a[8:11], v[24:27], v[48:63]
 s_waitcnt vmcnt(1) lgkmcnt(0)
 v_exp_f32 v96, v64
 v_exp_f32 v97, v65
 v_exp_f32 v98, v66
 v_mfma_f32_32x32x16_bf16 v[80:95], a[12:15], v[28:31], v[80:95]
 s_barrier
 v_exp_f32 v99, v67
 v_exp_f32 v100, v68
 v_exp_f32 v101, v69
 v_smfmac_f32_16x16x64_bf16 v[148:151], v[152:155], v[224:231], v156
 ds_read_b128 a[0:3], v8
 v_exp_f32 v102, v70
 v_smfmac_f32_16x16x64_bf16 v[148:151], v[152:155], v[232:239], v156
 ds_read_b128 a[4:7], v8 offset:1024
 v_exp_f32 v103, v71
 v_exp_f32 v104, v72
 v_smfmac_f32_32x32x32_bf16 v[128:143], a[16:19], v[224:231], v156
 v_exp_f32 v105, v73
 v_exp_f32 v106, v74
 v_exp_f32 v107, v75
 v_smfmac_f32_32x32x32_bf16 v[128:143], a[20:23], v[232:239], v156
 s_waitcnt lgkmcnt(0)
 v_exp_f32 v108, v76
 v_exp_f32 v109, v77
 v_exp_f32 v110, v78
 v_exp_f32 v111, v79
 v_mfma_f32_32x32x16_bf16 v[64:79], a[0:3], v[16:19], v[32:47]
 v_exp_f32 v224, v80
 v_exp_f32 v225, v81
 v_exp_f32 v226, v82
 v_mfma_f32_32x32x16_bf16 v[64:79], a[4:7], v[20:23], v[64:79]
 v_exp_f32 v227, v83
 v_exp_f32 v228, v84
 v_exp_f32 v229, v85
 v_smfmac_f32_16x16x64_bf16 v[144:147], v[152:155], v[96:103], v156
 ds_read_b128 a[16:19], v8 offset:2048
 v_exp_f32 v230, v86
 v_smfmac_f32_16x16x64_bf16 v[144:147], v[152:155], v[104:111], v156
 ds_read_b128 a[20:23], v8 offset:3072
 v_exp_f32 v231, v87
 v_exp_f32 v232, v88
 v_smfmac_f32_32x32x32_bf16 v[112:127], a[24:27], v[96:103], v156
 v_exp_f32 v233, v89
 v_exp_f32 v234, v90
 v_exp_f32 v235, v91
 v_smfmac_f32_32x32x32_bf16 v[112:127], a[28:31], v[104:111], v156
 v_exp_f32 v236, v92
 v_exp_f32 v237, v93
 v_exp_f32 v238, v94
 v_exp_f32 v239, v95
 v_mfma_f32_32x32x16_bf16 v[80:95], a[0:3], v[24:27], v[48:63]
 s_mov_b32 m0, s19
 v_exp_f32 v96, v64
 v_exp_f32 v97, v65
 v_exp_f32 v98, v66
 v_mfma_f32_32x32x16_bf16 v[80:95], a[4:7], v[28:31], v[80:95]
 buffer_load_dwordx4 v206, s[8:11], s30 offen sc1 lds
 v_exp_f32 v99, v67
 v_exp_f32 v100, v68
 v_exp_f32 v101, v69
 v_smfmac_f32_16x16x64_bf16 v[148:151], v[152:155], v[224:231], v156
 ds_read_b128 a[8:11], v8 offset:4096
 v_exp_f32 v102, v70
 v_smfmac_f32_16x16x64_bf16 v[148:151], v[152:155], v[232:239], v156
 ds_read_b128 a[12:15], v8 offset:5120
 v_exp_f32 v103, v71
 v_exp_f32 v104, v72
 v_smfmac_f32_32x32x32_bf16 v[128:143], a[24:27], v[224:231], v156
 s_add_u32 s22, s30, 8192
 v_exp_f32 v105, v73
 v_exp_f32 v106, v74
 v_exp_f32 v107, v75
 v_smfmac_f32_32x32x32_bf16 v[128:143], a[28:31], v[232:239], v156
 s_waitcnt lgkmcnt(0)
 buffer_load_dwordx4 v206, s[8:11], s30 offen offset:1024 sc1 lds
 v_exp_f32 v108, v76
 v_exp_f32 v109, v77
 v_exp_f32 v110, v78
 v_exp_f32 v111, v79
 v_mfma_f32_32x32x16_bf16 v[64:79], a[8:11], v[16:19], v[32:47]
 s_and_b32 s22, s22, 0x3ffff
 v_exp_f32 v224, v80
 v_exp_f32 v225, v81
 v_exp_f32 v226, v82
 v_mfma_f32_32x32x16_bf16 v[64:79], a[12:15], v[20:23], v[64:79]
 buffer_load_dwordx4 v1, s[8:11], s30 offen offset:2048 sc1 lds
 v_exp_f32 v227, v83
 v_exp_f32 v228, v84
 v_exp_f32 v229, v85
 v_smfmac_f32_16x16x64_bf16 v[144:147], v[152:155], v[96:103], v156
 ds_read_b128 a[24:27], v8 offset:6144
 v_exp_f32 v230, v86
 v_smfmac_f32_16x16x64_bf16 v[144:147], v[152:155], v[104:111], v156
 ds_read_b128 a[28:31], v8 offset:7168
 v_exp_f32 v231, v87
 v_exp_f32 v232, v88
 v_smfmac_f32_32x32x32_bf16 v[112:127], a[16:19], v[96:103], v156
 v_exp_f32 v233, v89
 v_exp_f32 v234, v90
 v_exp_f32 v235, v91
 v_smfmac_f32_32x32x32_bf16 v[112:127], a[20:23], v[104:111], v156
 buffer_load_dwordx4 v1, s[8:11], s30 offen offset:3072 sc1 lds
 v_exp_f32 v236, v92
 v_exp_f32 v237, v93
 v_exp_f32 v238, v94
 v_exp_f32 v239, v95
 v_mfma_f32_32x32x16_bf16 v[80:95], a[8:11], v[24:27], v[48:63]
 s_add_u32 m0, s19, 16384
 v_exp_f32 v96, v64
 v_exp_f32 v97, v65
 v_exp_f32 v98, v66
 v_mfma_f32_32x32x16_bf16 v[80:95], a[12:15], v[28:31], v[80:95]
 buffer_load_dwordx4 v206, s[8:11], s22 offen sc1 lds
 v_exp_f32 v99, v67
 v_exp_f32 v100, v68
 v_exp_f32 v101, v69
 v_smfmac_f32_16x16x64_bf16 v[148:151], v[152:155], v[224:231], v156
 ds_read_b128 a[0:3], v8 offset:16384
 v_exp_f32 v102, v70
 v_smfmac_f32_16x16x64_bf16 v[148:151], v[152:155], v[232:239], v156
 ds_read_b128 a[4:7], v8 offset:17408
 v_exp_f32 v103, v71
 v_exp_f32 v104, v72
 v_smfmac_f32_32x32x32_bf16 v[128:143], a[16:19], v[224:231], v156
 s_add_u32 s30, s22, 8192
 v_exp_f32 v105, v73
 v_exp_f32 v106, v74
 v_exp_f32 v107, v75
 v_smfmac_f32_32x32x32_bf16 v[128:143], a[20:23], v[232:239], v156
 s_waitcnt lgkmcnt(0)
 buffer_load_dwordx4 v206, s[8:11], s22 offen offset:1024 sc1 lds
 v_exp_f32 v108, v76
 v_exp_f32 v109, v77
 v_exp_f32 v110, v78
 v_exp_f32 v111, v79
 v_mfma_f32_32x32x16_bf16 v[64:79], a[0:3], v[16:19], v[32:47]
 s_and_b32 s30, s30, 0x3ffff
 v_exp_f32 v224, v80
 v_exp_f32 v225, v81
 v_exp_f32 v226, v82
 v_mfma_f32_32x32x16_bf16 v[64:79], a[4:7], v[20:23], v[64:79]
 buffer_load_dwordx4 v1, s[8:11], s22 offen offset:2048 sc1 lds
 v_exp_f32 v227, v83
 v_exp_f32 v228, v84
 v_exp_f32 v229, v85
 v_smfmac_f32_16x16x64_bf16 v[144:147], v[152:155], v[96:103], v156
 ds_read_b128 a[16:19], v8 offset:18432
 v_exp_f32 v230, v86
 v_smfmac_f32_16x16x64_bf16 v[144:147], v[152:155], v[104:111], v156
 ds_read_b128 a[20:23], v8 offset:19456
 v_exp_f32 v231, v87
 v_exp_f32 v232, v88
 v_smfmac_f32_32x32x32_bf16 v[112:127], a[24:27], v[96:103], v156
 v_exp_f32 v233, v89
 v_exp_f32 v234, v90
 v_exp_f32 v235, v91
 v_smfmac_f32_32x32x32_bf16 v[112:127], a[28:31], v[104:111], v156
 buffer_load_dwordx4 v1, s[8:11], s22 offen offset:3072 sc1 lds
 v_exp_f32 v236, v92
 v_exp_f32 v237, v93
 v_exp_f32 v238, v94
 v_exp_f32 v239, v95
 v_mfma_f32_32x32x16_bf16 v[80:95], a[0:3], v[24:27], v[48:63]
 s_add_u32 m0, s19, 32768
 v_exp_f32 v96, v64
 v_exp_f32 v97, v65
 v_exp_f32 v98, v66
 v_mfma_f32_32x32x16_bf16 v[80:95], a[4:7], v[28:31], v[80:95]
 buffer_load_dwordx4 v206, s[8:11], s30 offen sc1 lds
 v_exp_f32 v99, v67
 v_exp_f32 v100, v68
 v_exp_f32 v101, v69
 v_smfmac_f32_16x16x64_bf16 v[148:151], v[152:155], v[224:231], v156
 ds_read_b128 a[8:11], v8 offset:20480
 v_exp_f32 v102, v70
 v_smfmac_f32_16x16x64_bf16 v[148:151], v[152:155], v[232:239], v156
 ds_read_b128 a[12:15], v8 offset:21504
 v_exp_f32 v103, v71
 v_exp_f32 v104, v72
 v_smfmac_f32_32x32x32_bf16 v[128:143], a[24:27], v[224:231], v156
 s_add_u32 s22, s30, 8192
 v_exp_f32 v105, v73
 v_exp_f32 v106, v74
 v_exp_f32 v107, v75
 v_smfmac_f32_32x32x32_bf16 v[128:143], a[28:31], v[232:239], v156
 s_waitcnt lgkmcnt(0)
 buffer_load_dwordx4 v206, s[8:11], s30 offen offset:1024 sc1 lds
 v_exp_f32 v108, v76
 v_exp_f32 v109, v77
 v_exp_f32 v110, v78
 v_exp_f32 v111, v79
 v_mfma_f32_32x32x16_bf16 v[64:79], a[8:11], v[16:19], v[32:47]
 s_and_b32 s22, s22, 0x3ffff
 v_exp_f32 v224, v80
 v_exp_f32 v225, v81
 v_exp_f32 v226, v82
 v_mfma_f32_32x32x16_bf16 v[64:79], a[12:15], v[20:23], v[64:79]
 buffer_load_dwordx4 v1, s[8:11], s30 offen offset:2048 sc1 lds
 v_exp_f32 v227, v83
 v_exp_f32 v228, v84
 v_exp_f32 v229, v85
 v_smfmac_f32_16x16x64_bf16 v[144:147], v[152:155], v[96:103], v156
 ds_read_b128 a[24:27], v8 offset:22528
 v_exp_f32 v230, v86
 v_smfmac_f32_16x16x64_bf16 v[144:147], v[152:155], v[104:111], v156
 ds_read_b128 a[28:31], v8 offset:23552
 v_exp_f32 v231, v87
 v_exp_f32 v232, v88
 v_smfmac_f32_32x32x32_bf16 v[112:127], a[16:19], v[96:103], v156
 v_exp_f32 v233, v89
 v_exp_f32 v234, v90
 v_exp_f32 v235, v91
 v_smfmac_f32_32x32x32_bf16 v[112:127], a[20:23], v[104:111], v156
 buffer_load_dwordx4 v1, s[8:11], s30 offen offset:3072 sc1 lds
 v_exp_f32 v236, v92
 v_exp_f32 v237, v93
 v_exp_f32 v238, v94
 v_exp_f32 v239, v95
 v_mfma_f32_32x32x16_bf16 v[80:95], a[8:11], v[24:27], v[48:63]
 s_add_u32 m0, s19, 49152
 v_exp_f32 v96, v64
 v_exp_f32 v97, v65
 v_exp_f32 v98, v66
 v_mfma_f32_32x32x16_bf16 v[80:95], a[12:15], v[28:31], v[80:95]
 buffer_load_dwordx4 v206, s[8:11], s22 offen sc1 lds
 v_exp_f32 v99, v67
 v_exp_f32 v100, v68
 v_exp_f32 v101, v69
 v_smfmac_f32_16x16x64_bf16 v[148:151], v[152:155], v[224:231], v156
 ds_read_b128 a[0:3], v8 offset:32768
 v_exp_f32 v102, v70
 v_smfmac_f32_16x16x64_bf16 v[148:151], v[152:155], v[232:239], v156
 ds_read_b128 a[4:7], v8 offset:33792
 v_exp_f32 v103, v71
 v_exp_f32 v104, v72
 v_smfmac_f32_32x32x32_bf16 v[128:143], a[16:19], v[224:231], v156
 s_add_u32 s30, s22, 8192
 v_exp_f32 v105, v73
 v_exp_f32 v106, v74
 v_exp_f32 v107, v75
 v_smfmac_f32_32x32x32_bf16 v[128:143], a[20:23], v[232:239], v156
 s_waitcnt lgkmcnt(0)
 buffer_load_dwordx4 v206, s[8:11], s22 offen offset:1024 sc1 lds
 v_exp_f32 v108, v76
 v_exp_f32 v109, v77
 v_exp_f32 v110, v78
 v_exp_f32 v111, v79
 v_mfma_f32_32x32x16_bf16 v[64:79], a[0:3], v[16:19], v[32:47]
 s_and_b32 s30, s30, 0x3ffff
 v_exp_f32 v224, v80
 v_exp_f32 v225, v81
 v_exp_f32 v226, v82
 v_mfma_f32_32x32x16_bf16 v[64:79], a[4:7], v[20:23], v[64:79]
 buffer_load_dwordx4 v1, s[8:11], s22 offen offset:2048 sc1 lds
 v_exp_f32 v227, v83
 v_exp_f32 v228, v84
 v_exp_f32 v229, v85
 v_smfmac_f32_16x16x64_bf16 v[144:147], v[152:155], v[96:103], v156
 ds_read_b128 a[16:19], v8 offset:34816
 v_exp_f32 v230, v86
 v_smfmac_f32_16x16x64_bf16 v[144:147], v[152:155], v[104:111], v156
 ds_read_b128 a[20:23], v8 offset:35840
 v_exp_f32 v231, v87
 v_exp_f32 v232, v88
 v_smfmac_f32_32x32x32_bf16 v[112:127], a[24:27], v[96:103], v156
 v_exp_f32 v233, v89
 v_exp_f32 v234, v90
 v_exp_f32 v235, v91
 v_smfmac_f32_32x32x32_bf16 v[112:127], a[28:31], v[104:111], v156
 buffer_load_dwordx4 v1, s[8:11], s22 offen offset:3072 sc1 lds
 v_exp_f32 v236, v92
 v_exp_f32 v237, v93
 v_exp_f32 v238, v94
 v_exp_f32 v239, v95
 v_mfma_f32_32x32x16_bf16 v[80:95], a[0:3], v[24:27], v[48:63]
 v_exp_f32 v96, v64
 v_exp_f32 v97, v65
 v_exp_f32 v98, v66
 v_mfma_f32_32x32x16_bf16 v[80:95], a[4:7], v[28:31], v[80:95]
 global_load_dword v7, v201, s[44:45]
 v_exp_f32 v99, v67
 v_exp_f32 v100, v68
 v_exp_f32 v101, v69
 v_smfmac_f32_16x16x64_bf16 v[148:151], v[152:155], v[224:231], v156
 ds_read_b128 a[8:11], v8 offset:36864
 v_exp_f32 v102, v70
 v_smfmac_f32_16x16x64_bf16 v[148:151], v[152:155], v[232:239], v156
 ds_read_b128 a[12:15], v8 offset:37888
 v_exp_f32 v103, v71
 v_exp_f32 v104, v72
 v_smfmac_f32_32x32x32_bf16 v[128:143], a[24:27], v[224:231], v156
 s_waitcnt vmcnt(17)
 v_exp_f32 v105, v73
 v_exp_f32 v106, v74
 v_exp_f32 v107, v75
 v_smfmac_f32_32x32x32_bf16 v[128:143], a[28:31], v[232:239], v156
 s_waitcnt lgkmcnt(0)
 v_exp_f32 v108, v76
 v_exp_f32 v109, v77
 v_exp_f32 v110, v78
 v_exp_f32 v111, v79
 v_mfma_f32_32x32x16_bf16 v[64:79], a[8:11], v[16:19], v[32:47]
 ds_read_b64_tr_b16 v[216:217], v196
 v_exp_f32 v224, v80
 v_exp_f32 v225, v81
 v_exp_f32 v226, v82
 v_mfma_f32_32x32x16_bf16 v[64:79], a[12:15], v[20:23], v[64:79]
 ds_read_b64_tr_b16 v[218:219], v196 offset:512
 v_exp_f32 v227, v83
 v_exp_f32 v228, v84
 v_exp_f32 v229, v85
 v_smfmac_f32_16x16x64_bf16 v[144:147], v[152:155], v[96:103], v156
 ds_read_b128 a[24:27], v8 offset:38912
 v_exp_f32 v230, v86
 v_smfmac_f32_16x16x64_bf16 v[144:147], v[152:155], v[104:111], v156
 ds_read_b128 a[28:31], v8 offset:39936
 v_exp_f32 v231, v87
 v_exp_f32 v232, v88
 v_smfmac_f32_32x32x32_bf16 v[112:127], a[16:19], v[96:103], v156
 v_exp_f32 v233, v89
 v_exp_f32 v234, v90
 v_exp_f32 v235, v91
 v_smfmac_f32_32x32x32_bf16 v[112:127], a[20:23], v[104:111], v156
 v_exp_f32 v236, v92
 v_exp_f32 v237, v93
 v_exp_f32 v238, v94
 v_exp_f32 v239, v95
 v_mfma_f32_32x32x16_bf16 v[80:95], a[8:11], v[24:27], v[48:63]
 s_waitcnt lgkmcnt(2)
 v_exp_f32 v96, v64
 v_exp_f32 v97, v65
 v_exp_f32 v98, v66
 v_mfma_f32_32x32x16_bf16 v[80:95], a[12:15], v[28:31], v[80:95]
 buffer_store_dwordx4 v[216:219], v197, s[4:7], s27 offen sc1
 v_exp_f32 v99, v67
 v_exp_f32 v100, v68
 v_exp_f32 v101, v69
 v_smfmac_f32_16x16x64_bf16 v[148:151], v[152:155], v[224:231], v156
 ds_read_b128 a[0:3], v8 offset:49152
 v_exp_f32 v102, v70
 v_smfmac_f32_16x16x64_bf16 v[148:151], v[152:155], v[232:239], v156
 ds_read_b128 a[4:7], v8 offset:50176
 v_exp_f32 v103, v71
 v_exp_f32 v104, v72
 v_smfmac_f32_32x32x32_bf16 v[128:143], a[16:19], v[224:231], v156
 s_add_u32 s27, s27, 1048576
 v_exp_f32 v105, v73
 v_exp_f32 v106, v74
 v_exp_f32 v107, v75
 v_smfmac_f32_32x32x32_bf16 v[128:143], a[20:23], v[232:239], v156
 s_waitcnt lgkmcnt(0)
 global_load_dwordx4 v[160:163], v199, s[36:37]
 v_exp_f32 v108, v76
 v_exp_f32 v109, v77
 v_exp_f32 v110, v78
 v_exp_f32 v111, v79
 v_mfma_f32_32x32x16_bf16 v[64:79], a[0:3], v[16:19], v[32:47]
 v_exp_f32 v224, v80
 v_exp_f32 v225, v81
 v_exp_f32 v226, v82
 v_mfma_f32_32x32x16_bf16 v[64:79], a[4:7], v[20:23], v[64:79]
 v_exp_f32 v227, v83
 v_exp_f32 v228, v84
 v_exp_f32 v229, v85
 v_smfmac_f32_16x16x64_bf16 v[144:147], v[152:155], v[96:103], v156
 ds_read_b128 a[16:19], v8 offset:51200
 v_exp_f32 v230, v86
 v_smfmac_f32_16x16x64_bf16 v[144:147], v[152:155], v[104:111], v156
 ds_read_b128 a[20:23], v8 offset:52224
 v_exp_f32 v231, v87
 v_exp_f32 v232, v88
 v_smfmac_f32_32x32x32_bf16 v[112:127], a[24:27], v[96:103], v156
 v_exp_f32 v233, v89
 v_exp_f32 v234, v90
 v_exp_f32 v235, v91
 v_smfmac_f32_32x32x32_bf16 v[112:127], a[28:31], v[104:111], v156
 v_exp_f32 v236, v92
 v_exp_f32 v237, v93
 v_exp_f32 v238, v94
 v_exp_f32 v239, v95
 v_mfma_f32_32x32x16_bf16 v[80:95], a[0:3], v[24:27], v[48:63]
 s_mov_b32 m0, s24
 v_exp_f32 v96, v64
 v_exp_f32 v97, v65
 v_exp_f32 v98, v66
 v_mfma_f32_32x32x16_bf16 v[80:95], a[4:7], v[28:31], v[80:95]
 buffer_load_dwordx4 v198, s[12:15], s20 offen nt lds
 v_exp_f32 v99, v67
 v_exp_f32 v100, v68
 v_exp_f32 v101, v69
 v_smfmac_f32_16x16x64_bf16 v[148:151], v[152:155], v[224:231], v156
 ds_read_b128 a[8:11], v8 offset:53248
 v_exp_f32 v102, v70
 v_smfmac_f32_16x16x64_bf16 v[148:151], v[152:155], v[232:239], v156
 ds_read_b128 a[12:15], v8 offset:54272
 v_exp_f32 v103, v71
 v_exp_f32 v104, v72
 v_smfmac_f32_32x32x32_bf16 v[128:143], a[24:27], v[224:231], v156
 s_add_u32 s20, s20, 1048576
 v_exp_f32 v105, v73
 v_exp_f32 v106, v74
 v_exp_f32 v107, v75
 v_smfmac_f32_32x32x32_bf16 v[128:143], a[28:31], v[232:239], v156
 s_waitcnt lgkmcnt(0)
 v_exp_f32 v108, v76
 v_exp_f32 v109, v77
 v_exp_f32 v110, v78
 v_exp_f32 v111, v79
 v_mfma_f32_32x32x16_bf16 v[64:79], a[8:11], v[16:19], v[32:47]
 v_exp_f32 v224, v80
 v_exp_f32 v225, v81
 v_exp_f32 v226, v82
 v_mfma_f32_32x32x16_bf16 v[64:79], a[12:15], v[20:23], v[64:79]
 v_exp_f32 v227, v83
 v_exp_f32 v228, v84
 v_exp_f32 v229, v85
 v_smfmac_f32_16x16x64_bf16 v[144:147], v[152:155], v[96:103], v156
 ds_read_b128 a[24:27], v8 offset:55296
 v_exp_f32 v230, v86
 v_smfmac_f32_16x16x64_bf16 v[144:147], v[152:155], v[104:111], v156
L_hop_5:
 s_cbranch_execz L_ret_0
 ds_read_b128 a[28:31], v8 offset:56320
 v_exp_f32 v231, v87
 v_exp_f32 v232, v88
 v_smfmac_f32_32x32x32_bf16 v[112:127], a[16:19], v[96:103], v156
 v_exp_f32 v233, v89
 v_exp_f32 v234, v90
 v_exp_f32 v235, v91
 v_smfmac_f32_32x32x32_bf16 v[112:127], a[20:23], v[104:111], v156
 v_exp_f32 v236, v92
 v_exp_f32 v237, v93
 v_exp_f32 v238, v94
 v_exp_f32 v239, v95
 v_mfma_f32_32x32x16_bf16 v[80:95], a[8:11], v[24:27], v[48:63]
 s_waitcnt vmcnt(4) lgkmcnt(0)
 v_exp_f32 v96, v64
 v_exp_f32 v97, v65
 v_exp_f32 v98, v66
 v_mfma_f32_32x32x16_bf16 v[80:95], a[12:15], v[28:31], v[80:95]
 s_barrier
 v_exp_f32 v99, v67
 v_exp_f32 v100, v68
 v_exp_f32 v101, v69
 v_smfmac_f32_16x16x64_bf16 v[148:151], v[152:155], v[224:231], v156
 ds_read_b128 a[0:3], v202
 v_exp_f32 v102, v70
 v_smfmac_f32_16x16x64_bf16 v[148:151], v[152:155], v[232:239], v156
 ds_read_b128 a[4:7], v202 offset:1024
 v_exp_f32 v103, v71
 v_exp_f32 v104, v72
 v_smfmac_f32_32x32x32_bf16 v[128:143], a[16:19], v[224:231], v156
 v_exp_f32 v105, v73
 v_exp_f32 v106, v74
 v_exp_f32 v107, v75
 v_smfmac_f32_32x32x32_bf16 v[128:143], a[20:23], v[232:239], v156
 s_waitcnt lgkmcnt(0)
 buffer_store_dwordx4 v[208:211], v1, s[4:7], s25 offen sc1
 v_exp_f32 v108, v76
 v_exp_f32 v109, v77
 v_exp_f32 v110, v78
 v_exp_f32 v111, v79
 v_mfma_f32_32x32x16_bf16 v[64:79], a[0:3], v[16:19], v[32:47]
 v_exp_f32 v224, v80
 v_exp_f32 v225, v81
 v_exp_f32 v226, v82
 v_mfma_f32_32x32x16_bf16 v[64:79], a[4:7], v[20:23], v[64:79]
 buffer_store_dwordx4 v[208:211], v1, s[4:7], s25 offen offset:1024 sc1
 v_exp_f32 v227, v83
 v_exp_f32 v228, v84
 v_exp_f32 v229, v85
 v_smfmac_f32_16x16x64_bf16 v[144:147], v[152:155], v[96:103], v156
 ds_read_b128 a[16:19], v202 offset:2048
 v_exp_f32 v230, v86
 v_smfmac_f32_16x16x64_bf16 v[144:147], v[152:155], v[104:111], v156
 ds_read_b128 a[20:23], v202 offset:3072
 v_exp_f32 v231, v87
 v_exp_f32 v232, v88
 v_smfmac_f32_32x32x32_bf16 v[112:127], a[24:27], v[96:103], v156
 v_exp_f32 v233, v89
 v_exp_f32 v234, v90
 v_exp_f32 v235, v91
 v_smfmac_f32_32x32x32_bf16 v[112:127], a[28:31], v[104:111], v156
 v_exp_f32 v236, v92
 v_exp_f32 v237, v93
 v_exp_f32 v238, v94
 v_exp_f32 v239, v95
 v_mfma_f32_32x32x16_bf16 v[80:95], a[0:3], v[24:27], v[48:63]
 s_add_u32 m0, s19, 65536
 v_exp_f32 v96, v64
 v_exp_f32 v97, v65
 v_exp_f32 v98, v66
 v_mfma_f32_32x32x16_bf16 v[80:95], a[4:7], v[28:31], v[80:95]
 buffer_load_dwordx4 v206, s[8:11], s30 offen sc1 lds
 v_exp_f32 v99, v67
 v_exp_f32 v100, v68
 v_exp_f32 v101, v69
 v_smfmac_f32_16x16x64_bf16 v[148:151], v[152:155], v[224:231], v156
 ds_read_b128 a[8:11], v202 offset:4096
 v_exp_f32 v102, v70
 v_smfmac_f32_16x16x64_bf16 v[148:151], v[152:155], v[232:239], v156
 ds_read_b128 a[12:15], v202 offset:5120
 v_exp_f32 v103, v71
 v_exp_f32 v104, v72
 v_smfmac_f32_32x32x32_bf16 v[128:143], a[24:27], v[224:231], v156
 s_add_u32 s22, s30, 8192
 v_exp_f32 v105, v73
 v_exp_f32 v106, v74
 v_exp_f32 v107, v75
 v_smfmac_f32_32x32x32_bf16 v[128:143], a[28:31], v[232:239], v156
 s_waitcnt lgkmcnt(0)
 buffer_load_dwordx4 v206, s[8:11], s30 offen offset:1024 sc1 lds
 v_exp_f32 v108, v76
 v_exp_f32 v109, v77
 v_exp_f32 v110, v78
 v_exp_f32 v111, v79
 v_mfma_f32_32x32x16_bf16 v[64:79], a[8:11], v[16:19], v[32:47]
 s_and_b32 s22, s22, 0x3ffff
 v_exp_f32 v224, v80
 v_exp_f32 v225, v81
 v_exp_f32 v226, v82
 v_mfma_f32_32x32x16_bf16 v[64:79], a[12:15], v[20:23], v[64:79]
 buffer_load_dwordx4 v1, s[8:11], s30 offen offset:2048 sc1 lds
 v_exp_f32 v227, v83
 v_exp_f32 v228, v84
 v_exp_f32 v229, v85
 v_smfmac_f32_16x16x64_bf16 v[144:147], v[152:155], v[96:103], v156
 ds_read_b128 a[24:27], v202 offset:6144
 v_exp_f32 v230, v86
 v_smfmac_f32_16x16x64_bf16 v[144:147], v[152:155], v[104:111], v156
 ds_read_b128 a[28:31], v202 offset:7168
 v_exp_f32 v231, v87
 v_exp_f32 v232, v88
 v_smfmac_f32_32x32x32_bf16 v[112:127], a[16:19], v[96:103], v156
 v_exp_f32 v233, v89
 v_exp_f32 v234, v90
 v_exp_f32 v235, v91
 v_smfmac_f32_32x32x32_bf16 v[112:127], a[20:23], v[104:111], v156
 buffer_load_dwordx4 v1, s[8:11], s30 offen offset:3072 sc1 lds
 v_exp_f32 v236, v92
 v_exp_f32 v237, v93
 v_exp_f32 v238, v94
 v_exp_f32 v239, v95
 v_mfma_f32_32x32x16_bf16 v[80:95], a[8:11], v[24:27], v[48:63]
 s_add_u32 m0, s19, 81920
 v_exp_f32 v96, v64
 v_exp_f32 v97, v65
 v_exp_f32 v98, v66
 v_mfma_f32_32x32x16_bf16 v[80:95], a[12:15], v[28:31], v[80:95]
 buffer_load_dwordx4 v206, s[8:11], s22 offen sc1 lds
 v_exp_f32 v99, v67
 v_exp_f32 v100, v68
 v_exp_f32 v101, v69
 v_smfmac_f32_16x16x64_bf16 v[148:151], v[152:155], v[224:231], v156
 ds_read_b128 a[0:3], v202 offset:16384
 v_exp_f32 v102, v70
 v_smfmac_f32_16x16x64_bf16 v[148:151], v[152:155], v[232:239], v156
 ds_read_b128 a[4:7], v202 offset:17408
 v_exp_f32 v103, v71
 v_exp_f32 v104, v72
 v_smfmac_f32_32x32x32_bf16 v[128:143], a[16:19], v[224:231], v156
 s_add_u32 s30, s22, 8192
 v_exp_f32 v105, v73
 v_exp_f32 v106, v74
 v_exp_f32 v107, v75
 v_smfmac_f32_32x32x32_bf16 v[128:143], a[20:23], v[232:239], v156
 s_waitcnt lgkmcnt(0)
 buffer_load_dwordx4 v206, s[8:11], s22 offen offset:1024 sc1 lds
 v_exp_f32 v108, v76
 v_exp_f32 v109, v77
 v_exp_f32 v110, v78
 v_exp_f32 v111, v79
 v_mfma_f32_32x32x16_bf16 v[64:79], a[0:3], v[16:19], v[32:47]
 s_and_b32 s30, s30, 0x3ffff
 v_exp_f32 v224, v80
 v_exp_f32 v225, v81
 v_exp_f32 v226, v82
 v_mfma_f32_32x32x16_bf16 v[64:79], a[4:7], v[20:23], v[64:79]
 buffer_load_dwordx4 v1, s[8:11], s22 offen offset:2048 sc1 lds
 v_exp_f32 v227, v83
 v_exp_f32 v228, v84
 v_exp_f32 v229, v85
 v_smfmac_f32_16x16x64_bf16 v[144:147], v[152:155], v[96:103], v156
 ds_read_b128 a[16:19], v202 offset:18432
 v_exp_f32 v230, v86
 v_smfmac_f32_16x16x64_bf16 v[144:147], v[152:155], v[104:111], v156
 ds_read_b128 a[20:23], v202 offset:19456
 v_exp_f32 v231, v87
 v_exp_f32 v232, v88
 v_smfmac_f32_32x32x32_bf16 v[112:127], a[24:27], v[96:103], v156
 v_exp_f32 v233, v89
 v_exp_f32 v234, v90
 v_exp_f32 v235, v91
 v_smfmac_f32_32x32x32_bf16 v[112:127], a[28:31], v[104:111], v156
 buffer_load_dwordx4 v1, s[8:11], s22 offen offset:3072 sc1 lds
 v_exp_f32 v236, v92
 v_exp_f32 v237, v93
 v_exp_f32 v238, v94
 v_exp_f32 v239, v95
 v_mfma_f32_32x32x16_bf16 v[80:95], a[0:3], v[24:27], v[48:63]
 s_add_u32 m0, s19, 98304
 v_exp_f32 v96, v64
 v_exp_f32 v97, v65
 v_exp_f32 v98, v66
 v_mfma_f32_32x32x16_bf16 v[80:95], a[4:7], v[28:31], v[80:95]
 buffer_load_dwordx4 v206, s[8:11], s30 offen sc1 lds
 v_exp_f32 v99, v67
 v_exp_f32 v100, v68
 v_exp_f32 v101, v69
 v_smfmac_f32_16x16x64_bf16 v[148:151], v[152:155], v[224:231], v156
 ds_read_b128 a[8:11], v202 offset:20480
 v_exp_f32 v102, v70
 v_smfmac_f32_16x16x64_bf16 v[148:151], v[152:155], v[232:239], v156
 ds_read_b128 a[12:15], v202 offset:21504
 v_exp_f32 v103, v71
 v_exp_f32 v104, v72
 v_smfmac_f32_32x32x32_bf16 v[128:143], a[24:27], v[224:231], v156
 s_add_u32 s22, s30, 8192
 v_exp_f32 v105, v73
 v_exp_f32 v106, v74
 v_exp_f32 v107, v75
 v_smfmac_f32_32x32x32_bf16 v[128:143], a[28:31], v[232:239], v156
 s_waitcnt lgkmcnt(0)
 buffer_load_dwordx4 v206, s[8:11], s30 offen offset:1024 sc1 lds
 v_exp_f32 v108, v76
 v_exp_f32 v109, v77
 v_exp_f32 v110, v78
 v_exp_f32 v111, v79
 v_mfma_f32_32x32x16_bf16 v[64:79], a[8:11], v[16:19], v[32:47]
 s_and_b32 s22, s22, 0x3ffff
 v_exp_f32 v224, v80
 v_exp_f32 v225, v81
 v_exp_f32 v226, v82
 v_mfma_f32_32x32x16_bf16 v[64:79], a[12:15], v[20:23], v[64:79]
 buffer_load_dwordx4 v1, s[8:11], s30 offen offset:2048 sc1 lds
 v_exp_f32 v227, v83
 v_exp_f32 v228, v84
 v_exp_f32 v229, v85
 v_smfmac_f32_16x16x64_bf16 v[144:147], v[152:155], v[96:103], v156
 ds_read_b128 a[24:27], v202 offset:22528
 v_exp_f32 v230, v86
 v_smfmac_f32_16x16x64_bf16 v[144:147], v[152:155], v[104:111], v156
 ds_read_b128 a[28:31], v202 offset:23552
 v_exp_f32 v231, v87
 v_exp_f32 v232, v88
 v_smfmac_f32_32x32x32_bf16 v[112:127], a[16:19], v[96:103], v156
 v_exp_f32 v233, v89
 v_exp_f32 v234, v90
 v_exp_f32 v235, v91
 v_smfmac_f32_32x32x32_bf16 v[112:127], a[20:23], v[104:111], v156
 buffer_load_dwordx4 v1, s[8:11], s30 offen offset:3072 sc1 lds
 v_exp_f32 v236, v92
 v_exp_f32 v237, v93
 v_exp_f32 v238, v94
 v_exp_f32 v239, v95
 v_mfma_f32_32x32x16_bf16 v[80:95], a[8:11], v[24:27], v[48:63]
 s_add_u32 m0, s19, 114688
 v_exp_f32 v96, v64
 v_exp_f32 v97, v65
 v_exp_f32 v98, v66
 v_mfma_f32_32x32x16_bf16 v[80:95], a[12:15], v[28:31], v[80:95]
 buffer_load_dwordx4 v206, s[8:11], s22 offen sc1 lds
 v_exp_f32 v99, v67
 v_exp_f32 v100, v68
 v_exp_f32 v101, v69
 v_smfmac_f32_16x16x64_bf16 v[148:151], v[152:155], v[224:231], v156
 ds_read_b128 a[0:3], v202 offset:32768
 v_exp_f32 v102, v70
 v_smfmac_f32_16x16x64_bf16 v[148:151], v[152:155], v[232:239], v156
 ds_read_b128 a[4:7], v202 offset:33792
 v_exp_f32 v103, v71
 v_exp_f32 v104, v72
 v_smfmac_f32_32x32x32_bf16 v[128:143], a[16:19], v[224:231], v156
 s_add_u32 s30, s22, 8192
 v_exp_f32 v105, v73
 v_exp_f32 v106, v74
 v_exp_f32 v107, v75
 v_smfmac_f32_32x32x32_bf16 v[128:143], a[20:23], v[232:239], v156
 s_waitcnt lgkmcnt(0)
 buffer_load_dwordx4 v206, s[8:11], s22 offen offset:1024 sc1 lds
 v_exp_f32 v108, v76
 v_exp_f32 v109, v77
 v_exp_f32 v110, v78
 v_exp_f32 v111, v79
 v_mfma_f32_32x32x16_bf16 v[64:79], a[0:3], v[16:19], v[32:47]
 s_and_b32 s30, s30, 0x3ffff
 v_exp_f32 v224, v80
 v_exp_f32 v225, v81
 v_exp_f32 v226, v82
 v_mfma_f32_32x32x16_bf16 v[64:79], a[4:7], v[20:23], v[64:79]
 buffer_load_dwordx4 v1, s[8:11], s22 offen offset:2048 sc1 lds
 v_exp_f32 v227, v83
 v_exp_f32 v228, v84
 v_exp_f32 v229, v85
 v_smfmac_f32_16x16x64_bf16 v[144:147], v[152:155], v[96:103], v156
 ds_read_b128 a[16:19], v202 offset:34816
 v_exp_f32 v230, v86
 v_smfmac_f32_16x16x64_bf16 v[144:147], v[152:155], v[104:111], v156
 ds_read_b128 a[20:23], v202 offset:35840
 v_exp_f32 v231, v87
 v_exp_f32 v232, v88
 v_smfmac_f32_32x32x32_bf16 v[112:127], a[24:27], v[96:103], v156
 v_exp_f32 v233, v89
 v_exp_f32 v234, v90
 v_exp_f32 v235, v91
 v_smfmac_f32_32x32x32_bf16 v[112:127], a[28:31], v[104:111], v156
 buffer_load_dwordx4 v1, s[8:11], s22 offen offset:3072 sc1 lds
 v_exp_f32 v236, v92
 v_exp_f32 v237, v93
 v_exp_f32 v238, v94
 v_exp_f32 v239, v95
 v_mfma_f32_32x32x16_bf16 v[80:95], a[0:3], v[24:27], v[48:63]
 v_exp_f32 v96, v64
 v_exp_f32 v97, v65
 v_exp_f32 v98, v66
 v_mfma_f32_32x32x16_bf16 v[80:95], a[4:7], v[28:31], v[80:95]
 global_load_dword v7, v201, s[46:47]
 v_exp_f32 v99, v67
 v_exp_f32 v100, v68
 v_exp_f32 v101, v69
 v_smfmac_f32_16x16x64_bf16 v[148:151], v[152:155], v[224:231], v156
 ds_read_b128 a[8:11], v202 offset:36864
 v_exp_f32 v102, v70
 v_smfmac_f32_16x16x64_bf16 v[148:151], v[152:155], v[232:239], v156
 ds_read_b128 a[12:15], v202 offset:37888
 v_exp_f32 v103, v71
 v_exp_f32 v104, v72
 v_smfmac_f32_32x32x32_bf16 v[128:143], a[24:27], v[224:231], v156
 s_waitcnt vmcnt(19)
 v_exp_f32 v105, v73
 v_exp_f32 v106, v74
 v_exp_f32 v107, v75
 v_smfmac_f32_32x32x32_bf16 v[128:143], a[28:31], v[232:239], v156
 s_waitcnt lgkmcnt(0)
 v_exp_f32 v108, v76
 v_exp_f32 v109, v77
 v_exp_f32 v110, v78
 v_exp_f32 v111, v79
 v_mfma_f32_32x32x16_bf16 v[64:79], a[8:11], v[16:19], v[32:47]
 ds_read_b64_tr_b16 v[216:217], v196
 v_exp_f32 v224, v80
 v_exp_f32 v225, v81
 v_exp_f32 v226, v82
 v_mfma_f32_32x32x16_bf16 v[64:79], a[12:15], v[20:23], v[64:79]
 ds_read_b64_tr_b16 v[218:219], v196 offset:512
 v_exp_f32 v227, v83
 v_exp_f32 v228, v84
 v_exp_f32 v229, v85
 v_smfmac_f32_16x16x64_bf16 v[144:147], v[152:155], v[96:103], v156
 ds_read_b128 a[24:27], v202 offset:38912
 v_exp_f32 v230, v86
 v_smfmac_f32_16x16x64_bf16 v[144:147], v[152:155], v[104:111], v156
 ds_read_b128 a[28:31], v202 offset:39936
 v_exp_f32 v231, v87
 v_exp_f32 v232, v88
 v_smfmac_f32_32x32x32_bf16 v[112:127], a[16:19], v[96:103], v156
 v_exp_f32 v233, v89
 v_exp_f32 v234, v90
 v_exp_f32 v235, v91
 v_smfmac_f32_32x32x32_bf16 v[112:127], a[20:23], v[104:111], v156
 v_exp_f32 v236, v92
 v_exp_f32 v237, v93
 v_exp_f32 v238, v94
 v_exp_f32 v239, v95
 v_mfma_f32_32x32x16_bf16 v[80:95], a[8:11], v[24:27], v[48:63]
 s_waitcnt lgkmcnt(2)
 v_exp_f32 v96, v64
 v_exp_f32 v97, v65
 v_exp_f32 v98, v66
 v_mfma_f32_32x32x16_bf16 v[80:95], a[12:15], v[28:31], v[80:95]
 buffer_store_dwordx4 v[216:219], v197, s[4:7], s27 offen sc1
 v_exp_f32 v99, v67
 v_exp_f32 v100, v68
 v_exp_f32 v101, v69
 v_smfmac_f32_16x16x64_bf16 v[148:151], v[152:155], v[224:231], v156
 ds_read_b128 a[0:3], v202 offset:49152
 v_exp_f32 v102, v70
 v_smfmac_f32_16x16x64_bf16 v[148:151], v[152:155], v[232:239], v156
 ds_read_b128 a[4:7], v202 offset:50176
 v_exp_f32 v103, v71
 v_exp_f32 v104, v72
 v_smfmac_f32_32x32x32_bf16 v[128:143], a[16:19], v[224:231], v156
 s_add_u32 s27, s27, 1048576
 v_exp_f32 v105, v73
 v_exp_f32 v106, v74
 v_exp_f32 v107, v75
 v_smfmac_f32_32x32x32_bf16 v[128:143], a[20:23], v[232:239], v156
 s_waitcnt lgkmcnt(0)
 global_load_dwordx4 v[164:167], v199, s[36:37] offset:32
 v_exp_f32 v108, v76
 v_exp_f32 v109, v77
 v_exp_f32 v110, v78
 v_exp_f32 v111, v79
 v_mfma_f32_32x32x16_bf16 v[64:79], a[0:3], v[16:19], v[32:47]
 v_exp_f32 v224, v80
 v_exp_f32 v225, v81
 v_exp_f32 v226, v82
 v_mfma_f32_32x32x16_bf16 v[64:79], a[4:7], v[20:23], v[64:79]
 v_exp_f32 v227, v83
 v_exp_f32 v228, v84
 v_exp_f32 v229, v85
 v_smfmac_f32_16x16x64_bf16 v[144:147], v[152:155], v[96:103], v156
 ds_read_b128 a[16:19], v202 offset:51200
 v_exp_f32 v230, v86
 v_smfmac_f32_16x16x64_bf16 v[144:147], v[152:155], v[104:111], v156
 ds_read_b128 a[20:23], v202 offset:52224
 v_exp_f32 v231, v87
 v_exp_f32 v232, v88
 v_smfmac_f32_32x32x32_bf16 v[112:127], a[24:27], v[96:103], v156
 v_exp_f32 v233, v89
 v_exp_f32 v234, v90
 v_exp_f32 v235, v91
 v_smfmac_f32_32x32x32_bf16 v[112:127], a[28:31], v[104:111], v156
 v_exp_f32 v236, v92
 v_exp_f32 v237, v93
 v_exp_f32 v238, v94
 v_exp_f32 v239, v95
 v_mfma_f32_32x32x16_bf16 v[80:95], a[0:3], v[24:27], v[48:63]
 s_mov_b32 m0, s24
 v_exp_f32 v96, v64
 v_exp_f32 v97, v65
 v_exp_f32 v98, v66
 v_mfma_f32_32x32x16_bf16 v[80:95], a[4:7], v[28:31], v[80:95]
 buffer_load_dwordx4 v198, s[12:15], s20 offen nt lds
 v_exp_f32 v99, v67
 v_exp_f32 v100, v68
 v_exp_f32 v101, v69
 v_smfmac_f32_16x16x64_bf16 v[148:151], v[152:155], v[224:231], v156
 ds_read_b128 a[8:11], v202 offset:53248
 v_exp_f32 v102, v70
 v_smfmac_f32_16x16x64_bf16 v[148:151], v[152:155], v[232:239], v156
 ds_read_b128 a[12:15], v202 offset:54272
 v_exp_f32 v103, v71
 v_exp_f32 v104, v72
 v_smfmac_f32_32x32x32_bf16 v[128:143], a[24:27], v[224:231], v156
 s_add_u32 s20, s20, 1048576
 v_exp_f32 v105, v73
 v_exp_f32 v106, v74
 v_exp_f32 v107, v75
 v_smfmac_f32_32x32x32_bf16 v[128:143], a[28:31], v[232:239], v156
 s_waitcnt lgkmcnt(0)
 v_exp_f32 v108, v76
 v_exp_f32 v109, v77
 v_exp_f32 v110, v78
 v_exp_f32 v111, v79
 v_mfma_f32_32x32x16_bf16 v[64:79], a[8:11], v[16:19], v[32:47]
 v_exp_f32 v224, v80
 v_exp_f32 v225, v81
 v_exp_f32 v226, v82
 v_mfma_f32_32x32x16_bf16 v[64:79], a[12:15], v[20:23], v[64:79]
 v_exp_f32 v227, v83
 v_exp_f32 v228, v84
 v_exp_f32 v229, v85
 v_smfmac_f32_16x16x64_bf16 v[144:147], v[152:155], v[96:103], v156
 ds_read_b128 a[24:27], v202 offset:55296
 v_exp_f32 v230, v86
 v_smfmac_f32_16x16x64_bf16 v[144:147], v[152:155], v[104:111], v156
 ds_read_b128 a[28:31], v202 offset:56320
 v_exp_f32 v231, v87
 v_exp_f32 v232, v88
 v_smfmac_f32_32x32x32_bf16 v[112:127], a[16:19], v[96:103], v156
 v_exp_f32 v233, v89
 v_exp_f32 v234, v90
 v_exp_f32 v235, v91
 v_smfmac_f32_32x32x32_bf16 v[112:127], a[20:23], v[104:111], v156
 v_exp_f32 v236, v92
 v_exp_f32 v237, v93
 v_exp_f32 v238, v94
 v_exp_f32 v239, v95
 v_mfma_f32_32x32x16_bf16 v[80:95], a[8:11], v[24:27], v[48:63]
 s_waitcnt vmcnt(4) lgkmcnt(0)
 v_exp_f32 v96, v64
 v_exp_f32 v97, v65
 v_exp_f32 v98, v66
 v_mfma_f32_32x32x16_bf16 v[80:95], a[12:15], v[28:31], v[80:95]
 s_barrier
 v_exp_f32 v99, v67
 v_exp_f32 v100, v68
 v_exp_f32 v101, v69
 v_smfmac_f32_16x16x64_bf16 v[148:151], v[152:155], v[224:231], v156
 ds_read_b128 a[0:3], v8
 v_exp_f32 v102, v70
 v_smfmac_f32_16x16x64_bf16 v[148:151], v[152:155], v[232:239], v156
 ds_read_b128 a[4:7], v8 offset:1024
 v_exp_f32 v103, v71
 v_exp_f32 v104, v72
 v_smfmac_f32_32x32x32_bf16 v[128:143], a[16:19], v[224:231], v156
 v_exp_f32 v105, v73
 v_exp_f32 v106, v74
 v_exp_f32 v107, v75
 v_smfmac_f32_32x32x32_bf16 v[128:143], a[20:23], v[232:239], v156
 s_waitcnt lgkmcnt(0)
 buffer_store_dwordx4 v[208:211], v1, s[4:7], s25 offen offset:2048 sc1
 v_exp_f32 v108, v76
 v_exp_f32 v109, v77
 v_exp_f32 v110, v78
 v_exp_f32 v111, v79
 v_mfma_f32_32x32x16_bf16 v[64:79], a[0:3], v[16:19], v[32:47]
 v_exp_f32 v224, v80
 v_exp_f32 v225, v81
 v_exp_f32 v226, v82
 v_mfma_f32_32x32x16_bf16 v[64:79], a[4:7], v[20:23], v[64:79]
 buffer_store_dwordx4 v[208:211], v1, s[4:7], s25 offen offset:3072 sc1
 v_exp_f32 v227, v83
 v_exp_f32 v228, v84
 v_exp_f32 v229, v85
 v_smfmac_f32_16x16x64_bf16 v[144:147], v[152:155], v[96:103], v156
 ds_read_b128 a[16:19], v8 offset:2048
 v_exp_f32 v230, v86
 v_smfmac_f32_16x16x64_bf16 v[144:147], v[152:155], v[104:111], v156
 ds_read_b128 a[20:23], v8 offset:3072
 v_exp_f32 v231, v87
 v_exp_f32 v232, v88
 v_smfmac_f32_32x32x32_bf16 v[112:127], a[24:27], v[96:103], v156
 v_exp_f32 v233, v89
 v_exp_f32 v234, v90
 v_exp_f32 v235, v91
 v_smfmac_f32_32x32x32_bf16 v[112:127], a[28:31], v[104:111], v156
 v_exp_f32 v236, v92
 v_exp_f32 v237, v93
 v_exp_f32 v238, v94
 v_exp_f32 v239, v95
 v_mfma_f32_32x32x16_bf16 v[80:95], a[0:3], v[24:27], v[48:63]
 s_mov_b32 m0, s19
 v_exp_f32 v96, v64
 v_exp_f32 v97, v65
 v_exp_f32 v98, v66
 v_mfma_f32_32x32x16_bf16 v[80:95], a[4:7], v[28:31], v[80:95]
 buffer_load_dwordx4 v206, s[8:11], s30 offen sc1 lds
 v_exp_f32 v99, v67
 v_exp_f32 v100, v68
 v_exp_f32 v101, v69
 v_smfmac_f32_16x16x64_bf16 v[148:151], v[152:155], v[224:231], v156
 ds_read_b128 a[8:11], v8 offset:4096
 v_exp_f32 v102, v70
 v_smfmac_f32_16x16x64_bf16 v[148:151], v[152:155], v[232:239], v156
 ds_read_b128 a[12:15], v8 offset:5120
 v_exp_f32 v103, v71
 v_exp_f32 v104, v72
 v_smfmac_f32_32x32x32_bf16 v[128:143], a[24:27], v[224:231], v156
 s_add_u32 s22, s30, 8192
 v_exp_f32 v105, v73
 v_exp_f32 v106, v74
 v_exp_f32 v107, v75
 v_smfmac_f32_32x32x32_bf16 v[128:143], a[28:31], v[232:239], v156
 s_waitcnt lgkmcnt(0)
 buffer_load_dwordx4 v206, s[8:11], s30 offen offset:1024 sc1 lds
 v_exp_f32 v108, v76
 v_exp_f32 v109, v77
 v_exp_f32 v110, v78
 v_exp_f32 v111, v79
 v_mfma_f32_32x32x16_bf16 v[64:79], a[8:11], v[16:19], v[32:47]
 s_and_b32 s22, s22, 0x3ffff
 v_exp_f32 v224, v80
 v_exp_f32 v225, v81
 v_exp_f32 v226, v82
 v_mfma_f32_32x32x16_bf16 v[64:79], a[12:15], v[20:23], v[64:79]
 buffer_load_dwordx4 v1, s[8:11], s30 offen offset:2048 sc1 lds
 v_exp_f32 v227, v83
 v_exp_f32 v228, v84
 v_exp_f32 v229, v85
 v_smfmac_f32_16x16x64_bf16 v[144:147], v[152:155], v[96:103], v156
 ds_read_b128 a[24:27], v8 offset:6144
 v_exp_f32 v230, v86
 v_smfmac_f32_16x16x64_bf16 v[144:147], v[152:155], v[104:111], v156
 ds_read_b128 a[28:31], v8 offset:7168
 v_exp_f32 v231, v87
 v_exp_f32 v232, v88
 v_smfmac_f32_32x32x32_bf16 v[112:127], a[16:19], v[96:103], v156
 v_exp_f32 v233, v89
 v_exp_f32 v234, v90
 v_exp_f32 v235, v91
 v_smfmac_f32_32x32x32_bf16 v[112:127], a[20:23], v[104:111], v156
 buffer_load_dwordx4 v1, s[8:11], s30 offen offset:3072 sc1 lds
 v_exp_f32 v236, v92
 v_exp_f32 v237, v93
 v_exp_f32 v238, v94
 v_exp_f32 v239, v95
 v_mfma_f32_32x32x16_bf16 v[80:95], a[8:11], v[24:27], v[48:63]
 s_add_u32 m0, s19, 16384
 v_exp_f32 v96, v64
 v_exp_f32 v97, v65
 v_exp_f32 v98, v66
 v_mfma_f32_32x32x16_bf16 v[80:95], a[12:15], v[28:31], v[80:95]
 buffer_load_dwordx4 v206, s[8:11], s22 offen sc1 lds
 v_exp_f32 v99, v67
 v_exp_f32 v100, v68
 v_exp_f32 v101, v69
 v_smfmac_f32_16x16x64_bf16 v[148:151], v[152:155], v[224:231], v156
 ds_read_b128 a[0:3], v8 offset:16384
 v_exp_f32 v102, v70
 v_smfmac_f32_16x16x64_bf16 v[148:151], v[152:155], v[232:239], v156
 ds_read_b128 a[4:7], v8 offset:17408
 v_exp_f32 v103, v71
 v_exp_f32 v104, v72
 v_smfmac_f32_32x32x32_bf16 v[128:143], a[16:19], v[224:231], v156
 s_add_u32 s30, s22, 8192
 v_exp_f32 v105, v73
 v_exp_f32 v106, v74
 v_exp_f32 v107, v75
 v_smfmac_f32_32x32x32_bf16 v[128:143], a[20:23], v[232:239], v156
 s_waitcnt lgkmcnt(0)
 buffer_load_dwordx4 v206, s[8:11], s22 offen offset:1024 sc1 lds
 v_exp_f32 v108, v76
 v_exp_f32 v109, v77
 v_exp_f32 v110, v78
 v_exp_f32 v111, v79
 v_mfma_f32_32x32x16_bf16 v[64:79], a[0:3], v[16:19], v[32:47]
 s_and_b32 s30, s30, 0x3ffff
 v_exp_f32 v224, v80
 v_exp_f32 v225, v81
 v_exp_f32 v226, v82
 v_mfma_f32_32x32x16_bf16 v[64:79], a[4:7], v[20:23], v[64:79]
 buffer_load_dwordx4 v1, s[8:11], s22 offen offset:2048 sc1 lds
 v_exp_f32 v227, v83
 v_exp_f32 v228, v84
 v_exp_f32 v229, v85
 v_smfmac_f32_16x16x64_bf16 v[144:147], v[152:155], v[96:103], v156
 ds_read_b128 a[16:19], v8 offset:18432
 v_exp_f32 v230, v86
 v_smfmac_f32_16x16x64_bf16 v[144:147], v[152:155], v[104:111], v156
 ds_read_b128 a[20:23], v8 offset:19456
 v_exp_f32 v231, v87
 v_exp_f32 v232, v88
 v_smfmac_f32_32x32x32_bf16 v[112:127], a[24:27], v[96:103], v156
 v_exp_f32 v233, v89
 v_exp_f32 v234, v90
 v_exp_f32 v235, v91
 v_smfmac_f32_32x32x32_bf16 v[112:127], a[28:31], v[104:111], v156
 buffer_load_dwordx4 v1, s[8:11], s22 offen offset:3072 sc1 lds
 v_exp_f32 v236, v92
 v_exp_f32 v237, v93
 v_exp_f32 v238, v94
 v_exp_f32 v239, v95
 v_mfma_f32_32x32x16_bf16 v[80:95], a[0:3], v[24:27], v[48:63]
 s_add_u32 m0, s19, 32768
 v_exp_f32 v96, v64
 v_exp_f32 v97, v65
 v_exp_f32 v98, v66
 v_mfma_f32_32x32x16_bf16 v[80:95], a[4:7], v[28:31], v[80:95]
 buffer_load_dwordx4 v206, s[8:11], s30 offen sc1 lds
 v_exp_f32 v99, v67
 v_exp_f32 v100, v68
 v_exp_f32 v101, v69
 v_smfmac_f32_16x16x64_bf16 v[148:151], v[152:155], v[224:231], v156
 ds_read_b128 a[8:11], v8 offset:20480
 v_exp_f32 v102, v70
 v_smfmac_f32_16x16x64_bf16 v[148:151], v[152:155], v[232:239], v156
 ds_read_b128 a[12:15], v8 offset:21504
 v_exp_f32 v103, v71
 v_exp_f32 v104, v72
 v_smfmac_f32_32x32x32_bf16 v[128:143], a[24:27], v[224:231], v156
 s_add_u32 s22, s30, 8192
 v_exp_f32 v105, v73
 v_exp_f32 v106, v74
 v_exp_f32 v107, v75
 v_smfmac_f32_32x32x32_bf16 v[128:143], a[28:31], v[232:239], v156
 s_waitcnt lgkmcnt(0)
 buffer_load_dwordx4 v206, s[8:11], s30 offen offset:1024 sc1 lds
 v_exp_f32 v108, v76
 v_exp_f32 v109, v77
 v_exp_f32 v110, v78
 v_exp_f32 v111, v79
 v_mfma_f32_32x32x16_bf16 v[64:79], a[8:11], v[16:19], v[32:47]
 s_and_b32 s22, s22, 0x3ffff
 v_exp_f32 v224, v80
 v_exp_f32 v225, v81
 v_exp_f32 v226, v82
 v_mfma_f32_32x32x16_bf16 v[64:79], a[12:15], v[20:23], v[64:79]
 buffer_load_dwordx4 v1, s[8:11], s30 offen offset:2048 sc1 lds
 v_exp_f32 v227, v83
 v_exp_f32 v228, v84
 v_exp_f32 v229, v85
 v_smfmac_f32_16x16x64_bf16 v[144:147], v[152:155], v[96:103], v156
 ds_read_b128 a[24:27], v8 offset:22528
 v_exp_f32 v230, v86
 v_smfmac_f32_16x16x64_bf16 v[144:147], v[152:155], v[104:111], v156
 ds_read_b128 a[28:31], v8 offset:23552
 v_exp_f32 v231, v87
 v_exp_f32 v232, v88
 v_smfmac_f32_32x32x32_bf16 v[112:127], a[16:19], v[96:103], v156
 v_exp_f32 v233, v89
 v_exp_f32 v234, v90
 v_exp_f32 v235, v91
 v_smfmac_f32_32x32x32_bf16 v[112:127], a[20:23], v[104:111], v156
 buffer_load_dwordx4 v1, s[8:11], s30 offen offset:3072 sc1 lds
 v_exp_f32 v236, v92
 v_exp_f32 v237, v93
 v_exp_f32 v238, v94
 v_exp_f32 v239, v95
 v_mfma_f32_32x32x16_bf16 v[80:95], a[8:11], v[24:27], v[48:63]
 s_add_u32 m0, s19, 49152
 v_exp_f32 v96, v64
 v_exp_f32 v97, v65
 v_exp_f32 v98, v66
 v_mfma_f32_32x32x16_bf16 v[80:95], a[12:15], v[28:31], v[80:95]
 buffer_load_dwordx4 v206, s[8:11], s22 offen sc1 lds
 v_exp_f32 v99, v67
 v_exp_f32 v100, v68
 v_exp_f32 v101, v69
 v_smfmac_f32_16x16x64_bf16 v[148:151], v[152:155], v[224:231], v156
 ds_read_b128 a[0:3], v8 offset:32768
 v_exp_f32 v102, v70
 v_smfmac_f32_16x16x64_bf16 v[148:151], v[152:155], v[232:239], v156
 ds_read_b128 a[4:7], v8 offset:33792
 v_exp_f32 v103, v71
 v_exp_f32 v104, v72
 v_smfmac_f32_32x32x32_bf16 v[128:143], a[16:19], v[224:231], v156
 s_add_u32 s30, s22, 8192
 v_exp_f32 v105, v73
 v_exp_f32 v106, v74
 v_exp_f32 v107, v75
 v_smfmac_f32_32x32x32_bf16 v[128:143], a[20:23], v[232:239], v156
 s_waitcnt lgkmcnt(0)
 buffer_load_dwordx4 v206, s[8:11], s22 offen offset:1024 sc1 lds
 v_exp_f32 v108, v76
 v_exp_f32 v109, v77
 v_exp_f32 v110, v78
 v_exp_f32 v111, v79
 v_mfma_f32_32x32x16_bf16 v[64:79], a[0:3], v[16:19], v[32:47]
 s_and_b32 s30, s30, 0x3ffff
 v_exp_f32 v224, v80
 v_exp_f32 v225, v81
 v_exp_f32 v226, v82
 v_mfma_f32_32x32x16_bf16 v[64:79], a[4:7], v[20:23], v[64:79]
 buffer_load_dwordx4 v1, s[8:11], s22 offen offset:2048 sc1 lds
 v_exp_f32 v227, v83
 v_exp_f32 v228, v84
 v_exp_f32 v229, v85
 v_smfmac_f32_16x16x64_bf16 v[144:147], v[152:155], v[96:103], v156
 ds_read_b128 a[16:19], v8 offset:34816
 v_exp_f32 v230, v86
 v_smfmac_f32_16x16x64_bf16 v[144:147], v[152:155], v[104:111], v156
 ds_read_b128 a[20:23], v8 offset:35840
 v_exp_f32 v231, v87
 v_exp_f32 v232, v88
 v_smfmac_f32_32x32x32_bf16 v[112:127], a[24:27], v[96:103], v156
 v_exp_f32 v233, v89
 v_exp_f32 v234, v90
 v_exp_f32 v235, v91
 v_smfmac_f32_32x32x32_bf16 v[112:127], a[28:31], v[104:111], v156
 buffer_load_dwordx4 v1, s[8:11], s22 offen offset:3072 sc1 lds
 v_exp_f32 v236, v92
 v_exp_f32 v237, v93
 v_exp_f32 v238, v94
 v_exp_f32 v239, v95
 v_mfma_f32_32x32x16_bf16 v[80:95], a[0:3], v[24:27], v[48:63]
 v_exp_f32 v96, v64
 v_exp_f32 v97, v65
 v_exp_f32 v98, v66
 v_mfma_f32_32x32x16_bf16 v[80:95], a[4:7], v[28:31], v[80:95]
 global_load_dword v7, v201, s[44:45] offset:3584
 v_exp_f32 v99, v67
 v_exp_f32 v100, v68
 v_exp_f32 v101, v69
 v_smfmac_f32_16x16x64_bf16 v[148:151], v[152:155], v[224:231], v156
 ds_read_b128 a[8:11], v8 offset:36864
 v_exp_f32 v102, v70
 v_smfmac_f32_16x16x64_bf16 v[148:151], v[152:155], v[232:239], v156
 ds_read_b128 a[12:15], v8 offset:37888
 v_exp_f32 v103, v71
 v_exp_f32 v104, v72
 v_smfmac_f32_32x32x32_bf16 v[128:143], a[24:27], v[224:231], v156
L_hop_6:
 s_cbranch_execz L_ret_1
 s_waitcnt vmcnt(19)
 v_exp_f32 v105, v73
 v_exp_f32 v106, v74
 v_exp_f32 v107, v75
 v_smfmac_f32_32x32x32_bf16 v[128:143], a[28:31], v[232:239], v156
 s_waitcnt lgkmcnt(0)
 v_exp_f32 v108, v76
 v_exp_f32 v109, v77
 v_exp_f32 v110, v78
 v_exp_f32 v111, v79
 v_mfma_f32_32x32x16_bf16 v[64:79], a[8:11], v[16:19], v[32:47]
 ds_read_b64_tr_b16 v[216:217], v196
 v_exp_f32 v224, v80
 v_exp_f32 v225, v81
 v_exp_f32 v226, v82
 v_mfma_f32_32x32x16_bf16 v[64:79], a[12:15], v[20:23], v[64:79]
 ds_read_b64_tr_b16 v[218:219], v196 offset:512
 v_exp_f32 v227, v83
 v_exp_f32 v228, v84
 v_exp_f32 v229, v85
 v_smfmac_f32_16x16x64_bf16 v[144:147], v[152:155], v[96:103], v156
 ds_read_b128 a[24:27], v8 offset:38912
 v_exp_f32 v230, v86
 v_smfmac_f32_16x16x64_bf16 v[144:147], v[152:155], v[104:111], v156
 ds_read_b128 a[28:31], v8 offset:39936
 v_exp_f32 v231, v87
 v_exp_f32 v232, v88
 v_smfmac_f32_32x32x32_bf16 v[112:127], a[16:19], v[96:103], v156
 v_exp_f32 v233, v89
 v_exp_f32 v234, v90
 v_exp_f32 v235, v91
 v_smfmac_f32_32x32x32_bf16 v[112:127], a[20:23], v[104:111], v156
 v_exp_f32 v236, v92
 v_exp_f32 v237, v93
 v_exp_f32 v238, v94
 v_exp_f32 v239, v95
 v_mfma_f32_32x32x16_bf16 v[80:95], a[8:11], v[24:27], v[48:63]
 s_waitcnt lgkmcnt(2)
 v_exp_f32 v96, v64
 v_exp_f32 v97, v65
 v_exp_f32 v98, v66
 v_mfma_f32_32x32x16_bf16 v[80:95], a[12:15], v[28:31], v[80:95]
 buffer_store_dwordx4 v[216:219], v197, s[4:7], s27 offen sc1
 v_exp_f32 v99, v67
 v_exp_f32 v100, v68
 v_exp_f32 v101, v69
 v_smfmac_f32_16x16x64_bf16 v[148:151], v[152:155], v[224:231], v156
 ds_read_b128 a[0:3], v8 offset:49152
 v_exp_f32 v102, v70
 v_smfmac_f32_16x16x64_bf16 v[148:151], v[152:155], v[232:239], v156
 ds_read_b128 a[4:7], v8 offset:50176
 v_exp_f32 v103, v71
 v_exp_f32 v104, v72
 v_smfmac_f32_32x32x32_bf16 v[128:143], a[16:19], v[224:231], v156
 s_add_u32 s27, s27, 1048576
 v_exp_f32 v105, v73
 v_exp_f32 v106, v74
 v_exp_f32 v107, v75
 v_smfmac_f32_32x32x32_bf16 v[128:143], a[20:23], v[232:239], v156
 s_waitcnt lgkmcnt(0)
 global_load_dwordx4 v[168:171], v199, s[36:37] offset:64
 v_exp_f32 v108, v76
 v_exp_f32 v109, v77
 v_exp_f32 v110, v78
 v_exp_f32 v111, v79
 v_mfma_f32_32x32x16_bf16 v[64:79], a[0:3], v[16:19], v[32:47]
 v_exp_f32 v224, v80
 v_exp_f32 v225, v81
 v_exp_f32 v226, v82
 v_mfma_f32_32x32x16_bf16 v[64:79], a[4:7], v[20:23], v[64:79]
 v_exp_f32 v227, v83
 v_exp_f32 v228, v84
 v_exp_f32 v229, v85
 v_smfmac_f32_16x16x64_bf16 v[144:147], v[152:155], v[96:103], v156
 ds_read_b128 a[16:19], v8 offset:51200
 v_exp_f32 v230, v86
 v_smfmac_f32_16x16x64_bf16 v[144:147], v[152:155], v[104:111], v156
 ds_read_b128 a[20:23], v8 offset:52224
 v_exp_f32 v231, v87
 v_exp_f32 v232, v88
 v_smfmac_f32_32x32x32_bf16 v[112:127], a[24:27], v[96:103], v156
 v_exp_f32 v233, v89
 v_exp_f32 v234, v90
 v_exp_f32 v235, v91
 v_smfmac_f32_32x32x32_bf16 v[112:127], a[28:31], v[104:111], v156
 v_exp_f32 v236, v92
 v_exp_f32 v237, v93
 v_exp_f32 v238, v94
 v_exp_f32 v239, v95
 v_mfma_f32_32x32x16_bf16 v[80:95], a[0:3], v[24:27], v[48:63]
 s_mov_b32 m0, s24
 v_exp_f32 v96, v64
 v_exp_f32 v97, v65
 v_exp_f32 v98, v66
 v_mfma_f32_32x32x16_bf16 v[80:95], a[4:7], v[28:31], v[80:95]
 buffer_load_dwordx4 v198, s[12:15], s20 offen nt lds
 v_exp_f32 v99, v67
 v_exp_f32 v100, v68
 v_exp_f32 v101, v69
 v_smfmac_f32_16x16x64_bf16 v[148:151], v[152:155], v[224:231], v156
 ds_read_b128 a[8:11], v8 offset:53248
 v_exp_f32 v102, v70
 v_smfmac_f32_16x16x64_bf16 v[148:151], v[152:155], v[232:239], v156
 ds_read_b128 a[12:15], v8 offset:54272
 v_exp_f32 v103, v71
 v_exp_f32 v104, v72
 v_smfmac_f32_32x32x32_bf16 v[128:143], a[24:27], v[224:231], v156
 s_add_u32 s20, s20, 1048576
 v_exp_f32 v105, v73
 v_exp_f32 v106, v74
 v_exp_f32 v107, v75
 v_smfmac_f32_32x32x32_bf16 v[128:143], a[28:31], v[232:239], v156
 s_waitcnt lgkmcnt(0)
 v_exp_f32 v108, v76
 v_exp_f32 v109, v77
 v_exp_f32 v110, v78
 v_exp_f32 v111, v79
 v_mfma_f32_32x32x16_bf16 v[64:79], a[8:11], v[16:19], v[32:47]
 s_mov_b32 s21, 1835008
 v_exp_f32 v224, v80
 v_exp_f32 v225, v81
 v_exp_f32 v226, v82
 v_mfma_f32_32x32x16_bf16 v[64:79], a[12:15], v[20:23], v[64:79]
 s_add_u32 m0, s19, 131072
 s_nop 0
 buffer_load_dwordx4 v192, s[56:59], s21 offen lds
 v_exp_f32 v227, v83
 v_exp_f32 v228, v84
 v_exp_f32 v229, v85
 v_smfmac_f32_16x16x64_bf16 v[144:147], v[152:155], v[96:103], v156
 ds_read_b128 a[24:27], v8 offset:55296
 v_exp_f32 v230, v86
 v_smfmac_f32_16x16x64_bf16 v[144:147], v[152:155], v[104:111], v156
 ds_read_b128 a[28:31], v8 offset:56320
 v_exp_f32 v231, v87
 v_exp_f32 v232, v88
 v_smfmac_f32_32x32x32_bf16 v[112:127], a[16:19], v[96:103], v156
 v_exp_f32 v233, v89
 v_exp_f32 v234, v90
 v_exp_f32 v235, v91
 v_smfmac_f32_32x32x32_bf16 v[112:127], a[20:23], v[104:111], v156
 buffer_load_dwordx4 v193, s[56:59], s21 offen offset:1024 lds
 v_exp_f32 v236, v92
 v_exp_f32 v237, v93
 v_exp_f32 v238, v94
 v_exp_f32 v239, v95
 v_mfma_f32_32x32x16_bf16 v[80:95], a[8:11], v[24:27], v[48:63]
 s_waitcnt vmcnt(6) lgkmcnt(0)
 v_exp_f32 v96, v64
 v_exp_f32 v97, v65
 v_exp_f32 v98, v66
 v_mfma_f32_32x32x16_bf16 v[80:95], a[12:15], v[28:31], v[80:95]
 s_barrier
 v_exp_f32 v99, v67
 v_exp_f32 v100, v68
 v_exp_f32 v101, v69
 v_smfmac_f32_16x16x64_bf16 v[148:151], v[152:155], v[224:231], v156
 ds_read_b128 a[0:3], v202
 v_exp_f32 v102, v70
 v_smfmac_f32_16x16x64_bf16 v[148:151], v[152:155], v[232:239], v156
 ds_read_b128 a[4:7], v202 offset:1024
 v_exp_f32 v103, v71
 v_exp_f32 v104, v72
 v_smfmac_f32_32x32x32_bf16 v[128:143], a[16:19], v[224:231], v156
 s_mov_b32 s29, 0
 v_exp_f32 v105, v73
 v_exp_f32 v106, v74
 v_exp_f32 v107, v75
 v_smfmac_f32_32x32x32_bf16 v[128:143], a[20:23], v[232:239], v156
 s_waitcnt lgkmcnt(0)
 buffer_load_dwordx4 v194, s[56:59], s21 offen offset:2048 lds
 v_exp_f32 v108, v76
 v_exp_f32 v109, v77
 v_exp_f32 v110, v78
 v_exp_f32 v111, v79
 v_mfma_f32_32x32x16_bf16 v[64:79], a[0:3], v[16:19], v[32:47]
 v_exp_f32 v224, v80
 v_exp_f32 v225, v81
 v_exp_f32 v226, v82
 v_mfma_f32_32x32x16_bf16 v[64:79], a[4:7], v[20:23], v[64:79]
 buffer_load_dwordx4 v195, s[56:59], s21 offen offset:3072 lds
 v_exp_f32 v227, v83
 v_exp_f32 v228, v84
 v_exp_f32 v229, v85
 v_smfmac_f32_16x16x64_bf16 v[144:147], v[152:155], v[96:103], v156
 ds_read_b128 a[16:19], v202 offset:2048
 v_exp_f32 v230, v86
 v_smfmac_f32_16x16x64_bf16 v[144:147], v[152:155], v[104:111], v156
 ds_read_b128 a[20:23], v202 offset:3072
 v_exp_f32 v231, v87
 v_exp_f32 v232, v88
 v_smfmac_f32_32x32x32_bf16 v[112:127], a[24:27], v[96:103], v156
 v_exp_f32 v233, v89
 v_exp_f32 v234, v90
 v_exp_f32 v235, v91
 v_smfmac_f32_32x32x32_bf16 v[112:127], a[28:31], v[104:111], v156
 v_exp_f32 v236, v92
 v_exp_f32 v237, v93
 v_exp_f32 v238, v94
 v_exp_f32 v239, v95
 v_mfma_f32_32x32x16_bf16 v[80:95], a[0:3], v[24:27], v[48:63]
 s_add_u32 m0, s19, 65536
 v_exp_f32 v96, v64
 v_exp_f32 v97, v65
 v_exp_f32 v98, v66
 v_mfma_f32_32x32x16_bf16 v[80:95], a[4:7], v[28:31], v[80:95]
 buffer_load_dwordx4 v206, s[8:11], s30 offen sc1 lds
 v_exp_f32 v99, v67
 v_exp_f32 v100, v68
 v_exp_f32 v101, v69
 v_smfmac_f32_16x16x64_bf16 v[148:151], v[152:155], v[224:231], v156
 ds_read_b128 a[8:11], v202 offset:4096
 v_exp_f32 v102, v70
 v_smfmac_f32_16x16x64_bf16 v[148:151], v[152:155], v[232:239], v156
 ds_read_b128 a[12:15], v202 offset:5120
 v_exp_f32 v103, v71
 v_exp_f32 v104, v72
 v_smfmac_f32_32x32x32_bf16 v[128:143], a[24:27], v[224:231], v156
 s_add_u32 s22, s30, 8192
 v_exp_f32 v105, v73
 v_exp_f32 v106, v74
 v_exp_f32 v107, v75
 v_smfmac_f32_32x32x32_bf16 v[128:143], a[28:31], v[232:239], v156
 s_waitcnt lgkmcnt(0)
 buffer_load_dwordx4 v206, s[8:11], s30 offen offset:1024 sc1 lds
 v_exp_f32 v108, v76
 v_exp_f32 v109, v77
 v_exp_f32 v110, v78
 v_exp_f32 v111, v79
 v_mfma_f32_32x32x16_bf16 v[64:79], a[8:11], v[16:19], v[32:47]
 s_and_b32 s22, s22, 0x3ffff
 v_exp_f32 v224, v80
 v_exp_f32 v225, v81
 v_exp_f32 v226, v82
 v_mfma_f32_32x32x16_bf16 v[64:79], a[12:15], v[20:23], v[64:79]
 buffer_load_dwordx4 v1, s[8:11], s30 offen offset:2048 sc1 lds
 v_exp_f32 v227, v83
 v_exp_f32 v228, v84
 v_exp_f32 v229, v85
 v_smfmac_f32_16x16x64_bf16 v[144:147], v[152:155], v[96:103], v156
 ds_read_b128 a[24:27], v202 offset:6144
 v_exp_f32 v230, v86
 v_smfmac_f32_16x16x64_bf16 v[144:147], v[152:155], v[104:111], v156
 ds_read_b128 a[28:31], v202 offset:7168
 v_exp_f32 v231, v87
 v_exp_f32 v232, v88
 v_smfmac_f32_32x32x32_bf16 v[112:127], a[16:19], v[96:103], v156
 v_exp_f32 v233, v89
 v_exp_f32 v234, v90
 v_exp_f32 v235, v91
 v_smfmac_f32_32x32x32_bf16 v[112:127], a[20:23], v[104:111], v156
 buffer_load_dwordx4 v1, s[8:11], s30 offen offset:3072 sc1 lds
 v_exp_f32 v236, v92
 v_exp_f32 v237, v93
 v_exp_f32 v238, v94
 v_exp_f32 v239, v95
 v_mfma_f32_32x32x16_bf16 v[80:95], a[8:11], v[24:27], v[48:63]
 s_add_u32 m0, s19, 81920
 v_exp_f32 v96, v64
 v_exp_f32 v97, v65
 v_exp_f32 v98, v66
 v_mfma_f32_32x32x16_bf16 v[80:95], a[12:15], v[28:31], v[80:95]
 buffer_load_dwordx4 v206, s[8:11], s22 offen sc1 lds
 v_exp_f32 v99, v67
 v_exp_f32 v100, v68
 v_exp_f32 v101, v69
 v_smfmac_f32_16x16x64_bf16 v[148:151], v[152:155], v[224:231], v156
 ds_read_b128 a[0:3], v202 offset:16384
 v_exp_f32 v102, v70
 v_smfmac_f32_16x16x64_bf16 v[148:151], v[152:155], v[232:239], v156
 ds_read_b128 a[4:7], v202 offset:17408
 v_exp_f32 v103, v71
 v_exp_f32 v104, v72
 v_smfmac_f32_32x32x32_bf16 v[128:143], a[16:19], v[224:231], v156
 s_add_u32 s30, s22, 8192
 v_exp_f32 v105, v73
 v_exp_f32 v106, v74
 v_exp_f32 v107, v75
 v_smfmac_f32_32x32x32_bf16 v[128:143], a[20:23], v[232:239], v156
 s_waitcnt lgkmcnt(0)
 buffer_load_dwordx4 v206, s[8:11], s22 offen offset:1024 sc1 lds
 v_exp_f32 v108, v76
 v_exp_f32 v109, v77
 v_exp_f32 v110, v78
 v_exp_f32 v111, v79
 v_mfma_f32_32x32x16_bf16 v[64:79], a[0:3], v[16:19], v[32:47]
 s_and_b32 s30, s30, 0x3ffff
 v_exp_f32 v224, v80
 v_exp_f32 v225, v81
 v_exp_f32 v226, v82
 v_mfma_f32_32x32x16_bf16 v[64:79], a[4:7], v[20:23], v[64:79]
 buffer_load_dwordx4 v1, s[8:11], s22 offen offset:2048 sc1 lds
 v_exp_f32 v227, v83
 v_exp_f32 v228, v84
 v_exp_f32 v229, v85
 v_smfmac_f32_16x16x64_bf16 v[144:147], v[152:155], v[96:103], v156
 ds_read_b128 a[16:19], v202 offset:18432
 v_exp_f32 v230, v86
 v_smfmac_f32_16x16x64_bf16 v[144:147], v[152:155], v[104:111], v156
 ds_read_b128 a[20:23], v202 offset:19456
 v_exp_f32 v231, v87
 v_exp_f32 v232, v88
 v_smfmac_f32_32x32x32_bf16 v[112:127], a[24:27], v[96:103], v156
 v_exp_f32 v233, v89
 v_exp_f32 v234, v90
 v_exp_f32 v235, v91
 v_smfmac_f32_32x32x32_bf16 v[112:127], a[28:31], v[104:111], v156
 buffer_load_dwordx4 v1, s[8:11], s22 offen offset:3072 sc1 lds
 v_exp_f32 v236, v92
 v_exp_f32 v237, v93
 v_exp_f32 v238, v94
 v_exp_f32 v239, v95
 v_mfma_f32_32x32x16_bf16 v[80:95], a[0:3], v[24:27], v[48:63]
 s_add_u32 m0, s19, 98304
 v_exp_f32 v96, v64
 v_exp_f32 v97, v65
 v_exp_f32 v98, v66
 v_mfma_f32_32x32x16_bf16 v[80:95], a[4:7], v[28:31], v[80:95]
 buffer_load_dwordx4 v206, s[8:11], s30 offen sc1 lds
 v_exp_f32 v99, v67
 v_exp_f32 v100, v68
 v_exp_f32 v101, v69
 v_smfmac_f32_16x16x64_bf16 v[148:151], v[152:155], v[224:231], v156
 ds_read_b128 a[8:11], v202 offset:20480
 v_exp_f32 v102, v70
 v_smfmac_f32_16x16x64_bf16 v[148:151], v[152:155], v[232:239], v156
 ds_read_b128 a[12:15], v202 offset:21504
 v_exp_f32 v103, v71
 v_exp_f32 v104, v72
 v_smfmac_f32_32x32x32_bf16 v[128:143], a[24:27], v[224:231], v156
 s_add_u32 s22, s30, 8192
 v_exp_f32 v105, v73
 v_exp_f32 v106, v74
 v_exp_f32 v107, v75
 v_smfmac_f32_32x32x32_bf16 v[128:143], a[28:31], v[232:239], v156
 s_waitcnt lgkmcnt(0)
 buffer_load_dwordx4 v206, s[8:11], s30 offen offset:1024 sc1 lds
 v_exp_f32 v108, v76
 v_exp_f32 v109, v77
 v_exp_f32 v110, v78
 v_exp_f32 v111, v79
 v_mfma_f32_32x32x16_bf16 v[64:79], a[8:11], v[16:19], v[32:47]
 s_and_b32 s22, s22, 0x3ffff
 v_exp_f32 v224, v80
 v_exp_f32 v225, v81
 v_exp_f32 v226, v82
 v_mfma_f32_32x32x16_bf16 v[64:79], a[12:15], v[20:23], v[64:79]
 buffer_load_dwordx4 v1, s[8:11], s30 offen offset:2048 sc1 lds
 v_exp_f32 v227, v83
 v_exp_f32 v228, v84
 v_exp_f32 v229, v85
 v_smfmac_f32_16x16x64_bf16 v[144:147], v[152:155], v[96:103], v156
 ds_read_b128 a[24:27], v202 offset:22528
 v_exp_f32 v230, v86
 v_smfmac_f32_16x16x64_bf16 v[144:147], v[152:155], v[104:111], v156
 ds_read_b128 a[28:31], v202 offset:23552
 v_exp_f32 v231, v87
 v_exp_f32 v232, v88
 v_smfmac_f32_32x32x32_bf16 v[112:127], a[16:19], v[96:103], v156
 v_exp_f32 v233, v89
 v_exp_f32 v234, v90
 v_exp_f32 v235, v91
 v_smfmac_f32_32x32x32_bf16 v[112:127], a[20:23], v[104:111], v156
 buffer_load_dwordx4 v1, s[8:11], s30 offen offset:3072 sc1 lds
 v_exp_f32 v236, v92
 v_exp_f32 v237, v93
 v_exp_f32 v238, v94
 v_exp_f32 v239, v95
 v_mfma_f32_32x32x16_bf16 v[80:95], a[8:11], v[24:27], v[48:63]
 s_add_u32 m0, s19, 114688
 v_exp_f32 v96, v64
 v_exp_f32 v97, v65
 v_exp_f32 v98, v66
 v_mfma_f32_32x32x16_bf16 v[80:95], a[12:15], v[28:31], v[80:95]
 buffer_load_dwordx4 v206, s[8:11], s22 offen sc1 lds
 v_exp_f32 v99, v67
 v_exp_f32 v100, v68
 v_exp_f32 v101, v69
 v_smfmac_f32_16x16x64_bf16 v[148:151], v[152:155], v[224:231], v156
 ds_read_b128 a[0:3], v202 offset:32768
 v_exp_f32 v102, v70
 v_smfmac_f32_16x16x64_bf16 v[148:151], v[152:155], v[232:239], v156
 ds_read_b128 a[4:7], v202 offset:33792
 v_exp_f32 v103, v71
 v_exp_f32 v104, v72
 v_smfmac_f32_32x32x32_bf16 v[128:143], a[16:19], v[224:231], v156
 s_add_u32 s30, s22, 8192
 v_exp_f32 v105, v73
 v_exp_f32 v106, v74
 v_exp_f32 v107, v75
 v_smfmac_f32_32x32x32_bf16 v[128:143], a[20:23], v[232:239], v156
 s_waitcnt lgkmcnt(0)
 buffer_load_dwordx4 v206, s[8:11], s22 offen offset:1024 sc1 lds
 v_exp_f32 v108, v76
 v_exp_f32 v109, v77
 v_exp_f32 v110, v78
 v_exp_f32 v111, v79
 v_mfma_f32_32x32x16_bf16 v[64:79], a[0:3], v[16:19], v[32:47]
 s_and_b32 s30, s30, 0x3ffff
 v_exp_f32 v224, v80
 v_exp_f32 v225, v81
 v_exp_f32 v226, v82
 v_mfma_f32_32x32x16_bf16 v[64:79], a[4:7], v[20:23], v[64:79]
 buffer_load_dwordx4 v1, s[8:11], s22 offen offset:2048 sc1 lds
 v_exp_f32 v227, v83
 v_exp_f32 v228, v84
 v_exp_f32 v229, v85
 v_smfmac_f32_16x16x64_bf16 v[144:147], v[152:155], v[96:103], v156
 ds_read_b128 a[16:19], v202 offset:34816
 v_exp_f32 v230, v86
 v_smfmac_f32_16x16x64_bf16 v[144:147], v[152:155], v[104:111], v156
 ds_read_b128 a[20:23], v202 offset:35840
 v_exp_f32 v231, v87
 v_exp_f32 v232, v88
 v_smfmac_f32_32x32x32_bf16 v[112:127], a[24:27], v[96:103], v156
 v_exp_f32 v233, v89
 v_exp_f32 v234, v90
 v_exp_f32 v235, v91
 v_smfmac_f32_32x32x32_bf16 v[112:127], a[28:31], v[104:111], v156
 buffer_load_dwordx4 v1, s[8:11], s22 offen offset:3072 sc1 lds
 v_exp_f32 v236, v92
 v_exp_f32 v237, v93
 v_exp_f32 v238, v94
 v_exp_f32 v239, v95
 v_mfma_f32_32x32x16_bf16 v[80:95], a[0:3], v[24:27], v[48:63]
 v_exp_f32 v96, v64
 v_exp_f32 v97, v65
 v_exp_f32 v98, v66
 v_mfma_f32_32x32x16_bf16 v[80:95], a[4:7], v[28:31], v[80:95]
 global_load_dword v7, v201, s[46:47] offset:3584
 v_exp_f32 v99, v67
 v_exp_f32 v100, v68
 v_exp_f32 v101, v69
 v_smfmac_f32_16x16x64_bf16 v[148:151], v[152:155], v[224:231], v156
 ds_read_b128 a[8:11], v202 offset:36864
 v_exp_f32 v102, v70
 v_smfmac_f32_16x16x64_bf16 v[148:151], v[152:155], v[232:239], v156
 ds_read_b128 a[12:15], v202 offset:37888
 v_exp_f32 v103, v71
 v_exp_f32 v104, v72
 v_smfmac_f32_32x32x32_bf16 v[128:143], a[24:27], v[224:231], v156
 s_waitcnt vmcnt(21)
 v_exp_f32 v105, v73
 v_exp_f32 v106, v74
 v_exp_f32 v107, v75
 v_smfmac_f32_32x32x32_bf16 v[128:143], a[28:31], v[232:239], v156
 s_waitcnt lgkmcnt(0)
 v_exp_f32 v108, v76
 v_exp_f32 v109, v77
 v_exp_f32 v110, v78
 v_exp_f32 v111, v79
 v_mfma_f32_32x32x16_bf16 v[64:79], a[8:11], v[16:19], v[32:47]
 ds_read_b64_tr_b16 v[216:217], v196
 v_exp_f32 v224, v80
 v_exp_f32 v225, v81
 v_exp_f32 v226, v82
 v_mfma_f32_32x32x16_bf16 v[64:79], a[12:15], v[20:23], v[64:79]
 ds_read_b64_tr_b16 v[218:219], v196 offset:512
 v_exp_f32 v227, v83
 v_exp_f32 v228, v84
 v_exp_f32 v229, v85
 v_smfmac_f32_16x16x64_bf16 v[144:147], v[152:155], v[96:103], v156
 ds_read_b128 a[24:27], v202 offset:38912
 v_exp_f32 v230, v86
 v_smfmac_f32_16x16x64_bf16 v[144:147], v[152:155], v[104:111], v156
 ds_read_b128 a[28:31], v202 offset:39936
 v_exp_f32 v231, v87
 v_exp_f32 v232, v88
 v_smfmac_f32_32x32x32_bf16 v[112:127], a[16:19], v[96:103], v156
 v_exp_f32 v233, v89
 v_exp_f32 v234, v90
 v_exp_f32 v235, v91
 v_smfmac_f32_32x32x32_bf16 v[112:127], a[20:23], v[104:111], v156
 v_exp_f32 v236, v92
 v_exp_f32 v237, v93
 v_exp_f32 v238, v94
 v_exp_f32 v239, v95
 v_mfma_f32_32x32x16_bf16 v[80:95], a[8:11], v[24:27], v[48:63]
 s_waitcnt lgkmcnt(2)
 v_exp_f32 v96, v64
 v_exp_f32 v97, v65
 v_exp_f32 v98, v66
 v_mfma_f32_32x32x16_bf16 v[80:95], a[12:15], v[28:31], v[80:95]
 buffer_store_dwordx4 v[216:219], v197, s[4:7], s27 offen sc1
 v_exp_f32 v99, v67
 v_exp_f32 v100, v68
 v_exp_f32 v101, v69
 v_smfmac_f32_16x16x64_bf16 v[148:151], v[152:155], v[224:231], v156
 ds_read_b128 a[0:3], v202 offset:49152
 v_exp_f32 v102, v70
 v_smfmac_f32_16x16x64_bf16 v[148:151], v[152:155], v[232:239], v156
 ds_read_b128 a[4:7], v202 offset:50176
 v_exp_f32 v103, v71
 v_exp_f32 v104, v72
 v_smfmac_f32_32x32x32_bf16 v[128:143], a[16:19], v[224:231], v156
 s_add_u32 s27, s27, 1048576
 v_exp_f32 v105, v73
 v_exp_f32 v106, v74
 v_exp_f32 v107, v75
 v_smfmac_f32_32x32x32_bf16 v[128:143], a[20:23], v[232:239], v156
 s_waitcnt lgkmcnt(0)
 global_load_dwordx4 v[172:175], v199, s[36:37] offset:96
 v_exp_f32 v108, v76
 v_exp_f32 v109, v77
 v_exp_f32 v110, v78
 v_exp_f32 v111, v79
 v_mfma_f32_32x32x16_bf16 v[64:79], a[0:3], v[16:19], v[32:47]
 v_exp_f32 v224, v80
 v_exp_f32 v225, v81
 v_exp_f32 v226, v82
 v_mfma_f32_32x32x16_bf16 v[64:79], a[4:7], v[20:23], v[64:79]
 v_exp_f32 v227, v83
 v_exp_f32 v228, v84
 v_exp_f32 v229, v85
 v_smfmac_f32_16x16x64_bf16 v[144:147], v[152:155], v[96:103], v156
 ds_read_b128 a[16:19], v202 offset:51200
 v_exp_f32 v230, v86
 v_smfmac_f32_16x16x64_bf16 v[144:147], v[152:155], v[104:111], v156
 ds_read_b128 a[20:23], v202 offset:52224
 v_exp_f32 v231, v87
 v_exp_f32 v232, v88
 v_smfmac_f32_32x32x32_bf16 v[112:127], a[24:27], v[96:103], v156
 v_exp_f32 v233, v89
 v_exp_f32 v234, v90
 v_exp_f32 v235, v91
 v_smfmac_f32_32x32x32_bf16 v[112:127], a[28:31], v[104:111], v156
 v_exp_f32 v236, v92
 v_exp_f32 v237, v93
 v_exp_f32 v238, v94
 v_exp_f32 v239, v95
 v_mfma_f32_32x32x16_bf16 v[80:95], a[0:3], v[24:27], v[48:63]
 s_mov_b32 m0, s24
 v_exp_f32 v96, v64
 v_exp_f32 v97, v65
 v_exp_f32 v98, v66
 v_mfma_f32_32x32x16_bf16 v[80:95], a[4:7], v[28:31], v[80:95]
 buffer_load_dwordx4 v198, s[12:15], s20 offen nt lds
 v_exp_f32 v99, v67
 v_exp_f32 v100, v68
 v_exp_f32 v101, v69
 v_smfmac_f32_16x16x64_bf16 v[148:151], v[152:155], v[224:231], v156
 ds_read_b128 a[8:11], v202 offset:53248
 v_exp_f32 v102, v70
 v_smfmac_f32_16x16x64_bf16 v[148:151], v[152:155], v[232:239], v156
 ds_read_b128 a[12:15], v202 offset:54272
 v_exp_f32 v103, v71
 v_exp_f32 v104, v72
 v_smfmac_f32_32x32x32_bf16 v[128:143], a[24:27], v[224:231], v156
 s_add_u32 s20, s20, 1048576
 v_exp_f32 v105, v73
 v_exp_f32 v106, v74
 v_exp_f32 v107, v75
 v_smfmac_f32_32x32x32_bf16 v[128:143], a[28:31], v[232:239], v156
 s_waitcnt lgkmcnt(0)
 s_cmp_lg_u32 s16, 0
 s_cbranch_scc1 L_look_16
 buffer_load_dword v207, v213, s[4:7], s28 offen sc1
L_look_16:
 v_exp_f32 v108, v76
 v_exp_f32 v109, v77
 v_exp_f32 v110, v78
 v_exp_f32 v111, v79
 v_mfma_f32_32x32x16_bf16 v[64:79], a[8:11], v[16:19], v[32:47]
 v_exp_f32 v224, v80
 v_exp_f32 v225, v81
 v_exp_f32 v226, v82
 v_mfma_f32_32x32x16_bf16 v[64:79], a[12:15], v[20:23], v[64:79]
 v_exp_f32 v227, v83
 v_exp_f32 v228, v84
 v_exp_f32 v229, v85
 v_smfmac_f32_16x16x64_bf16 v[144:147], v[152:155], v[96:103], v156
 ds_read_b128 a[24:27], v202 offset:55296
 v_exp_f32 v230, v86
 v_smfmac_f32_16x16x64_bf16 v[144:147], v[152:155], v[104:111], v156
 ds_read_b128 a[28:31], v202 offset:56320
 v_exp_f32 v231, v87
 v_exp_f32 v232, v88
 v_smfmac_f32_32x32x32_bf16 v[112:127], a[16:19], v[96:103], v156
 v_exp_f32 v233, v89
 v_exp_f32 v234, v90
 v_exp_f32 v235, v91
 v_smfmac_f32_32x32x32_bf16 v[112:127], a[20:23], v[104:111], v156
 v_exp_f32 v236, v92
 v_exp_f32 v237, v93
 v_exp_f32 v238, v94
 v_exp_f32 v239, v95
 v_mfma_f32_32x32x16_bf16 v[80:95], a[8:11], v[24:27], v[48:63]
 s_waitcnt vmcnt(4) lgkmcnt(0)
 v_exp_f32 v96, v64
 v_exp_f32 v97, v65
 v_exp_f32 v98, v66
 v_mfma_f32_32x32x16_bf16 v[80:95], a[12:15], v[28:31], v[80:95]
 s_barrier
 v_exp_f32 v99, v67
 v_exp_f32 v100, v68
 v_exp_f32 v101, v69
 v_smfmac_f32_16x16x64_bf16 v[148:151], v[152:155], v[224:231], v156
 ds_read_b128 a[0:3], v8
 v_exp_f32 v102, v70
 v_smfmac_f32_16x16x64_bf16 v[148:151], v[152:155], v[232:239], v156
 ds_read_b128 a[4:7], v8 offset:1024
 v_exp_f32 v103, v71
 v_exp_f32 v104, v72
 v_smfmac_f32_32x32x32_bf16 v[128:143], a[16:19], v[224:231], v156
 v_exp_f32 v105, v73
 v_exp_f32 v106, v74
 v_exp_f32 v107, v75
 v_smfmac_f32_32x32x32_bf16 v[128:143], a[20:23], v[232:239], v156
 s_waitcnt lgkmcnt(0)
 v_exp_f32 v108, v76
 v_exp_f32 v109, v77
 v_exp_f32 v110, v78
 v_exp_f32 v111, v79
 v_mfma_f32_32x32x16_bf16 v[64:79], a[0:3], v[16:19], v[32:47]
 v_exp_f32 v224, v80
 v_exp_f32 v225, v81
 v_exp_f32 v226, v82
 v_mfma_f32_32x32x16_bf16 v[64:79], a[4:7], v[20:23], v[64:79]
 v_exp_f32 v227, v83
 v_exp_f32 v228, v84
 v_exp_f32 v229, v85
 v_smfmac_f32_16x16x64_bf16 v[144:147], v[152:155], v[96:103], v156
 ds_read_b128 a[16:19], v8 offset:2048
 v_exp_f32 v230, v86
 v_smfmac_f32_16x16x64_bf16 v[144:147], v[152:155], v[104:111], v156
 ds_read_b128 a[20:23], v8 offset:3072
 v_exp_f32 v231, v87
 v_exp_f32 v232, v88
 v_smfmac_f32_32x32x32_bf16 v[112:127], a[24:27], v[96:103], v156
 v_exp_f32 v233, v89
 v_exp_f32 v234, v90
 v_exp_f32 v235, v91
 v_smfmac_f32_32x32x32_bf16 v[112:127], a[28:31], v[104:111], v156
 v_exp_f32 v236, v92
 v_exp_f32 v237, v93
 v_exp_f32 v238, v94
 v_exp_f32 v239, v95
 v_mfma_f32_32x32x16_bf16 v[80:95], a[0:3], v[24:27], v[48:63]
 s_mov_b32 m0, s19
 v_exp_f32 v96, v64
 v_exp_f32 v97, v65
 v_exp_f32 v98, v66
 v_mfma_f32_32x32x16_bf16 v[80:95], a[4:7], v[28:31], v[80:95]
 buffer_load_dwordx4 v206, s[8:11], s30 offen sc1 lds
 v_exp_f32 v99, v67
 v_exp_f32 v100, v68
 v_exp_f32 v101, v69
 v_smfmac_f32_16x16x64_bf16 v[148:151], v[152:155], v[224:231], v156
 ds_read_b128 a[8:11], v8 offset:4096
 v_exp_f32 v102, v70
 v_smfmac_f32_16x16x64_bf16 v[148:151], v[152:155], v[232:239], v156
 ds_read_b128 a[12:15], v8 offset:5120
 v_exp_f32 v103, v71
 v_exp_f32 v104, v72
 v_smfmac_f32_32x32x32_bf16 v[128:143], a[24:27], v[224:231], v156
 s_add_u32 s22, s30, 8192
 v_exp_f32 v105, v73
 v_exp_f32 v106, v74
 v_exp_f32 v107, v75
 v_smfmac_f32_32x32x32_bf16 v[128:143], a[28:31], v[232:239], v156
 s_waitcnt lgkmcnt(0)
 buffer_load_dwordx4 v206, s[8:11], s30 offen offset:1024 sc1 lds
 v_exp_f32 v108, v76
 v_exp_f32 v109, v77
 v_exp_f32 v110, v78
 v_exp_f32 v111, v79
 v_mfma_f32_32x32x16_bf16 v[64:79], a[8:11], v[16:19], v[32:47]
 s_and_b32 s22, s22, 0x3ffff
 v_exp_f32 v224, v80
 v_exp_f32 v225, v81
 v_exp_f32 v226, v82
 v_mfma_f32_32x32x16_bf16 v[64:79], a[12:15], v[20:23], v[64:79]
 buffer_load_dwordx4 v1, s[8:11], s30 offen offset:2048 sc1 lds
 v_exp_f32 v227, v83
 v_exp_f32 v228, v84
 v_exp_f32 v229, v85
 v_smfmac_f32_16x16x64_bf16 v[144:147], v[152:155], v[96:103], v156
 ds_read_b128 a[24:27], v8 offset:6144
 v_exp_f32 v230, v86
 v_smfmac_f32_16x16x64_bf16 v[144:147], v[152:155], v[104:111], v156
 ds_read_b128 a[28:31], v8 offset:7168
 v_exp_f32 v231, v87
 v_exp_f32 v232, v88
 v_smfmac_f32_32x32x32_bf16 v[112:127], a[16:19], v[96:103], v156
 v_exp_f32 v233, v89
 v_exp_f32 v234, v90
 v_exp_f32 v235, v91
 v_smfmac_f32_32x32x32_bf16 v[112:127], a[20:23], v[104:111], v156
 buffer_load_dwordx4 v1, s[8:11], s30 offen offset:3072 sc1 lds
 v_exp_f32 v236, v92
 v_exp_f32 v237, v93
 v_exp_f32 v238, v94
 v_exp_f32 v239, v95
 v_mfma_f32_32x32x16_bf16 v[80:95], a[8:11], v[24:27], v[48:63]
 s_add_u32 m0, s19, 16384
 v_exp_f32 v96, v64
 v_exp_f32 v97, v65
 v_exp_f32 v98, v66
 v_mfma_f32_32x32x16_bf16 v[80:95], a[12:15], v[28:31], v[80:95]
 buffer_load_dwordx4 v206, s[8:11], s22 offen sc1 lds
 v_exp_f32 v99, v67
 v_exp_f32 v100, v68
 v_exp_f32 v101, v69
 v_smfmac_f32_16x16x64_bf16 v[148:151], v[152:155], v[224:231], v156
 ds_read_b128 a[0:3], v8 offset:16384
 v_exp_f32 v102, v70
 v_smfmac_f32_16x16x64_bf16 v[148:151], v[152:155], v[232:239], v156
 ds_read_b128 a[4:7], v8 offset:17408
 v_exp_f32 v103, v71
 v_exp_f32 v104, v72
 v_smfmac_f32_32x32x32_bf16 v[128:143], a[16:19], v[224:231], v156
 s_add_u32 s30, s22, 8192
 v_exp_f32 v105, v73
 v_exp_f32 v106, v74
 v_exp_f32 v107, v75
 v_smfmac_f32_32x32x32_bf16 v[128:143], a[20:23], v[232:239], v156
 s_waitcnt lgkmcnt(0)
 buffer_load_dwordx4 v206, s[8:11], s22 offen offset:1024 sc1 lds
 v_exp_f32 v108, v76
 v_exp_f32 v109, v77
 v_exp_f32 v110, v78
 v_exp_f32 v111, v79
 v_mfma_f32_32x32x16_bf16 v[64:79], a[0:3], v[16:19], v[32:47]
 s_and_b32 s30, s30, 0x3ffff
 v_exp_f32 v224, v80
 v_exp_f32 v225, v81
 v_exp_f32 v226, v82
 v_mfma_f32_32x32x16_bf16 v[64:79], a[4:7], v[20:23], v[64:79]
 buffer_load_dwordx4 v1, s[8:11], s22 offen offset:2048 sc1 lds
 v_exp_f32 v227, v83
 v_exp_f32 v228, v84
 v_exp_f32 v229, v85
 v_smfmac_f32_16x16x64_bf16 v[144:147], v[152:155], v[96:103], v156
 ds_read_b128 a[16:19], v8 offset:18432
 v_exp_f32 v230, v86
 v_smfmac_f32_16x16x64_bf16 v[144:147], v[152:155], v[104:111], v156
 ds_read_b128 a[20:23], v8 offset:19456
 v_exp_f32 v231, v87
 v_exp_f32 v232, v88
 v_smfmac_f32_32x32x32_bf16 v[112:127], a[24:27], v[96:103], v156
 v_exp_f32 v233, v89
 v_exp_f32 v234, v90
 v_exp_f32 v235, v91
 v_smfmac_f32_32x32x32_bf16 v[112:127], a[28:31], v[104:111], v156
L_hop_7:
 s_cbranch_execz L_ret_1
 buffer_load_dwordx4 v1, s[8:11], s22 offen offset:3072 sc1 lds
 v_exp_f32 v236, v92
 v_exp_f32 v237, v93
 v_exp_f32 v238, v94
 v_exp_f32 v239, v95
 v_mfma_f32_32x32x16_bf16 v[80:95], a[0:3], v[24:27], v[48:63]
 s_add_u32 m0, s19, 32768
 v_exp_f32 v96, v64
 v_exp_f32 v97, v65
 v_exp_f32 v98, v66
 v_mfma_f32_32x32x16_bf16 v[80:95], a[4:7], v[28:31], v[80:95]
 buffer_load_dwordx4 v206, s[8:11], s30 offen sc1 lds
 v_exp_f32 v99, v67
 v_exp_f32 v100, v68
 v_exp_f32 v101, v69
 v_smfmac_f32_16x16x64_bf16 v[148:151], v[152:155], v[224:231], v156
 ds_read_b128 a[8:11], v8 offset:20480
 v_exp_f32 v102, v70
 v_smfmac_f32_16x16x64_bf16 v[148:151], v[152:155], v[232:239], v156
 ds_read_b128 a[12:15], v8 offset:21504
 v_exp_f32 v103, v71
 v_exp_f32 v104, v72
 v_smfmac_f32_32x32x32_bf16 v[128:143], a[24:27], v[224:231], v156
 s_add_u32 s22, s30, 8192
 v_exp_f32 v105, v73
 v_exp_f32 v106, v74
 v_exp_f32 v107, v75
 v_smfmac_f32_32x32x32_bf16 v[128:143], a[28:31], v[232:239], v156
 s_waitcnt lgkmcnt(0)
 buffer_load_dwordx4 v206, s[8:11], s30 offen offset:1024 sc1 lds
 v_exp_f32 v108, v76
 v_exp_f32 v109, v77
 v_exp_f32 v110, v78
 v_exp_f32 v111, v79
 v_mfma_f32_32x32x16_bf16 v[64:79], a[8:11], v[16:19], v[32:47]
 s_and_b32 s22, s22, 0x3ffff
 v_exp_f32 v224, v80
 v_exp_f32 v225, v81
 v_exp_f32 v226, v82
 v_mfma_f32_32x32x16_bf16 v[64:79], a[12:15], v[20:23], v[64:79]
 buffer_load_dwordx4 v1, s[8:11], s30 offen offset:2048 sc1 lds
 v_exp_f32 v227, v83
 v_exp_f32 v228, v84
 v_exp_f32 v229, v85
 v_smfmac_f32_16x16x64_bf16 v[144:147], v[152:155], v[96:103], v156
 ds_read_b128 a[24:27], v8 offset:22528
 v_exp_f32 v230, v86
 v_smfmac_f32_16x16x64_bf16 v[144:147], v[152:155], v[104:111], v156
 ds_read_b128 a[28:31], v8 offset:23552
 v_exp_f32 v231, v87
 v_exp_f32 v232, v88
 v_smfmac_f32_32x32x32_bf16 v[112:127], a[16:19], v[96:103], v156
 v_exp_f32 v233, v89
 v_exp_f32 v234, v90
 v_exp_f32 v235, v91
 v_smfmac_f32_32x32x32_bf16 v[112:127], a[20:23], v[104:111], v156
 buffer_load_dwordx4 v1, s[8:11], s30 offen offset:3072 sc1 lds
 v_exp_f32 v236, v92
 v_exp_f32 v237, v93
 v_exp_f32 v238, v94
 v_exp_f32 v239, v95
 v_mfma_f32_32x32x16_bf16 v[80:95], a[8:11], v[24:27], v[48:63]
 s_add_u32 m0, s19, 49152
 v_exp_f32 v96, v64
 v_exp_f32 v97, v65
 v_exp_f32 v98, v66
 v_mfma_f32_32x32x16_bf16 v[80:95], a[12:15], v[28:31], v[80:95]
 buffer_load_dwordx4 v206, s[8:11], s22 offen sc1 lds
 v_exp_f32 v99, v67
 v_exp_f32 v100, v68
 v_exp_f32 v101, v69
 v_smfmac_f32_16x16x64_bf16 v[148:151], v[152:155], v[224:231], v156
 ds_read_b128 a[0:3], v8 offset:32768
 v_exp_f32 v102, v70
 v_smfmac_f32_16x16x64_bf16 v[148:151], v[152:155], v[232:239], v156
 ds_read_b128 a[4:7], v8 offset:33792
 v_exp_f32 v103, v71
 v_exp_f32 v104, v72
 v_smfmac_f32_32x32x32_bf16 v[128:143], a[16:19], v[224:231], v156
 s_add_u32 s30, s22, 8192
 v_exp_f32 v105, v73
 v_exp_f32 v106, v74
 v_exp_f32 v107, v75
 v_smfmac_f32_32x32x32_bf16 v[128:143], a[20:23], v[232:239], v156
 s_waitcnt lgkmcnt(0)
 buffer_load_dwordx4 v206, s[8:11], s22 offen offset:1024 sc1 lds
 v_exp_f32 v108, v76
 v_exp_f32 v109, v77
 v_exp_f32 v110, v78
 v_exp_f32 v111, v79
 v_mfma_f32_32x32x16_bf16 v[64:79], a[0:3], v[16:19], v[32:47]
 s_and_b32 s30, s30, 0x3ffff
 v_exp_f32 v224, v80
 v_exp_f32 v225, v81
 v_exp_f32 v226, v82
 v_mfma_f32_32x32x16_bf16 v[64:79], a[4:7], v[20:23], v[64:79]
 buffer_load_dwordx4 v1, s[8:11], s22 offen offset:2048 sc1 lds
 v_exp_f32 v227, v83
 v_exp_f32 v228, v84
 v_exp_f32 v229, v85
 v_smfmac_f32_16x16x64_bf16 v[144:147], v[152:155], v[96:103], v156
 ds_read_b128 a[16:19], v8 offset:34816
 v_exp_f32 v230, v86
 v_smfmac_f32_16x16x64_bf16 v[144:147], v[152:155], v[104:111], v156
 ds_read_b128 a[20:23], v8 offset:35840
 v_exp_f32 v231, v87
 v_exp_f32 v232, v88
 v_smfmac_f32_32x32x32_bf16 v[112:127], a[24:27], v[96:103], v156
 v_exp_f32 v233, v89
 v_exp_f32 v234, v90
 v_exp_f32 v235, v91
 v_smfmac_f32_32x32x32_bf16 v[112:127], a[28:31], v[104:111], v156
 buffer_load_dwordx4 v1, s[8:11], s22 offen offset:3072 sc1 lds
 v_exp_f32 v236, v92
 v_exp_f32 v237, v93
 v_exp_f32 v238, v94
 v_exp_f32 v239, v95
 v_mfma_f32_32x32x16_bf16 v[80:95], a[0:3], v[24:27], v[48:63]
 s_waitcnt vmcnt(16)
 v_exp_f32 v96, v64
 v_exp_f32 v97, v65
 v_exp_f32 v98, v66
 v_mfma_f32_32x32x16_bf16 v[80:95], a[4:7], v[28:31], v[80:95]
 ds_read_b64_tr_b16 v[216:217], v196
 v_exp_f32 v99, v67
 v_exp_f32 v100, v68
 v_exp_f32 v101, v69
 v_smfmac_f32_16x16x64_bf16 v[148:151], v[152:155], v[224:231], v156
 ds_read_b128 a[8:11], v8 offset:36864
 v_exp_f32 v102, v70
 v_smfmac_f32_16x16x64_bf16 v[148:151], v[152:155], v[232:239], v156
 ds_read_b128 a[12:15], v8 offset:37888
 v_exp_f32 v103, v71
 v_exp_f32 v104, v72
 v_smfmac_f32_32x32x32_bf16 v[128:143], a[24:27], v[224:231], v156
 ds_read_b64_tr_b16 v[218:219], v196 offset:512
 v_exp_f32 v105, v73
 v_exp_f32 v106, v74
 v_exp_f32 v107, v75
 v_smfmac_f32_32x32x32_bf16 v[128:143], a[28:31], v[232:239], v156
 s_waitcnt lgkmcnt(1)
 v_exp_f32 v108, v76
 v_exp_f32 v109, v77
 v_exp_f32 v110, v78
 v_exp_f32 v111, v79
 v_mfma_f32_32x32x16_bf16 v[64:79], a[8:11], v[16:19], v[32:47]
 v_exp_f32 v224, v80
 v_exp_f32 v225, v81
 v_exp_f32 v226, v82
 v_mfma_f32_32x32x16_bf16 v[64:79], a[12:15], v[20:23], v[64:79]
 v_exp_f32 v227, v83
 v_exp_f32 v228, v84
 v_exp_f32 v229, v85
 v_smfmac_f32_16x16x64_bf16 v[144:147], v[152:155], v[96:103], v156
 ds_read_b128 a[24:27], v8 offset:38912
 v_exp_f32 v230, v86
 v_smfmac_f32_16x16x64_bf16 v[144:147], v[152:155], v[104:111], v156
 ds_read_b128 a[28:31], v8 offset:39936
 v_exp_f32 v231, v87
 v_exp_f32 v232, v88
 v_smfmac_f32_32x32x32_bf16 v[112:127], a[16:19], v[96:103], v156
 v_exp_f32 v233, v89
 v_exp_f32 v234, v90
 v_exp_f32 v235, v91
 v_smfmac_f32_32x32x32_bf16 v[112:127], a[20:23], v[104:111], v156
 v_exp_f32 v236, v92
 v_exp_f32 v237, v93
 v_exp_f32 v238, v94
 v_exp_f32 v239, v95
 v_mfma_f32_32x32x16_bf16 v[80:95], a[8:11], v[24:27], v[48:63]
 s_waitcnt lgkmcnt(2)
 v_exp_f32 v96, v64
 v_exp_f32 v97, v65
 v_exp_f32 v98, v66
 v_mfma_f32_32x32x16_bf16 v[80:95], a[12:15], v[28:31], v[80:95]
 buffer_store_dwordx4 v[216:219], v197, s[4:7], s27 offen sc1
 v_exp_f32 v99, v67
 v_exp_f32 v100, v68
 v_exp_f32 v101, v69
 v_smfmac_f32_16x16x64_bf16 v[148:151], v[152:155], v[224:231], v156
 ds_read_b128 a[0:3], v8 offset:49152
 v_exp_f32 v102, v70
 v_smfmac_f32_16x16x64_bf16 v[148:151], v[152:155], v[232:239], v156
 ds_read_b128 a[4:7], v8 offset:50176
 v_exp_f32 v103, v71
 v_exp_f32 v104, v72
 v_smfmac_f32_32x32x32_bf16 v[128:143], a[16:19], v[224:231], v156
 s_add_u32 s27, s27, 1048576
 v_exp_f32 v105, v73
 v_exp_f32 v106, v74
 v_exp_f32 v107, v75
 v_smfmac_f32_32x32x32_bf16 v[128:143], a[20:23], v[232:239], v156
 s_waitcnt lgkmcnt(0)
 v_exp_f32 v108, v76
 v_exp_f32 v109, v77
 v_exp_f32 v110, v78
 v_exp_f32 v111, v79
 v_mfma_f32_32x32x16_bf16 v[64:79], a[0:3], v[16:19], v[32:47]
 v_cmp_gt_u32 vcc, 16, v207
 v_exp_f32 v224, v80
 v_exp_f32 v225, v81
 v_exp_f32 v226, v82
 v_mfma_f32_32x32x16_bf16 v[64:79], a[4:7], v[20:23], v[64:79]
 v_exp_f32 v227, v83
 v_exp_f32 v228, v84
 v_exp_f32 v229, v85
 v_smfmac_f32_16x16x64_bf16 v[144:147], v[152:155], v[96:103], v156
 ds_read_b128 a[16:19], v8 offset:51200
 v_exp_f32 v230, v86
 v_smfmac_f32_16x16x64_bf16 v[144:147], v[152:155], v[104:111], v156
 ds_read_b128 a[20:23], v8 offset:52224
 v_exp_f32 v231, v87
 v_exp_f32 v232, v88
 v_smfmac_f32_32x32x32_bf16 v[112:127], a[24:27], v[96:103], v156
 v_exp_f32 v233, v89
 v_exp_f32 v234, v90
 v_exp_f32 v235, v91
 v_smfmac_f32_32x32x32_bf16 v[112:127], a[28:31], v[104:111], v156
 v_exp_f32 v236, v92
 v_exp_f32 v237, v93
 v_exp_f32 v238, v94
 v_exp_f32 v239, v95
 v_mfma_f32_32x32x16_bf16 v[80:95], a[0:3], v[24:27], v[48:63]
 s_mov_b32 m0, s24
 v_exp_f32 v96, v64
 v_exp_f32 v97, v65
 v_exp_f32 v98, v66
 v_mfma_f32_32x32x16_bf16 v[80:95], a[4:7], v[28:31], v[80:95]
 buffer_load_dwordx4 v198, s[12:15], s20 offen nt lds
 v_exp_f32 v99, v67
 v_exp_f32 v100, v68
 v_exp_f32 v101, v69
 v_smfmac_f32_16x16x64_bf16 v[148:151], v[152:155], v[224:231], v156
 ds_read_b128 a[8:11], v8 offset:53248
 v_exp_f32 v102, v70
 v_smfmac_f32_16x16x64_bf16 v[148:151], v[152:155], v[232:239], v156
 ds_read_b128 a[12:15], v8 offset:54272
 v_exp_f32 v103, v71
 v_exp_f32 v104, v72
 v_smfmac_f32_32x32x32_bf16 v[128:143], a[24:27], v[224:231], v156
 s_add_u32 s20, s20, 1048576
 v_exp_f32 v105, v73
 v_exp_f32 v106, v74
 v_exp_f32 v107, v75
 v_smfmac_f32_32x32x32_bf16 v[128:143], a[28:31], v[232:239], v156
 s_waitcnt lgkmcnt(0)
 s_and_b32 s67, s1, vcc_lo
 s_cbranch_scc1 L_poll_17
L_polled_18:
 v_exp_f32 v108, v76
 v_exp_f32 v109, v77
 v_exp_f32 v110, v78
 v_exp_f32 v111, v79
 v_mfma_f32_32x32x16_bf16 v[64:79], a[8:11], v[16:19], v[32:47]
 v_exp_f32 v224, v80
 v_exp_f32 v225, v81
 v_exp_f32 v226, v82
 v_mfma_f32_32x32x16_bf16 v[64:79], a[12:15], v[20:23], v[64:79]
 v_exp_f32 v227, v83
 v_exp_f32 v228, v84
 v_exp_f32 v229, v85
 v_smfmac_f32_16x16x64_bf16 v[144:147], v[152:155], v[96:103], v156
 ds_read_b128 a[24:27], v8 offset:55296
 v_exp_f32 v230, v86
 v_smfmac_f32_16x16x64_bf16 v[144:147], v[152:155], v[104:111], v156
 ds_read_b128 a[28:31], v8 offset:56320
 v_exp_f32 v231, v87
 v_exp_f32 v232, v88
 v_smfmac_f32_32x32x32_bf16 v[112:127], a[16:19], v[96:103], v156
 v_exp_f32 v233, v89
 v_exp_f32 v234, v90
 v_exp_f32 v235, v91
 v_smfmac_f32_32x32x32_bf16 v[112:127], a[20:23], v[104:111], v156
 v_exp_f32 v236, v92
 v_exp_f32 v237, v93
 v_exp_f32 v238, v94
 v_exp_f32 v239, v95
 v_mfma_f32_32x32x16_bf16 v[80:95], a[8:11], v[24:27], v[48:63]
 s_waitcnt vmcnt(2) lgkmcnt(0)
 v_exp_f32 v96, v64
 v_exp_f32 v97, v65
 v_exp_f32 v98, v66
 v_mfma_f32_32x32x16_bf16 v[80:95], a[12:15], v[28:31], v[80:95]
 s_barrier
 v_exp_f32 v99, v67
 v_exp_f32 v100, v68
 v_exp_f32 v101, v69
 v_smfmac_f32_16x16x64_bf16 v[148:151], v[152:155], v[224:231], v156
 ds_read_b128 a[0:3], v202
 v_exp_f32 v102, v70
 v_smfmac_f32_16x16x64_bf16 v[148:151], v[152:155], v[232:239], v156
 ds_read_b128 a[4:7], v202 offset:1024
 v_exp_f32 v103, v71
 v_exp_f32 v104, v72
 v_smfmac_f32_32x32x32_bf16 v[128:143], a[16:19], v[224:231], v156
 s_lshl_b32 s3, s16, 10
 v_exp_f32 v105, v73
 v_exp_f32 v106, v74
 v_exp_f32 v107, v75
 v_smfmac_f32_32x32x32_bf16 v[128:143], a[20:23], v[232:239], v156
 s_waitcnt lgkmcnt(0)
 v_exp_f32 v108, v76
 v_exp_f32 v109, v77
 v_exp_f32 v110, v78
 v_exp_f32 v111, v79
 v_mfma_f32_32x32x16_bf16 v[64:79], a[0:3], v[16:19], v[32:47]
 s_add_u32 m0, s3, 147456
 v_exp_f32 v224, v80
 v_exp_f32 v225, v81
 v_exp_f32 v226, v82
 v_mfma_f32_32x32x16_bf16 v[64:79], a[4:7], v[20:23], v[64:79]
 buffer_load_dwordx4 v215, s[4:7], 0 offen sc1 lds
 v_exp_f32 v227, v83
 v_exp_f32 v228, v84
 v_exp_f32 v229, v85
 v_smfmac_f32_16x16x64_bf16 v[144:147], v[152:155], v[96:103], v156
 ds_read_b128 a[16:19], v202 offset:2048
 v_exp_f32 v230, v86
 v_smfmac_f32_16x16x64_bf16 v[144:147], v[152:155], v[104:111], v156
 ds_read_b128 a[20:23], v202 offset:3072
 v_exp_f32 v231, v87
 v_exp_f32 v232, v88
 v_smfmac_f32_32x32x32_bf16 v[112:127], a[24:27], v[96:103], v156
 v_exp_f32 v233, v89
 v_exp_f32 v234, v90
 v_exp_f32 v235, v91
 v_smfmac_f32_32x32x32_bf16 v[112:127], a[28:31], v[104:111], v156
 v_exp_f32 v236, v92
 v_exp_f32 v237, v93
 v_exp_f32 v238, v94
 v_exp_f32 v239, v95
 v_mfma_f32_32x32x16_bf16 v[80:95], a[0:3], v[24:27], v[48:63]
 s_add_u32 m0, s19, 65536
 v_exp_f32 v96, v64
 v_exp_f32 v97, v65
 v_exp_f32 v98, v66
 v_mfma_f32_32x32x16_bf16 v[80:95], a[4:7], v[28:31], v[80:95]
 buffer_load_dwordx4 v206, s[8:11], s30 offen sc1 lds
 v_exp_f32 v99, v67
 v_exp_f32 v100, v68
 v_exp_f32 v101, v69
 v_smfmac_f32_16x16x64_bf16 v[148:151], v[152:155], v[224:231], v156
 ds_read_b128 a[8:11], v202 offset:4096
 v_exp_f32 v102, v70
 v_smfmac_f32_16x16x64_bf16 v[148:151], v[152:155], v[232:239], v156
 ds_read_b128 a[12:15], v202 offset:5120
 v_exp_f32 v103, v71
 v_exp_f32 v104, v72
 v_smfmac_f32_32x32x32_bf16 v[128:143], a[24:27], v[224:231], v156
 s_add_u32 s22, s30, 8192
 v_exp_f32 v105, v73
 v_exp_f32 v106, v74
 v_exp_f32 v107, v75
 v_smfmac_f32_32x32x32_bf16 v[128:143], a[28:31], v[232:239], v156
 s_waitcnt lgkmcnt(0)
 buffer_load_dwordx4 v206, s[8:11], s30 offen offset:1024 sc1 lds
 v_exp_f32 v108, v76
 v_exp_f32 v109, v77
 v_exp_f32 v110, v78
 v_exp_f32 v111, v79
 v_mfma_f32_32x32x16_bf16 v[64:79], a[8:11], v[16:19], v[32:47]
 s_and_b32 s22, s22, 0x3ffff
 v_exp_f32 v224, v80
 v_exp_f32 v225, v81
 v_exp_f32 v226, v82
 v_mfma_f32_32x32x16_bf16 v[64:79], a[12:15], v[20:23], v[64:79]
 buffer_load_dwordx4 v1, s[8:11], s30 offen offset:2048 sc1 lds
 v_exp_f32 v227, v83
 v_exp_f32 v228, v84
 v_exp_f32 v229, v85
 v_smfmac_f32_16x16x64_bf16 v[144:147], v[152:155], v[96:103], v156
 ds_read_b128 a[24:27], v202 offset:6144
 v_exp_f32 v230, v86
 v_smfmac_f32_16x16x64_bf16 v[144:147], v[152:155], v[104:111], v156
 ds_read_b128 a[28:31], v202 offset:7168
 v_exp_f32 v231, v87
 v_exp_f32 v232, v88
 v_smfmac_f32_32x32x32_bf16 v[112:127], a[16:19], v[96:103], v156
 v_exp_f32 v233, v89
 v_exp_f32 v234, v90
 v_exp_f32 v235, v91
 v_smfmac_f32_32x32x32_bf16 v[112:127], a[20:23], v[104:111], v156
 buffer_load_dwordx4 v1, s[8:11], s30 offen offset:3072 sc1 lds
 v_exp_f32 v236, v92
 v_exp_f32 v237, v93
 v_exp_f32 v238, v94
 v_exp_f32 v239, v95
 v_mfma_f32_32x32x16_bf16 v[80:95], a[8:11], v[24:27], v[48:63]
 s_add_u32 m0, s19, 81920
 v_exp_f32 v96, v64
 v_exp_f32 v97, v65
 v_exp_f32 v98, v66
 v_mfma_f32_32x32x16_bf16 v[80:95], a[12:15], v[28:31], v[80:95]
 buffer_load_dwordx4 v206, s[8:11], s22 offen sc1 lds
 v_exp_f32 v99, v67
 v_exp_f32 v100, v68
 v_exp_f32 v101, v69
 v_smfmac_f32_16x16x64_bf16 v[148:151], v[152:155], v[224:231], v156
 ds_read_b128 a[0:3], v202 offset:16384
 v_exp_f32 v102, v70
 v_smfmac_f32_16x16x64_bf16 v[148:151], v[152:155], v[232:239], v156
 ds_read_b128 a[4:7], v202 offset:17408
 v_exp_f32 v103, v71
 v_exp_f32 v104, v72
 v_smfmac_f32_32x32x32_bf16 v[128:143], a[16:19], v[224:231], v156
 s_add_u32 s30, s22, 8192
 v_exp_f32 v105, v73
 v_exp_f32 v106, v74
 v_exp_f32 v107, v75
 v_smfmac_f32_32x32x32_bf16 v[128:143], a[20:23], v[232:239], v156
 s_waitcnt lgkmcnt(0)
 buffer_load_dwordx4 v206, s[8:11], s22 offen offset:1024 sc1 lds
 v_exp_f32 v108, v76
 v_exp_f32 v109, v77
 v_exp_f32 v110, v78
 v_exp_f32 v111, v79
 v_mfma_f32_32x32x16_bf16 v[64:79], a[0:3], v[16:19], v[32:47]
 s_and_b32 s30, s30, 0x3ffff
 v_exp_f32 v224, v80
 v_exp_f32 v225, v81
 v_exp_f32 v226, v82
 v_mfma_f32_32x32x16_bf16 v[64:79], a[4:7], v[20:23], v[64:79]
 buffer_load_dwordx4 v1, s[8:11], s22 offen offset:2048 sc1 lds
 v_exp_f32 v227, v83
 v_exp_f32 v228, v84
 v_exp_f32 v229, v85
 v_smfmac_f32_16x16x64_bf16 v[144:147], v[152:155], v[96:103], v156
 ds_read_b128 a[16:19], v202 offset:18432
 v_exp_f32 v230, v86
 v_smfmac_f32_16x16x64_bf16 v[144:147], v[152:155], v[104:111], v156
 ds_read_b128 a[20:23], v202 offset:19456
 v_exp_f32 v231, v87
 v_exp_f32 v232, v88
 v_smfmac_f32_32x32x32_bf16 v[112:127], a[24:27], v[96:103], v156
 v_exp_f32 v233, v89
 v_exp_f32 v234, v90
 v_exp_f32 v235, v91
 v_smfmac_f32_32x32x32_bf16 v[112:127], a[28:31], v[104:111], v156
 buffer_load_dwordx4 v1, s[8:11], s22 offen offset:3072 sc1 lds
 v_exp_f32 v236, v92
 v_exp_f32 v237, v93
 v_exp_f32 v238, v94
 v_exp_f32 v239, v95
 v_mfma_f32_32x32x16_bf16 v[80:95], a[0:3], v[24:27], v[48:63]
 s_add_u32 m0, s19, 98304
 v_exp_f32 v96, v64
 v_exp_f32 v97, v65
 v_exp_f32 v98, v66
 v_mfma_f32_32x32x16_bf16 v[80:95], a[4:7], v[28:31], v[80:95]
 buffer_load_dwordx4 v206, s[8:11], s30 offen sc1 lds
 v_exp_f32 v99, v67
 v_exp_f32 v100, v68
 v_exp_f32 v101, v69
 v_smfmac_f32_16x16x64_bf16 v[148:151], v[152:155], v[224:231], v156
 ds_read_b128 a[8:11], v202 offset:20480
 v_exp_f32 v102, v70
 v_smfmac_f32_16x16x64_bf16 v[148:151], v[152:155], v[232:239], v156
 ds_read_b128 a[12:15], v202 offset:21504
 v_exp_f32 v103, v71
 v_exp_f32 v104, v72
 v_smfmac_f32_32x32x32_bf16 v[128:143], a[24:27], v[224:231], v156
 s_add_u32 s22, s30, 8192
 v_exp_f32 v105, v73
 v_exp_f32 v106, v74
 v_exp_f32 v107, v75
 v_smfmac_f32_32x32x32_bf16 v[128:143], a[28:31], v[232:239], v156
 s_waitcnt lgkmcnt(0)
 buffer_load_dwordx4 v206, s[8:11], s30 offen offset:1024 sc1 lds
 v_exp_f32 v108, v76
 v_exp_f32 v109, v77
 v_exp_f32 v110, v78
 v_exp_f32 v111, v79
 v_mfma_f32_32x32x16_bf16 v[64:79], a[8:11], v[16:19], v[32:47]
 s_and_b32 s22, s22, 0x3ffff
 v_exp_f32 v224, v80
 v_exp_f32 v225, v81
 v_exp_f32 v226, v82
 v_mfma_f32_32x32x16_bf16 v[64:79], a[12:15], v[20:23], v[64:79]
 buffer_load_dwordx4 v1, s[8:11], s30 offen offset:2048 sc1 lds
 v_exp_f32 v227, v83
 v_exp_f32 v228, v84
 v_exp_f32 v229, v85
 v_smfmac_f32_16x16x64_bf16 v[144:147], v[152:155], v[96:103], v156
 ds_read_b128 a[24:27], v202 offset:22528
 v_exp_f32 v230, v86
 v_smfmac_f32_16x16x64_bf16 v[144:147], v[152:155], v[104:111], v156
 ds_read_b128 a[28:31], v202 offset:23552
 v_exp_f32 v231, v87
 v_exp_f32 v232, v88
 v_smfmac_f32_32x32x32_bf16 v[112:127], a[16:19], v[96:103], v156
 v_exp_f32 v233, v89
 v_exp_f32 v234, v90
 v_exp_f32 v235, v91
 v_smfmac_f32_32x32x32_bf16 v[112:127], a[20:23], v[104:111], v156
 buffer_load_dwordx4 v1, s[8:11], s30 offen offset:3072 sc1 lds
 v_exp_f32 v236, v92
 v_exp_f32 v237, v93
 v_exp_f32 v238, v94
 v_exp_f32 v239, v95
 v_mfma_f32_32x32x16_bf16 v[80:95], a[8:11], v[24:27], v[48:63]
 s_add_u32 m0, s19, 114688
 v_exp_f32 v96, v64
 v_exp_f32 v97, v65
 v_exp_f32 v98, v66
 v_mfma_f32_32x32x16_bf16 v[80:95], a[12:15], v[28:31], v[80:95]
 buffer_load_dwordx4 v206, s[8:11], s22 offen sc1 lds
 v_exp_f32 v99, v67
 v_exp_f32 v100, v68
 v_exp_f32 v101, v69
 v_smfmac_f32_16x16x64_bf16 v[148:151], v[152:155], v[224:231], v156
 ds_read_b128 a[0:3], v202 offset:32768
 v_exp_f32 v102, v70
 v_smfmac_f32_16x16x64_bf16 v[148:151], v[152:155], v[232:239], v156
 ds_read_b128 a[4:7], v202 offset:33792
 v_exp_f32 v103, v71
 v_exp_f32 v104, v72
 v_smfmac_f32_32x32x32_bf16 v[128:143], a[16:19], v[224:231], v156
 s_add_u32 s30, s22, 8192
 v_exp_f32 v105, v73
 v_exp_f32 v106, v74
 v_exp_f32 v107, v75
 v_smfmac_f32_32x32x32_bf16 v[128:143], a[20:23], v[232:239], v156
 s_waitcnt lgkmcnt(0)
 buffer_load_dwordx4 v206, s[8:11], s22 offen offset:1024 sc1 lds
 v_exp_f32 v108, v76
 v_exp_f32 v109, v77
 v_exp_f32 v110, v78
 v_exp_f32 v111, v79
 v_mfma_f32_32x32x16_bf16 v[64:79], a[0:3], v[16:19], v[32:47]
 s_and_b32 s30, s30, 0x3ffff
 v_exp_f32 v224, v80
 v_exp_f32 v225, v81
 v_exp_f32 v226, v82
 v_mfma_f32_32x32x16_bf16 v[64:79], a[4:7], v[20:23], v[64:79]
 buffer_load_dwordx4 v1, s[8:11], s22 offen offset:2048 sc1 lds
 v_exp_f32 v227, v83
 v_exp_f32 v228, v84
 v_exp_f32 v229, v85
 v_smfmac_f32_16x16x64_bf16 v[144:147], v[152:155], v[96:103], v156
 ds_read_b128 a[16:19], v202 offset:34816
 v_exp_f32 v230, v86
 v_smfmac_f32_16x16x64_bf16 v[144:147], v[152:155], v[104:111], v156
 ds_read_b128 a[20:23], v202 offset:35840
 v_exp_f32 v231, v87
 v_exp_f32 v232, v88
 v_smfmac_f32_32x32x32_bf16 v[112:127], a[24:27], v[96:103], v156
 v_exp_f32 v233, v89
 v_exp_f32 v234, v90
 v_exp_f32 v235, v91
 v_smfmac_f32_32x32x32_bf16 v[112:127], a[28:31], v[104:111], v156
 buffer_load_dwordx4 v1, s[8:11], s22 offen offset:3072 sc1 lds
 v_exp_f32 v236, v92
 v_exp_f32 v237, v93
 v_exp_f32 v238, v94
 v_exp_f32 v239, v95
 v_mfma_f32_32x32x16_bf16 v[80:95], a[0:3], v[24:27], v[48:63]
 s_waitcnt vmcnt(17)
 v_exp_f32 v96, v64
 v_exp_f32 v97, v65
 v_exp_f32 v98, v66
 v_mfma_f32_32x32x16_bf16 v[80:95], a[4:7], v[28:31], v[80:95]
 ds_read_b64_tr_b16 v[216:217], v196
 v_exp_f32 v99, v67
 v_exp_f32 v100, v68
 v_exp_f32 v101, v69
 v_smfmac_f32_16x16x64_bf16 v[148:151], v[152:155], v[224:231], v156
 ds_read_b128 a[8:11], v202 offset:36864
 v_exp_f32 v102, v70
 v_smfmac_f32_16x16x64_bf16 v[148:151], v[152:155], v[232:239], v156
 ds_read_b128 a[12:15], v202 offset:37888
 v_exp_f32 v103, v71
 v_exp_f32 v104, v72
 v_smfmac_f32_32x32x32_bf16 v[128:143], a[24:27], v[224:231], v156
 ds_read_b64_tr_b16 v[218:219], v196 offset:512
 v_exp_f32 v105, v73
 v_exp_f32 v106, v74
 v_exp_f32 v107, v75
 v_smfmac_f32_32x32x32_bf16 v[128:143], a[28:31], v[232:239], v156
 s_waitcnt lgkmcnt(1)
 v_exp_f32 v108, v76
 v_exp_f32 v109, v77
 v_exp_f32 v110, v78
 v_exp_f32 v111, v79
 v_mfma_f32_32x32x16_bf16 v[64:79], a[8:11], v[16:19], v[32:47]
 v_exp_f32 v224, v80
 v_exp_f32 v225, v81
 v_exp_f32 v226, v82
 v_mfma_f32_32x32x16_bf16 v[64:79], a[12:15], v[20:23], v[64:79]
 v_exp_f32 v227, v83
 v_exp_f32 v228, v84
 v_exp_f32 v229, v85
 v_smfmac_f32_16x16x64_bf16 v[144:147], v[152:155], v[96:103], v156
 ds_read_b128 a[24:27], v202 offset:38912
 v_exp_f32 v230, v86
 v_smfmac_f32_16x16x64_bf16 v[144:147], v[152:155], v[104:111], v156
 ds_read_b128 a[28:31], v202 offset:39936
 v_exp_f32 v231, v87
 v_exp_f32 v232, v88
 v_smfmac_f32_32x32x32_bf16 v[112:127], a[16:19], v[96:103], v156
 v_exp_f32 v233, v89
 v_exp_f32 v234, v90
 v_exp_f32 v235, v91
 v_smfmac_f32_32x32x32_bf16 v[112:127], a[20:23], v[104:111], v156
 v_exp_f32 v236, v92
 v_exp_f32 v237, v93
 v_exp_f32 v238, v94
 v_exp_f32 v239, v95
 v_mfma_f32_32x32x16_bf16 v[80:95], a[8:11], v[24:27], v[48:63]
 s_waitcnt lgkmcnt(2)
 v_exp_f32 v96, v64
 v_exp_f32 v97, v65
 v_exp_f32 v98, v66
 v_mfma_f32_32x32x16_bf16 v[80:95], a[12:15], v[28:31], v[80:95]
 buffer_store_dwordx4 v[216:219], v197, s[4:7], s27 offen sc1
 v_exp_f32 v99, v67
 v_exp_f32 v100, v68
 v_exp_f32 v101, v69
 v_smfmac_f32_16x16x64_bf16 v[148:151], v[152:155], v[224:231], v156
 ds_read_b128 a[0:3], v202 offset:49152
 v_exp_f32 v102, v70
 v_smfmac_f32_16x16x64_bf16 v[148:151], v[152:155], v[232:239], v156
 ds_read_b128 a[4:7], v202 offset:50176
 v_exp_f32 v103, v71
 v_exp_f32 v104, v72
 v_smfmac_f32_32x32x32_bf16 v[128:143], a[16:19], v[224:231], v156
 s_add_u32 s27, s27, 1048576
 v_exp_f32 v105, v73
 v_exp_f32 v106, v74
 v_exp_f32 v107, v75
 v_smfmac_f32_32x32x32_bf16 v[128:143], a[20:23], v[232:239], v156
 s_waitcnt lgkmcnt(0)
 v_exp_f32 v108, v76
 v_exp_f32 v109, v77
 v_exp_f32 v110, v78
 v_exp_f32 v111, v79
 v_mfma_f32_32x32x16_bf16 v[64:79], a[0:3], v[16:19], v[32:47]
 s_getpc_b64 s[22:23]
L_pc2:
 v_exp_f32 v224, v80
 v_exp_f32 v225, v81
 v_exp_f32 v226, v82
 v_mfma_f32_32x32x16_bf16 v[64:79], a[4:7], v[20:23], v[64:79]
 s_and_b32 s22, s22, 0xfffff000
 v_exp_f32 v227, v83
 v_exp_f32 v228, v84
 v_exp_f32 v229, v85
 v_smfmac_f32_16x16x64_bf16 v[144:147], v[152:155], v[96:103], v156
 ds_read_b128 a[16:19], v202 offset:51200
 v_exp_f32 v230, v86
 v_smfmac_f32_16x16x64_bf16 v[144:147], v[152:155], v[104:111], v156
 ds_read_b128 a[20:23], v202 offset:52224
 v_exp_f32 v231, v87
 v_exp_f32 v232, v88
 v_smfmac_f32_32x32x32_bf16 v[112:127], a[24:27], v[96:103], v156
 v_lshlrev_b32 v6, 12, v0
 v_exp_f32 v233, v89
 v_exp_f32 v234, v90
 v_exp_f32 v235, v91
 v_smfmac_f32_32x32x32_bf16 v[112:127], a[28:31], v[104:111], v156
 v_min_u32 v6, L_hotend-L_pc2, v6
 global_load_dword v6, v6, s[22:23]
 v_exp_f32 v236, v92
 v_exp_f32 v237, v93
 v_exp_f32 v238, v94
 v_exp_f32 v239, v95
 v_mfma_f32_32x32x16_bf16 v[80:95], a[0:3], v[24:27], v[48:63]
 s_mov_b32 m0, s24
 v_exp_f32 v96, v64
 v_exp_f32 v97, v65
 v_exp_f32 v98, v66
 v_mfma_f32_32x32x16_bf16 v[80:95], a[4:7], v[28:31], v[80:95]
 buffer_load_dwordx4 v198, s[12:15], s20 offen nt lds
 v_exp_f32 v99, v67
 v_exp_f32 v100, v68
 v_exp_f32 v101, v69
 v_smfmac_f32_16x16x64_bf16 v[148:151], v[152:155], v[224:231], v156
 ds_read_b128 a[8:11], v202 offset:53248
 v_exp_f32 v102, v70
 v_smfmac_f32_16x16x64_bf16 v[148:151], v[152:155], v[232:239], v156
 ds_read_b128 a[12:15], v202 offset:54272
 v_exp_f32 v103, v71
 v_exp_f32 v104, v72
 v_smfmac_f32_32x32x32_bf16 v[128:143], a[24:27], v[224:231], v156
 s_add_u32 s20, s20, 1048576
 v_exp_f32 v105, v73
 v_exp_f32 v106, v74
 v_exp_f32 v107, v75
 v_smfmac_f32_32x32x32_bf16 v[128:143], a[28:31], v[232:239], v156
 s_waitcnt lgkmcnt(0)
 v_exp_f32 v108, v76
 v_exp_f32 v109, v77
 v_exp_f32 v110, v78
 v_exp_f32 v111, v79
 v_mfma_f32_32x32x16_bf16 v[64:79], a[8:11], v[16:19], v[32:47]
 v_exp_f32 v224, v80
 v_exp_f32 v225, v81
 v_exp_f32 v226, v82
 v_mfma_f32_32x32x16_bf16 v[64:79], a[12:15], v[20:23], v[64:79]
 v_exp_f32 v227, v83
 v_exp_f32 v228, v84
 v_exp_f32 v229, v85
 v_smfmac_f32_16x16x64_bf16 v[144:147], v[152:155], v[96:103], v156
 ds_read_b128 a[24:27], v202 offset:55296
 v_exp_f32 v230, v86
 v_smfmac_f32_16x16x64_bf16 v[144:147], v[152:155], v[104:111], v156
 ds_read_b128 a[28:31], v202 offset:56320
 v_exp_f32 v231, v87
 v_exp_f32 v232, v88
 v_smfmac_f32_32x32x32_bf16 v[112:127], a[16:19], v[96:103], v156
 v_exp_f32 v233, v89
 v_exp_f32 v234, v90
 v_exp_f32 v235, v91
 v_smfmac_f32_32x32x32_bf16 v[112:127], a[20:23], v[104:111], v156
 v_exp_f32 v236, v92
 v_exp_f32 v237, v93
 v_exp_f32 v238, v94
 v_exp_f32 v239, v95
 v_mfma_f32_32x32x16_bf16 v[80:95], a[8:11], v[24:27], v[48:63]
 s_waitcnt vmcnt(3) lgkmcnt(0)
 v_exp_f32 v96, v64
 v_exp_f32 v97, v65
 v_exp_f32 v98, v66
 v_mfma_f32_32x32x16_bf16 v[80:95], a[12:15], v[28:31], v[80:95]
 s_barrier
 v_exp_f32 v99, v67
 v_exp_f32 v100, v68
 v_exp_f32 v101, v69
 v_smfmac_f32_16x16x64_bf16 v[148:151], v[152:155], v[224:231], v156
 ds_read_b128 a[0:3], v8
 v_exp_f32 v102, v70
 v_smfmac_f32_16x16x64_bf16 v[148:151], v[152:155], v[232:239], v156
 ds_read_b128 a[4:7], v8 offset:1024
 v_exp_f32 v103, v71
 v_exp_f32 v104, v72
 v_smfmac_f32_32x32x32_bf16 v[128:143], a[16:19], v[224:231], v156
 v_exp_f32 v105, v73
 v_exp_f32 v106, v74
 v_exp_f32 v107, v75
 v_smfmac_f32_32x32x32_bf16 v[128:143], a[20:23], v[232:239], v156
 s_waitcnt lgkmcnt(0)
 buffer_load_dword v176, v212, s[4:7], 0 offen sc1
 v_exp_f32 v108, v76
 v_exp_f32 v109, v77
 v_exp_f32 v110, v78
 v_exp_f32 v111, v79
 v_mfma_f32_32x32x16_bf16 v[64:79], a[0:3], v[16:19], v[32:47]
L_hop_8:
 s_cbranch_execz L_ret_1
 v_exp_f32 v224, v80
 v_exp_f32 v225, v81
 v_exp_f32 v226, v82
 v_mfma_f32_32x32x16_bf16 v[64:79], a[4:7], v[20:23], v[64:79]
 buffer_load_dword v177, v212, s[4:7], 0 offen offset:64 sc1
 v_exp_f32 v227, v83
 v_exp_f32 v228, v84
 v_exp_f32 v229, v85
 v_smfmac_f32_16x16x64_bf16 v[144:147], v[152:155], v[96:103], v156
 ds_read_b128 a[16:19], v8 offset:2048
 v_exp_f32 v230, v86
 v_smfmac_f32_16x16x64_bf16 v[144:147], v[152:155], v[104:111], v156
 ds_read_b128 a[20:23], v8 offset:3072
 v_exp_f32 v231, v87
 v_exp_f32 v232, v88
 v_smfmac_f32_32x32x32_bf16 v[112:127], a[24:27], v[96:103], v156
 v_exp_f32 v233, v89
 v_exp_f32 v234, v90
 v_exp_f32 v235, v91
 v_smfmac_f32_32x32x32_bf16 v[112:127], a[28:31], v[104:111], v156
 v_exp_f32 v236, v92
 v_exp_f32 v237, v93
 v_exp_f32 v238, v94
 v_exp_f32 v239, v95
 v_mfma_f32_32x32x16_bf16 v[80:95], a[0:3], v[24:27], v[48:63]
 s_mov_b32 m0, s19
 v_exp_f32 v96, v64
 v_exp_f32 v97, v65
 v_exp_f32 v98, v66
 v_mfma_f32_32x32x16_bf16 v[80:95], a[4:7], v[28:31], v[80:95]
 buffer_load_dwordx4 v192, s[56:59], s29 offen lds
 v_exp_f32 v99, v67
 v_exp_f32 v100, v68
 v_exp_f32 v101, v69
 v_smfmac_f32_16x16x64_bf16 v[148:151], v[152:155], v[224:231], v156
 ds_read_b128 a[8:11], v8 offset:4096
 v_exp_f32 v102, v70
 v_smfmac_f32_16x16x64_bf16 v[148:151], v[152:155], v[232:239], v156
 ds_read_b128 a[12:15], v8 offset:5120
 v_exp_f32 v103, v71
 v_exp_f32 v104, v72
 v_smfmac_f32_32x32x32_bf16 v[128:143], a[24:27], v[224:231], v156
 buffer_load_dwordx4 v193, s[56:59], s29 offen offset:1024 lds
 v_exp_f32 v105, v73
 v_exp_f32 v106, v74
 v_exp_f32 v107, v75
 v_smfmac_f32_32x32x32_bf16 v[128:143], a[28:31], v[232:239], v156
 s_mov_b32 s21, 262144
 s_waitcnt lgkmcnt(0)
 buffer_load_dwordx4 v194, s[56:59], s29 offen offset:2048 lds
 v_exp_f32 v108, v76
 v_exp_f32 v109, v77
 v_exp_f32 v110, v78
 v_exp_f32 v111, v79
 v_mfma_f32_32x32x16_bf16 v[64:79], a[8:11], v[16:19], v[32:47]
 v_exp_f32 v224, v80
 v_exp_f32 v225, v81
 v_exp_f32 v226, v82
 v_mfma_f32_32x32x16_bf16 v[64:79], a[12:15], v[20:23], v[64:79]
 buffer_load_dwordx4 v195, s[56:59], s29 offen offset:3072 lds
 v_exp_f32 v227, v83
 v_exp_f32 v228, v84
 v_exp_f32 v229, v85
 v_smfmac_f32_16x16x64_bf16 v[144:147], v[152:155], v[96:103], v156
 ds_read_b128 a[24:27], v8 offset:6144
 v_exp_f32 v230, v86
 v_smfmac_f32_16x16x64_bf16 v[144:147], v[152:155], v[104:111], v156
 ds_read_b128 a[28:31], v8 offset:7168
 v_exp_f32 v231, v87
 v_exp_f32 v232, v88
 v_smfmac_f32_32x32x32_bf16 v[112:127], a[16:19], v[96:103], v156
 v_exp_f32 v233, v89
 v_exp_f32 v234, v90
 v_exp_f32 v235, v91
 v_smfmac_f32_32x32x32_bf16 v[112:127], a[20:23], v[104:111], v156
 v_exp_f32 v236, v92
 v_exp_f32 v237, v93
 v_exp_f32 v238, v94
 v_exp_f32 v239, v95
 v_mfma_f32_32x32x16_bf16 v[80:95], a[8:11], v[24:27], v[48:63]
 s_add_u32 m0, s19, 16384
 v_exp_f32 v96, v64
 v_exp_f32 v97, v65
 v_exp_f32 v98, v66
 v_mfma_f32_32x32x16_bf16 v[80:95], a[12:15], v[28:31], v[80:95]
 buffer_load_dwordx4 v192, s[56:59], s21 offen lds
 v_exp_f32 v99, v67
 v_exp_f32 v100, v68
 v_exp_f32 v101, v69
 v_smfmac_f32_16x16x64_bf16 v[148:151], v[152:155], v[224:231], v156
 ds_read_b128 a[0:3], v8 offset:16384
 v_exp_f32 v102, v70
 v_smfmac_f32_16x16x64_bf16 v[148:151], v[152:155], v[232:239], v156
 ds_read_b128 a[4:7], v8 offset:17408
 v_exp_f32 v103, v71
 v_exp_f32 v104, v72
 v_smfmac_f32_32x32x32_bf16 v[128:143], a[16:19], v[224:231], v156
 buffer_load_dwordx4 v193, s[56:59], s21 offen offset:1024 lds
 v_exp_f32 v105, v73
 v_exp_f32 v106, v74
 v_exp_f32 v107, v75
 v_smfmac_f32_32x32x32_bf16 v[128:143], a[20:23], v[232:239], v156
 s_mov_b32 s29, 524288
 s_waitcnt lgkmcnt(0)
 buffer_load_dwordx4 v194, s[56:59], s21 offen offset:2048 lds
 v_exp_f32 v108, v76
 v_exp_f32 v109, v77
 v_exp_f32 v110, v78
 v_exp_f32 v111, v79
 v_mfma_f32_32x32x16_bf16 v[64:79], a[0:3], v[16:19], v[32:47]
 v_exp_f32 v224, v80
 v_exp_f32 v225, v81
 v_exp_f32 v226, v82
 v_mfma_f32_32x32x16_bf16 v[64:79], a[4:7], v[20:23], v[64:79]
 buffer_load_dwordx4 v195, s[56:59], s21 offen offset:3072 lds
 v_exp_f32 v227, v83
 v_exp_f32 v228, v84
 v_exp_f32 v229, v85
 v_smfmac_f32_16x16x64_bf16 v[144:147], v[152:155], v[96:103], v156
 ds_read_b128 a[16:19], v8 offset:18432
 v_exp_f32 v230, v86
 v_smfmac_f32_16x16x64_bf16 v[144:147], v[152:155], v[104:111], v156
 ds_read_b128 a[20:23], v8 offset:19456
 v_exp_f32 v231, v87
 v_exp_f32 v232, v88
 v_smfmac_f32_32x32x32_bf16 v[112:127], a[24:27], v[96:103], v156
 v_exp_f32 v233, v89
 v_exp_f32 v234, v90
 v_exp_f32 v235, v91
 v_smfmac_f32_32x32x32_bf16 v[112:127], a[28:31], v[104:111], v156
 v_exp_f32 v236, v92
 v_exp_f32 v237, v93
 v_exp_f32 v238, v94
 v_exp_f32 v239, v95
 v_mfma_f32_32x32x16_bf16 v[80:95], a[0:3], v[24:27], v[48:63]
 s_add_u32 m0, s19, 32768
 v_exp_f32 v96, v64
 v_exp_f32 v97, v65
 v_exp_f32 v98, v66
 v_mfma_f32_32x32x16_bf16 v[80:95], a[4:7], v[28:31], v[80:95]
 buffer_load_dwordx4 v192, s[56:59], s29 offen lds
 v_exp_f32 v99, v67
 v_exp_f32 v100, v68
 v_exp_f32 v101, v69
 v_smfmac_f32_16x16x64_bf16 v[148:151], v[152:155], v[224:231], v156
 ds_read_b128 a[8:11], v8 offset:20480
 v_exp_f32 v102, v70
 v_smfmac_f32_16x16x64_bf16 v[148:151], v[152:155], v[232:239], v156
 ds_read_b128 a[12:15], v8 offset:21504
 v_exp_f32 v103, v71
 v_exp_f32 v104, v72
 v_smfmac_f32_32x32x32_bf16 v[128:143], a[24:27], v[224:231], v156
 buffer_load_dwordx4 v193, s[56:59], s29 offen offset:1024 lds
 v_exp_f32 v105, v73
 v_exp_f32 v106, v74
 v_exp_f32 v107, v75
 v_smfmac_f32_32x32x32_bf16 v[128:143], a[28:31], v[232:239], v156
 s_mov_b32 s21, 786432
 s_waitcnt lgkmcnt(0)
 buffer_load_dwordx4 v194, s[56:59], s29 offen offset:2048 lds
 v_exp_f32 v108, v76
 v_exp_f32 v109, v77
 v_exp_f32 v110, v78
 v_exp_f32 v111, v79
 v_mfma_f32_32x32x16_bf16 v[64:79], a[8:11], v[16:19], v[32:47]
 v_exp_f32 v224, v80
 v_exp_f32 v225, v81
 v_exp_f32 v226, v82
 v_mfma_f32_32x32x16_bf16 v[64:79], a[12:15], v[20:23], v[64:79]
 buffer_load_dwordx4 v195, s[56:59], s29 offen offset:3072 lds
 v_exp_f32 v227, v83
 v_exp_f32 v228, v84
 v_exp_f32 v229, v85
 v_smfmac_f32_16x16x64_bf16 v[144:147], v[152:155], v[96:103], v156
 ds_read_b128 a[24:27], v8 offset:22528
 v_exp_f32 v230, v86
 v_smfmac_f32_16x16x64_bf16 v[144:147], v[152:155], v[104:111], v156
 s_waitcnt vmcnt(14)
 ds_read_b128 a[28:31], v8 offset:23552
 v_exp_f32 v231, v87
 v_exp_f32 v232, v88
 v_smfmac_f32_32x32x32_bf16 v[112:127], a[16:19], v[96:103], v156
 ds_read_b64_tr_b16 v[216:217], v196
 v_exp_f32 v233, v89
 v_exp_f32 v234, v90
 v_exp_f32 v235, v91
 v_smfmac_f32_32x32x32_bf16 v[112:127], a[20:23], v[104:111], v156
 v_exp_f32 v236, v92
 v_exp_f32 v237, v93
 v_exp_f32 v238, v94
 v_exp_f32 v239, v95
 v_mfma_f32_32x32x16_bf16 v[80:95], a[8:11], v[24:27], v[48:63]
 s_waitcnt lgkmcnt(1)
 v_exp_f32 v96, v64
 v_exp_f32 v97, v65
 v_exp_f32 v98, v66
 v_mfma_f32_32x32x16_bf16 v[80:95], a[12:15], v[28:31], v[80:95]
 s_barrier
 v_exp_f32 v99, v67
 v_exp_f32 v100, v68
 v_exp_f32 v101, v69
 v_smfmac_f32_16x16x64_bf16 v[148:151], v[152:155], v[224:231], v156
 ds_read_b128 a[0:3], v8 offset:32768
 v_exp_f32 v102, v70
 v_smfmac_f32_16x16x64_bf16 v[148:151], v[152:155], v[232:239], v156
 ds_read_b128 a[4:7], v8 offset:33792
 v_exp_f32 v103, v71
 v_exp_f32 v104, v72
 v_smfmac_f32_32x32x32_bf16 v[128:143], a[16:19], v[224:231], v156
 s_add_u32 m0, s19, 49152
 s_nop 0
 buffer_load_dwordx4 v192, s[56:59], s21 offen lds
 v_exp_f32 v105, v73
 v_exp_f32 v106, v74
 v_exp_f32 v107, v75
 v_smfmac_f32_32x32x32_bf16 v[128:143], a[20:23], v[232:239], v156
 s_waitcnt lgkmcnt(0)
 buffer_load_dwordx4 v193, s[56:59], s21 offen offset:1024 lds
 v_exp_f32 v108, v76
 v_exp_f32 v109, v77
 v_exp_f32 v110, v78
 v_exp_f32 v111, v79
 v_mfma_f32_32x32x16_bf16 v[64:79], a[0:3], v[16:19], v[32:47]
 s_mov_b32 s29, 1048576
 v_exp_f32 v224, v80
 v_exp_f32 v225, v81
 v_exp_f32 v226, v82
 v_mfma_f32_32x32x16_bf16 v[64:79], a[4:7], v[20:23], v[64:79]
 buffer_load_dwordx4 v194, s[56:59], s21 offen offset:2048 lds
 v_exp_f32 v227, v83
 v_exp_f32 v228, v84
 v_exp_f32 v229, v85
 v_smfmac_f32_16x16x64_bf16 v[144:147], v[152:155], v[96:103], v156
 ds_read_b128 a[16:19], v8 offset:34816
 v_exp_f32 v230, v86
 v_smfmac_f32_16x16x64_bf16 v[144:147], v[152:155], v[104:111], v156
 ds_read_b128 a[20:23], v8 offset:35840
 v_exp_f32 v231, v87
 v_exp_f32 v232, v88
 v_smfmac_f32_32x32x32_bf16 v[112:127], a[24:27], v[96:103], v156
 buffer_load_dwordx4 v195, s[56:59], s21 offen offset:3072 lds
 v_exp_f32 v233, v89
 v_exp_f32 v234, v90
 v_exp_f32 v235, v91
 v_smfmac_f32_32x32x32_bf16 v[112:127], a[28:31], v[104:111], v156
 v_exp_f32 v236, v92
 v_exp_f32 v237, v93
 v_exp_f32 v238, v94
 v_exp_f32 v239, v95
 v_mfma_f32_32x32x16_bf16 v[80:95], a[0:3], v[24:27], v[48:63]
 s_add_u32 m0, s19, 65536
 v_exp_f32 v96, v64
 v_exp_f32 v97, v65
 v_exp_f32 v98, v66
 v_mfma_f32_32x32x16_bf16 v[80:95], a[4:7], v[28:31], v[80:95]
 buffer_load_dwordx4 v192, s[56:59], s29 offen lds
 v_exp_f32 v99, v67
 v_exp_f32 v100, v68
 v_exp_f32 v101, v69
 v_smfmac_f32_16x16x64_bf16 v[148:151], v[152:155], v[224:231], v156
 ds_read_b128 a[8:11], v8 offset:36864
 v_exp_f32 v102, v70
 v_smfmac_f32_16x16x64_bf16 v[148:151], v[152:155], v[232:239], v156
 ds_read_b128 a[12:15], v8 offset:37888
 v_exp_f32 v103, v71
 v_exp_f32 v104, v72
 v_smfmac_f32_32x32x32_bf16 v[128:143], a[24:27], v[224:231], v156
 buffer_load_dwordx4 v193, s[56:59], s29 offen offset:1024 lds
 v_exp_f32 v105, v73
 v_exp_f32 v106, v74
 v_exp_f32 v107, v75
 v_smfmac_f32_32x32x32_bf16 v[128:143], a[28:31], v[232:239], v156
 s_mov_b32 s21, 1310720
 s_waitcnt lgkmcnt(0)
 buffer_load_dwordx4 v194, s[56:59], s29 offen offset:2048 lds
 v_exp_f32 v108, v76
 v_exp_f32 v109, v77
 v_exp_f32 v110, v78
 v_exp_f32 v111, v79
 v_mfma_f32_32x32x16_bf16 v[64:79], a[8:11], v[16:19], v[32:47]
 v_exp_f32 v224, v80
 v_exp_f32 v225, v81
 v_exp_f32 v226, v82
 v_mfma_f32_32x32x16_bf16 v[64:79], a[12:15], v[20:23], v[64:79]
 buffer_load_dwordx4 v195, s[56:59], s29 offen offset:3072 lds
 v_exp_f32 v227, v83
 v_exp_f32 v228, v84
 v_exp_f32 v229, v85
 v_smfmac_f32_16x16x64_bf16 v[144:147], v[152:155], v[96:103], v156
 ds_read_b128 a[24:27], v8 offset:38912
 v_exp_f32 v230, v86
 v_smfmac_f32_16x16x64_bf16 v[144:147], v[152:155], v[104:111], v156
 ds_read_b64_tr_b16 v[218:219], v196 offset:512
 ds_read_b128 a[28:31], v8 offset:39936
 v_exp_f32 v231, v87
 v_exp_f32 v232, v88
 v_smfmac_f32_32x32x32_bf16 v[112:127], a[16:19], v[96:103], v156
 v_exp_f32 v233, v89
 v_exp_f32 v234, v90
 v_exp_f32 v235, v91
 v_smfmac_f32_32x32x32_bf16 v[112:127], a[20:23], v[104:111], v156
 v_exp_f32 v236, v92
 v_exp_f32 v237, v93
 v_exp_f32 v238, v94
 v_exp_f32 v239, v95
 v_mfma_f32_32x32x16_bf16 v[80:95], a[8:11], v[24:27], v[48:63]
 s_add_u32 m0, s19, 81920
 v_exp_f32 v96, v64
 v_exp_f32 v97, v65
 v_exp_f32 v98, v66
 v_mfma_f32_32x32x16_bf16 v[80:95], a[12:15], v[28:31], v[80:95]
 buffer_load_dwordx4 v192, s[56:59], s21 offen lds
 v_exp_f32 v99, v67
 v_exp_f32 v100, v68
 v_exp_f32 v101, v69
 v_smfmac_f32_16x16x64_bf16 v[148:151], v[152:155], v[224:231], v156
 ds_read_b128 a[0:3], v8 offset:49152
 v_exp_f32 v102, v70
 v_smfmac_f32_16x16x64_bf16 v[148:151], v[152:155], v[232:239], v156
 ds_read_b128 a[4:7], v8 offset:50176
 v_exp_f32 v103, v71
 v_exp_f32 v104, v72
 v_smfmac_f32_32x32x32_bf16 v[128:143], a[16:19], v[224:231], v156
 buffer_load_dwordx4 v193, s[56:59], s21 offen offset:1024 lds
 v_exp_f32 v105, v73
 v_exp_f32 v106, v74
 v_exp_f32 v107, v75
 v_smfmac_f32_32x32x32_bf16 v[128:143], a[20:23], v[232:239], v156
 s_mov_b32 s29, 1572864
 s_waitcnt lgkmcnt(0)
 buffer_load_dwordx4 v194, s[56:59], s21 offen offset:2048 lds
 v_exp_f32 v108, v76
 v_exp_f32 v109, v77
 v_exp_f32 v110, v78
 v_exp_f32 v111, v79
 v_mfma_f32_32x32x16_bf16 v[64:79], a[0:3], v[16:19], v[32:47]
 v_exp_f32 v224, v80
 v_exp_f32 v225, v81
 v_exp_f32 v226, v82
 v_mfma_f32_32x32x16_bf16 v[64:79], a[4:7], v[20:23], v[64:79]
 s_barrier
 v_exp_f32 v227, v83
 v_exp_f32 v228, v84
 v_exp_f32 v229, v85
 v_smfmac_f32_16x16x64_bf16 v[144:147], v[152:155], v[96:103], v156
 ds_read_b128 a[16:19], v8 offset:51200
 v_exp_f32 v230, v86
 v_smfmac_f32_16x16x64_bf16 v[144:147], v[152:155], v[104:111], v156
 ds_read_b128 a[20:23], v8 offset:52224
 v_exp_f32 v231, v87
 v_exp_f32 v232, v88
 v_smfmac_f32_32x32x32_bf16 v[112:127], a[24:27], v[96:103], v156
 buffer_load_dwordx4 v195, s[56:59], s21 offen offset:3072 lds
 v_exp_f32 v233, v89
 v_exp_f32 v234, v90
 v_exp_f32 v235, v91
 v_smfmac_f32_32x32x32_bf16 v[112:127], a[28:31], v[104:111], v156
 v_exp_f32 v236, v92
 v_exp_f32 v237, v93
 v_exp_f32 v238, v94
 v_exp_f32 v239, v95
 v_mfma_f32_32x32x16_bf16 v[80:95], a[0:3], v[24:27], v[48:63]
 s_add_u32 m0, s19, 98304
 v_exp_f32 v96, v64
 v_exp_f32 v97, v65
 v_exp_f32 v98, v66
 v_mfma_f32_32x32x16_bf16 v[80:95], a[4:7], v[28:31], v[80:95]
 buffer_load_dwordx4 v192, s[56:59], s29 offen lds
 v_exp_f32 v99, v67
 v_exp_f32 v100, v68
 v_exp_f32 v101, v69
 v_smfmac_f32_16x16x64_bf16 v[148:151], v[152:155], v[224:231], v156
 ds_read_b128 a[8:11], v8 offset:53248
 v_exp_f32 v102, v70
 v_smfmac_f32_16x16x64_bf16 v[148:151], v[152:155], v[232:239], v156
 ds_read_b128 a[12:15], v8 offset:54272
 v_exp_f32 v103, v71
 v_exp_f32 v104, v72
 v_smfmac_f32_32x32x32_bf16 v[128:143], a[24:27], v[224:231], v156
 buffer_load_dwordx4 v193, s[56:59], s29 offen offset:1024 lds
 v_exp_f32 v105, v73
 v_exp_f32 v106, v74
 v_exp_f32 v107, v75
 v_smfmac_f32_32x32x32_bf16 v[128:143], a[28:31], v[232:239], v156
 s_mov_b32 s21, 1835008
 s_waitcnt lgkmcnt(0)
 buffer_load_dwordx4 v194, s[56:59], s29 offen offset:2048 lds
 v_exp_f32 v108, v76
 v_exp_f32 v109, v77
 v_exp_f32 v110, v78
 v_exp_f32 v111, v79
 v_mfma_f32_32x32x16_bf16 v[64:79], a[8:11], v[16:19], v[32:47]
 v_exp_f32 v224, v80
 v_exp_f32 v225, v81
 v_exp_f32 v226, v82
 v_mfma_f32_32x32x16_bf16 v[64:79], a[12:15], v[20:23], v[64:79]
 buffer_load_dwordx4 v195, s[56:59], s29 offen offset:3072 lds
 v_exp_f32 v227, v83
 v_exp_f32 v228, v84
 v_exp_f32 v229, v85
 v_smfmac_f32_16x16x64_bf16 v[144:147], v[152:155], v[96:103], v156
 ds_read_b128 a[24:27], v8 offset:55296
 v_exp_f32 v230, v86
 v_smfmac_f32_16x16x64_bf16 v[144:147], v[152:155], v[104:111], v156
 ds_read_b128 a[28:31], v8 offset:56320
 v_exp_f32 v231, v87
 v_exp_f32 v232, v88
 v_smfmac_f32_32x32x32_bf16 v[112:127], a[16:19], v[96:103], v156
 buffer_store_dwordx4 v[216:219], v197, s[4:7], s27 offen sc1
 v_exp_f32 v233, v89
 v_exp_f32 v234, v90
 v_exp_f32 v235, v91
 v_smfmac_f32_32x32x32_bf16 v[112:127], a[20:23], v[104:111], v156
 v_exp_f32 v236, v92
 v_exp_f32 v237, v93
 v_exp_f32 v238, v94
 v_exp_f32 v239, v95
 v_mfma_f32_32x32x16_bf16 v[80:95], a[8:11], v[24:27], v[48:63]
 v_exp_f32 v96, v64
 v_exp_f32 v97, v65
 v_exp_f32 v98, v66
 v_mfma_f32_32x32x16_bf16 v[80:95], a[12:15], v[28:31], v[80:95]
 v_exp_f32 v99, v67
 v_exp_f32 v100, v68
 v_exp_f32 v101, v69
 v_smfmac_f32_16x16x64_bf16 v[148:151], v[152:155], v[224:231], v156
 v_exp_f32 v102, v70
 v_smfmac_f32_16x16x64_bf16 v[148:151], v[152:155], v[232:239], v156
 v_exp_f32 v103, v71
 v_exp_f32 v104, v72
 v_smfmac_f32_32x32x32_bf16 v[128:143], a[16:19], v[224:231], v156
 v_exp_f32 v105, v73
 v_exp_f32 v106, v74
 v_exp_f32 v107, v75
 v_smfmac_f32_32x32x32_bf16 v[128:143], a[20:23], v[232:239], v156
 v_exp_f32 v108, v76
 v_exp_f32 v109, v77
 v_exp_f32 v110, v78
 v_exp_f32 v111, v79
 v_exp_f32 v224, v80
 v_exp_f32 v225, v81
 v_exp_f32 v226, v82
 v_exp_f32 v227, v83
 v_exp_f32 v228, v84
 v_exp_f32 v229, v85
 v_smfmac_f32_16x16x64_bf16 v[144:147], v[152:155], v[96:103], v156
 v_exp_f32 v230, v86
 v_smfmac_f32_16x16x64_bf16 v[144:147], v[152:155], v[104:111], v156
 v_exp_f32 v231, v87
 v_exp_f32 v232, v88
 s_waitcnt lgkmcnt(1)
 v_smfmac_f32_32x32x32_bf16 v[112:127], a[24:27], v[96:103], v156
 v_exp_f32 v233, v89
 v_exp_f32 v234, v90
 v_exp_f32 v235, v91
 s_waitcnt lgkmcnt(0)
 v_smfmac_f32_32x32x32_bf16 v[112:127], a[28:31], v[104:111], v156
 v_exp_f32 v236, v92
 v_exp_f32 v237, v93
 v_exp_f32 v238, v94
 v_exp_f32 v239, v95
 v_smfmac_f32_16x16x64_bf16 v[148:151], v[152:155], v[224:231], v156
 v_smfmac_f32_32x32x32_bf16 v[128:143], a[24:27], v[224:231], v156
 v_smfmac_f32_16x16x64_bf16 v[148:151], v[152:155], v[232:239], v156
 v_smfmac_f32_32x32x32_bf16 v[128:143], a[28:31], v[232:239], v156
 v_rcp_f32 v4, v144
 s_nop 2
 v_pk_mul_f32 v[112:113], v[112:113], v[4:5] op_sel_hi:[1,0]
 v_pk_mul_f32 v[114:115], v[114:115], v[4:5] op_sel_hi:[1,0]
 v_pk_mul_f32 v[116:117], v[116:117], v[4:5] op_sel_hi:[1,0]
 v_pk_mul_f32 v[118:119], v[118:119], v[4:5] op_sel_hi:[1,0]
 v_cvt_pk_bf16_f32 v64, v112, v113
 v_cvt_pk_bf16_f32 v65, v114, v115
 v_cvt_pk_bf16_f32 v66, v116, v117
 v_cvt_pk_bf16_f32 v67, v118, v119
 buffer_store_dwordx4 v[64:67], v9, s[4:7], s33 offen sc1
 v_pk_mul_f32 v[120:121], v[120:121], v[4:5] op_sel_hi:[1,0]
 v_pk_mul_f32 v[122:123], v[122:123], v[4:5] op_sel_hi:[1,0]
 v_pk_mul_f32 v[124:125], v[124:125], v[4:5] op_sel_hi:[1,0]
 v_pk_mul_f32 v[126:127], v[126:127], v[4:5] op_sel_hi:[1,0]
 v_cvt_pk_bf16_f32 v68, v120, v121
 v_cvt_pk_bf16_f32 v69, v122, v123
 v_cvt_pk_bf16_f32 v70, v124, v125
 v_cvt_pk_bf16_f32 v71, v126, v127
 buffer_store_dwordx4 v[68:71], v9, s[4:7], s33 offen offset:1024 sc1
 v_rcp_f32 v4, v148
 s_nop 0
 v_pk_mul_f32 v[128:129], v[128:129], v[4:5] op_sel_hi:[1,0]
 v_pk_mul_f32 v[130:131], v[130:131], v[4:5] op_sel_hi:[1,0]
 v_pk_mul_f32 v[132:133], v[132:133], v[4:5] op_sel_hi:[1,0]
 v_pk_mul_f32 v[134:135], v[134:135], v[4:5] op_sel_hi:[1,0]
 v_cvt_pk_bf16_f32 v80, v128, v129
 v_cvt_pk_bf16_f32 v81, v130, v131
 v_cvt_pk_bf16_f32 v82, v132, v133
 v_cvt_pk_bf16_f32 v83, v134, v135
 buffer_store_dwordx4 v[80:83], v9, s[4:7], s34 offen sc1
 v_pk_mul_f32 v[136:137], v[136:137], v[4:5] op_sel_hi:[1,0]
 v_pk_mul_f32 v[138:139], v[138:139], v[4:5] op_sel_hi:[1,0]
 v_pk_mul_f32 v[140:141], v[140:141], v[4:5] op_sel_hi:[1,0]
 v_pk_mul_f32 v[142:143], v[142:143], v[4:5] op_sel_hi:[1,0]
 v_cvt_pk_bf16_f32 v84, v136, v137
 v_cvt_pk_bf16_f32 v85, v138, v139
 v_cvt_pk_bf16_f32 v86, v140, v141
 v_cvt_pk_bf16_f32 v87, v142, v143
 buffer_store_dwordx4 v[84:87], v9, s[4:7], s34 offen offset:1024 sc1
 s_mov_b32 s3, 0x71800000
 v_maximum3_f32 v6, v144, v148, v148
 v_maximum3_f32 v6, abs(v112), abs(v113), v6
 v_maximum3_f32 v6, abs(v114), abs(v115), v6
 v_maximum3_f32 v6, abs(v116), abs(v117), v6
 v_maximum3_f32 v6, abs(v118), abs(v119), v6
 v_maximum3_f32 v6, abs(v120), abs(v121), v6
 v_maximum3_f32 v6, abs(v122), abs(v123), v6
 v_maximum3_f32 v6, abs(v124), abs(v125), v6
 v_maximum3_f32 v6, abs(v126), abs(v127), v6
 v_maximum3_f32 v6, abs(v128), abs(v129), v6
 v_maximum3_f32 v6, abs(v130), abs(v131), v6
 v_maximum3_f32 v6, abs(v132), abs(v133), v6
 v_maximum3_f32 v6, abs(v134), abs(v135), v6
 v_maximum3_f32 v6, abs(v136), abs(v137), v6
 v_maximum3_f32 v6, abs(v138), abs(v139), v6
 v_maximum3_f32 v6, abs(v140), abs(v141), v6
 v_maximum3_f32 v6, abs(v142), abs(v143), v6
 v_cmp_ngt_f32 vcc, s3, v6
 s_nop 1
 s_cbranch_vccnz L_exact_19
L_exacted_20:
 s_bfe_u32 s0, s2, 0x20005
 s_and_b32 s3, s2, 1
 s_lshl2_add_u32 s0, s3, s0
 s_lshl_b32 s0, s0, 8
 v_mov_b32 v29, 1
 v_mov_b32 v30, 0
 v_lshlrev_b32 v28, 8, v0
 s_lshl_b32 s28, s17, 11
 s_add_u32 s28, s28, s0
 s_add_u32 s28, s28, 40173568
 s_lshl_b32 s29, s60, 11
 s_add_u32 s29, s29, s0
 s_add_u32 s29, s29, 40173568
 s_cmp_lg_u32 s16, 0
 s_cbranch_scc1 L_look_21
 buffer_load_dword v31, v30, s[4:7], s29 offen sc1
L_look_21:
 s_mov_b64 exec, 0
 s_cmp_eq_u32 s16, 0
 s_cbranch_scc1 L_hop_9
 s_cmp_eq_u32 s16, 1
 s_cbranch_scc1 L_hop_10
 s_cmp_eq_u32 s16, 2
 s_cbranch_scc1 L_hop_11
 s_branch L_hop_12
L_ret_2:
 s_mov_b64 exec, -1
 v_bfe_u32 v2, v0, 2, 2
 v_lshrrev_b32 v3, 4, v0
 v_and_b32 v21, 2, v2
 v_and_or_b32 v21, v3, 1, v21
 v_lshlrev_b32 v3, 10, v3
 v_lshl_add_u32 v3, v2, 7, v3
 v_and_b32 v2, 3, v0
 v_lshl_add_u32 v3, v2, 3, v3
 v_xor_b32 v2, 0, v21
 v_lshl_add_u32 v136, v2, 5, v3
 v_xor_b32 v2, 1, v21
 v_lshl_add_u32 v137, v2, 5, v3
 v_xor_b32 v2, 2, v21
 v_lshl_add_u32 v138, v2, 5, v3
 v_xor_b32 v2, 3, v21
 v_lshl_add_u32 v139, v2, 5, v3
 s_lshl2_add_u32 s31, s60, s16
 s_lshl_b32 s20, s31, 16
 v_and_b32 v23, 1, v0
 v_lshlrev_b32 v23, 11, v23
 v_lshrrev_b32 v2, 4, v0
 v_lshl_add_u32 v23, v2, 4, v23
 v_add_u32 v23, 147456, v23
 v_add_u32 v148, s20, v1
 v_and_b32 v2, 0xffffff80, v148
 v_add_u32 v148, v2, v148
 v_add_u32 v149, 65536, v148
 s_mov_b32 s23, 58720256
 s_waitcnt vmcnt(0)
 s_barrier
 s_cmp_lg_u32 s16, 0
 s_cbranch_scc1 L_arrived_22
 s_sub_u32 s67, s28, s0
 s_mov_b64 exec, 0xff
 buffer_atomic_add v29, v28, s[4:7], s67 offen sc1
 s_mov_b64 exec, -1
L_arrived_22:
 v_cmp_gt_u32 vcc, 16, v31
 s_cmp_lg_u32 s16, 0
 s_cbranch_scc1 L_other_24
 s_bitcmp0_b32 vcc_lo, 0
 s_cbranch_scc1 L_join_25
 s_mov_b32 s67, 400000
 s_mov_b64 exec, 1
L_spin_23:
 buffer_load_dword v31, v30, s[4:7], s29 offen sc1
 s_waitcnt vmcnt(0)
 v_cmp_gt_u32 vcc, 16, v31
 s_sub_u32 s67, s67, 1
 s_cmp_lg_u32 s67, 0
 s_cbranch_vccz L_join_25
 s_sleep 2
 s_cbranch_scc1 L_spin_23
 s_branch L_join_25
L_other_24:
L_join_25:
 s_mov_b64 exec, -1
 s_barrier
 buffer_load_dwordx4 a[0:3], v148, s[4:7], s23 offen sc1
 buffer_load_dwordx4 a[4:7], v149, s[4:7], s23 offen sc1
 buffer_load_dwordx4 a[8:11], v148, s[4:7], s23 offen offset:2048 sc1
 buffer_load_dwordx4 a[12:15], v149, s[4:7], s23 offen offset:2048 sc1
 s_add_u32 s23, s23, 4096
 buffer_load_dwordx4 a[16:19], v148, s[4:7], s23 offen sc1
 ds_read_b128 a[216:219], v23
 ds_read_b128 a[220:223], v23 offset:64
 ds_read_b64_tr_b16 a[224:225], v136
 ds_read_b64_tr_b16 a[226:227], v136 offset:512
 ds_read_b64_tr_b16 a[228:229], v136 offset:4096
 ds_read_b64_tr_b16 a[230:231], v136 offset:4608
 ds_read_b64_tr_b16 a[232:233], v137
 ds_read_b64_tr_b16 a[234:235], v137 offset:512
 ds_read_b64_tr_b16 a[236:237], v137 offset:4096
 ds_read_b64_tr_b16 a[238:239], v137 offset:4608
 ds_read_b128 a[240:243], v23 offset:128
 v_permlane16_swap_b32 v160, v162
 v_permlane16_swap_b32 v161, v163
 v_lshlrev_b32 v48, 16, v160
 v_and_b32 v49, s64, v160
 v_lshlrev_b32 v50, 16, v161
 v_and_b32 v51, s64, v161
 v_lshlrev_b32 v52, 16, v162
 v_and_b32 v53, s64, v162
 v_lshlrev_b32 v54, 16, v163
 v_and_b32 v55, s64, v163
 v_permlane16_swap_b32 v164, v166
 v_permlane16_swap_b32 v165, v167
 v_lshlrev_b32 v56, 16, v164
 v_and_b32 v57, s64, v164
 v_lshlrev_b32 v58, 16, v165
 v_and_b32 v59, s64, v165
 v_lshlrev_b32 v60, 16, v166
 v_and_b32 v61, s64, v166
 v_lshlrev_b32 v62, 16, v167
 v_and_b32 v63, s64, v167
 buffer_load_dwordx4 a[20:23], v149, s[4:7], s23 offen sc1
 buffer_load_dwordx4 a[24:27], v148, s[4:7], s23 offen offset:2048 sc1
 buffer_load_dwordx4 a[28:31], v149, s[4:7], s23 offen offset:2048 sc1
 s_add_u32 s23, s23, 4096
 buffer_load_dwordx4 a[32:35], v148, s[4:7], s23 offen sc1
 buffer_load_dwordx4 a[36:39], v149, s[4:7], s23 offen sc1
 buffer_load_dwordx4 a[40:43], v148, s[4:7], s23 offen offset:2048 sc1
 buffer_load_dwordx4 a[44:47], v149, s[4:7], s23 offen offset:2048 sc1
 s_add_u32 s23, s23, 4096
 buffer_load_dwordx4 a[48:51], v148, s[4:7], s23 offen sc1
 buffer_load_dwordx4 a[52:55], v149, s[4:7], s23 offen sc1
 v_permlane16_swap_b32 v168, v170
 v_permlane16_swap_b32 v169, v171
 v_lshlrev_b32 v64, 16, v168
 v_and_b32 v65, s64, v168
 v_lshlrev_b32 v66, 16, v169
 v_and_b32 v67, s64, v169
 v_lshlrev_b32 v68, 16, v170
 v_and_b32 v69, s64, v170
 v_lshlrev_b32 v70, 16, v171
 v_and_b32 v71, s64, v171
 v_permlane16_swap_b32 v172, v174
 v_permlane16_swap_b32 v173, v175
 v_lshlrev_b32 v72, 16, v172
 v_and_b32 v73, s64, v172
 v_lshlrev_b32 v74, 16, v173
 v_and_b32 v75, s64, v173
 v_lshlrev_b32 v76, 16, v174
 v_and_b32 v77, s64, v174
 v_lshlrev_b32 v78, 16, v175
 v_and_b32 v79, s64, v175
 s_waitcnt vmcnt(10) lgkmcnt(10)
 v_mfma_f32_16x16x32_bf16 v[132:135], a[216:219], a[4:7], 0
 ds_read_b128 a[244:247], v23 offset:192
 v_add_u32 v140, 65536, v136
 s_waitcnt lgkmcnt(10)
 v_mfma_f32_16x16x32_bf16 v[132:135], a[220:223], a[12:15], v[132:135]
 buffer_load_dwordx4 a[56:59], v148, s[4:7], s23 offen offset:2048 sc1
 v_mfma_f32_16x16x32_bf16 v[112:115], a[220:223], a[8:11], 0
 ds_read_b64_tr_b16 a[248:249], v136 offset:8192
 v_add_u32 v141, 65536, v137
 v_mfma_f32_16x16x32_bf16 v[112:115], a[216:219], a[0:3], v[112:115]
 ds_read_b64_tr_b16 a[250:251], v136 offset:8704
 s_waitcnt lgkmcnt(8)
 v_mfma_f32_16x16x32_bf16 v[96:99], a[224:227], a[0:3], v[48:51]
 ds_read_b64_tr_b16 a[252:253], v136 offset:12288
 buffer_load_dwordx4 a[60:63], v149, s[4:7], s23 offen offset:2048 sc1
 v_mfma_f32_16x16x32_bf16 v[96:99], a[228:231], a[8:11], v[96:99]
 ds_read_b64_tr_b16 a[254:255], v136 offset:12800
 s_add_u32 s23, s23, 4096
 v_mfma_f32_16x16x32_bf16 v[116:119], a[228:231], a[12:15], v[52:55]
 ds_read_b64_tr_b16 a[216:217], v137 offset:8192
 v_add_u32 v142, 65536, v138
 v_mfma_f32_16x16x32_bf16 v[116:119], a[224:227], a[4:7], v[116:119]
 ds_read_b64_tr_b16 a[218:219], v137 offset:8704
 s_waitcnt lgkmcnt(8)
 v_mfma_f32_16x16x32_bf16 v[120:123], a[232:235], a[4:7], v[60:63]
 ds_read_b64_tr_b16 a[220:221], v137 offset:12288
 buffer_load_dwordx4 a[64:67], v148, s[4:7], s23 offen sc1
 v_mfma_f32_16x16x32_bf16 v[120:123], a[236:239], a[12:15], v[120:123]
 ds_read_b64_tr_b16 a[222:223], v137 offset:12800
 v_add_u32 v143, 65536, v139
 v_mfma_f32_16x16x32_bf16 v[100:103], a[236:239], a[8:11], v[56:59]
 ds_read_b128 a[224:227], v23 offset:256
 v_add_u32 v144, 131072, v136
 v_mfma_f32_16x16x32_bf16 v[100:103], a[232:235], a[0:3], v[100:103]
L_hop_9:
 s_cbranch_execz L_ret_2
 s_waitcnt vmcnt(9) lgkmcnt(9)
 v_mfma_f32_16x16x32_bf16 v[112:115], a[240:243], a[16:19], v[112:115]
 ds_read_b128 a[228:231], v23 offset:320
 buffer_load_dwordx4 a[68:71], v149, s[4:7], s23 offen sc1
 v_mfma_f32_16x16x32_bf16 v[112:115], a[244:247], a[24:27], v[112:115]
 v_add_u32 v145, 131072, v137
 v_mfma_f32_16x16x32_bf16 v[132:135], a[244:247], a[28:31], v[132:135]
 ds_read_b64_tr_b16 a[232:233], v136 offset:16384
 buffer_load_dwordx4 a[72:75], v148, s[4:7], s23 offen offset:2048 sc1
 v_mfma_f32_16x16x32_bf16 v[132:135], a[240:243], a[20:23], v[132:135]
 ds_read_b64_tr_b16 a[234:235], v136 offset:16896
 s_waitcnt lgkmcnt(8)
 v_mfma_f32_16x16x32_bf16 v[116:119], a[248:251], a[20:23], v[116:119]
 ds_read_b64_tr_b16 a[236:237], v136 offset:20480
 v_add_u32 v146, 131072, v138
 v_mfma_f32_16x16x32_bf16 v[116:119], a[252:255], a[28:31], v[116:119]
 ds_read_b64_tr_b16 a[238:239], v136 offset:20992
 buffer_load_dwordx4 a[76:79], v149, s[4:7], s23 offen offset:2048 sc1
 v_mfma_f32_16x16x32_bf16 v[96:99], a[252:255], a[24:27], v[96:99]
 ds_read_b64_tr_b16 a[240:241], v137 offset:16384
 s_add_u32 s23, s23, 4096
 v_mfma_f32_16x16x32_bf16 v[96:99], a[248:251], a[16:19], v[96:99]
 ds_read_b64_tr_b16 a[242:243], v137 offset:16896
 s_waitcnt lgkmcnt(8)
 v_mfma_f32_16x16x32_bf16 v[100:103], a[216:219], a[16:19], v[100:103]
 ds_read_b64_tr_b16 a[244:245], v137 offset:20480
 buffer_load_dwordx4 a[80:83], v148, s[4:7], s23 offen sc1
 v_mfma_f32_16x16x32_bf16 v[100:103], a[220:223], a[24:27], v[100:103]
 ds_read_b64_tr_b16 a[246:247], v137 offset:20992
 v_add_u32 v147, 131072, v139
 v_mfma_f32_16x16x32_bf16 v[120:123], a[220:223], a[28:31], v[120:123]
 ds_read_b128 a[248:251], v23 offset:384
 s_cmp_lg_u32 s16, 0
 s_cselect_b64 exec, -1, 0
 s_cbranch_execz L_hop_13
L_ret_3:
 s_mov_b64 exec, -1
 v_mfma_f32_16x16x32_bf16 v[120:123], a[216:219], a[20:23], v[120:123]
 s_waitcnt vmcnt(9) lgkmcnt(9)
 v_mfma_f32_16x16x32_bf16 v[132:135], a[224:227], a[36:39], v[132:135]
 ds_read_b128 a[252:255], v23 offset:448
 buffer_load_dwordx4 a[84:87], v149, s[4:7], s23 offen sc1
 v_mfma_f32_16x16x32_bf16 v[132:135], a[228:231], a[44:47], v[132:135]
 v_and_b32 v22, 15, v0
 v_mfma_f32_16x16x32_bf16 v[112:115], a[228:231], a[40:43], v[112:115]
 ds_read_b64_tr_b16 a[216:217], v136 offset:24576
 buffer_load_dwordx4 a[88:91], v148, s[4:7], s23 offen offset:2048 sc1
 v_mfma_f32_16x16x32_bf16 v[112:115], a[224:227], a[32:35], v[112:115]
 ds_read_b64_tr_b16 a[218:219], v136 offset:25088
 s_waitcnt lgkmcnt(8)
 v_mfma_f32_16x16x32_bf16 v[96:99], a[232:235], a[32:35], v[96:99]
 ds_read_b64_tr_b16 a[220:221], v136 offset:28672
 v_lshlrev_b32 v22, 2, v22
 v_mfma_f32_16x16x32_bf16 v[96:99], a[236:239], a[40:43], v[96:99]
 ds_read_b64_tr_b16 a[222:223], v136 offset:29184
 buffer_load_dwordx4 a[92:95], v149, s[4:7], s23 offen offset:2048 sc1
 v_mfma_f32_16x16x32_bf16 v[116:119], a[236:239], a[44:47], v[116:119]
 ds_read_b64_tr_b16 a[224:225], v137 offset:24576
 s_add_u32 s23, s23, 4096
 v_mfma_f32_16x16x32_bf16 v[116:119], a[232:235], a[36:39], v[116:119]
 ds_read_b64_tr_b16 a[226:227], v137 offset:25088
 s_waitcnt lgkmcnt(8)
 v_mfma_f32_16x16x32_bf16 v[120:123], a[240:243], a[36:39], v[120:123]
 ds_read_b64_tr_b16 a[228:229], v137 offset:28672
 buffer_load_dwordx4 a[96:99], v148, s[4:7], s23 offen sc1
 v_mfma_f32_16x16x32_bf16 v[120:123], a[244:247], a[44:47], v[120:123]
 ds_read_b64_tr_b16 a[230:231], v137 offset:29184
 v_lshrrev_b32 v24, 5, v0
 v_mfma_f32_16x16x32_bf16 v[100:103], a[244:247], a[40:43], v[100:103]
 ds_read_b64_tr_b16 a[232:233], v138
 s_cmp_lg_u32 s16, 1
 s_cselect_b64 exec, -1, 0
 s_cbranch_execz L_hop_14
L_ret_4:
 s_mov_b64 exec, -1
 v_mfma_f32_16x16x32_bf16 v[100:103], a[240:243], a[32:35], v[100:103]
 ds_read_b64_tr_b16 a[234:235], v138 offset:512
 s_waitcnt vmcnt(9) lgkmcnt(10)
 v_mfma_f32_16x16x32_bf16 v[112:115], a[248:251], a[48:51], v[112:115]
 ds_read_b64_tr_b16 a[236:237], v138 offset:4096
 buffer_load_dwordx4 a[100:103], v149, s[4:7], s23 offen sc1
 v_mfma_f32_16x16x32_bf16 v[112:115], a[252:255], a[56:59], v[112:115]
 ds_read_b64_tr_b16 a[238:239], v138 offset:4608
 v_lshl_add_u32 v22, v24, 10, v22
 v_mfma_f32_16x16x32_bf16 v[132:135], a[252:255], a[60:63], v[132:135]
 ds_read_b64_tr_b16 a[240:241], v139
 buffer_load_dwordx4 a[104:107], v148, s[4:7], s23 offen offset:2048 sc1
 v_mfma_f32_16x16x32_bf16 v[132:135], a[248:251], a[52:55], v[132:135]
 ds_read_b64_tr_b16 a[242:243], v139 offset:512
 s_waitcnt lgkmcnt(10)
 v_mfma_f32_16x16x32_bf16 v[116:119], a[216:219], a[52:55], v[116:119]
 ds_read_b64_tr_b16 a[244:245], v139 offset:4096
 v_mov_b32 v24, v176
 v_mfma_f32_16x16x32_bf16 v[116:119], a[220:223], a[60:63], v[116:119]
 ds_read_b64_tr_b16 a[246:247], v139 offset:4608
 buffer_load_dwordx4 a[108:111], v149, s[4:7], s23 offen offset:2048 sc1
 v_mfma_f32_16x16x32_bf16 v[96:99], a[220:223], a[56:59], v[96:99]
 ds_read_b128 a[248:251], v23 offset:512
 s_add_u32 s23, s23, 4096
 v_mfma_f32_16x16x32_bf16 v[96:99], a[216:219], a[48:51], v[96:99]
 s_waitcnt lgkmcnt(9)
 v_mfma_f32_16x16x32_bf16 v[100:103], a[224:227], a[48:51], v[100:103]
 ds_read_b128 a[252:255], v23 offset:576
 buffer_load_dwordx4 a[112:115], v148, s[4:7], s23 offen sc1
 v_mfma_f32_16x16x32_bf16 v[100:103], a[228:231], a[56:59], v[100:103]
 v_mov_b32 v25, v177
 v_mfma_f32_16x16x32_bf16 v[120:123], a[228:231], a[60:63], v[120:123]
 ds_read_b64_tr_b16 a[216:217], v136 offset:32768
 v_and_b32 v21, 0, v200
 v_mfma_f32_16x16x32_bf16 v[120:123], a[224:227], a[52:55], v[120:123]
 ds_read_b64_tr_b16 a[218:219], v136 offset:33280
 s_waitcnt lgkmcnt(8)
 v_mfma_f32_16x16x32_bf16 v[124:127], a[232:235], a[4:7], v[68:71]
 ds_read_b64_tr_b16 a[220:221], v136 offset:36864
 buffer_load_dwordx4 a[116:119], v149, s[4:7], s23 offen sc1
 v_mfma_f32_16x16x32_bf16 v[124:127], a[236:239], a[12:15], v[124:127]
 ds_read_b64_tr_b16 a[222:223], v136 offset:37376
 v_add_u32 v21, v21, v200
 v_mfma_f32_16x16x32_bf16 v[104:107], a[236:239], a[8:11], v[64:67]
 ds_read_b64_tr_b16 a[224:225], v137 offset:32768
 buffer_load_dwordx4 a[120:123], v148, s[4:7], s23 offen offset:2048 sc1
 v_mfma_f32_16x16x32_bf16 v[104:107], a[232:235], a[0:3], v[104:107]
 ds_read_b64_tr_b16 a[226:227], v137 offset:33280
 s_waitcnt lgkmcnt(8)
 v_mfma_f32_16x16x32_bf16 v[108:111], a[240:243], a[0:3], v[72:75]
 ds_read_b64_tr_b16 a[228:229], v137 offset:36864
 s_lshl_b32 s3, s61, 11
 s_add_u32 s20, s20, s3
 v_mfma_f32_16x16x32_bf16 v[108:111], a[244:247], a[8:11], v[108:111]
 ds_read_b64_tr_b16 a[230:231], v137 offset:37376
 buffer_load_dwordx4 a[124:127], v149, s[4:7], s23 offen offset:2048 sc1
 v_mfma_f32_16x16x32_bf16 v[128:131], a[244:247], a[12:15], v[76:79]
 ds_read_b128 a[232:235], v23 offset:640
 s_add_u32 s23, s23, 4096
 v_mfma_f32_16x16x32_bf16 v[128:131], a[240:243], a[4:7], v[128:131]
 s_waitcnt vmcnt(12) lgkmcnt(9)
 v_mfma_f32_16x16x32_bf16 v[132:135], a[248:251], a[68:71], v[132:135]
 ds_read_b128 a[236:239], v23 offset:704
 buffer_load_dwordx4 a[128:131], v148, s[4:7], s23 offen sc1
 v_mfma_f32_16x16x32_bf16 v[132:135], a[252:255], a[76:79], v[132:135]
 s_cmp_lg_u32 s16, 2
 s_cselect_b64 exec, -1, 0
 s_cbranch_execz L_hop_15
L_ret_5:
 s_mov_b64 exec, -1
 v_mfma_f32_16x16x32_bf16 v[112:115], a[252:255], a[72:75], v[112:115]
 ds_read_b64_tr_b16 a[240:241], v136 offset:40960
 s_lshl_b32 s20, s20, 0
 s_add_u32 s20, s20, 20971520
 v_mfma_f32_16x16x32_bf16 v[112:115], a[248:251], a[64:67], v[112:115]
 ds_read_b64_tr_b16 a[242:243], v136 offset:41472
 s_waitcnt lgkmcnt(8)
 v_mfma_f32_16x16x32_bf16 v[96:99], a[216:219], a[64:67], v[96:99]
 ds_read_b64_tr_b16 a[244:245], v136 offset:45056
 buffer_load_dwordx4 a[132:135], v149, s[4:7], s23 offen sc1
 v_mfma_f32_16x16x32_bf16 v[96:99], a[220:223], a[72:75], v[96:99]
 ds_read_b64_tr_b16 a[246:247], v136 offset:45568
 s_lshl_b32 s24, s31, 11
 s_lshl_b32 s3, s61, 6
 v_mfma_f32_16x16x32_bf16 v[116:119], a[220:223], a[76:79], v[116:119]
 ds_read_b64_tr_b16 a[248:249], v137 offset:40960
 buffer_load_dwordx4 a[136:139], v148, s[4:7], s23 offen offset:2048 sc1
 v_mfma_f32_16x16x32_bf16 v[116:119], a[216:219], a[68:71], v[116:119]
 ds_read_b64_tr_b16 a[250:251], v137 offset:41472
 s_waitcnt lgkmcnt(8)
 v_mfma_f32_16x16x32_bf16 v[120:123], a[224:227], a[68:71], v[120:123]
 ds_read_b64_tr_b16 a[252:253], v137 offset:45056
 s_add_u32 s24, s24, s3
 s_add_u32 s24, s24, 39878656
 v_mfma_f32_16x16x32_bf16 v[120:123], a[228:231], a[76:79], v[120:123]
 ds_read_b64_tr_b16 a[254:255], v137 offset:45568
 buffer_load_dwordx4 a[140:143], v149, s[4:7], s23 offen offset:2048 sc1
 v_mfma_f32_16x16x32_bf16 v[100:103], a[228:231], a[72:75], v[100:103]
 ds_read_b128 a[216:219], v23 offset:768
 s_add_u32 s23, s23, 4096
 v_mfma_f32_16x16x32_bf16 v[100:103], a[224:227], a[64:67], v[100:103]
 s_waitcnt vmcnt(12) lgkmcnt(9)
 v_mfma_f32_16x16x32_bf16 v[112:115], a[232:235], a[80:83], v[112:115]
 ds_read_b128 a[220:223], v23 offset:832
 buffer_load_dwordx4 a[144:147], v148, s[4:7], s23 offen sc1
 v_mfma_f32_16x16x32_bf16 v[112:115], a[236:239], a[88:91], v[112:115]
 s_cmp_lg_u32 s16, 3
 s_cselect_b64 exec, -1, 0
 s_cbranch_execz L_hop_16
L_ret_6:
 s_mov_b64 exec, -1
 v_mfma_f32_16x16x32_bf16 v[132:135], a[236:239], a[92:95], v[132:135]
 ds_read_b64_tr_b16 a[224:225], v136 offset:49152
 s_mov_b32 s12, s44
 s_mov_b32 s13, s45
 v_mfma_f32_16x16x32_bf16 v[132:135], a[232:235], a[84:87], v[132:135]
 ds_read_b64_tr_b16 a[226:227], v136 offset:49664
 s_waitcnt lgkmcnt(8)
 v_mfma_f32_16x16x32_bf16 v[116:119], a[240:243], a[84:87], v[116:119]
 ds_read_b64_tr_b16 a[228:229], v136 offset:53248
 buffer_load_dwordx4 a[148:151], v149, s[4:7], s23 offen sc1
 v_mfma_f32_16x16x32_bf16 v[116:119], a[244:247], a[92:95], v[116:119]
 ds_read_b64_tr_b16 a[230:231], v136 offset:53760
 s_mov_b32 s14, 0x700000
 s_mov_b32 s15, 0x20000
 v_mfma_f32_16x16x32_bf16 v[96:99], a[244:247], a[88:91], v[96:99]
 ds_read_b64_tr_b16 a[232:233], v137 offset:49152
 buffer_load_dwordx4 a[152:155], v148, s[4:7], s23 offen offset:2048 sc1
 v_mfma_f32_16x16x32_bf16 v[96:99], a[240:243], a[80:83], v[96:99]
 ds_read_b64_tr_b16 a[234:235], v137 offset:49664
 s_waitcnt lgkmcnt(8)
 v_mfma_f32_16x16x32_bf16 v[100:103], a[248:251], a[80:83], v[100:103]
 ds_read_b64_tr_b16 a[236:237], v137 offset:53248
 s_mov_b32 s8, s46
 s_mov_b32 s9, s47
 v_mfma_f32_16x16x32_bf16 v[100:103], a[252:255], a[88:91], v[100:103]
 ds_read_b64_tr_b16 a[238:239], v137 offset:53760
 buffer_load_dwordx4 a[156:159], v149, s[4:7], s23 offen offset:2048 sc1
 v_mfma_f32_16x16x32_bf16 v[120:123], a[252:255], a[92:95], v[120:123]
 ds_read_b128 a[240:243], v23 offset:896
 s_add_u32 s23, s23, 4096
 v_mfma_f32_16x16x32_bf16 v[120:123], a[248:251], a[84:87], v[120:123]
 s_waitcnt vmcnt(12) lgkmcnt(9)
 v_mfma_f32_16x16x32_bf16 v[132:135], a[216:219], a[100:103], v[132:135]
 ds_read_b128 a[244:247], v23 offset:960
 buffer_load_dwordx4 a[160:163], v148, s[4:7], s23 offen sc1
 v_mfma_f32_16x16x32_bf16 v[132:135], a[220:223], a[108:111], v[132:135]
 s_cmp_lg_u32 s16, 0
 s_cselect_b64 exec, -1, 0
 s_cbranch_execz L_hop_17
L_ret_7:
 s_mov_b64 exec, -1
 v_mfma_f32_16x16x32_bf16 v[112:115], a[220:223], a[104:107], v[112:115]
 ds_read_b64_tr_b16 a[248:249], v136 offset:57344
 s_mov_b32 s10, 0x700000
 s_mov_b32 s11, 0x20000
 v_mfma_f32_16x16x32_bf16 v[112:115], a[216:219], a[96:99], v[112:115]
 ds_read_b64_tr_b16 a[250:251], v136 offset:57856
 s_waitcnt lgkmcnt(8)
 v_mfma_f32_16x16x32_bf16 v[96:99], a[224:227], a[96:99], v[96:99]
 ds_read_b64_tr_b16 a[252:253], v136 offset:61440
 buffer_load_dwordx4 a[164:167], v149, s[4:7], s23 offen sc1
 v_mfma_f32_16x16x32_bf16 v[96:99], a[228:231], a[104:107], v[96:99]
 ds_read_b64_tr_b16 a[254:255], v136 offset:61952
 s_and_b32 s3, s16, 2
 s_add_u32 s3, s3, s16
 v_mfma_f32_16x16x32_bf16 v[116:119], a[228:231], a[108:111], v[116:119]
 ds_read_b64_tr_b16 a[216:217], v137 offset:57344
 buffer_load_dwordx4 a[168:171], v148, s[4:7], s23 offen offset:2048 sc1
 v_mfma_f32_16x16x32_bf16 v[116:119], a[224:227], a[100:103], v[116:119]
 ds_read_b64_tr_b16 a[218:219], v137 offset:57856
 s_waitcnt lgkmcnt(8)
 v_mfma_f32_16x16x32_bf16 v[120:123], a[232:235], a[100:103], v[120:123]
 ds_read_b64_tr_b16 a[220:221], v137 offset:61440
 s_mul_i32 s3, s3, 114688
 s_mul_i32 s28, s63, 224
 v_mfma_f32_16x16x32_bf16 v[120:123], a[236:239], a[108:111], v[120:123]
 ds_read_b64_tr_b16 a[222:223], v137 offset:61952
 buffer_load_dwordx4 a[172:175], v149, s[4:7], s23 offen offset:2048 sc1
 v_mfma_f32_16x16x32_bf16 v[100:103], a[236:239], a[104:107], v[100:103]
 ds_read_b64_tr_b16 a[224:225], v138 offset:8192
 s_add_u32 s23, s23, 4096
 v_mfma_f32_16x16x32_bf16 v[100:103], a[232:235], a[96:99], v[100:103]
 ds_read_b64_tr_b16 a[226:227], v138 offset:8704
 s_waitcnt vmcnt(12) lgkmcnt(10)
 v_mfma_f32_16x16x32_bf16 v[112:115], a[240:243], a[112:115], v[112:115]
 ds_read_b64_tr_b16 a[228:229], v138 offset:12288
 buffer_load_dwordx4 a[176:179], v148, s[4:7], s23 offen sc1
 v_mfma_f32_16x16x32_bf16 v[112:115], a[244:247], a[120:123], v[112:115]
 ds_read_b64_tr_b16 a[230:231], v138 offset:12800
 s_cmp_lg_u32 s16, 1
 s_cselect_b64 exec, -1, 0
 s_cbranch_execz L_hop_18
L_ret_8:
 s_mov_b64 exec, -1
 v_mfma_f32_16x16x32_bf16 v[132:135], a[244:247], a[124:127], v[132:135]
 ds_read_b64_tr_b16 a[232:233], v139 offset:8192
 s_and_b32 s28, s28, 0xffffffc0
 s_add_u32 s3, s3, s28
 v_mfma_f32_16x16x32_bf16 v[132:135], a[240:243], a[116:119], v[132:135]
 ds_read_b64_tr_b16 a[234:235], v139 offset:8704
 s_waitcnt lgkmcnt(10)
 v_mfma_f32_16x16x32_bf16 v[116:119], a[248:251], a[116:119], v[116:119]
 ds_read_b64_tr_b16 a[236:237], v139 offset:12288
 buffer_load_dwordx4 a[180:183], v149, s[4:7], s23 offen sc1
 v_mfma_f32_16x16x32_bf16 v[116:119], a[252:255], a[124:127], v[116:119]
 ds_read_b64_tr_b16 a[238:239], v139 offset:12800
 s_and_b32 s28, s63, 1
 v_mfma_f32_16x16x32_bf16 v[96:99], a[252:255], a[120:123], v[96:99]
 ds_read_b128 a[240:243], v23 offset:1024
 buffer_load_dwordx4 a[184:187], v148, s[4:7], s23 offen offset:2048 sc1
 v_mfma_f32_16x16x32_bf16 v[96:99], a[248:251], a[112:115], v[96:99]
 s_waitcnt lgkmcnt(9)
 v_mfma_f32_16x16x32_bf16 v[100:103], a[216:219], a[112:115], v[100:103]
 ds_read_b128 a[244:247], v23 offset:1088
 v_bfe_u32 v14, v0, 3, 2
 v_mfma_f32_16x16x32_bf16 v[100:103], a[220:223], a[120:123], v[100:103]
 buffer_load_dwordx4 a[188:191], v149, s[4:7], s23 offen offset:2048 sc1
 v_mfma_f32_16x16x32_bf16 v[120:123], a[220:223], a[124:127], v[120:123]
 ds_read_b64_tr_b16 a[248:249], v140
 s_add_u32 s23, s23, 4096
 v_mfma_f32_16x16x32_bf16 v[120:123], a[216:219], a[116:119], v[120:123]
 ds_read_b64_tr_b16 a[250:251], v140 offset:512
 s_waitcnt lgkmcnt(8)
 v_mfma_f32_16x16x32_bf16 v[124:127], a[224:227], a[20:23], v[124:127]
 ds_read_b64_tr_b16 a[252:253], v140 offset:4096
 buffer_load_dwordx4 a[192:195], v148, s[4:7], s23 offen sc1
 v_mfma_f32_16x16x32_bf16 v[124:127], a[228:231], a[28:31], v[124:127]
 ds_read_b64_tr_b16 a[254:255], v140 offset:4608
 v_and_b32 v15, 2, v14
 v_mfma_f32_16x16x32_bf16 v[104:107], a[228:231], a[24:27], v[104:107]
 ds_read_b64_tr_b16 a[216:217], v141
 v_lshlrev_b32 v15, 1, v15
 v_mfma_f32_16x16x32_bf16 v[104:107], a[224:227], a[16:19], v[104:107]
 ds_read_b64_tr_b16 a[218:219], v141 offset:512
 s_waitcnt lgkmcnt(8)
 v_mfma_f32_16x16x32_bf16 v[108:111], a[232:235], a[16:19], v[108:111]
 ds_read_b64_tr_b16 a[220:221], v141 offset:4096
 buffer_load_dwordx4 a[196:199], v149, s[4:7], s23 offen sc1
 v_mfma_f32_16x16x32_bf16 v[108:111], a[236:239], a[24:27], v[108:111]
 ds_read_b64_tr_b16 a[222:223], v141 offset:4608
 v_and_b32 v16, 7, v0
 v_mfma_f32_16x16x32_bf16 v[128:131], a[236:239], a[28:31], v[128:131]
 ds_read_b128 a[224:227], v23 offset:1152
 buffer_load_dwordx4 a[200:203], v148, s[4:7], s23 offen offset:2048 sc1
 v_mfma_f32_16x16x32_bf16 v[128:131], a[232:235], a[20:23], v[128:131]
 s_waitcnt vmcnt(15) lgkmcnt(9)
 v_mfma_f32_16x16x32_bf16 v[132:135], a[240:243], a[132:135], v[132:135]
 ds_read_b128 a[228:231], v23 offset:1216
 s_cmp_lg_u32 s16, 2
 s_cselect_b64 exec, -1, 0
 s_cbranch_execz L_hop_19
L_ret_9:
 s_mov_b64 exec, -1
 v_mfma_f32_16x16x32_bf16 v[132:135], a[244:247], a[140:143], v[132:135]
 buffer_load_dwordx4 a[204:207], v149, s[4:7], s23 offen offset:2048 sc1
 v_mfma_f32_16x16x32_bf16 v[112:115], a[244:247], a[136:139], v[112:115]
 ds_read_b64_tr_b16 a[232:233], v140 offset:8192
 s_add_u32 s23, s23, 4096
 v_mfma_f32_16x16x32_bf16 v[112:115], a[240:243], a[128:131], v[112:115]
 ds_read_b64_tr_b16 a[234:235], v140 offset:8704
 s_waitcnt lgkmcnt(8)
 v_mfma_f32_16x16x32_bf16 v[96:99], a[248:251], a[128:131], v[96:99]
 ds_read_b64_tr_b16 a[236:237], v140 offset:12288
 buffer_load_dwordx4 a[208:211], v148, s[4:7], s23 offen sc1
 v_mfma_f32_16x16x32_bf16 v[96:99], a[252:255], a[136:139], v[96:99]
 ds_read_b64_tr_b16 a[238:239], v140 offset:12800
 v_xor_b32 v15, v15, v16
 v_mfma_f32_16x16x32_bf16 v[116:119], a[252:255], a[140:143], v[116:119]
 ds_read_b64_tr_b16 a[240:241], v141 offset:8192
 v_mul_u32_u24 v14, 7168, v14
 v_mfma_f32_16x16x32_bf16 v[116:119], a[248:251], a[132:135], v[116:119]
 ds_read_b64_tr_b16 a[242:243], v141 offset:8704
 s_waitcnt lgkmcnt(8)
 v_mfma_f32_16x16x32_bf16 v[120:123], a[216:219], a[132:135], v[120:123]
 ds_read_b64_tr_b16 a[244:245], v141 offset:12288
 buffer_load_dwordx4 a[212:215], v149, s[4:7], s23 offen sc1
 v_mfma_f32_16x16x32_bf16 v[120:123], a[220:223], a[140:143], v[120:123]
 ds_read_b64_tr_b16 a[246:247], v141 offset:12800
 v_add_u32 v14, s3, v14
 v_mfma_f32_16x16x32_bf16 v[100:103], a[220:223], a[136:139], v[100:103]
 ds_read_b128 a[248:251], v23 offset:1280
 buffer_load_dwordx4 v[216:219], v148, s[4:7], s23 offen offset:2048 sc1
 v_mfma_f32_16x16x32_bf16 v[100:103], a[216:219], a[128:131], v[100:103]
 s_waitcnt vmcnt(15) lgkmcnt(9)
 v_mfma_f32_16x16x32_bf16 v[112:115], a[224:227], a[144:147], v[112:115]
 ds_read_b128 a[252:255], v23 offset:1344
 s_cmp_lg_u32 s16, 3
 s_cselect_b64 exec, -1, 0
 s_cbranch_execz L_hop_20
L_ret_10:
 s_mov_b64 exec, -1
 v_mfma_f32_16x16x32_bf16 v[112:115], a[228:231], a[152:155], v[112:115]
 buffer_load_dwordx4 v[220:223], v149, s[4:7], s23 offen offset:2048 sc1
 v_mfma_f32_16x16x32_bf16 v[132:135], a[228:231], a[156:159], v[132:135]
 ds_read_b64_tr_b16 a[216:217], v140 offset:16384
 s_add_u32 s23, s23, 4096
 v_mfma_f32_16x16x32_bf16 v[132:135], a[224:227], a[148:151], v[132:135]
 ds_read_b64_tr_b16 a[218:219], v140 offset:16896
 s_waitcnt lgkmcnt(8)
 v_mfma_f32_16x16x32_bf16 v[116:119], a[232:235], a[148:151], v[116:119]
 ds_read_b64_tr_b16 a[220:221], v140 offset:20480
 buffer_load_dwordx4 v[224:227], v148, s[4:7], s23 offen sc1
 v_mfma_f32_16x16x32_bf16 v[116:119], a[236:239], a[156:159], v[116:119]
 ds_read_b64_tr_b16 a[222:223], v140 offset:20992
 v_lshrrev_b32 v16, 5, v0
 v_mfma_f32_16x16x32_bf16 v[96:99], a[236:239], a[152:155], v[96:99]
 ds_read_b64_tr_b16 a[224:225], v141 offset:16384
 v_xor_b32 v16, s28, v16
 v_mfma_f32_16x16x32_bf16 v[96:99], a[232:235], a[144:147], v[96:99]
 ds_read_b64_tr_b16 a[226:227], v141 offset:16896
 s_waitcnt lgkmcnt(8)
 v_mfma_f32_16x16x32_bf16 v[100:103], a[240:243], a[144:147], v[100:103]
 ds_read_b64_tr_b16 a[228:229], v141 offset:20480
 buffer_load_dwordx4 v[228:231], v149, s[4:7], s23 offen sc1
 v_mfma_f32_16x16x32_bf16 v[100:103], a[244:247], a[152:155], v[100:103]
 ds_read_b64_tr_b16 a[230:231], v141 offset:20992
 v_lshl_add_u32 v14, v16, 7, v14
 v_mfma_f32_16x16x32_bf16 v[120:123], a[244:247], a[156:159], v[120:123]
 ds_read_b128 a[232:235], v23 offset:1408
 buffer_load_dwordx4 v[232:235], v148, s[4:7], s23 offen offset:2048 sc1
 v_mfma_f32_16x16x32_bf16 v[120:123], a[240:243], a[148:151], v[120:123]
 s_waitcnt vmcnt(15) lgkmcnt(9)
 v_mfma_f32_16x16x32_bf16 v[132:135], a[248:251], a[164:167], v[132:135]
 ds_read_b128 a[236:239], v23 offset:1472
 s_cmp_lg_u32 s16, 0
 s_cselect_b64 exec, -1, 0
 s_cbranch_execz L_hop_21
L_ret_11:
 s_mov_b64 exec, -1
 v_mfma_f32_16x16x32_bf16 v[132:135], a[252:255], a[172:175], v[132:135]
 buffer_load_dwordx4 v[236:239], v149, s[4:7], s23 offen offset:2048 sc1
 v_mfma_f32_16x16x32_bf16 v[112:115], a[252:255], a[168:171], v[112:115]
 ds_read_b64_tr_b16 a[240:241], v140 offset:24576
 s_add_u32 s23, s23, 4096
 v_mfma_f32_16x16x32_bf16 v[112:115], a[248:251], a[160:163], v[112:115]
 ds_read_b64_tr_b16 a[242:243], v140 offset:25088
 s_waitcnt lgkmcnt(8)
 v_mfma_f32_16x16x32_bf16 v[96:99], a[216:219], a[160:163], v[96:99]
 ds_read_b64_tr_b16 a[244:245], v140 offset:28672
 buffer_load_dwordx4 v[240:243], v148, s[4:7], s23 offen sc1
 v_mfma_f32_16x16x32_bf16 v[96:99], a[220:223], a[168:171], v[96:99]
 ds_read_b64_tr_b16 a[246:247], v140 offset:29184
 v_xor_b32 v16, 2, v15
 v_mfma_f32_16x16x32_bf16 v[116:119], a[220:223], a[172:175], v[116:119]
 ds_read_b64_tr_b16 a[248:249], v141 offset:24576
 v_lshl_add_u32 v15, v15, 4, v14
 v_mfma_f32_16x16x32_bf16 v[116:119], a[216:219], a[164:167], v[116:119]
 ds_read_b64_tr_b16 a[250:251], v141 offset:25088
 s_waitcnt lgkmcnt(8)
 v_mfma_f32_16x16x32_bf16 v[120:123], a[224:227], a[164:167], v[120:123]
 ds_read_b64_tr_b16 a[252:253], v141 offset:28672
 buffer_load_dwordx4 v[244:247], v149, s[4:7], s23 offen sc1
 v_mfma_f32_16x16x32_bf16 v[120:123], a[228:231], a[172:175], v[120:123]
 ds_read_b64_tr_b16 a[254:255], v141 offset:29184
 v_lshl_add_u32 v16, v16, 4, v14
 v_mfma_f32_16x16x32_bf16 v[100:103], a[228:231], a[168:171], v[100:103]
 ds_read_b64_tr_b16 a[216:217], v138 offset:16384
 buffer_load_dwordx4 v[248:251], v148, s[4:7], s23 offen offset:2048 sc1
 v_mfma_f32_16x16x32_bf16 v[100:103], a[224:227], a[160:163], v[100:103]
 ds_read_b64_tr_b16 a[218:219], v138 offset:16896
 s_waitcnt vmcnt(15) lgkmcnt(10)
 v_mfma_f32_16x16x32_bf16 v[112:115], a[232:235], a[176:179], v[112:115]
 ds_read_b64_tr_b16 a[220:221], v138 offset:20480
 v_add_u32 v8, 0, v15
 v_mfma_f32_16x16x32_bf16 v[112:115], a[236:239], a[184:187], v[112:115]
 ds_read_b64_tr_b16 a[222:223], v138 offset:20992
 buffer_load_dwordx4 v[252:255], v149, s[4:7], s23 offen offset:2048 sc1
 v_mfma_f32_16x16x32_bf16 v[132:135], a[236:239], a[188:191], v[132:135]
 ds_read_b64_tr_b16 a[224:225], v139 offset:16384
 s_add_u32 s23, s23, 4096
 v_mfma_f32_16x16x32_bf16 v[132:135], a[232:235], a[180:183], v[132:135]
 ds_read_b64_tr_b16 a[226:227], v139 offset:16896
 s_waitcnt lgkmcnt(10)
 v_mfma_f32_16x16x32_bf16 v[116:119], a[240:243], a[180:183], v[116:119]
 ds_read_b64_tr_b16 a[228:229], v139 offset:20480
 v_add_u32 v9, 27648, v15
 v_mfma_f32_16x16x32_bf16 v[116:119], a[244:247], a[188:191], v[116:119]
 ds_read_b64_tr_b16 a[230:231], v139 offset:20992
 v_add_u32 v10, 55296, v16
 v_mfma_f32_16x16x32_bf16 v[96:99], a[244:247], a[184:187], v[96:99]
 ds_read_b128 a[232:235], v23 offset:1536
 v_add_u32 v11, 82944, v16
 v_mfma_f32_16x16x32_bf16 v[96:99], a[240:243], a[176:179], v[96:99]
 s_waitcnt lgkmcnt(9)
 v_mfma_f32_16x16x32_bf16 v[100:103], a[248:251], a[176:179], v[100:103]
 ds_read_b128 a[236:239], v23 offset:1600
 s_lshl2_add_u32 s32, s62, s16
 s_lshl_b32 s32, s32, 2
 v_mfma_f32_16x16x32_bf16 v[100:103], a[252:255], a[184:187], v[100:103]
 s_lshl_b32 s3, s32, 15
 v_mfma_f32_16x16x32_bf16 v[120:123], a[252:255], a[188:191], v[120:123]
 ds_read_b64_tr_b16 a[240:241], v140 offset:32768
 v_add_u32 v2, s3, v1
 v_mfma_f32_16x16x32_bf16 v[120:123], a[248:251], a[180:183], v[120:123]
 ds_read_b64_tr_b16 a[242:243], v140 offset:33280
 s_waitcnt lgkmcnt(8)
 v_mfma_f32_16x16x32_bf16 v[124:127], a[216:219], a[36:39], v[124:127]
 ds_read_b64_tr_b16 a[244:245], v140 offset:36864
 v_add_u32 v3, 32768, v2
 v_mfma_f32_16x16x32_bf16 v[124:127], a[220:223], a[44:47], v[124:127]
 ds_read_b64_tr_b16 a[246:247], v140 offset:37376
 v_add_u32 v12, 65536, v2
 v_mfma_f32_16x16x32_bf16 v[104:107], a[220:223], a[40:43], v[104:107]
 ds_read_b64_tr_b16 a[248:249], v141 offset:32768
 v_add_u32 v13, 98304, v2
 v_mfma_f32_16x16x32_bf16 v[104:107], a[216:219], a[32:35], v[104:107]
 ds_read_b64_tr_b16 a[250:251], v141 offset:33280
 s_waitcnt lgkmcnt(8)
 v_mfma_f32_16x16x32_bf16 v[108:111], a[224:227], a[32:35], v[108:111]
 ds_read_b64_tr_b16 a[252:253], v141 offset:36864
 v_bfe_u32 v14, v0, 2, 2
 v_mfma_f32_16x16x32_bf16 v[108:111], a[228:231], a[40:43], v[108:111]
 ds_read_b64_tr_b16 a[254:255], v141 offset:37376
 v_lshrrev_b32 v15, 4, v0
 v_mfma_f32_16x16x32_bf16 v[128:131], a[228:231], a[44:47], v[128:131]
 ds_read_b128 a[216:219], v23 offset:1664
 v_and_b32 v16, 2, v14
 v_mfma_f32_16x16x32_bf16 v[128:131], a[224:227], a[36:39], v[128:131]
 s_waitcnt vmcnt(12) lgkmcnt(9)
 v_mfma_f32_16x16x32_bf16 v[132:135], a[232:235], a[196:199], v[132:135]
 ds_read_b128 a[220:223], v23 offset:1728
 v_and_or_b32 v16, v15, 1, v16
 v_mfma_f32_16x16x32_bf16 v[132:135], a[236:239], a[204:207], v[132:135]
 v_lshlrev_b32 v15, 11, v15
 v_mfma_f32_16x16x32_bf16 v[112:115], a[236:239], a[200:203], v[112:115]
 ds_read_b64_tr_b16 a[224:225], v140 offset:40960
 v_lshl_add_u32 v15, v14, 7, v15
 v_mfma_f32_16x16x32_bf16 v[112:115], a[232:235], a[192:195], v[112:115]
 ds_read_b64_tr_b16 a[226:227], v140 offset:41472
 s_waitcnt lgkmcnt(8)
 v_mfma_f32_16x16x32_bf16 v[96:99], a[240:243], a[192:195], v[96:99]
 ds_read_b64_tr_b16 a[228:229], v140 offset:45056
 v_and_b32 v14, 3, v0
 v_mfma_f32_16x16x32_bf16 v[96:99], a[244:247], a[200:203], v[96:99]
 ds_read_b64_tr_b16 a[230:231], v140 offset:45568
 v_lshl_add_u32 v15, v14, 3, v15
 v_mfma_f32_16x16x32_bf16 v[116:119], a[244:247], a[204:207], v[116:119]
 ds_read_b64_tr_b16 a[232:233], v141 offset:40960
 s_mul_i32 s3, s28, 3
 v_mfma_f32_16x16x32_bf16 v[116:119], a[240:243], a[196:199], v[116:119]
 ds_read_b64_tr_b16 a[234:235], v141 offset:41472
 s_waitcnt lgkmcnt(8)
 v_mfma_f32_16x16x32_bf16 v[120:123], a[248:251], a[196:199], v[120:123]
 ds_read_b64_tr_b16 a[236:237], v141 offset:45056
 v_xor_b32 v16, s3, v16
 v_mfma_f32_16x16x32_bf16 v[120:123], a[252:255], a[204:207], v[120:123]
 ds_read_b64_tr_b16 a[238:239], v141 offset:45568
 v_xor_b32 v14, 0, v16
 v_mfma_f32_16x16x32_bf16 v[100:103], a[252:255], a[200:203], v[100:103]
 ds_read_b128 a[240:243], v23 offset:1792
 v_lshl_add_u32 v4, v14, 5, v15
 v_mfma_f32_16x16x32_bf16 v[100:103], a[248:251], a[192:195], v[100:103]
 s_waitcnt vmcnt(8) lgkmcnt(9)
 v_mfma_f32_16x16x32_bf16 v[112:115], a[216:219], a[208:211], v[112:115]
 ds_read_b128 a[244:247], v23 offset:1856
 v_xor_b32 v14, 1, v16
 v_mfma_f32_16x16x32_bf16 v[112:115], a[220:223], v[216:219], v[112:115]
 v_lshl_add_u32 v5, v14, 5, v15
 v_mfma_f32_16x16x32_bf16 v[132:135], a[220:223], v[220:223], v[132:135]
 ds_read_b64_tr_b16 a[248:249], v144
 v_xor_b32 v14, 2, v16
 v_mfma_f32_16x16x32_bf16 v[132:135], a[216:219], a[212:215], v[132:135]
 ds_read_b64_tr_b16 a[250:251], v144 offset:512
 s_waitcnt lgkmcnt(8)
 v_mfma_f32_16x16x32_bf16 v[116:119], a[224:227], a[212:215], v[116:119]
 ds_read_b64_tr_b16 a[252:253], v144 offset:4096
 v_lshl_add_u32 v6, v14, 5, v15
 v_mfma_f32_16x16x32_bf16 v[116:119], a[228:231], v[220:223], v[116:119]
 ds_read_b64_tr_b16 a[254:255], v144 offset:4608
 v_xor_b32 v14, 3, v16
 v_mfma_f32_16x16x32_bf16 v[96:99], a[228:231], v[216:219], v[96:99]
 ds_read_b64_tr_b16 a[216:217], v145
 v_lshl_add_u32 v7, v14, 5, v15
 v_mfma_f32_16x16x32_bf16 v[96:99], a[224:227], a[208:211], v[96:99]
 ds_read_b64_tr_b16 a[218:219], v145 offset:512
 s_waitcnt lgkmcnt(8)
 v_mfma_f32_16x16x32_bf16 v[100:103], a[232:235], a[208:211], v[100:103]
 ds_read_b64_tr_b16 a[220:221], v145 offset:4096
 s_mul_i32 s34, s32, 114688
 s_mul_i32 s3, s63, 3584
 v_mfma_f32_16x16x32_bf16 v[100:103], a[236:239], v[216:219], v[100:103]
 ds_read_b64_tr_b16 a[222:223], v145 offset:4608
 s_add_u32 s34, s34, s3
 s_mul_i32 s3, s28, 3072
 v_mfma_f32_16x16x32_bf16 v[120:123], a[236:239], v[220:223], v[120:123]
 ds_read_b64_tr_b16 a[224:225], v138 offset:24576
 s_add_u32 s34, s34, s3
 s_add_u32 s34, s34, 25165824
 v_mfma_f32_16x16x32_bf16 v[120:123], a[232:235], a[212:215], v[120:123]
 ds_read_b64_tr_b16 a[226:227], v138 offset:25088
 s_waitcnt vmcnt(4) lgkmcnt(10)
 v_mfma_f32_16x16x32_bf16 v[132:135], a[240:243], v[228:231], v[132:135]
 ds_read_b64_tr_b16 a[228:229], v138 offset:28672
 s_add_u32 s35, s34, 229376
 s_lshl_b32 s3, s28, 10
 v_mfma_f32_16x16x32_bf16 v[132:135], a[244:247], v[236:239], v[132:135]
 ds_read_b64_tr_b16 a[230:231], v138 offset:29184
 s_sub_u32 s27, 512, s3
 s_lshl_b32 s30, s32, 10
 v_mfma_f32_16x16x32_bf16 v[112:115], a[244:247], v[232:235], v[112:115]
 ds_read_b64_tr_b16 a[232:233], v139 offset:24576
 s_add_u32 s30, s30, 39878656
 s_bfe_u32 s0, s2, 0x10005
 v_mfma_f32_16x16x32_bf16 v[112:115], a[240:243], v[224:227], v[112:115]
 ds_read_b64_tr_b16 a[234:235], v139 offset:25088
 s_waitcnt lgkmcnt(10)
 v_mfma_f32_16x16x32_bf16 v[96:99], a[248:251], v[224:227], v[96:99]
 ds_read_b64_tr_b16 a[236:237], v139 offset:28672
 s_and_b32 s3, s2, 3
 s_lshl1_add_u32 s0, s3, s0
 v_mfma_f32_16x16x32_bf16 v[96:99], a[252:255], v[232:235], v[96:99]
L_hop_10:
 s_cbranch_execz L_ret_2
 ds_read_b64_tr_b16 a[238:239], v139 offset:29184
 s_lshl_b32 s0, s0, 8
 s_lshr_b32 s25, s60, 1
 v_mfma_f32_16x16x32_bf16 v[116:119], a[252:255], v[236:239], v[116:119]
 ds_read_b128 a[240:243], v23 offset:1920
 s_lshl_b32 s25, s25, 11
 s_add_u32 s25, s25, s0
 v_mfma_f32_16x16x32_bf16 v[116:119], a[248:251], v[228:231], v[116:119]
 s_waitcnt lgkmcnt(9)
 v_mfma_f32_16x16x32_bf16 v[120:123], a[216:219], v[228:231], v[120:123]
 ds_read_b128 a[244:247], v23 offset:1984
 s_add_u32 s25, s25, 40255488
 s_lshl_b32 s65, s62, 11
 v_mfma_f32_16x16x32_bf16 v[120:123], a[220:223], v[236:239], v[120:123]
 s_add_u32 s65, s65, s0
 s_add_u32 s65, s65, 40255488
 v_mfma_f32_16x16x32_bf16 v[100:103], a[220:223], v[232:235], v[100:103]
 ds_read_b64_tr_b16 a[248:249], v144 offset:8192
 v_mfma_f32_16x16x32_bf16 v[100:103], a[216:219], v[224:227], v[100:103]
 ds_read_b64_tr_b16 a[250:251], v144 offset:8704
 s_waitcnt lgkmcnt(8)
 v_mfma_f32_16x16x32_bf16 v[104:107], a[224:227], a[48:51], v[104:107]
 ds_read_b64_tr_b16 a[252:253], v144 offset:12288
 v_mfma_f32_16x16x32_bf16 v[104:107], a[228:231], a[56:59], v[104:107]
 ds_read_b64_tr_b16 a[254:255], v144 offset:12800
 v_mfma_f32_16x16x32_bf16 v[124:127], a[228:231], a[60:63], v[124:127]
 ds_read_b64_tr_b16 a[216:217], v145 offset:8192
 v_mfma_f32_16x16x32_bf16 v[124:127], a[224:227], a[52:55], v[124:127]
 ds_read_b64_tr_b16 a[218:219], v145 offset:8704
 s_waitcnt lgkmcnt(8)
 v_mfma_f32_16x16x32_bf16 v[128:131], a[232:235], a[52:55], v[128:131]
 ds_read_b64_tr_b16 a[220:221], v145 offset:12288
 v_mfma_f32_16x16x32_bf16 v[128:131], a[236:239], a[60:63], v[128:131]
 ds_read_b64_tr_b16 a[222:223], v145 offset:12800
 v_mfma_f32_16x16x32_bf16 v[108:111], a[236:239], a[56:59], v[108:111]
 ds_read_b64_tr_b16 a[8:9], v138 offset:32768
 v_mfma_f32_16x16x32_bf16 v[108:111], a[232:235], a[48:51], v[108:111]
 ds_read_b64_tr_b16 a[10:11], v138 offset:33280
 s_waitcnt vmcnt(0) lgkmcnt(10)
 v_mfma_f32_16x16x32_bf16 v[112:115], a[240:243], v[240:243], v[112:115]
 ds_read_b64_tr_b16 a[12:13], v138 offset:36864
 v_mfma_f32_16x16x32_bf16 v[112:115], a[244:247], v[248:251], v[112:115]
 ds_read_b64_tr_b16 a[14:15], v138 offset:37376
 v_mfma_f32_16x16x32_bf16 v[132:135], a[244:247], v[252:255], v[132:135]
 ds_read_b64_tr_b16 a[16:17], v139 offset:32768
 v_mfma_f32_16x16x32_bf16 v[132:135], a[240:243], v[244:247], v[132:135]
 ds_read_b64_tr_b16 a[18:19], v139 offset:33280
 s_waitcnt lgkmcnt(10)
 v_mfma_f32_16x16x32_bf16 v[116:119], a[248:251], v[244:247], v[116:119]
 ds_read_b64_tr_b16 a[20:21], v139 offset:36864
 v_mfma_f32_16x16x32_bf16 v[116:119], a[252:255], v[252:255], v[116:119]
 ds_read_b64_tr_b16 a[22:23], v139 offset:37376
 v_mfma_f32_16x16x32_bf16 v[96:99], a[252:255], v[248:251], v[96:99]
 ds_read_b64_tr_b16 a[24:25], v138 offset:40960
 v_mfma_f32_16x16x32_bf16 v[96:99], a[248:251], v[240:243], v[96:99]
 ds_read_b64_tr_b16 a[26:27], v138 offset:41472
 s_waitcnt lgkmcnt(10)
 v_mfma_f32_16x16x32_bf16 v[100:103], a[216:219], v[240:243], v[100:103]
 ds_read_b64_tr_b16 a[28:29], v138 offset:45056
 v_add_f32 v24, v24, v112
 v_mfma_f32_16x16x32_bf16 v[100:103], a[220:223], v[248:251], v[100:103]
 ds_read_b64_tr_b16 a[30:31], v138 offset:45568
 v_add_f32 v25, v25, v132
 v_mfma_f32_16x16x32_bf16 v[120:123], a[220:223], v[252:255], v[120:123]
 ds_read_b64_tr_b16 a[32:33], v139 offset:40960
 v_add_f32 v24, v24, v113
 v_add_f32 v26, v25, v133
 v_mfma_f32_16x16x32_bf16 v[120:123], a[216:219], v[244:247], v[120:123]
 ds_read_b64_tr_b16 a[34:35], v139 offset:41472
 s_waitcnt lgkmcnt(10)
 v_pk_add_f32 v[48:49], v[96:97], v[24:25] op_sel_hi:[1,0] neg_lo:[0,1] neg_hi:[0,1]
 v_pk_add_f32 v[50:51], v[98:99], v[24:25] op_sel_hi:[1,0] neg_lo:[0,1] neg_hi:[0,1]
 v_pk_add_f32 v[52:53], v[116:117], v[26:27] op_sel_hi:[1,0] neg_lo:[0,1] neg_hi:[0,1]
 v_pk_add_f32 v[54:55], v[118:119], v[26:27] op_sel_hi:[1,0] neg_lo:[0,1] neg_hi:[0,1]
 v_cvt_pk_bf16_f32 v32, v48, v49
 v_cvt_pk_bf16_f32 v33, v50, v51
 v_cvt_pk_bf16_f32 v34, v52, v53
 v_cvt_pk_bf16_f32 v35, v54, v55
 v_pk_add_f32 v[56:57], v[100:101], v[24:25] op_sel_hi:[1,0] neg_lo:[0,1] neg_hi:[0,1]
 v_pk_add_f32 v[58:59], v[102:103], v[24:25] op_sel_hi:[1,0] neg_lo:[0,1] neg_hi:[0,1]
 v_pk_add_f32 v[60:61], v[120:121], v[26:27] op_sel_hi:[1,0] neg_lo:[0,1] neg_hi:[0,1]
 v_pk_add_f32 v[62:63], v[122:123], v[26:27] op_sel_hi:[1,0] neg_lo:[0,1] neg_hi:[0,1]
 v_permlane16_swap_b32 v32, v34
 v_permlane16_swap_b32 v33, v35
 buffer_store_dwordx4 v[32:35], v21, s[4:7], s20 offen sc1
 v_cvt_pk_bf16_f32 v36, v56, v57
 v_cvt_pk_bf16_f32 v37, v58, v59
 v_cvt_pk_bf16_f32 v38, v60, v61
 v_cvt_pk_bf16_f32 v39, v62, v63
 s_nop 0
 v_permlane16_swap_b32 v36, v38
 v_permlane16_swap_b32 v37, v39
 buffer_store_dwordx4 v[36:39], v21, s[4:7], s20 offen offset:512 sc1
 v_mfma_f32_16x16x32_bf16 v[124:127], a[8:11], a[68:71], v[124:127]
 ds_read_b64_tr_b16 a[36:37], v139 offset:45056
 v_mul_f32 v80, v48, v48
 v_mfma_f32_16x16x32_bf16 v[124:127], a[12:15], a[76:79], v[124:127]
 ds_read_b64_tr_b16 a[38:39], v139 offset:45568
 s_barrier
 v_mfma_f32_16x16x32_bf16 v[104:107], a[12:15], a[72:75], v[104:107]
 ds_read_b64_tr_b16 a[0:1], v138 offset:49152
 s_mov_b32 s21, 0
 v_mfma_f32_16x16x32_bf16 v[104:107], a[8:11], a[64:67], v[104:107]
 ds_read_b64_tr_b16 a[2:3], v138 offset:49664
 s_waitcnt lgkmcnt(10)
 v_mfma_f32_16x16x32_bf16 v[108:111], a[16:19], a[64:67], v[108:111]
 ds_read_b64_tr_b16 a[4:5], v138 offset:53248
 s_add_u32 m0, s19, 0
 v_mfma_f32_16x16x32_bf16 v[108:111], a[20:23], a[72:75], v[108:111]
 ds_read_b64_tr_b16 a[6:7], v138 offset:53760
 buffer_load_dwordx4 v8, s[12:15], s21 offen lds
 v_mfma_f32_16x16x32_bf16 v[128:131], a[20:23], a[76:79], v[128:131]
 ds_read_b64_tr_b16 a[8:9], v139 offset:49152
 v_mul_f32 v81, v49, v49
 v_mfma_f32_16x16x32_bf16 v[128:131], a[16:19], a[68:71], v[128:131]
 ds_read_b64_tr_b16 a[10:11], v139 offset:49664
 s_waitcnt lgkmcnt(10)
 v_mfma_f32_16x16x32_bf16 v[124:127], a[24:27], a[84:87], v[124:127]
 ds_read_b64_tr_b16 a[12:13], v139 offset:53248
 buffer_load_dwordx4 v9, s[12:15], s21 offen offset:1024 lds
 v_mfma_f32_16x16x32_bf16 v[124:127], a[28:31], a[92:95], v[124:127]
 ds_read_b64_tr_b16 a[14:15], v139 offset:53760
 v_mul_f32 v82, v52, v52
 v_mfma_f32_16x16x32_bf16 v[104:107], a[28:31], a[88:91], v[104:107]
 ds_read_b64_tr_b16 a[16:17], v138 offset:57344
 v_mul_f32 v83, v53, v53
 v_mfma_f32_16x16x32_bf16 v[104:107], a[24:27], a[80:83], v[104:107]
 ds_read_b64_tr_b16 a[18:19], v138 offset:57856
 s_waitcnt lgkmcnt(10)
 v_mfma_f32_16x16x32_bf16 v[108:111], a[32:35], a[80:83], v[108:111]
 ds_read_b64_tr_b16 a[20:21], v138 offset:61440
 buffer_load_dwordx4 v10, s[12:15], s21 offen offset:2048 lds
 v_mfma_f32_16x16x32_bf16 v[108:111], a[36:39], a[88:91], v[108:111]
 ds_read_b64_tr_b16 a[22:23], v138 offset:61952
 v_fmac_f32 v80, v50, v50
 v_mfma_f32_16x16x32_bf16 v[128:131], a[36:39], a[92:95], v[128:131]
 ds_read_b64_tr_b16 a[24:25], v139 offset:57344
 v_fmac_f32 v81, v51, v51
 v_mfma_f32_16x16x32_bf16 v[128:131], a[32:35], a[84:87], v[128:131]
 ds_read_b64_tr_b16 a[26:27], v139 offset:57856
 s_waitcnt lgkmcnt(10)
 v_mfma_f32_16x16x32_bf16 v[124:127], a[0:3], a[100:103], v[124:127]
 ds_read_b64_tr_b16 a[28:29], v139 offset:61440
 buffer_load_dwordx4 v11, s[12:15], s21 offen offset:3072 lds
 v_mfma_f32_16x16x32_bf16 v[124:127], a[4:7], a[108:111], v[124:127]
 ds_read_b64_tr_b16 a[30:31], v139 offset:61952
 s_add_u32 m0, s19, 16384
 v_mfma_f32_16x16x32_bf16 v[104:107], a[4:7], a[104:107], v[104:107]
 ds_read_b64_tr_b16 a[32:33], v142
 v_fmac_f32 v82, v54, v54
 v_mfma_f32_16x16x32_bf16 v[104:107], a[0:3], a[96:99], v[104:107]
 ds_read_b64_tr_b16 a[34:35], v142 offset:512
 s_waitcnt lgkmcnt(10)
 v_mfma_f32_16x16x32_bf16 v[108:111], a[8:11], a[96:99], v[108:111]
 ds_read_b64_tr_b16 a[36:37], v142 offset:4096
 buffer_load_dwordx4 v8, s[8:11], s21 offen lds
 v_mfma_f32_16x16x32_bf16 v[108:111], a[12:15], a[104:107], v[108:111]
 ds_read_b64_tr_b16 a[38:39], v142 offset:4608
 v_fmac_f32 v83, v55, v55
 v_mfma_f32_16x16x32_bf16 v[128:131], a[12:15], a[108:111], v[128:131]
 ds_read_b64_tr_b16 a[0:1], v143
 v_fmac_f32 v80, v56, v56
 v_mfma_f32_16x16x32_bf16 v[128:131], a[8:11], a[100:103], v[128:131]
 ds_read_b64_tr_b16 a[2:3], v143 offset:512
 s_waitcnt lgkmcnt(10)
 v_mfma_f32_16x16x32_bf16 v[124:127], a[16:19], a[116:119], v[124:127]
 ds_read_b64_tr_b16 a[4:5], v143 offset:4096
 buffer_load_dwordx4 v9, s[8:11], s21 offen offset:1024 lds
 v_mfma_f32_16x16x32_bf16 v[124:127], a[20:23], a[124:127], v[124:127]
 ds_read_b64_tr_b16 a[6:7], v143 offset:4608
 v_fmac_f32 v81, v57, v57
 v_mfma_f32_16x16x32_bf16 v[104:107], a[20:23], a[120:123], v[104:107]
 ds_read_b64_tr_b16 a[8:9], v142 offset:8192
 v_fmac_f32 v80, v58, v58
 v_mfma_f32_16x16x32_bf16 v[104:107], a[16:19], a[112:115], v[104:107]
 ds_read_b64_tr_b16 a[10:11], v142 offset:8704
 s_waitcnt lgkmcnt(10)
 v_mfma_f32_16x16x32_bf16 v[108:111], a[24:27], a[112:115], v[108:111]
 ds_read_b64_tr_b16 a[12:13], v142 offset:12288
 buffer_load_dwordx4 v10, s[8:11], s21 offen offset:2048 lds
 v_mfma_f32_16x16x32_bf16 v[108:111], a[28:31], a[120:123], v[108:111]
 ds_read_b64_tr_b16 a[14:15], v142 offset:12800
 v_fmac_f32 v81, v59, v59
 v_mfma_f32_16x16x32_bf16 v[128:131], a[28:31], a[124:127], v[128:131]
 ds_read_b64_tr_b16 a[16:17], v143 offset:8192
 v_fmac_f32 v82, v60, v60
 v_mfma_f32_16x16x32_bf16 v[128:131], a[24:27], a[116:119], v[128:131]
 ds_read_b64_tr_b16 a[18:19], v143 offset:8704
 s_waitcnt lgkmcnt(10)
 v_mfma_f32_16x16x32_bf16 v[124:127], a[32:35], a[132:135], v[124:127]
 ds_read_b64_tr_b16 a[20:21], v143 offset:12288
 buffer_load_dwordx4 v11, s[8:11], s21 offen offset:3072 lds
 v_mfma_f32_16x16x32_bf16 v[124:127], a[36:39], a[140:143], v[124:127]
 ds_read_b64_tr_b16 a[22:23], v143 offset:12800
 v_fmac_f32 v83, v61, v61
 v_mfma_f32_16x16x32_bf16 v[104:107], a[36:39], a[136:139], v[104:107]
 ds_read_b64_tr_b16 a[24:25], v142 offset:16384
 v_fmac_f32 v82, v62, v62
 v_mfma_f32_16x16x32_bf16 v[104:107], a[32:35], a[128:131], v[104:107]
 ds_read_b64_tr_b16 a[26:27], v142 offset:16896
 s_waitcnt lgkmcnt(10)
 v_mfma_f32_16x16x32_bf16 v[108:111], a[0:3], a[128:131], v[108:111]
 ds_read_b64_tr_b16 a[28:29], v142 offset:20480
 s_waitcnt vmcnt(8)
 s_barrier
 s_cmp_lg_u32 s16, 0
 s_cbranch_scc1 L_arrived_26
 s_sub_u32 s67, s25, s0
 s_mov_b64 exec, 0xff
 buffer_atomic_add v29, v28, s[4:7], s67 offen sc1
 s_mov_b64 exec, -1
L_arrived_26:
 v_mfma_f32_16x16x32_bf16 v[108:111], a[4:7], a[136:139], v[108:111]
 ds_read_b64_tr_b16 a[30:31], v142 offset:20992
 s_mov_b32 s21, 917504
 v_mfma_f32_16x16x32_bf16 v[128:131], a[4:7], a[140:143], v[128:131]
 ds_read_b64_tr_b16 a[32:33], v143 offset:16384
 s_add_u32 m0, s19, 32768
 v_mfma_f32_16x16x32_bf16 v[128:131], a[0:3], a[132:135], v[128:131]
 ds_read_b64_tr_b16 a[34:35], v143 offset:16896
 s_waitcnt lgkmcnt(10)
 v_mfma_f32_16x16x32_bf16 v[124:127], a[8:11], a[148:151], v[124:127]
 ds_read_b64_tr_b16 a[36:37], v143 offset:20480
 buffer_load_dwordx4 v8, s[12:15], s21 offen lds
 v_mfma_f32_16x16x32_bf16 v[124:127], a[12:15], a[156:159], v[124:127]
 ds_read_b64_tr_b16 a[38:39], v143 offset:20992
 v_fmac_f32 v83, v63, v63
 v_mfma_f32_16x16x32_bf16 v[104:107], a[12:15], a[152:155], v[104:107]
 ds_read_b64_tr_b16 a[0:1], v142 offset:24576
 buffer_load_dwordx4 v9, s[12:15], s21 offen offset:1024 lds
 v_mfma_f32_16x16x32_bf16 v[104:107], a[8:11], a[144:147], v[104:107]
 ds_read_b64_tr_b16 a[2:3], v142 offset:25088
 s_waitcnt lgkmcnt(10)
 v_mfma_f32_16x16x32_bf16 v[108:111], a[16:19], a[144:147], v[108:111]
 ds_read_b64_tr_b16 a[4:5], v142 offset:28672
 buffer_load_dwordx4 v10, s[12:15], s21 offen offset:2048 lds
 v_mfma_f32_16x16x32_bf16 v[108:111], a[20:23], a[152:155], v[108:111]
 ds_read_b64_tr_b16 a[6:7], v142 offset:29184
 v_accvgpr_write_b32 a224, v96
 v_mfma_f32_16x16x32_bf16 v[128:131], a[20:23], a[156:159], v[128:131]
 ds_read_b64_tr_b16 a[8:9], v143 offset:24576
 buffer_load_dwordx4 v11, s[12:15], s21 offen offset:3072 lds
 v_mfma_f32_16x16x32_bf16 v[128:131], a[16:19], a[148:151], v[128:131]
 ds_read_b64_tr_b16 a[10:11], v143 offset:25088
 s_waitcnt lgkmcnt(10)
 v_mfma_f32_16x16x32_bf16 v[124:127], a[24:27], a[164:167], v[124:127]
 ds_read_b64_tr_b16 a[12:13], v143 offset:28672
 s_add_u32 m0, s19, 49152
 v_mfma_f32_16x16x32_bf16 v[124:127], a[28:31], a[172:175], v[124:127]
 ds_read_b64_tr_b16 a[14:15], v143 offset:29184
 buffer_load_dwordx4 v8, s[8:11], s21 offen lds
 v_mfma_f32_16x16x32_bf16 v[104:107], a[28:31], a[168:171], v[104:107]
 ds_read_b64_tr_b16 a[16:17], v142 offset:32768
 v_accvgpr_write_b32 a225, v97
 v_mfma_f32_16x16x32_bf16 v[104:107], a[24:27], a[160:163], v[104:107]
 ds_read_b64_tr_b16 a[18:19], v142 offset:33280
 s_waitcnt lgkmcnt(10)
 v_mfma_f32_16x16x32_bf16 v[108:111], a[32:35], a[160:163], v[108:111]
 ds_read_b64_tr_b16 a[20:21], v142 offset:36864
 buffer_load_dwordx4 v9, s[8:11], s21 offen offset:1024 lds
 v_mfma_f32_16x16x32_bf16 v[108:111], a[36:39], a[168:171], v[108:111]
 ds_read_b64_tr_b16 a[22:23], v142 offset:37376
 v_accvgpr_write_b32 a226, v98
 v_mfma_f32_16x16x32_bf16 v[128:131], a[36:39], a[172:175], v[128:131]
 ds_read_b64_tr_b16 a[24:25], v143 offset:32768
 buffer_load_dwordx4 v10, s[8:11], s21 offen offset:2048 lds
 v_mfma_f32_16x16x32_bf16 v[128:131], a[32:35], a[164:167], v[128:131]
 ds_read_b64_tr_b16 a[26:27], v143 offset:33280
 s_waitcnt lgkmcnt(10)
 v_mfma_f32_16x16x32_bf16 v[124:127], a[0:3], a[180:183], v[124:127]
 ds_read_b64_tr_b16 a[28:29], v143 offset:36864
 buffer_load_dwordx4 v11, s[8:11], s21 offen offset:3072 lds
 v_mfma_f32_16x16x32_bf16 v[124:127], a[4:7], a[188:191], v[124:127]
 ds_read_b64_tr_b16 a[30:31], v143 offset:37376
 v_accvgpr_write_b32 a227, v99
 v_mfma_f32_16x16x32_bf16 v[104:107], a[4:7], a[184:187], v[104:107]
 ds_read_b64_tr_b16 a[32:33], v142 offset:40960
 v_accvgpr_write_b32 a240, v116
 v_mfma_f32_16x16x32_bf16 v[104:107], a[0:3], a[176:179], v[104:107]
 ds_read_b64_tr_b16 a[34:35], v142 offset:41472
 s_waitcnt lgkmcnt(10)
 v_mfma_f32_16x16x32_bf16 v[108:111], a[8:11], a[176:179], v[108:111]
 ds_read_b64_tr_b16 a[36:37], v142 offset:45056
 v_accvgpr_write_b32 a241, v117
 v_mfma_f32_16x16x32_bf16 v[108:111], a[12:15], a[184:187], v[108:111]
 ds_read_b64_tr_b16 a[38:39], v142 offset:45568
 v_accvgpr_write_b32 a242, v118
 v_mfma_f32_16x16x32_bf16 v[128:131], a[12:15], a[188:191], v[128:131]
 ds_read_b64_tr_b16 a[0:1], v143 offset:40960
 v_accvgpr_write_b32 a243, v119
 v_mfma_f32_16x16x32_bf16 v[128:131], a[8:11], a[180:183], v[128:131]
 ds_read_b64_tr_b16 a[2:3], v143 offset:41472
 s_waitcnt lgkmcnt(10)
 v_mfma_f32_16x16x32_bf16 v[124:127], a[16:19], a[196:199], v[124:127]
 ds_read_b64_tr_b16 a[4:5], v143 offset:45056
 v_accvgpr_write_b32 a228, v100
 v_mfma_f32_16x16x32_bf16 v[124:127], a[20:23], a[204:207], v[124:127]
 ds_read_b64_tr_b16 a[6:7], v143 offset:45568
 v_accvgpr_write_b32 a229, v101
 v_mfma_f32_16x16x32_bf16 v[104:107], a[20:23], a[200:203], v[104:107]
 ds_read_b64_tr_b16 a[8:9], v146
 s_cmp_lg_u32 s16, 0
 s_cbranch_scc1 L_look_27
 buffer_load_dword v31, v30, s[4:7], s65 offen sc1
L_look_27:
 v_mfma_f32_16x16x32_bf16 v[104:107], a[16:19], a[192:195], v[104:107]
 ds_read_b64_tr_b16 a[10:11], v146 offset:512
 s_waitcnt lgkmcnt(10)
 v_mfma_f32_16x16x32_bf16 v[108:111], a[24:27], a[192:195], v[108:111]
 ds_read_b64_tr_b16 a[12:13], v146 offset:4096
 v_accvgpr_write_b32 a230, v102
 v_mfma_f32_16x16x32_bf16 v[108:111], a[28:31], a[200:203], v[108:111]
 ds_read_b64_tr_b16 a[14:15], v146 offset:4608
 v_accvgpr_write_b32 a231, v103
 v_mfma_f32_16x16x32_bf16 v[128:131], a[28:31], a[204:207], v[128:131]
 ds_read_b64_tr_b16 a[16:17], v147
 v_accvgpr_write_b32 a244, v120
 v_mfma_f32_16x16x32_bf16 v[128:131], a[24:27], a[196:199], v[128:131]
 ds_read_b64_tr_b16 a[18:19], v147 offset:512
 s_waitcnt lgkmcnt(10)
 v_mfma_f32_16x16x32_bf16 v[124:127], a[32:35], a[212:215], v[124:127]
 ds_read_b64_tr_b16 a[20:21], v147 offset:4096
 v_accvgpr_write_b32 a245, v121
 v_mfma_f32_16x16x32_bf16 v[124:127], a[36:39], v[220:223], v[124:127]
 ds_read_b64_tr_b16 a[22:23], v147 offset:4608
 v_accvgpr_write_b32 a246, v122
 v_mfma_f32_16x16x32_bf16 v[104:107], a[36:39], v[216:219], v[104:107]
 ds_read_b64_tr_b16 a[24:25], v146 offset:8192
 v_accvgpr_write_b32 a247, v123
 v_mfma_f32_16x16x32_bf16 v[104:107], a[32:35], a[208:211], v[104:107]
 ds_read_b64_tr_b16 a[26:27], v146 offset:8704
 s_waitcnt lgkmcnt(10)
 v_mfma_f32_16x16x32_bf16 v[108:111], a[0:3], a[208:211], v[108:111]
 ds_read_b64_tr_b16 a[28:29], v146 offset:12288
 v_mfma_f32_16x16x32_bf16 v[108:111], a[4:7], v[216:219], v[108:111]
 ds_read_b64_tr_b16 a[30:31], v146 offset:12800
 v_mfma_f32_16x16x32_bf16 v[128:131], a[4:7], v[220:223], v[128:131]
 ds_read_b64_tr_b16 a[32:33], v147 offset:8192
 v_mfma_f32_16x16x32_bf16 v[128:131], a[0:3], a[212:215], v[128:131]
 ds_read_b64_tr_b16 a[34:35], v147 offset:8704
 s_waitcnt lgkmcnt(10)
 v_mfma_f32_16x16x32_bf16 v[124:127], a[8:11], v[228:231], v[124:127]
 ds_read_b64_tr_b16 a[36:37], v147 offset:12288
 v_mfma_f32_16x16x32_bf16 v[124:127], a[12:15], v[236:239], v[124:127]
 ds_read_b64_tr_b16 a[38:39], v147 offset:12800
 v_mfma_f32_16x16x32_bf16 v[104:107], a[12:15], v[232:235], v[104:107]
 v_mfma_f32_16x16x32_bf16 v[104:107], a[8:11], v[224:227], v[104:107]
 s_waitcnt lgkmcnt(8)
 v_mfma_f32_16x16x32_bf16 v[108:111], a[16:19], v[224:227], v[108:111]
 v_mfma_f32_16x16x32_bf16 v[108:111], a[20:23], v[232:235], v[108:111]
 v_mfma_f32_16x16x32_bf16 v[128:131], a[20:23], v[236:239], v[128:131]
 v_mfma_f32_16x16x32_bf16 v[128:131], a[16:19], v[228:231], v[128:131]
 s_waitcnt lgkmcnt(4)
 v_mfma_f32_16x16x32_bf16 v[124:127], a[24:27], v[244:247], v[124:127]
 v_mfma_f32_16x16x32_bf16 v[124:127], a[28:31], v[252:255], v[124:127]
 v_mfma_f32_16x16x32_bf16 v[104:107], a[28:31], v[248:251], v[104:107]
 v_mfma_f32_16x16x32_bf16 v[104:107], a[24:27], v[240:243], v[104:107]
 s_waitcnt lgkmcnt(0)
 v_mfma_f32_16x16x32_bf16 v[108:111], a[32:35], v[240:243], v[108:111]
 v_mfma_f32_16x16x32_bf16 v[108:111], a[36:39], v[248:251], v[108:111]
 v_mfma_f32_16x16x32_bf16 v[128:131], a[36:39], v[252:255], v[128:131]
 v_mfma_f32_16x16x32_bf16 v[128:131], a[32:35], v[244:247], v[128:131]
 s_nop 2
 v_pk_add_f32 v[64:65], v[104:105], v[24:25] op_sel_hi:[1,0] neg_lo:[0,1] neg_hi:[0,1]
 v_pk_add_f32 v[66:67], v[106:107], v[24:25] op_sel_hi:[1,0] neg_lo:[0,1] neg_hi:[0,1]
 v_pk_add_f32 v[68:69], v[124:125], v[26:27] op_sel_hi:[1,0] neg_lo:[0,1] neg_hi:[0,1]
 v_pk_add_f32 v[70:71], v[126:127], v[26:27] op_sel_hi:[1,0] neg_lo:[0,1] neg_hi:[0,1]
 v_cvt_pk_bf16_f32 v40, v64, v65
 v_cvt_pk_bf16_f32 v41, v66, v67
 v_cvt_pk_bf16_f32 v42, v68, v69
 v_cvt_pk_bf16_f32 v43, v70, v71
 v_pk_fma_f32 v[80:81], v[64:65], v[64:65], v[80:81]
 v_pk_fma_f32 v[82:83], v[68:69], v[68:69], v[82:83]
 v_pk_fma_f32 v[80:81], v[66:67], v[66:67], v[80:81]
 v_pk_fma_f32 v[82:83], v[70:71], v[70:71], v[82:83]
 v_permlane16_swap_b32 v40, v42
 v_permlane16_swap_b32 v41, v43
 v_pk_add_f32 v[72:73], v[108:109], v[24:25] op_sel_hi:[1,0] neg_lo:[0,1] neg_hi:[0,1]
 v_pk_add_f32 v[74:75], v[110:111], v[24:25] op_sel_hi:[1,0] neg_lo:[0,1] neg_hi:[0,1]
 v_pk_add_f32 v[76:77], v[128:129], v[26:27] op_sel_hi:[1,0] neg_lo:[0,1] neg_hi:[0,1]
 v_pk_add_f32 v[78:79], v[130:131], v[26:27] op_sel_hi:[1,0] neg_lo:[0,1] neg_hi:[0,1]
 v_cvt_pk_bf16_f32 v44, v72, v73
 v_cvt_pk_bf16_f32 v45, v74, v75
 v_cvt_pk_bf16_f32 v46, v76, v77
 v_cvt_pk_bf16_f32 v47, v78, v79
 v_pk_fma_f32 v[80:81], v[72:73], v[72:73], v[80:81]
 v_pk_fma_f32 v[82:83], v[76:77], v[76:77], v[82:83]
 v_pk_fma_f32 v[80:81], v[74:75], v[74:75], v[80:81]
 v_pk_fma_f32 v[82:83], v[78:79], v[78:79], v[82:83]
 v_permlane16_swap_b32 v44, v46
 v_permlane16_swap_b32 v45, v47
 v_add_f32 v80, v80, v81
 v_add_f32 v82, v82, v83
 v_accvgpr_write_b32 a232, v104
 v_accvgpr_write_b32 a233, v105
 v_accvgpr_write_b32 a234, v106
 v_accvgpr_write_b32 a235, v107
 v_accvgpr_write_b32 a248, v124
 v_accvgpr_write_b32 a249, v125
 v_accvgpr_write_b32 a250, v126
 v_accvgpr_write_b32 a251, v127
 v_permlane32_swap_b32 v80, v82
 v_add_f32 v80, v80, v82
 v_mov_b32 v81, v80
 v_accvgpr_write_b32 a236, v108
 v_accvgpr_write_b32 a237, v109
 v_accvgpr_write_b32 a238, v110
 v_accvgpr_write_b32 a239, v111
 v_accvgpr_write_b32 a252, v128
 v_accvgpr_write_b32 a253, v129
 v_accvgpr_write_b32 a254, v130
 v_accvgpr_write_b32 a255, v131
 v_permlane16_swap_b32 v80, v81
 v_add_f32 v80, v80, v81
 s_waitcnt vmcnt(0)
 v_cmp_gt_u32 vcc, 32, v31
 s_cmp_lg_u32 s16, 0
 s_cbranch_scc1 L_other_29
 s_bitcmp0_b32 vcc_lo, 0
 s_cbranch_scc1 L_join_30
 s_mov_b32 s67, 400000
 s_mov_b64 exec, 1
L_spin_28:
 buffer_load_dword v31, v30, s[4:7], s65 offen sc1
 s_waitcnt vmcnt(0)
 v_cmp_gt_u32 vcc, 32, v31
 s_sub_u32 s67, s67, 1
 s_cmp_lg_u32 s67, 0
 s_cbranch_vccz L_join_30
 s_sleep 2
 s_cbranch_scc1 L_spin_28
 s_branch L_join_30
L_other_29:
L_join_30:
 s_mov_b64 exec, -1
 s_barrier
 s_mov_b32 s23, 20971520
 buffer_load_dwordx4 a[0:3], v2, s[4:7], s23 offen sc1
 buffer_load_dwordx4 a[4:7], v3, s[4:7], s23 offen sc1
 buffer_load_dwordx4 a[8:11], v12, s[4:7], s23 offen sc1
 buffer_load_dwordx4 a[12:15], v13, s[4:7], s23 offen sc1
 ds_read_b64_tr_b16 a[128:129], v4
 ds_read_b64_tr_b16 a[130:131], v4 offset:1024
 ds_read_b64_tr_b16 a[132:133], v4 offset:16384
 ds_read_b64_tr_b16 a[134:135], v4 offset:17408
 ds_read_b64_tr_b16 a[136:137], v5
 ds_read_b64_tr_b16 a[138:139], v5 offset:1024
 ds_read_b64_tr_b16 a[140:141], v5 offset:16384
 ds_read_b64_tr_b16 a[142:143], v5 offset:17408
 buffer_store_dwordx4 v[40:43], v21, s[4:7], s20 offen offset:1024 sc1
 buffer_store_dwordx4 v[44:47], v21, s[4:7], s20 offen offset:1536 sc1
 s_mov_b32 exec_lo, 0xffff
 s_mov_b32 exec_hi, 0xffff
 buffer_store_dword v80, v22, s[4:7], s24 offen sc1
 s_mov_b64 exec, -1
 s_waitcnt vmcnt(6) lgkmcnt(6)
 v_mfma_f32_16x16x32_bf16 v[32:35], a[128:131], a[0:3], 0
 ds_read_b64_tr_b16 a[144:145], v6
 s_waitcnt vmcnt(5)
 v_mfma_f32_16x16x32_bf16 v[88:91], a[128:131], a[4:7], 0
 ds_read_b64_tr_b16 a[146:147], v6 offset:1024
 s_waitcnt vmcnt(4)
 v_mfma_f32_16x16x32_bf16 v[144:147], a[128:131], a[8:11], 0
 buffer_load_dwordx4 a[16:19], v2, s[4:7], s23 offen offset:2048 sc1
 s_waitcnt vmcnt(4)
 v_mfma_f32_16x16x32_bf16 v[200:203], a[128:131], a[12:15], 0
 s_waitcnt lgkmcnt(6)
 v_mfma_f32_16x16x32_bf16 v[204:207], a[132:135], a[12:15], 0
 ds_read_b64_tr_b16 a[148:149], v6 offset:16384
 v_mfma_f32_16x16x32_bf16 v[148:151], a[132:135], a[8:11], 0
 ds_read_b64_tr_b16 a[150:151], v6 offset:17408
 s_waitcnt lgkmcnt(4)
 v_mfma_f32_16x16x32_bf16 v[92:95], a[132:135], a[4:7], 0
 buffer_load_dwordx4 a[20:23], v3, s[4:7], s23 offen offset:2048 sc1
 v_mfma_f32_16x16x32_bf16 v[36:39], a[132:135], a[0:3], 0
 v_mfma_f32_16x16x32_bf16 v[40:43], a[136:139], a[0:3], 0
 ds_read_b64_tr_b16 a[152:153], v7
 s_sub_u32 s25, s25, 49152
 v_mfma_f32_16x16x32_bf16 v[96:99], a[136:139], a[4:7], 0
 ds_read_b64_tr_b16 a[154:155], v7 offset:1024
 v_mfma_f32_16x16x32_bf16 v[152:155], a[136:139], a[8:11], 0
 buffer_load_dwordx4 a[24:27], v12, s[4:7], s23 offen offset:2048 sc1
 v_mfma_f32_16x16x32_bf16 v[208:211], a[136:139], a[12:15], 0
 v_mfma_f32_16x16x32_bf16 v[212:215], a[140:143], a[12:15], 0
 ds_read_b64_tr_b16 a[128:129], v7 offset:16384
 s_sub_u32 s65, s65, 49152
 v_mfma_f32_16x16x32_bf16 v[156:159], a[140:143], a[8:11], 0
 ds_read_b64_tr_b16 a[130:131], v7 offset:17408
 s_waitcnt lgkmcnt(4)
 v_mfma_f32_16x16x32_bf16 v[100:103], a[140:143], a[4:7], 0
 v_mfma_f32_16x16x32_bf16 v[44:47], a[140:143], a[0:3], 0
 v_and_b32 v16, 15, v0
 v_mfma_f32_16x16x32_bf16 v[48:51], a[144:147], a[0:3], 0
 ds_read_b64_tr_b16 a[132:133], v4 offset:512
 v_mfma_f32_16x16x32_bf16 v[104:107], a[144:147], a[4:7], 0
 ds_read_b64_tr_b16 a[134:135], v4 offset:1536
 v_mfma_f32_16x16x32_bf16 v[160:163], a[144:147], a[8:11], 0
 buffer_load_dwordx4 a[28:31], v13, s[4:7], s23 offen offset:2048 sc1
 v_mfma_f32_16x16x32_bf16 v[216:219], a[144:147], a[12:15], 0
 s_mov_b32 s23, 20975616
 v_mfma_f32_16x16x32_bf16 v[220:223], a[148:151], a[12:15], 0
 ds_read_b64_tr_b16 a[136:137], v4 offset:16896
 v_lshlrev_b32 v16, 11, v16
 v_mfma_f32_16x16x32_bf16 v[164:167], a[148:151], a[8:11], 0
 ds_read_b64_tr_b16 a[138:139], v4 offset:17920
 s_waitcnt lgkmcnt(4)
 v_mfma_f32_16x16x32_bf16 v[108:111], a[148:151], a[4:7], 0
 buffer_load_dwordx4 a[32:35], v2, s[4:7], s23 offen sc1
 v_mfma_f32_16x16x32_bf16 v[52:55], a[148:151], a[0:3], 0
 v_mfma_f32_16x16x32_bf16 v[56:59], a[152:155], a[0:3], 0
 ds_read_b64_tr_b16 a[140:141], v5 offset:512
 s_add_u32 s33, s0, 40173568
 v_mfma_f32_16x16x32_bf16 v[112:115], a[152:155], a[4:7], 0
 ds_read_b64_tr_b16 a[142:143], v5 offset:1536
 v_mfma_f32_16x16x32_bf16 v[168:171], a[152:155], a[8:11], 0
 v_mfma_f32_16x16x32_bf16 v[224:227], a[152:155], a[12:15], 0
 v_bfe_u32 v15, v0, 4, 1
 v_mfma_f32_16x16x32_bf16 v[228:231], a[128:131], a[12:15], 0
 ds_read_b64_tr_b16 a[144:145], v5 offset:16896
 v_mfma_f32_16x16x32_bf16 v[172:175], a[128:131], a[8:11], 0
 ds_read_b64_tr_b16 a[146:147], v5 offset:17920
 s_waitcnt lgkmcnt(4)
 v_mfma_f32_16x16x32_bf16 v[116:119], a[128:131], a[4:7], 0
 buffer_load_dwordx4 a[36:39], v3, s[4:7], s23 offen sc1
 v_mfma_f32_16x16x32_bf16 v[60:63], a[128:131], a[0:3], 0
 v_mul_u32_u24 v15, 114688, v15
 v_mfma_f32_16x16x32_bf16 v[64:67], a[132:135], a[0:3], 0
 ds_read_b64_tr_b16 a[148:149], v6 offset:512
 v_mfma_f32_16x16x32_bf16 v[120:123], a[132:135], a[4:7], 0
 ds_read_b64_tr_b16 a[150:151], v6 offset:1536
 v_mfma_f32_16x16x32_bf16 v[176:179], a[132:135], a[8:11], 0
 buffer_load_dwordx4 a[40:43], v12, s[4:7], s23 offen sc1
 v_mfma_f32_16x16x32_bf16 v[232:235], a[132:135], a[12:15], 0
 v_lshrrev_b32 v14, 5, v0
 v_mfma_f32_16x16x32_bf16 v[236:239], a[136:139], a[12:15], 0
 ds_read_b64_tr_b16 a[152:153], v6 offset:16896
 v_mfma_f32_16x16x32_bf16 v[180:183], a[136:139], a[8:11], 0
 ds_read_b64_tr_b16 a[154:155], v6 offset:17920
 s_waitcnt lgkmcnt(4)
 v_mfma_f32_16x16x32_bf16 v[124:127], a[136:139], a[4:7], 0
 buffer_load_dwordx4 a[44:47], v13, s[4:7], s23 offen sc1
 v_mfma_f32_16x16x32_bf16 v[68:71], a[136:139], a[0:3], 0
 v_lshl_add_u32 v15, v14, 8, v15
 v_mfma_f32_16x16x32_bf16 v[72:75], a[140:143], a[0:3], 0
 ds_read_b64_tr_b16 a[128:129], v4 offset:8192
 v_mfma_f32_16x16x32_bf16 v[128:131], a[140:143], a[4:7], 0
 ds_read_b64_tr_b16 a[130:131], v4 offset:9216
 v_mfma_f32_16x16x32_bf16 v[184:187], a[140:143], a[8:11], 0
 v_and_b32 v14, 15, v0
 v_mfma_f32_16x16x32_bf16 v[240:243], a[140:143], a[12:15], 0
 v_mfma_f32_16x16x32_bf16 v[244:247], a[144:147], a[12:15], 0
 ds_read_b64_tr_b16 a[132:133], v4 offset:24576
 v_lshl_add_u32 v15, v14, 4, v15
 v_mfma_f32_16x16x32_bf16 v[188:191], a[144:147], a[8:11], 0
 ds_read_b64_tr_b16 a[134:135], v4 offset:25600
 s_waitcnt lgkmcnt(4)
 v_mfma_f32_16x16x32_bf16 v[132:135], a[144:147], a[4:7], 0
 buffer_load_dwordx4 a[48:51], v2, s[4:7], s23 offen offset:2048 sc1
 v_mfma_f32_16x16x32_bf16 v[76:79], a[144:147], a[0:3], 0
 v_mfma_f32_16x16x32_bf16 v[80:83], a[148:151], a[0:3], 0
 ds_read_b64_tr_b16 a[136:137], v5 offset:8192
 v_lshlrev_b32 v14, 2, v0
 v_mfma_f32_16x16x32_bf16 v[136:139], a[148:151], a[4:7], 0
 ds_read_b64_tr_b16 a[138:139], v5 offset:9216
 v_mfma_f32_16x16x32_bf16 v[192:195], a[148:151], a[8:11], 0
 buffer_load_dwordx4 a[52:55], v3, s[4:7], s23 offen offset:2048 sc1
 v_mfma_f32_16x16x32_bf16 v[248:251], a[148:151], a[12:15], 0
 v_mfma_f32_16x16x32_bf16 v[252:255], a[152:155], a[12:15], 0
 ds_read_b64_tr_b16 a[140:141], v5 offset:24576
 s_and_b32 s3, s61, 1
 v_mfma_f32_16x16x32_bf16 v[196:199], a[152:155], a[8:11], 0
 ds_read_b64_tr_b16 a[142:143], v5 offset:25600
 s_waitcnt vmcnt(6) lgkmcnt(4)
 v_mfma_f32_16x16x32_bf16 v[140:143], a[152:155], a[4:7], 0
 v_mfma_f32_16x16x32_bf16 v[84:87], a[152:155], a[0:3], 0
 s_lshr_b32 s28, s16, 1
 v_mfma_f32_16x16x32_bf16 v[32:35], a[128:131], a[16:19], v[32:35]
L_hop_11:
 s_cbranch_execz L_ret_2
 ds_read_b64_tr_b16 a[144:145], v6 offset:8192
 v_mfma_f32_16x16x32_bf16 v[88:91], a[128:131], a[20:23], v[88:91]
 ds_read_b64_tr_b16 a[146:147], v6 offset:9216
 v_mfma_f32_16x16x32_bf16 v[144:147], a[128:131], a[24:27], v[144:147]
 buffer_load_dwordx4 a[56:59], v12, s[4:7], s23 offen offset:2048 sc1
 v_mfma_f32_16x16x32_bf16 v[200:203], a[128:131], a[28:31], v[200:203]
 s_lshl1_add_u32 s3, s3, s28
 v_mfma_f32_16x16x32_bf16 v[204:207], a[132:135], a[28:31], v[204:207]
 ds_read_b64_tr_b16 a[148:149], v6 offset:24576
 v_mfma_f32_16x16x32_bf16 v[148:151], a[132:135], a[24:27], v[148:151]
 ds_read_b64_tr_b16 a[150:151], v6 offset:25600
 s_waitcnt lgkmcnt(4)
 v_mfma_f32_16x16x32_bf16 v[92:95], a[132:135], a[20:23], v[92:95]
 buffer_load_dwordx4 a[60:63], v13, s[4:7], s23 offen offset:2048 sc1
 v_mfma_f32_16x16x32_bf16 v[36:39], a[132:135], a[16:19], v[36:39]
 s_mov_b32 s21, 1835008
 v_mfma_f32_16x16x32_bf16 v[40:43], a[136:139], a[16:19], v[40:43]
 ds_read_b64_tr_b16 a[152:153], v7 offset:8192
 s_add_u32 m0, s19, 65536
 v_mfma_f32_16x16x32_bf16 v[96:99], a[136:139], a[20:23], v[96:99]
 ds_read_b64_tr_b16 a[154:155], v7 offset:9216
 v_mfma_f32_16x16x32_bf16 v[152:155], a[136:139], a[24:27], v[152:155]
 buffer_load_dwordx4 v8, s[12:15], s21 offen lds
 v_mfma_f32_16x16x32_bf16 v[208:211], a[136:139], a[28:31], v[208:211]
 s_mul_i32 s22, s3, 1835008
 v_mfma_f32_16x16x32_bf16 v[212:215], a[140:143], a[28:31], v[212:215]
 ds_read_b64_tr_b16 a[128:129], v7 offset:24576
 v_mfma_f32_16x16x32_bf16 v[156:159], a[140:143], a[24:27], v[156:159]
 ds_read_b64_tr_b16 a[130:131], v7 offset:25600
 s_waitcnt lgkmcnt(4)
 v_mfma_f32_16x16x32_bf16 v[100:103], a[140:143], a[20:23], v[100:103]
 s_and_b32 s28, s16, 1
 v_mfma_f32_16x16x32_bf16 v[44:47], a[140:143], a[16:19], v[44:47]
 v_mfma_f32_16x16x32_bf16 v[48:51], a[144:147], a[16:19], v[48:51]
 ds_read_b64_tr_b16 a[132:133], v4 offset:8704
 s_xor_b32 s28, s28, s61
 v_mfma_f32_16x16x32_bf16 v[104:107], a[144:147], a[20:23], v[104:107]
 ds_read_b64_tr_b16 a[134:135], v4 offset:9728
 v_mfma_f32_16x16x32_bf16 v[160:163], a[144:147], a[24:27], v[160:163]
 buffer_load_dwordx4 v9, s[12:15], s21 offen offset:1024 lds
 v_mfma_f32_16x16x32_bf16 v[216:219], a[144:147], a[28:31], v[216:219]
 v_mfma_f32_16x16x32_bf16 v[220:223], a[148:151], a[28:31], v[220:223]
 ds_read_b64_tr_b16 a[136:137], v4 offset:25088
 s_lshl_b32 s28, s28, 12
 v_mfma_f32_16x16x32_bf16 v[164:167], a[148:151], a[24:27], v[164:167]
 ds_read_b64_tr_b16 a[138:139], v4 offset:26112
 s_waitcnt lgkmcnt(4)
 v_mfma_f32_16x16x32_bf16 v[108:111], a[148:151], a[20:23], v[108:111]
 buffer_load_dwordx4 v10, s[12:15], s21 offen offset:2048 lds
 v_mfma_f32_16x16x32_bf16 v[52:55], a[148:151], a[16:19], v[52:55]
 v_mfma_f32_16x16x32_bf16 v[56:59], a[152:155], a[16:19], v[56:59]
 ds_read_b64_tr_b16 a[140:141], v5 offset:8704
 s_add_u32 s22, s22, s28
 v_mfma_f32_16x16x32_bf16 v[112:115], a[152:155], a[20:23], v[112:115]
 ds_read_b64_tr_b16 a[142:143], v5 offset:9728
 v_mfma_f32_16x16x32_bf16 v[168:171], a[152:155], a[24:27], v[168:171]
 v_mfma_f32_16x16x32_bf16 v[224:227], a[152:155], a[28:31], v[224:227]
 s_add_u32 s22, s22, 50331648
 v_mfma_f32_16x16x32_bf16 v[228:231], a[128:131], a[28:31], v[228:231]
 ds_read_b64_tr_b16 a[144:145], v5 offset:25088
 v_mfma_f32_16x16x32_bf16 v[172:175], a[128:131], a[24:27], v[172:175]
 ds_read_b64_tr_b16 a[146:147], v5 offset:26112
 s_waitcnt lgkmcnt(4)
 v_mfma_f32_16x16x32_bf16 v[116:119], a[128:131], a[20:23], v[116:119]
 buffer_load_dwordx4 v11, s[12:15], s21 offen offset:3072 lds
 v_mfma_f32_16x16x32_bf16 v[60:63], a[128:131], a[16:19], v[60:63]
 s_add_u32 m0, s19, 81920
 v_mfma_f32_16x16x32_bf16 v[64:67], a[132:135], a[16:19], v[64:67]
 ds_read_b64_tr_b16 a[148:149], v6 offset:8704
 v_mfma_f32_16x16x32_bf16 v[120:123], a[132:135], a[20:23], v[120:123]
 ds_read_b64_tr_b16 a[150:151], v6 offset:9728
 v_mfma_f32_16x16x32_bf16 v[176:179], a[132:135], a[24:27], v[176:179]
 buffer_load_dwordx4 v8, s[8:11], s21 offen lds
 v_mfma_f32_16x16x32_bf16 v[232:235], a[132:135], a[28:31], v[232:235]
 v_mfma_f32_16x16x32_bf16 v[236:239], a[136:139], a[28:31], v[236:239]
 ds_read_b64_tr_b16 a[152:153], v6 offset:25088
 v_mfma_f32_16x16x32_bf16 v[180:183], a[136:139], a[24:27], v[180:183]
 ds_read_b64_tr_b16 a[154:155], v6 offset:26112
 s_waitcnt lgkmcnt(4)
 v_mfma_f32_16x16x32_bf16 v[124:127], a[136:139], a[20:23], v[124:127]
 buffer_load_dwordx4 v9, s[8:11], s21 offen offset:1024 lds
 v_mfma_f32_16x16x32_bf16 v[68:71], a[136:139], a[16:19], v[68:71]
 v_mfma_f32_16x16x32_bf16 v[72:75], a[140:143], a[16:19], v[72:75]
 s_barrier
 s_cmp_lg_u32 s16, 0
 s_cbranch_scc1 L_arrived_31
 s_sub_u32 s67, s25, s0
 s_mov_b64 exec, 0xff
 buffer_atomic_add v29, v28, s[4:7], s67 offen sc1
 s_mov_b64 exec, -1
L_arrived_31:
 ds_read_b64_tr_b16 a[128:129], v4 offset:32768
 v_mfma_f32_16x16x32_bf16 v[128:131], a[140:143], a[20:23], v[128:131]
 ds_read_b64_tr_b16 a[130:131], v4 offset:33792
 v_mfma_f32_16x16x32_bf16 v[184:187], a[140:143], a[24:27], v[184:187]
 v_mfma_f32_16x16x32_bf16 v[240:243], a[140:143], a[28:31], v[240:243]
 v_mfma_f32_16x16x32_bf16 v[244:247], a[144:147], a[28:31], v[244:247]
 ds_read_b64_tr_b16 a[132:133], v4 offset:40960
 v_mfma_f32_16x16x32_bf16 v[188:191], a[144:147], a[24:27], v[188:191]
 ds_read_b64_tr_b16 a[134:135], v4 offset:41984
 s_waitcnt lgkmcnt(4)
 v_mfma_f32_16x16x32_bf16 v[132:135], a[144:147], a[20:23], v[132:135]
 buffer_load_dwordx4 v10, s[8:11], s21 offen offset:2048 lds
 v_mfma_f32_16x16x32_bf16 v[76:79], a[144:147], a[16:19], v[76:79]
 v_mfma_f32_16x16x32_bf16 v[80:83], a[148:151], a[16:19], v[80:83]
 ds_read_b64_tr_b16 a[136:137], v4 offset:49152
 v_mfma_f32_16x16x32_bf16 v[136:139], a[148:151], a[20:23], v[136:139]
 ds_read_b64_tr_b16 a[138:139], v4 offset:50176
 v_mfma_f32_16x16x32_bf16 v[192:195], a[148:151], a[24:27], v[192:195]
 buffer_load_dwordx4 v11, s[8:11], s21 offen offset:3072 lds
 v_mfma_f32_16x16x32_bf16 v[248:251], a[148:151], a[28:31], v[248:251]
 s_mov_b32 s23, 20979712
 v_mfma_f32_16x16x32_bf16 v[252:255], a[152:155], a[28:31], v[252:255]
 ds_read_b64_tr_b16 a[140:141], v4 offset:57344
 s_mov_b32 s21, 2752512
 v_mfma_f32_16x16x32_bf16 v[196:199], a[152:155], a[24:27], v[196:199]
 ds_read_b64_tr_b16 a[142:143], v4 offset:58368
 s_waitcnt vmcnt(8) lgkmcnt(4)
 v_mfma_f32_16x16x32_bf16 v[140:143], a[152:155], a[20:23], v[140:143]
 s_add_u32 m0, s19, 98304
 v_mfma_f32_16x16x32_bf16 v[84:87], a[152:155], a[16:19], v[84:87]
 v_mfma_f32_16x16x32_bf16 v[200:203], a[128:131], a[44:47], v[200:203]
 ds_read_b64_tr_b16 a[144:145], v5 offset:32768
 v_mfma_f32_16x16x32_bf16 v[200:203], a[132:135], a[60:63], v[200:203]
 ds_read_b64_tr_b16 a[146:147], v5 offset:33792
 v_mfma_f32_16x16x32_bf16 v[144:147], a[132:135], a[56:59], v[144:147]
 buffer_load_dwordx4 a[64:67], v2, s[4:7], s23 offen sc1
 v_mfma_f32_16x16x32_bf16 v[144:147], a[128:131], a[40:43], v[144:147]
 v_mfma_f32_16x16x32_bf16 v[88:91], a[128:131], a[36:39], v[88:91]
 ds_read_b64_tr_b16 a[148:149], v5 offset:40960
 v_mfma_f32_16x16x32_bf16 v[88:91], a[132:135], a[52:55], v[88:91]
 ds_read_b64_tr_b16 a[150:151], v5 offset:41984
 s_waitcnt lgkmcnt(4)
 v_mfma_f32_16x16x32_bf16 v[32:35], a[132:135], a[48:51], v[32:35]
 buffer_load_dwordx4 a[68:71], v3, s[4:7], s23 offen sc1
 v_mfma_f32_16x16x32_bf16 v[32:35], a[128:131], a[32:35], v[32:35]
 v_mfma_f32_16x16x32_bf16 v[36:39], a[136:139], a[32:35], v[36:39]
 ds_read_b64_tr_b16 a[152:153], v5 offset:49152
 v_mfma_f32_16x16x32_bf16 v[36:39], a[140:143], a[48:51], v[36:39]
 ds_read_b64_tr_b16 a[154:155], v5 offset:50176
 v_mfma_f32_16x16x32_bf16 v[92:95], a[140:143], a[52:55], v[92:95]
 buffer_load_dwordx4 a[72:75], v12, s[4:7], s23 offen sc1
 v_mfma_f32_16x16x32_bf16 v[92:95], a[136:139], a[36:39], v[92:95]
 v_mfma_f32_16x16x32_bf16 v[148:151], a[136:139], a[40:43], v[148:151]
 ds_read_b64_tr_b16 a[128:129], v5 offset:57344
 v_mfma_f32_16x16x32_bf16 v[148:151], a[140:143], a[56:59], v[148:151]
 ds_read_b64_tr_b16 a[130:131], v5 offset:58368
 s_waitcnt lgkmcnt(4)
 v_mfma_f32_16x16x32_bf16 v[204:207], a[140:143], a[60:63], v[204:207]
 v_mfma_f32_16x16x32_bf16 v[204:207], a[136:139], a[44:47], v[204:207]
 v_mfma_f32_16x16x32_bf16 v[208:211], a[144:147], a[44:47], v[208:211]
 ds_read_b64_tr_b16 a[132:133], v6 offset:32768
 v_mfma_f32_16x16x32_bf16 v[208:211], a[148:151], a[60:63], v[208:211]
 ds_read_b64_tr_b16 a[134:135], v6 offset:33792
 v_mfma_f32_16x16x32_bf16 v[152:155], a[148:151], a[56:59], v[152:155]
 buffer_load_dwordx4 a[76:79], v13, s[4:7], s23 offen sc1
 v_mfma_f32_16x16x32_bf16 v[152:155], a[144:147], a[40:43], v[152:155]
 v_mfma_f32_16x16x32_bf16 v[96:99], a[144:147], a[36:39], v[96:99]
 ds_read_b64_tr_b16 a[136:137], v6 offset:40960
 v_mfma_f32_16x16x32_bf16 v[96:99], a[148:151], a[52:55], v[96:99]
 ds_read_b64_tr_b16 a[138:139], v6 offset:41984
 s_waitcnt lgkmcnt(4)
 v_mfma_f32_16x16x32_bf16 v[40:43], a[148:151], a[48:51], v[40:43]
 buffer_load_dwordx4 a[80:83], v2, s[4:7], s23 offen offset:2048 sc1
 v_mfma_f32_16x16x32_bf16 v[40:43], a[144:147], a[32:35], v[40:43]
 v_mfma_f32_16x16x32_bf16 v[44:47], a[152:155], a[32:35], v[44:47]
 ds_read_b64_tr_b16 a[140:141], v6 offset:49152
 v_mfma_f32_16x16x32_bf16 v[44:47], a[128:131], a[48:51], v[44:47]
 ds_read_b64_tr_b16 a[142:143], v6 offset:50176
 v_mfma_f32_16x16x32_bf16 v[100:103], a[128:131], a[52:55], v[100:103]
 v_mfma_f32_16x16x32_bf16 v[100:103], a[152:155], a[36:39], v[100:103]
 v_mfma_f32_16x16x32_bf16 v[156:159], a[152:155], a[40:43], v[156:159]
 ds_read_b64_tr_b16 a[144:145], v6 offset:57344
 v_mfma_f32_16x16x32_bf16 v[156:159], a[128:131], a[56:59], v[156:159]
 ds_read_b64_tr_b16 a[146:147], v6 offset:58368
 s_waitcnt lgkmcnt(4)
 v_mfma_f32_16x16x32_bf16 v[212:215], a[128:131], a[60:63], v[212:215]
 buffer_load_dwordx4 a[84:87], v3, s[4:7], s23 offen offset:2048 sc1
 v_mfma_f32_16x16x32_bf16 v[212:215], a[152:155], a[44:47], v[212:215]
 v_mfma_f32_16x16x32_bf16 v[216:219], a[132:135], a[44:47], v[216:219]
 ds_read_b64_tr_b16 a[148:149], v7 offset:32768
 v_mfma_f32_16x16x32_bf16 v[216:219], a[136:139], a[60:63], v[216:219]
 ds_read_b64_tr_b16 a[150:151], v7 offset:33792
 v_mfma_f32_16x16x32_bf16 v[160:163], a[136:139], a[56:59], v[160:163]
 buffer_load_dwordx4 a[88:91], v12, s[4:7], s23 offen offset:2048 sc1
 v_mfma_f32_16x16x32_bf16 v[160:163], a[132:135], a[40:43], v[160:163]
 v_mfma_f32_16x16x32_bf16 v[104:107], a[132:135], a[36:39], v[104:107]
 ds_read_b64_tr_b16 a[152:153], v7 offset:40960
 v_mfma_f32_16x16x32_bf16 v[104:107], a[136:139], a[52:55], v[104:107]
 ds_read_b64_tr_b16 a[154:155], v7 offset:41984
 s_waitcnt lgkmcnt(4)
 v_mfma_f32_16x16x32_bf16 v[48:51], a[136:139], a[48:51], v[48:51]
 v_mfma_f32_16x16x32_bf16 v[48:51], a[132:135], a[32:35], v[48:51]
 v_mfma_f32_16x16x32_bf16 v[52:55], a[140:143], a[32:35], v[52:55]
 ds_read_b64_tr_b16 a[128:129], v7 offset:49152
 v_mfma_f32_16x16x32_bf16 v[52:55], a[144:147], a[48:51], v[52:55]
 ds_read_b64_tr_b16 a[130:131], v7 offset:50176
 v_mfma_f32_16x16x32_bf16 v[108:111], a[144:147], a[52:55], v[108:111]
 buffer_load_dwordx4 a[92:95], v13, s[4:7], s23 offen offset:2048 sc1
 v_mfma_f32_16x16x32_bf16 v[108:111], a[140:143], a[36:39], v[108:111]
 v_mfma_f32_16x16x32_bf16 v[164:167], a[140:143], a[40:43], v[164:167]
 ds_read_b64_tr_b16 a[132:133], v7 offset:57344
 v_mfma_f32_16x16x32_bf16 v[164:167], a[144:147], a[56:59], v[164:167]
 ds_read_b64_tr_b16 a[134:135], v7 offset:58368
 s_waitcnt lgkmcnt(4)
 v_mfma_f32_16x16x32_bf16 v[220:223], a[144:147], a[60:63], v[220:223]
 buffer_load_dwordx4 v8, s[12:15], s21 offen lds
 v_mfma_f32_16x16x32_bf16 v[220:223], a[140:143], a[44:47], v[220:223]
 v_add_u32 v7, 65536, v7
 v_mfma_f32_16x16x32_bf16 v[224:227], a[148:151], a[44:47], v[224:227]
 ds_read_b64_tr_b16 a[136:137], v4 offset:33280
 v_mfma_f32_16x16x32_bf16 v[224:227], a[152:155], a[60:63], v[224:227]
 ds_read_b64_tr_b16 a[138:139], v4 offset:34304
 v_mfma_f32_16x16x32_bf16 v[168:171], a[152:155], a[56:59], v[168:171]
 v_mfma_f32_16x16x32_bf16 v[168:171], a[148:151], a[40:43], v[168:171]
 v_mfma_f32_16x16x32_bf16 v[112:115], a[148:151], a[36:39], v[112:115]
 ds_read_b64_tr_b16 a[140:141], v4 offset:41472
 v_mfma_f32_16x16x32_bf16 v[112:115], a[152:155], a[52:55], v[112:115]
 ds_read_b64_tr_b16 a[142:143], v4 offset:42496
 s_waitcnt lgkmcnt(4)
 v_mfma_f32_16x16x32_bf16 v[56:59], a[152:155], a[48:51], v[56:59]
 buffer_load_dwordx4 v9, s[12:15], s21 offen offset:1024 lds
 v_mfma_f32_16x16x32_bf16 v[56:59], a[148:151], a[32:35], v[56:59]
 v_mfma_f32_16x16x32_bf16 v[60:63], a[128:131], a[32:35], v[60:63]
 ds_read_b64_tr_b16 a[144:145], v4 offset:49664
 v_mfma_f32_16x16x32_bf16 v[60:63], a[132:135], a[48:51], v[60:63]
 ds_read_b64_tr_b16 a[146:147], v4 offset:50688
 v_mfma_f32_16x16x32_bf16 v[116:119], a[132:135], a[52:55], v[116:119]
 buffer_load_dwordx4 v10, s[12:15], s21 offen offset:2048 lds
 v_mfma_f32_16x16x32_bf16 v[116:119], a[128:131], a[36:39], v[116:119]
 v_mfma_f32_16x16x32_bf16 v[172:175], a[128:131], a[40:43], v[172:175]
 ds_read_b64_tr_b16 a[148:149], v4 offset:57856
 v_mfma_f32_16x16x32_bf16 v[172:175], a[132:135], a[56:59], v[172:175]
 ds_read_b64_tr_b16 a[150:151], v4 offset:58880
 s_waitcnt lgkmcnt(4)
 v_mfma_f32_16x16x32_bf16 v[228:231], a[132:135], a[60:63], v[228:231]
 v_mfma_f32_16x16x32_bf16 v[228:231], a[128:131], a[44:47], v[228:231]
 v_add_u32 v4, 65536, v4
 v_mfma_f32_16x16x32_bf16 v[232:235], a[136:139], a[44:47], v[232:235]
 ds_read_b64_tr_b16 a[152:153], v5 offset:33280
 v_mfma_f32_16x16x32_bf16 v[232:235], a[140:143], a[60:63], v[232:235]
 ds_read_b64_tr_b16 a[154:155], v5 offset:34304
 v_mfma_f32_16x16x32_bf16 v[176:179], a[140:143], a[56:59], v[176:179]
 buffer_load_dwordx4 v11, s[12:15], s21 offen offset:3072 lds
 v_mfma_f32_16x16x32_bf16 v[176:179], a[136:139], a[40:43], v[176:179]
 s_add_u32 m0, s19, 114688
 v_mfma_f32_16x16x32_bf16 v[120:123], a[136:139], a[36:39], v[120:123]
 ds_read_b64_tr_b16 a[128:129], v5 offset:41472
 v_mfma_f32_16x16x32_bf16 v[120:123], a[140:143], a[52:55], v[120:123]
 ds_read_b64_tr_b16 a[130:131], v5 offset:42496
 s_waitcnt lgkmcnt(4)
 v_mfma_f32_16x16x32_bf16 v[64:67], a[140:143], a[48:51], v[64:67]
 buffer_load_dwordx4 v8, s[8:11], s21 offen lds
 v_mfma_f32_16x16x32_bf16 v[64:67], a[136:139], a[32:35], v[64:67]
 v_mfma_f32_16x16x32_bf16 v[68:71], a[144:147], a[32:35], v[68:71]
 ds_read_b64_tr_b16 a[132:133], v5 offset:49664
 v_mfma_f32_16x16x32_bf16 v[68:71], a[148:151], a[48:51], v[68:71]
 ds_read_b64_tr_b16 a[134:135], v5 offset:50688
 v_mfma_f32_16x16x32_bf16 v[124:127], a[148:151], a[52:55], v[124:127]
 v_mfma_f32_16x16x32_bf16 v[124:127], a[144:147], a[36:39], v[124:127]
 v_mfma_f32_16x16x32_bf16 v[180:183], a[144:147], a[40:43], v[180:183]
 ds_read_b64_tr_b16 a[136:137], v5 offset:57856
 v_mfma_f32_16x16x32_bf16 v[180:183], a[148:151], a[56:59], v[180:183]
 ds_read_b64_tr_b16 a[138:139], v5 offset:58880
 s_waitcnt lgkmcnt(4)
 v_mfma_f32_16x16x32_bf16 v[236:239], a[148:151], a[60:63], v[236:239]
 buffer_load_dwordx4 v9, s[8:11], s21 offen offset:1024 lds
 v_mfma_f32_16x16x32_bf16 v[236:239], a[144:147], a[44:47], v[236:239]
 v_add_u32 v5, 65536, v5
 v_mfma_f32_16x16x32_bf16 v[240:243], a[152:155], a[44:47], v[240:243]
 ds_read_b64_tr_b16 a[140:141], v6 offset:33280
 v_mfma_f32_16x16x32_bf16 v[240:243], a[128:131], a[60:63], v[240:243]
 ds_read_b64_tr_b16 a[142:143], v6 offset:34304
 v_mfma_f32_16x16x32_bf16 v[184:187], a[128:131], a[56:59], v[184:187]
 buffer_load_dwordx4 v10, s[8:11], s21 offen offset:2048 lds
 v_mfma_f32_16x16x32_bf16 v[184:187], a[152:155], a[40:43], v[184:187]
 v_mfma_f32_16x16x32_bf16 v[128:131], a[152:155], a[36:39], v[128:131]
 ds_read_b64_tr_b16 a[144:145], v6 offset:41472
 v_mfma_f32_16x16x32_bf16 v[128:131], a[128:131], a[52:55], v[128:131]
 ds_read_b64_tr_b16 a[146:147], v6 offset:42496
 s_waitcnt lgkmcnt(4)
 v_mfma_f32_16x16x32_bf16 v[72:75], a[128:131], a[48:51], v[72:75]
 v_mfma_f32_16x16x32_bf16 v[72:75], a[152:155], a[32:35], v[72:75]
 v_mfma_f32_16x16x32_bf16 v[76:79], a[132:135], a[32:35], v[76:79]
 ds_read_b64_tr_b16 a[148:149], v6 offset:49664
 v_mfma_f32_16x16x32_bf16 v[76:79], a[136:139], a[48:51], v[76:79]
 ds_read_b64_tr_b16 a[150:151], v6 offset:50688
 v_mfma_f32_16x16x32_bf16 v[132:135], a[136:139], a[52:55], v[132:135]
 buffer_load_dwordx4 v11, s[8:11], s21 offen offset:3072 lds
 v_mfma_f32_16x16x32_bf16 v[132:135], a[132:135], a[36:39], v[132:135]
 s_mov_b32 s23, 20983808
 v_mfma_f32_16x16x32_bf16 v[188:191], a[132:135], a[40:43], v[188:191]
 ds_read_b64_tr_b16 a[152:153], v6 offset:57856
 v_mfma_f32_16x16x32_bf16 v[188:191], a[136:139], a[56:59], v[188:191]
 ds_read_b64_tr_b16 a[154:155], v6 offset:58880
 s_waitcnt lgkmcnt(4)
 v_mfma_f32_16x16x32_bf16 v[244:247], a[136:139], a[60:63], v[244:247]
 buffer_load_dwordx4 a[0:3], v2, s[4:7], s23 offen sc1
 v_mfma_f32_16x16x32_bf16 v[244:247], a[132:135], a[44:47], v[244:247]
 v_add_u32 v6, 65536, v6
 v_mfma_f32_16x16x32_bf16 v[248:251], a[140:143], a[44:47], v[248:251]
 s_waitcnt vmcnt(17)
 s_barrier
 ds_read_b64_tr_b16 a[128:129], v4
 v_mfma_f32_16x16x32_bf16 v[248:251], a[144:147], a[60:63], v[248:251]
 ds_read_b64_tr_b16 a[130:131], v4 offset:1024
 v_mfma_f32_16x16x32_bf16 v[192:195], a[144:147], a[56:59], v[192:195]
 v_mfma_f32_16x16x32_bf16 v[192:195], a[140:143], a[40:43], v[192:195]
 v_mfma_f32_16x16x32_bf16 v[136:139], a[140:143], a[36:39], v[136:139]
 ds_read_b64_tr_b16 a[132:133], v4 offset:8192
 v_mfma_f32_16x16x32_bf16 v[136:139], a[144:147], a[52:55], v[136:139]
 ds_read_b64_tr_b16 a[134:135], v4 offset:9216
 s_waitcnt lgkmcnt(4)
 v_mfma_f32_16x16x32_bf16 v[80:83], a[144:147], a[48:51], v[80:83]
 buffer_load_dwordx4 a[4:7], v3, s[4:7], s23 offen sc1
 v_mfma_f32_16x16x32_bf16 v[80:83], a[140:143], a[32:35], v[80:83]
 v_mfma_f32_16x16x32_bf16 v[84:87], a[148:151], a[32:35], v[84:87]
 ds_read_b64_tr_b16 a[136:137], v4 offset:16384
 v_mfma_f32_16x16x32_bf16 v[84:87], a[152:155], a[48:51], v[84:87]
 ds_read_b64_tr_b16 a[138:139], v4 offset:17408
 v_mfma_f32_16x16x32_bf16 v[140:143], a[152:155], a[52:55], v[140:143]
 buffer_load_dwordx4 a[8:11], v12, s[4:7], s23 offen sc1
 v_mfma_f32_16x16x32_bf16 v[140:143], a[148:151], a[36:39], v[140:143]
 s_mov_b32 s21, 3670016
 v_mfma_f32_16x16x32_bf16 v[196:199], a[148:151], a[40:43], v[196:199]
 ds_read_b64_tr_b16 a[140:141], v4 offset:24576
 s_add_u32 m0, s19, 131072
 v_mfma_f32_16x16x32_bf16 v[196:199], a[152:155], a[56:59], v[196:199]
 ds_read_b64_tr_b16 a[142:143], v4 offset:25600
 s_waitcnt vmcnt(11) lgkmcnt(4)
 v_mfma_f32_16x16x32_bf16 v[252:255], a[152:155], a[60:63], v[252:255]
 s_cmp_lg_u32 s16, 0
 s_cbranch_scc1 L_look_32
 buffer_load_dword v17, v16, s[4:7], s33 offen sc1
L_look_32:
 v_mfma_f32_16x16x32_bf16 v[252:255], a[148:151], a[44:47], v[252:255]
 v_mfma_f32_16x16x32_bf16 v[200:203], a[128:131], a[76:79], v[200:203]
 ds_read_b64_tr_b16 a[144:145], v5
 s_cmp_lg_u32 s16, 0
 s_cbranch_scc1 L_look_33
 buffer_load_dword v31, v30, s[4:7], s65 offen sc1
L_look_33:
 v_mfma_f32_16x16x32_bf16 v[200:203], a[132:135], a[92:95], v[200:203]
 ds_read_b64_tr_b16 a[146:147], v5 offset:1024
 v_mfma_f32_16x16x32_bf16 v[144:147], a[132:135], a[88:91], v[144:147]
 buffer_load_dwordx4 a[12:15], v13, s[4:7], s23 offen sc1
 v_mfma_f32_16x16x32_bf16 v[144:147], a[128:131], a[72:75], v[144:147]
 v_mfma_f32_16x16x32_bf16 v[88:91], a[128:131], a[68:71], v[88:91]
 ds_read_b64_tr_b16 a[148:149], v5 offset:8192
 v_mfma_f32_16x16x32_bf16 v[88:91], a[132:135], a[84:87], v[88:91]
 ds_read_b64_tr_b16 a[150:151], v5 offset:9216
 s_waitcnt lgkmcnt(4)
 v_mfma_f32_16x16x32_bf16 v[32:35], a[132:135], a[80:83], v[32:35]
 buffer_load_dwordx4 a[16:19], v2, s[4:7], s23 offen offset:2048 sc1
 v_mfma_f32_16x16x32_bf16 v[32:35], a[128:131], a[64:67], v[32:35]
 v_mfma_f32_16x16x32_bf16 v[36:39], a[136:139], a[64:67], v[36:39]
 ds_read_b64_tr_b16 a[152:153], v5 offset:16384
 v_mfma_f32_16x16x32_bf16 v[36:39], a[140:143], a[80:83], v[36:39]
 ds_read_b64_tr_b16 a[154:155], v5 offset:17408
 v_mfma_f32_16x16x32_bf16 v[92:95], a[140:143], a[84:87], v[92:95]
 buffer_load_dwordx4 a[20:23], v3, s[4:7], s23 offen offset:2048 sc1
 v_mfma_f32_16x16x32_bf16 v[92:95], a[136:139], a[68:71], v[92:95]
 v_mfma_f32_16x16x32_bf16 v[148:151], a[136:139], a[72:75], v[148:151]
 ds_read_b64_tr_b16 a[128:129], v5 offset:24576
 v_mfma_f32_16x16x32_bf16 v[148:151], a[140:143], a[88:91], v[148:151]
 ds_read_b64_tr_b16 a[130:131], v5 offset:25600
 s_waitcnt lgkmcnt(4)
 v_mfma_f32_16x16x32_bf16 v[204:207], a[140:143], a[92:95], v[204:207]
 v_mfma_f32_16x16x32_bf16 v[204:207], a[136:139], a[76:79], v[204:207]
 v_mfma_f32_16x16x32_bf16 v[208:211], a[144:147], a[76:79], v[208:211]
 ds_read_b64_tr_b16 a[132:133], v6
 v_mfma_f32_16x16x32_bf16 v[208:211], a[148:151], a[92:95], v[208:211]
 ds_read_b64_tr_b16 a[134:135], v6 offset:1024
 v_mfma_f32_16x16x32_bf16 v[152:155], a[148:151], a[88:91], v[152:155]
 buffer_load_dwordx4 a[24:27], v12, s[4:7], s23 offen offset:2048 sc1
 v_mfma_f32_16x16x32_bf16 v[152:155], a[144:147], a[72:75], v[152:155]
 v_mfma_f32_16x16x32_bf16 v[96:99], a[144:147], a[68:71], v[96:99]
 ds_read_b64_tr_b16 a[136:137], v6 offset:8192
 v_mfma_f32_16x16x32_bf16 v[96:99], a[148:151], a[84:87], v[96:99]
 ds_read_b64_tr_b16 a[138:139], v6 offset:9216
 s_waitcnt lgkmcnt(4)
 v_mfma_f32_16x16x32_bf16 v[40:43], a[148:151], a[80:83], v[40:43]
 buffer_load_dwordx4 a[28:31], v13, s[4:7], s23 offen offset:2048 sc1
 v_mfma_f32_16x16x32_bf16 v[40:43], a[144:147], a[64:67], v[40:43]
 v_mfma_f32_16x16x32_bf16 v[44:47], a[152:155], a[64:67], v[44:47]
 ds_read_b64_tr_b16 a[140:141], v6 offset:16384
 v_mfma_f32_16x16x32_bf16 v[44:47], a[128:131], a[80:83], v[44:47]
 ds_read_b64_tr_b16 a[142:143], v6 offset:17408
 v_mfma_f32_16x16x32_bf16 v[100:103], a[128:131], a[84:87], v[100:103]
 v_mfma_f32_16x16x32_bf16 v[100:103], a[152:155], a[68:71], v[100:103]
 v_mfma_f32_16x16x32_bf16 v[156:159], a[152:155], a[72:75], v[156:159]
 ds_read_b64_tr_b16 a[144:145], v6 offset:24576
 v_mfma_f32_16x16x32_bf16 v[156:159], a[128:131], a[88:91], v[156:159]
 ds_read_b64_tr_b16 a[146:147], v6 offset:25600
 s_waitcnt lgkmcnt(4)
 v_mfma_f32_16x16x32_bf16 v[212:215], a[128:131], a[92:95], v[212:215]
 buffer_load_dwordx4 v8, s[12:15], s21 offen lds
 v_mfma_f32_16x16x32_bf16 v[212:215], a[152:155], a[76:79], v[212:215]
 v_mfma_f32_16x16x32_bf16 v[216:219], a[132:135], a[76:79], v[216:219]
 ds_read_b64_tr_b16 a[148:149], v7
 v_mfma_f32_16x16x32_bf16 v[216:219], a[136:139], a[92:95], v[216:219]
 ds_read_b64_tr_b16 a[150:151], v7 offset:1024
 v_mfma_f32_16x16x32_bf16 v[160:163], a[136:139], a[88:91], v[160:163]
 buffer_load_dwordx4 v9, s[12:15], s21 offen offset:1024 lds
 v_mfma_f32_16x16x32_bf16 v[160:163], a[132:135], a[72:75], v[160:163]
 v_mfma_f32_16x16x32_bf16 v[104:107], a[132:135], a[68:71], v[104:107]
 ds_read_b64_tr_b16 a[152:153], v7 offset:8192
 v_mfma_f32_16x16x32_bf16 v[104:107], a[136:139], a[84:87], v[104:107]
 ds_read_b64_tr_b16 a[154:155], v7 offset:9216
 s_waitcnt lgkmcnt(4)
 v_mfma_f32_16x16x32_bf16 v[48:51], a[136:139], a[80:83], v[48:51]
 v_mfma_f32_16x16x32_bf16 v[48:51], a[132:135], a[64:67], v[48:51]
 v_mfma_f32_16x16x32_bf16 v[52:55], a[140:143], a[64:67], v[52:55]
 ds_read_b64_tr_b16 a[128:129], v7 offset:16384
 v_mfma_f32_16x16x32_bf16 v[52:55], a[144:147], a[80:83], v[52:55]
 ds_read_b64_tr_b16 a[130:131], v7 offset:17408
 v_mfma_f32_16x16x32_bf16 v[108:111], a[144:147], a[84:87], v[108:111]
 buffer_load_dwordx4 v10, s[12:15], s21 offen offset:2048 lds
 v_mfma_f32_16x16x32_bf16 v[108:111], a[140:143], a[68:71], v[108:111]
 v_mfma_f32_16x16x32_bf16 v[164:167], a[140:143], a[72:75], v[164:167]
 ds_read_b64_tr_b16 a[132:133], v7 offset:24576
 v_mfma_f32_16x16x32_bf16 v[164:167], a[144:147], a[88:91], v[164:167]
 ds_read_b64_tr_b16 a[134:135], v7 offset:25600
 s_waitcnt lgkmcnt(4)
 v_mfma_f32_16x16x32_bf16 v[220:223], a[144:147], a[92:95], v[220:223]
 buffer_load_dwordx4 v11, s[12:15], s21 offen offset:3072 lds
 v_mfma_f32_16x16x32_bf16 v[220:223], a[140:143], a[76:79], v[220:223]
 s_add_u32 m0, s19, 147456
 v_mfma_f32_16x16x32_bf16 v[224:227], a[148:151], a[76:79], v[224:227]
 ds_read_b64_tr_b16 a[136:137], v4 offset:512
 v_mfma_f32_16x16x32_bf16 v[224:227], a[152:155], a[92:95], v[224:227]
 ds_read_b64_tr_b16 a[138:139], v4 offset:1536
 v_mfma_f32_16x16x32_bf16 v[168:171], a[152:155], a[88:91], v[168:171]
 v_mfma_f32_16x16x32_bf16 v[168:171], a[148:151], a[72:75], v[168:171]
 v_mfma_f32_16x16x32_bf16 v[112:115], a[148:151], a[68:71], v[112:115]
 ds_read_b64_tr_b16 a[140:141], v4 offset:8704
 v_mfma_f32_16x16x32_bf16 v[112:115], a[152:155], a[84:87], v[112:115]
 ds_read_b64_tr_b16 a[142:143], v4 offset:9728
 s_waitcnt lgkmcnt(4)
 v_mfma_f32_16x16x32_bf16 v[56:59], a[152:155], a[80:83], v[56:59]
 buffer_load_dwordx4 v8, s[8:11], s21 offen lds
 v_mfma_f32_16x16x32_bf16 v[56:59], a[148:151], a[64:67], v[56:59]
 v_mfma_f32_16x16x32_bf16 v[60:63], a[128:131], a[64:67], v[60:63]
 ds_read_b64_tr_b16 a[144:145], v4 offset:16896
 v_mfma_f32_16x16x32_bf16 v[60:63], a[132:135], a[80:83], v[60:63]
 ds_read_b64_tr_b16 a[146:147], v4 offset:17920
 v_mfma_f32_16x16x32_bf16 v[116:119], a[132:135], a[84:87], v[116:119]
 buffer_load_dwordx4 v9, s[8:11], s21 offen offset:1024 lds
 v_mfma_f32_16x16x32_bf16 v[116:119], a[128:131], a[68:71], v[116:119]
 v_mfma_f32_16x16x32_bf16 v[172:175], a[128:131], a[72:75], v[172:175]
 ds_read_b64_tr_b16 a[148:149], v4 offset:25088
 v_mfma_f32_16x16x32_bf16 v[172:175], a[132:135], a[88:91], v[172:175]
 ds_read_b64_tr_b16 a[150:151], v4 offset:26112
 s_waitcnt lgkmcnt(4)
 v_mfma_f32_16x16x32_bf16 v[228:231], a[132:135], a[92:95], v[228:231]
 v_mfma_f32_16x16x32_bf16 v[228:231], a[128:131], a[76:79], v[228:231]
 v_mfma_f32_16x16x32_bf16 v[232:235], a[136:139], a[76:79], v[232:235]
 ds_read_b64_tr_b16 a[152:153], v5 offset:512
 v_mfma_f32_16x16x32_bf16 v[232:235], a[140:143], a[92:95], v[232:235]
 ds_read_b64_tr_b16 a[154:155], v5 offset:1536
 v_mfma_f32_16x16x32_bf16 v[176:179], a[140:143], a[88:91], v[176:179]
 buffer_load_dwordx4 v10, s[8:11], s21 offen offset:2048 lds
 v_mfma_f32_16x16x32_bf16 v[176:179], a[136:139], a[72:75], v[176:179]
 v_mfma_f32_16x16x32_bf16 v[120:123], a[136:139], a[68:71], v[120:123]
 ds_read_b64_tr_b16 a[128:129], v5 offset:8704
 v_mfma_f32_16x16x32_bf16 v[120:123], a[140:143], a[84:87], v[120:123]
 ds_read_b64_tr_b16 a[130:131], v5 offset:9728
 s_waitcnt lgkmcnt(4)
 v_mfma_f32_16x16x32_bf16 v[64:67], a[140:143], a[80:83], v[64:67]
 buffer_load_dwordx4 v11, s[8:11], s21 offen offset:3072 lds
 v_mfma_f32_16x16x32_bf16 v[64:67], a[136:139], a[64:67], v[64:67]
 s_mov_b32 s23, 20987904
 v_mfma_f32_16x16x32_bf16 v[68:71], a[144:147], a[64:67], v[68:71]
 ds_read_b64_tr_b16 a[132:133], v5 offset:16896
 v_mfma_f32_16x16x32_bf16 v[68:71], a[148:151], a[80:83], v[68:71]
 ds_read_b64_tr_b16 a[134:135], v5 offset:17920
 v_mfma_f32_16x16x32_bf16 v[124:127], a[148:151], a[84:87], v[124:127]
 v_mfma_f32_16x16x32_bf16 v[124:127], a[144:147], a[68:71], v[124:127]
 v_mfma_f32_16x16x32_bf16 v[180:183], a[144:147], a[72:75], v[180:183]
 ds_read_b64_tr_b16 a[136:137], v5 offset:25088
 v_mfma_f32_16x16x32_bf16 v[180:183], a[148:151], a[88:91], v[180:183]
 ds_read_b64_tr_b16 a[138:139], v5 offset:26112
 s_waitcnt lgkmcnt(4)
 v_mfma_f32_16x16x32_bf16 v[236:239], a[148:151], a[92:95], v[236:239]
 buffer_load_dwordx4 a[32:35], v2, s[4:7], s23 offen sc1
 v_mfma_f32_16x16x32_bf16 v[236:239], a[144:147], a[76:79], v[236:239]
 v_mfma_f32_16x16x32_bf16 v[240:243], a[152:155], a[76:79], v[240:243]
 ds_read_b64_tr_b16 a[140:141], v6 offset:512
 v_mfma_f32_16x16x32_bf16 v[240:243], a[128:131], a[92:95], v[240:243]
 ds_read_b64_tr_b16 a[142:143], v6 offset:1536
 v_mfma_f32_16x16x32_bf16 v[184:187], a[128:131], a[88:91], v[184:187]
 buffer_load_dwordx4 a[36:39], v3, s[4:7], s23 offen sc1
 v_mfma_f32_16x16x32_bf16 v[184:187], a[152:155], a[72:75], v[184:187]
 v_mfma_f32_16x16x32_bf16 v[128:131], a[152:155], a[68:71], v[128:131]
 ds_read_b64_tr_b16 a[144:145], v6 offset:8704
 v_mfma_f32_16x16x32_bf16 v[128:131], a[128:131], a[84:87], v[128:131]
 ds_read_b64_tr_b16 a[146:147], v6 offset:9728
 s_waitcnt lgkmcnt(4)
 v_mfma_f32_16x16x32_bf16 v[72:75], a[128:131], a[80:83], v[72:75]
 v_mfma_f32_16x16x32_bf16 v[72:75], a[152:155], a[64:67], v[72:75]
 v_mfma_f32_16x16x32_bf16 v[76:79], a[132:135], a[64:67], v[76:79]
 ds_read_b64_tr_b16 a[148:149], v6 offset:16896
 v_mfma_f32_16x16x32_bf16 v[76:79], a[136:139], a[80:83], v[76:79]
 ds_read_b64_tr_b16 a[150:151], v6 offset:17920
 v_mfma_f32_16x16x32_bf16 v[132:135], a[136:139], a[84:87], v[132:135]
 buffer_load_dwordx4 a[40:43], v12, s[4:7], s23 offen sc1
 v_mfma_f32_16x16x32_bf16 v[132:135], a[132:135], a[68:71], v[132:135]
 v_mfma_f32_16x16x32_bf16 v[188:191], a[132:135], a[72:75], v[188:191]
 ds_read_b64_tr_b16 a[152:153], v6 offset:25088
 v_mfma_f32_16x16x32_bf16 v[188:191], a[136:139], a[88:91], v[188:191]
 ds_read_b64_tr_b16 a[154:155], v6 offset:26112
 s_waitcnt lgkmcnt(4)
 v_mfma_f32_16x16x32_bf16 v[244:247], a[136:139], a[92:95], v[244:247]
 buffer_load_dwordx4 a[44:47], v13, s[4:7], s23 offen sc1
 v_mfma_f32_16x16x32_bf16 v[244:247], a[132:135], a[76:79], v[244:247]
 v_mfma_f32_16x16x32_bf16 v[248:251], a[140:143], a[76:79], v[248:251]
 s_waitcnt vmcnt(20)
 s_barrier
 ds_read_b64_tr_b16 a[128:129], v4 offset:32768
 v_mfma_f32_16x16x32_bf16 v[248:251], a[144:147], a[92:95], v[248:251]
 ds_read_b64_tr_b16 a[130:131], v4 offset:33792
 v_mfma_f32_16x16x32_bf16 v[192:195], a[144:147], a[88:91], v[192:195]
 v_mfma_f32_16x16x32_bf16 v[192:195], a[140:143], a[72:75], v[192:195]
 v_mfma_f32_16x16x32_bf16 v[136:139], a[140:143], a[68:71], v[136:139]
 ds_read_b64_tr_b16 a[132:133], v4 offset:40960
 v_mfma_f32_16x16x32_bf16 v[136:139], a[144:147], a[84:87], v[136:139]
 ds_read_b64_tr_b16 a[134:135], v4 offset:41984
 s_waitcnt lgkmcnt(4)
 v_mfma_f32_16x16x32_bf16 v[80:83], a[144:147], a[80:83], v[80:83]
 buffer_load_dwordx4 a[48:51], v2, s[4:7], s23 offen offset:2048 sc1
 v_mfma_f32_16x16x32_bf16 v[80:83], a[140:143], a[64:67], v[80:83]
 v_mfma_f32_16x16x32_bf16 v[84:87], a[148:151], a[64:67], v[84:87]
 ds_read_b64_tr_b16 a[136:137], v4 offset:49152
 v_mfma_f32_16x16x32_bf16 v[84:87], a[152:155], a[80:83], v[84:87]
 ds_read_b64_tr_b16 a[138:139], v4 offset:50176
 v_mfma_f32_16x16x32_bf16 v[140:143], a[152:155], a[84:87], v[140:143]
 buffer_load_dwordx4 a[52:55], v3, s[4:7], s23 offen offset:2048 sc1
 v_mfma_f32_16x16x32_bf16 v[140:143], a[148:151], a[68:71], v[140:143]
 s_mov_b32 s21, 4587520
 v_mfma_f32_16x16x32_bf16 v[196:199], a[148:151], a[72:75], v[196:199]
 ds_read_b64_tr_b16 a[140:141], v4 offset:57344
 s_add_u32 m0, s19, 0
 v_mfma_f32_16x16x32_bf16 v[196:199], a[152:155], a[88:91], v[196:199]
L_hop_12:
 s_cbranch_execz L_ret_2
 ds_read_b64_tr_b16 a[142:143], v4 offset:58368
 s_waitcnt vmcnt(14) lgkmcnt(4)
 v_mfma_f32_16x16x32_bf16 v[252:255], a[152:155], a[92:95], v[252:255]
 v_mfma_f32_16x16x32_bf16 v[252:255], a[148:151], a[76:79], v[252:255]
 v_mfma_f32_16x16x32_bf16 v[200:203], a[128:131], a[12:15], v[200:203]
 ds_read_b64_tr_b16 a[144:145], v5 offset:32768
 v_mfma_f32_16x16x32_bf16 v[200:203], a[132:135], a[28:31], v[200:203]
 ds_read_b64_tr_b16 a[146:147], v5 offset:33792
 v_mfma_f32_16x16x32_bf16 v[144:147], a[132:135], a[24:27], v[144:147]
 buffer_load_dwordx4 a[56:59], v12, s[4:7], s23 offen offset:2048 sc1
 v_mfma_f32_16x16x32_bf16 v[144:147], a[128:131], a[8:11], v[144:147]
 v_mfma_f32_16x16x32_bf16 v[88:91], a[128:131], a[4:7], v[88:91]
 ds_read_b64_tr_b16 a[148:149], v5 offset:40960
 v_mfma_f32_16x16x32_bf16 v[88:91], a[132:135], a[20:23], v[88:91]
 ds_read_b64_tr_b16 a[150:151], v5 offset:41984
 s_waitcnt lgkmcnt(4)
 v_mfma_f32_16x16x32_bf16 v[32:35], a[132:135], a[16:19], v[32:35]
 buffer_load_dwordx4 a[60:63], v13, s[4:7], s23 offen offset:2048 sc1
 v_mfma_f32_16x16x32_bf16 v[32:35], a[128:131], a[0:3], v[32:35]
 v_cmp_gt_u32 vcc, 16, v17
 v_mfma_f32_16x16x32_bf16 v[36:39], a[136:139], a[0:3], v[36:39]
 ds_read_b64_tr_b16 a[152:153], v5 offset:49152
 v_mfma_f32_16x16x32_bf16 v[36:39], a[140:143], a[16:19], v[36:39]
 ds_read_b64_tr_b16 a[154:155], v5 offset:50176
 v_mfma_f32_16x16x32_bf16 v[92:95], a[140:143], a[20:23], v[92:95]
 buffer_load_dwordx4 v8, s[12:15], s21 offen lds
 v_mfma_f32_16x16x32_bf16 v[92:95], a[136:139], a[4:7], v[92:95]
 v_mfma_f32_16x16x32_bf16 v[148:151], a[136:139], a[8:11], v[148:151]
 ds_read_b64_tr_b16 a[128:129], v5 offset:57344
 v_mfma_f32_16x16x32_bf16 v[148:151], a[140:143], a[24:27], v[148:151]
 ds_read_b64_tr_b16 a[130:131], v5 offset:58368
 s_waitcnt lgkmcnt(4)
 v_mfma_f32_16x16x32_bf16 v[204:207], a[140:143], a[28:31], v[204:207]
 v_mfma_f32_16x16x32_bf16 v[204:207], a[136:139], a[12:15], v[204:207]
 v_mfma_f32_16x16x32_bf16 v[208:211], a[144:147], a[12:15], v[208:211]
 ds_read_b64_tr_b16 a[132:133], v6 offset:32768
 v_mfma_f32_16x16x32_bf16 v[208:211], a[148:151], a[28:31], v[208:211]
 ds_read_b64_tr_b16 a[134:135], v6 offset:33792
 v_mfma_f32_16x16x32_bf16 v[152:155], a[148:151], a[24:27], v[152:155]
 buffer_load_dwordx4 v9, s[12:15], s21 offen offset:1024 lds
 v_mfma_f32_16x16x32_bf16 v[152:155], a[144:147], a[8:11], v[152:155]
 v_mfma_f32_16x16x32_bf16 v[96:99], a[144:147], a[4:7], v[96:99]
 ds_read_b64_tr_b16 a[136:137], v6 offset:40960
 v_mfma_f32_16x16x32_bf16 v[96:99], a[148:151], a[20:23], v[96:99]
 ds_read_b64_tr_b16 a[138:139], v6 offset:41984
 s_waitcnt lgkmcnt(4)
 v_mfma_f32_16x16x32_bf16 v[40:43], a[148:151], a[16:19], v[40:43]
 buffer_load_dwordx4 v10, s[12:15], s21 offen offset:2048 lds
 v_mfma_f32_16x16x32_bf16 v[40:43], a[144:147], a[0:3], v[40:43]
 s_and_b32 s67, s1, vcc_lo
 s_cbranch_scc1 L_poll_34
L_polled_35:
 v_mfma_f32_16x16x32_bf16 v[44:47], a[152:155], a[0:3], v[44:47]
 ds_read_b64_tr_b16 a[140:141], v6 offset:49152
 v_mfma_f32_16x16x32_bf16 v[44:47], a[128:131], a[16:19], v[44:47]
 ds_read_b64_tr_b16 a[142:143], v6 offset:50176
 v_mfma_f32_16x16x32_bf16 v[100:103], a[128:131], a[20:23], v[100:103]
 v_mfma_f32_16x16x32_bf16 v[100:103], a[152:155], a[4:7], v[100:103]
 v_mfma_f32_16x16x32_bf16 v[156:159], a[152:155], a[8:11], v[156:159]
 ds_read_b64_tr_b16 a[144:145], v6 offset:57344
 v_mfma_f32_16x16x32_bf16 v[156:159], a[128:131], a[24:27], v[156:159]
 ds_read_b64_tr_b16 a[146:147], v6 offset:58368
 s_waitcnt lgkmcnt(4)
 v_mfma_f32_16x16x32_bf16 v[212:215], a[128:131], a[28:31], v[212:215]
 buffer_load_dwordx4 v11, s[12:15], s21 offen offset:3072 lds
 v_mfma_f32_16x16x32_bf16 v[212:215], a[152:155], a[12:15], v[212:215]
 s_add_u32 m0, s19, 16384
 v_mfma_f32_16x16x32_bf16 v[216:219], a[132:135], a[12:15], v[216:219]
 ds_read_b64_tr_b16 a[148:149], v7 offset:32768
 v_mfma_f32_16x16x32_bf16 v[216:219], a[136:139], a[28:31], v[216:219]
 ds_read_b64_tr_b16 a[150:151], v7 offset:33792
 v_mfma_f32_16x16x32_bf16 v[160:163], a[136:139], a[24:27], v[160:163]
 buffer_load_dwordx4 v8, s[8:11], s21 offen lds
 v_mfma_f32_16x16x32_bf16 v[160:163], a[132:135], a[8:11], v[160:163]
 v_cmp_gt_u32 vcc, 32, v31
 v_mfma_f32_16x16x32_bf16 v[104:107], a[132:135], a[4:7], v[104:107]
 ds_read_b64_tr_b16 a[152:153], v7 offset:40960
 v_mfma_f32_16x16x32_bf16 v[104:107], a[136:139], a[20:23], v[104:107]
 ds_read_b64_tr_b16 a[154:155], v7 offset:41984
 s_waitcnt lgkmcnt(4)
 v_mfma_f32_16x16x32_bf16 v[48:51], a[136:139], a[16:19], v[48:51]
 v_mfma_f32_16x16x32_bf16 v[48:51], a[132:135], a[0:3], v[48:51]
 v_mfma_f32_16x16x32_bf16 v[52:55], a[140:143], a[0:3], v[52:55]
 ds_read_b64_tr_b16 a[128:129], v7 offset:49152
 v_mfma_f32_16x16x32_bf16 v[52:55], a[144:147], a[16:19], v[52:55]
 ds_read_b64_tr_b16 a[130:131], v7 offset:50176
 v_mfma_f32_16x16x32_bf16 v[108:111], a[144:147], a[20:23], v[108:111]
 buffer_load_dwordx4 v9, s[8:11], s21 offen offset:1024 lds
 v_mfma_f32_16x16x32_bf16 v[108:111], a[140:143], a[4:7], v[108:111]
 v_mfma_f32_16x16x32_bf16 v[164:167], a[140:143], a[8:11], v[164:167]
 ds_read_b64_tr_b16 a[132:133], v7 offset:57344
 v_mfma_f32_16x16x32_bf16 v[164:167], a[144:147], a[24:27], v[164:167]
 ds_read_b64_tr_b16 a[134:135], v7 offset:58368
 s_waitcnt lgkmcnt(4)
 v_mfma_f32_16x16x32_bf16 v[220:223], a[144:147], a[28:31], v[220:223]
 buffer_load_dwordx4 v10, s[8:11], s21 offen offset:2048 lds
 v_mfma_f32_16x16x32_bf16 v[220:223], a[140:143], a[12:15], v[220:223]
 v_add_u32 v7, 65536, v7
 v_mfma_f32_16x16x32_bf16 v[224:227], a[148:151], a[12:15], v[224:227]
 ds_read_b64_tr_b16 a[136:137], v4 offset:33280
 v_mfma_f32_16x16x32_bf16 v[224:227], a[152:155], a[28:31], v[224:227]
 ds_read_b64_tr_b16 a[138:139], v4 offset:34304
 v_mfma_f32_16x16x32_bf16 v[168:171], a[152:155], a[24:27], v[168:171]
 v_mfma_f32_16x16x32_bf16 v[168:171], a[148:151], a[8:11], v[168:171]
 v_mfma_f32_16x16x32_bf16 v[112:115], a[148:151], a[4:7], v[112:115]
 ds_read_b64_tr_b16 a[140:141], v4 offset:41472
 v_mfma_f32_16x16x32_bf16 v[112:115], a[152:155], a[20:23], v[112:115]
 ds_read_b64_tr_b16 a[142:143], v4 offset:42496
 s_waitcnt lgkmcnt(4)
 v_mfma_f32_16x16x32_bf16 v[56:59], a[152:155], a[16:19], v[56:59]
 buffer_load_dwordx4 v11, s[8:11], s21 offen offset:3072 lds
 v_mfma_f32_16x16x32_bf16 v[56:59], a[148:151], a[0:3], v[56:59]
 s_and_b32 s67, s1, vcc_lo
 s_cbranch_scc1 L_poll_36
L_polled_37:
 v_mfma_f32_16x16x32_bf16 v[60:63], a[128:131], a[0:3], v[60:63]
 ds_read_b64_tr_b16 a[144:145], v4 offset:49664
 s_mov_b32 s23, 20992000
 v_mfma_f32_16x16x32_bf16 v[60:63], a[132:135], a[16:19], v[60:63]
 ds_read_b64_tr_b16 a[146:147], v4 offset:50688
 v_mfma_f32_16x16x32_bf16 v[116:119], a[132:135], a[20:23], v[116:119]
 buffer_load_dwordx4 a[64:67], v2, s[4:7], s23 offen sc1
 v_mfma_f32_16x16x32_bf16 v[116:119], a[128:131], a[4:7], v[116:119]
 v_mfma_f32_16x16x32_bf16 v[172:175], a[128:131], a[8:11], v[172:175]
 ds_read_b64_tr_b16 a[148:149], v4 offset:57856
 v_mfma_f32_16x16x32_bf16 v[172:175], a[132:135], a[24:27], v[172:175]
 ds_read_b64_tr_b16 a[150:151], v4 offset:58880
 s_waitcnt lgkmcnt(4)
 v_mfma_f32_16x16x32_bf16 v[228:231], a[132:135], a[28:31], v[228:231]
 v_mfma_f32_16x16x32_bf16 v[228:231], a[128:131], a[12:15], v[228:231]
 v_add_u32 v4, 65536, v4
 v_mfma_f32_16x16x32_bf16 v[232:235], a[136:139], a[12:15], v[232:235]
 ds_read_b64_tr_b16 a[152:153], v5 offset:33280
 v_mfma_f32_16x16x32_bf16 v[232:235], a[140:143], a[28:31], v[232:235]
 ds_read_b64_tr_b16 a[154:155], v5 offset:34304
 v_mfma_f32_16x16x32_bf16 v[176:179], a[140:143], a[24:27], v[176:179]
 buffer_load_dwordx4 a[68:71], v3, s[4:7], s23 offen sc1
 v_mfma_f32_16x16x32_bf16 v[176:179], a[136:139], a[8:11], v[176:179]
 v_mfma_f32_16x16x32_bf16 v[120:123], a[136:139], a[4:7], v[120:123]
 ds_read_b64_tr_b16 a[128:129], v5 offset:41472
 v_mfma_f32_16x16x32_bf16 v[120:123], a[140:143], a[20:23], v[120:123]
 ds_read_b64_tr_b16 a[130:131], v5 offset:42496
 s_waitcnt lgkmcnt(4)
 v_mfma_f32_16x16x32_bf16 v[64:67], a[140:143], a[16:19], v[64:67]
 buffer_load_dwordx4 a[72:75], v12, s[4:7], s23 offen sc1
 v_mfma_f32_16x16x32_bf16 v[64:67], a[136:139], a[0:3], v[64:67]
 v_mfma_f32_16x16x32_bf16 v[68:71], a[144:147], a[0:3], v[68:71]
 ds_read_b64_tr_b16 a[132:133], v5 offset:49664
 v_mfma_f32_16x16x32_bf16 v[68:71], a[148:151], a[16:19], v[68:71]
 ds_read_b64_tr_b16 a[134:135], v5 offset:50688
 v_mfma_f32_16x16x32_bf16 v[124:127], a[148:151], a[20:23], v[124:127]
 v_mfma_f32_16x16x32_bf16 v[124:127], a[144:147], a[4:7], v[124:127]
 v_mfma_f32_16x16x32_bf16 v[180:183], a[144:147], a[8:11], v[180:183]
 ds_read_b64_tr_b16 a[136:137], v5 offset:57856
 v_mfma_f32_16x16x32_bf16 v[180:183], a[148:151], a[24:27], v[180:183]
 ds_read_b64_tr_b16 a[138:139], v5 offset:58880
 s_waitcnt lgkmcnt(4)
 v_mfma_f32_16x16x32_bf16 v[236:239], a[148:151], a[28:31], v[236:239]
 buffer_load_dwordx4 a[76:79], v13, s[4:7], s23 offen sc1
 v_mfma_f32_16x16x32_bf16 v[236:239], a[144:147], a[12:15], v[236:239]
 v_add_u32 v5, 65536, v5
 v_mfma_f32_16x16x32_bf16 v[240:243], a[152:155], a[12:15], v[240:243]
 ds_read_b64_tr_b16 a[140:141], v6 offset:33280
 v_mfma_f32_16x16x32_bf16 v[240:243], a[128:131], a[28:31], v[240:243]
 ds_read_b64_tr_b16 a[142:143], v6 offset:34304
 v_mfma_f32_16x16x32_bf16 v[184:187], a[128:131], a[24:27], v[184:187]
 buffer_load_dwordx4 a[80:83], v2, s[4:7], s23 offen offset:2048 sc1
 v_mfma_f32_16x16x32_bf16 v[184:187], a[152:155], a[8:11], v[184:187]
 v_mfma_f32_16x16x32_bf16 v[128:131], a[152:155], a[4:7], v[128:131]
 ds_read_b64_tr_b16 a[144:145], v6 offset:41472
 v_mfma_f32_16x16x32_bf16 v[128:131], a[128:131], a[20:23], v[128:131]
 ds_read_b64_tr_b16 a[146:147], v6 offset:42496
 s_waitcnt lgkmcnt(4)
 v_mfma_f32_16x16x32_bf16 v[72:75], a[128:131], a[16:19], v[72:75]
 v_mfma_f32_16x16x32_bf16 v[72:75], a[152:155], a[0:3], v[72:75]
 v_mfma_f32_16x16x32_bf16 v[76:79], a[132:135], a[0:3], v[76:79]
 ds_read_b64_tr_b16 a[148:149], v6 offset:49664
 v_mfma_f32_16x16x32_bf16 v[76:79], a[136:139], a[16:19], v[76:79]
 ds_read_b64_tr_b16 a[150:151], v6 offset:50688
 v_mfma_f32_16x16x32_bf16 v[132:135], a[136:139], a[20:23], v[132:135]
 buffer_load_dwordx4 a[84:87], v3, s[4:7], s23 offen offset:2048 sc1
 v_mfma_f32_16x16x32_bf16 v[132:135], a[132:135], a[4:7], v[132:135]
 v_mfma_f32_16x16x32_bf16 v[188:191], a[132:135], a[8:11], v[188:191]
 ds_read_b64_tr_b16 a[152:153], v6 offset:57856
 v_mfma_f32_16x16x32_bf16 v[188:191], a[136:139], a[24:27], v[188:191]
 ds_read_b64_tr_b16 a[154:155], v6 offset:58880
 s_waitcnt lgkmcnt(4)
 v_mfma_f32_16x16x32_bf16 v[244:247], a[136:139], a[28:31], v[244:247]
 buffer_load_dwordx4 a[88:91], v12, s[4:7], s23 offen offset:2048 sc1
 v_mfma_f32_16x16x32_bf16 v[244:247], a[132:135], a[12:15], v[244:247]
 v_add_u32 v6, 65536, v6
 v_mfma_f32_16x16x32_bf16 v[248:251], a[140:143], a[12:15], v[248:251]
 s_waitcnt vmcnt(23)
 s_barrier
 ds_read_b64_tr_b16 a[128:129], v4
 v_mfma_f32_16x16x32_bf16 v[248:251], a[144:147], a[28:31], v[248:251]
 ds_read_b64_tr_b16 a[130:131], v4 offset:1024
 v_mfma_f32_16x16x32_bf16 v[192:195], a[144:147], a[24:27], v[192:195]
 v_mfma_f32_16x16x32_bf16 v[192:195], a[140:143], a[8:11], v[192:195]
 v_mfma_f32_16x16x32_bf16 v[136:139], a[140:143], a[4:7], v[136:139]
 ds_read_b64_tr_b16 a[132:133], v4 offset:8192
 v_mfma_f32_16x16x32_bf16 v[136:139], a[144:147], a[20:23], v[136:139]
 ds_read_b64_tr_b16 a[134:135], v4 offset:9216
 s_waitcnt lgkmcnt(4)
 v_mfma_f32_16x16x32_bf16 v[80:83], a[144:147], a[16:19], v[80:83]
 buffer_load_dwordx4 a[92:95], v13, s[4:7], s23 offen offset:2048 sc1
 v_mfma_f32_16x16x32_bf16 v[80:83], a[140:143], a[0:3], v[80:83]
 s_mov_b32 s21, 5505024
 v_mfma_f32_16x16x32_bf16 v[84:87], a[148:151], a[0:3], v[84:87]
 ds_read_b64_tr_b16 a[136:137], v4 offset:16384
 s_add_u32 m0, s19, 32768
 v_mfma_f32_16x16x32_bf16 v[84:87], a[152:155], a[16:19], v[84:87]
 ds_read_b64_tr_b16 a[138:139], v4 offset:17408
 v_mfma_f32_16x16x32_bf16 v[140:143], a[152:155], a[20:23], v[140:143]
 buffer_load_dwordx4 v8, s[12:15], s21 offen lds
 v_mfma_f32_16x16x32_bf16 v[140:143], a[148:151], a[4:7], v[140:143]
 v_mfma_f32_16x16x32_bf16 v[196:199], a[148:151], a[8:11], v[196:199]
 ds_read_b64_tr_b16 a[140:141], v4 offset:24576
 v_mfma_f32_16x16x32_bf16 v[196:199], a[152:155], a[24:27], v[196:199]
 ds_read_b64_tr_b16 a[142:143], v4 offset:25600
 s_waitcnt vmcnt(17) lgkmcnt(4)
 v_mfma_f32_16x16x32_bf16 v[252:255], a[152:155], a[28:31], v[252:255]
 v_mfma_f32_16x16x32_bf16 v[252:255], a[148:151], a[12:15], v[252:255]
 v_mfma_f32_16x16x32_bf16 v[200:203], a[128:131], a[44:47], v[200:203]
 ds_read_b64_tr_b16 a[144:145], v5
 v_mfma_f32_16x16x32_bf16 v[200:203], a[132:135], a[60:63], v[200:203]
 ds_read_b64_tr_b16 a[146:147], v5 offset:1024
 v_mfma_f32_16x16x32_bf16 v[144:147], a[132:135], a[56:59], v[144:147]
 buffer_load_dwordx4 v9, s[12:15], s21 offen offset:1024 lds
 v_mfma_f32_16x16x32_bf16 v[144:147], a[128:131], a[40:43], v[144:147]
 v_mfma_f32_16x16x32_bf16 v[88:91], a[128:131], a[36:39], v[88:91]
 ds_read_b64_tr_b16 a[148:149], v5 offset:8192
 v_mfma_f32_16x16x32_bf16 v[88:91], a[132:135], a[52:55], v[88:91]
 ds_read_b64_tr_b16 a[150:151], v5 offset:9216
 s_waitcnt lgkmcnt(4)
 v_mfma_f32_16x16x32_bf16 v[32:35], a[132:135], a[48:51], v[32:35]
 buffer_load_dwordx4 v10, s[12:15], s21 offen offset:2048 lds
 v_mfma_f32_16x16x32_bf16 v[32:35], a[128:131], a[32:35], v[32:35]
 v_mfma_f32_16x16x32_bf16 v[36:39], a[136:139], a[32:35], v[36:39]
 ds_read_b64_tr_b16 a[152:153], v5 offset:16384
 v_mfma_f32_16x16x32_bf16 v[36:39], a[140:143], a[48:51], v[36:39]
 ds_read_b64_tr_b16 a[154:155], v5 offset:17408
 v_mfma_f32_16x16x32_bf16 v[92:95], a[140:143], a[52:55], v[92:95]
 buffer_load_dwordx4 v11, s[12:15], s21 offen offset:3072 lds
 v_mfma_f32_16x16x32_bf16 v[92:95], a[136:139], a[36:39], v[92:95]
 s_add_u32 m0, s19, 49152
 v_mfma_f32_16x16x32_bf16 v[148:151], a[136:139], a[40:43], v[148:151]
 ds_read_b64_tr_b16 a[128:129], v5 offset:24576
 v_mfma_f32_16x16x32_bf16 v[148:151], a[140:143], a[56:59], v[148:151]
 ds_read_b64_tr_b16 a[130:131], v5 offset:25600
 s_waitcnt lgkmcnt(4)
 v_mfma_f32_16x16x32_bf16 v[204:207], a[140:143], a[60:63], v[204:207]
 v_mfma_f32_16x16x32_bf16 v[204:207], a[136:139], a[44:47], v[204:207]
 v_mfma_f32_16x16x32_bf16 v[208:211], a[144:147], a[44:47], v[208:211]
 ds_read_b64_tr_b16 a[132:133], v6
 v_mfma_f32_16x16x32_bf16 v[208:211], a[148:151], a[60:63], v[208:211]
 ds_read_b64_tr_b16 a[134:135], v6 offset:1024
 v_mfma_f32_16x16x32_bf16 v[152:155], a[148:151], a[56:59], v[152:155]
 buffer_load_dwordx4 v8, s[8:11], s21 offen lds
 v_mfma_f32_16x16x32_bf16 v[152:155], a[144:147], a[40:43], v[152:155]
 v_mfma_f32_16x16x32_bf16 v[96:99], a[144:147], a[36:39], v[96:99]
 ds_read_b64_tr_b16 a[136:137], v6 offset:8192
 v_mfma_f32_16x16x32_bf16 v[96:99], a[148:151], a[52:55], v[96:99]
 ds_read_b64_tr_b16 a[138:139], v6 offset:9216
 s_waitcnt lgkmcnt(4)
 v_mfma_f32_16x16x32_bf16 v[40:43], a[148:151], a[48:51], v[40:43]
 buffer_load_dwordx4 v9, s[8:11], s21 offen offset:1024 lds
 v_mfma_f32_16x16x32_bf16 v[40:43], a[144:147], a[32:35], v[40:43]
 v_mfma_f32_16x16x32_bf16 v[44:47], a[152:155], a[32:35], v[44:47]
 ds_read_b64_tr_b16 a[140:141], v6 offset:16384
 v_mfma_f32_16x16x32_bf16 v[44:47], a[128:131], a[48:51], v[44:47]
 ds_read_b64_tr_b16 a[142:143], v6 offset:17408
 v_mfma_f32_16x16x32_bf16 v[100:103], a[128:131], a[52:55], v[100:103]
 v_mfma_f32_16x16x32_bf16 v[100:103], a[152:155], a[36:39], v[100:103]
 v_mfma_f32_16x16x32_bf16 v[156:159], a[152:155], a[40:43], v[156:159]
 ds_read_b64_tr_b16 a[144:145], v6 offset:24576
 v_mfma_f32_16x16x32_bf16 v[156:159], a[128:131], a[56:59], v[156:159]
 ds_read_b64_tr_b16 a[146:147], v6 offset:25600
 s_waitcnt lgkmcnt(4)
 v_mfma_f32_16x16x32_bf16 v[212:215], a[128:131], a[60:63], v[212:215]
 buffer_load_dwordx4 v10, s[8:11], s21 offen offset:2048 lds
 v_mfma_f32_16x16x32_bf16 v[212:215], a[152:155], a[44:47], v[212:215]
 v_mfma_f32_16x16x32_bf16 v[216:219], a[132:135], a[44:47], v[216:219]
 ds_read_b64_tr_b16 a[148:149], v7
 v_mfma_f32_16x16x32_bf16 v[216:219], a[136:139], a[60:63], v[216:219]
 ds_read_b64_tr_b16 a[150:151], v7 offset:1024
 v_mfma_f32_16x16x32_bf16 v[160:163], a[136:139], a[56:59], v[160:163]
 buffer_load_dwordx4 v11, s[8:11], s21 offen offset:3072 lds
 v_mfma_f32_16x16x32_bf16 v[160:163], a[132:135], a[40:43], v[160:163]
 s_mov_b32 s23, 20996096
 v_mfma_f32_16x16x32_bf16 v[104:107], a[132:135], a[36:39], v[104:107]
 ds_read_b64_tr_b16 a[152:153], v7 offset:8192
 v_mfma_f32_16x16x32_bf16 v[104:107], a[136:139], a[52:55], v[104:107]
 ds_read_b64_tr_b16 a[154:155], v7 offset:9216
 s_waitcnt lgkmcnt(4)
 v_mfma_f32_16x16x32_bf16 v[48:51], a[136:139], a[48:51], v[48:51]
 v_mfma_f32_16x16x32_bf16 v[48:51], a[132:135], a[32:35], v[48:51]
 v_mfma_f32_16x16x32_bf16 v[52:55], a[140:143], a[32:35], v[52:55]
 ds_read_b64_tr_b16 a[128:129], v7 offset:16384
 v_mfma_f32_16x16x32_bf16 v[52:55], a[144:147], a[48:51], v[52:55]
 ds_read_b64_tr_b16 a[130:131], v7 offset:17408
 v_mfma_f32_16x16x32_bf16 v[108:111], a[144:147], a[52:55], v[108:111]
 buffer_load_dwordx4 a[0:3], v2, s[4:7], s23 offen sc1
 v_mfma_f32_16x16x32_bf16 v[108:111], a[140:143], a[36:39], v[108:111]
 v_mfma_f32_16x16x32_bf16 v[164:167], a[140:143], a[40:43], v[164:167]
 ds_read_b64_tr_b16 a[132:133], v7 offset:24576
 v_mfma_f32_16x16x32_bf16 v[164:167], a[144:147], a[56:59], v[164:167]
 ds_read_b64_tr_b16 a[134:135], v7 offset:25600
 s_waitcnt lgkmcnt(4)
 v_mfma_f32_16x16x32_bf16 v[220:223], a[144:147], a[60:63], v[220:223]
 buffer_load_dwordx4 a[4:7], v3, s[4:7], s23 offen sc1
 v_mfma_f32_16x16x32_bf16 v[220:223], a[140:143], a[44:47], v[220:223]
 v_add_u32 v7, -131072, v7
 v_mfma_f32_16x16x32_bf16 v[224:227], a[148:151], a[44:47], v[224:227]
 ds_read_b64_tr_b16 a[136:137], v4 offset:512
 v_mfma_f32_16x16x32_bf16 v[224:227], a[152:155], a[60:63], v[224:227]
 ds_read_b64_tr_b16 a[138:139], v4 offset:1536
 v_mfma_f32_16x16x32_bf16 v[168:171], a[152:155], a[56:59], v[168:171]
 v_mfma_f32_16x16x32_bf16 v[168:171], a[148:151], a[40:43], v[168:171]
 v_mfma_f32_16x16x32_bf16 v[112:115], a[148:151], a[36:39], v[112:115]
 ds_read_b64_tr_b16 a[140:141], v4 offset:8704
 v_mfma_f32_16x16x32_bf16 v[112:115], a[152:155], a[52:55], v[112:115]
 ds_read_b64_tr_b16 a[142:143], v4 offset:9728
 s_waitcnt lgkmcnt(4)
 v_mfma_f32_16x16x32_bf16 v[56:59], a[152:155], a[48:51], v[56:59]
 buffer_load_dwordx4 a[8:11], v12, s[4:7], s23 offen sc1
 v_mfma_f32_16x16x32_bf16 v[56:59], a[148:151], a[32:35], v[56:59]
 v_mfma_f32_16x16x32_bf16 v[60:63], a[128:131], a[32:35], v[60:63]
 ds_read_b64_tr_b16 a[144:145], v4 offset:16896
 v_mfma_f32_16x16x32_bf16 v[60:63], a[132:135], a[48:51], v[60:63]
 ds_read_b64_tr_b16 a[146:147], v4 offset:17920
 v_mfma_f32_16x16x32_bf16 v[116:119], a[132:135], a[52:55], v[116:119]
 buffer_load_dwordx4 a[12:15], v13, s[4:7], s23 offen sc1
 v_mfma_f32_16x16x32_bf16 v[116:119], a[128:131], a[36:39], v[116:119]
 v_mfma_f32_16x16x32_bf16 v[172:175], a[128:131], a[40:43], v[172:175]
 ds_read_b64_tr_b16 a[148:149], v4 offset:25088
 v_mfma_f32_16x16x32_bf16 v[172:175], a[132:135], a[56:59], v[172:175]
 ds_read_b64_tr_b16 a[150:151], v4 offset:26112
 s_waitcnt lgkmcnt(4)
 v_mfma_f32_16x16x32_bf16 v[228:231], a[132:135], a[60:63], v[228:231]
 v_mfma_f32_16x16x32_bf16 v[228:231], a[128:131], a[44:47], v[228:231]
 v_add_u32 v4, -131072, v4
 v_mfma_f32_16x16x32_bf16 v[232:235], a[136:139], a[44:47], v[232:235]
 ds_read_b64_tr_b16 a[152:153], v5 offset:512
 v_mfma_f32_16x16x32_bf16 v[232:235], a[140:143], a[60:63], v[232:235]
 ds_read_b64_tr_b16 a[154:155], v5 offset:1536
 v_mfma_f32_16x16x32_bf16 v[176:179], a[140:143], a[56:59], v[176:179]
 buffer_load_dwordx4 a[16:19], v2, s[4:7], s23 offen offset:2048 sc1
 v_mfma_f32_16x16x32_bf16 v[176:179], a[136:139], a[40:43], v[176:179]
 v_mfma_f32_16x16x32_bf16 v[120:123], a[136:139], a[36:39], v[120:123]
 ds_read_b64_tr_b16 a[128:129], v5 offset:8704
 v_mfma_f32_16x16x32_bf16 v[120:123], a[140:143], a[52:55], v[120:123]
 ds_read_b64_tr_b16 a[130:131], v5 offset:9728
 s_waitcnt lgkmcnt(4)
 v_mfma_f32_16x16x32_bf16 v[64:67], a[140:143], a[48:51], v[64:67]
 buffer_load_dwordx4 a[20:23], v3, s[4:7], s23 offen offset:2048 sc1
 v_mfma_f32_16x16x32_bf16 v[64:67], a[136:139], a[32:35], v[64:67]
 v_mfma_f32_16x16x32_bf16 v[68:71], a[144:147], a[32:35], v[68:71]
 ds_read_b64_tr_b16 a[132:133], v5 offset:16896
 v_mfma_f32_16x16x32_bf16 v[68:71], a[148:151], a[48:51], v[68:71]
 ds_read_b64_tr_b16 a[134:135], v5 offset:17920
 v_mfma_f32_16x16x32_bf16 v[124:127], a[148:151], a[52:55], v[124:127]
 v_mfma_f32_16x16x32_bf16 v[124:127], a[144:147], a[36:39], v[124:127]
 v_mfma_f32_16x16x32_bf16 v[180:183], a[144:147], a[40:43], v[180:183]
 ds_read_b64_tr_b16 a[136:137], v5 offset:25088
 v_mfma_f32_16x16x32_bf16 v[180:183], a[148:151], a[56:59], v[180:183]
 ds_read_b64_tr_b16 a[138:139], v5 offset:26112
 s_waitcnt lgkmcnt(4)
 v_mfma_f32_16x16x32_bf16 v[236:239], a[148:151], a[60:63], v[236:239]
 buffer_load_dwordx4 a[24:27], v12, s[4:7], s23 offen offset:2048 sc1
 v_mfma_f32_16x16x32_bf16 v[236:239], a[144:147], a[44:47], v[236:239]
 v_add_u32 v5, -131072, v5
 v_mfma_f32_16x16x32_bf16 v[240:243], a[152:155], a[44:47], v[240:243]
 ds_read_b64_tr_b16 a[140:141], v6 offset:512
 v_mfma_f32_16x16x32_bf16 v[240:243], a[128:131], a[60:63], v[240:243]
 ds_read_b64_tr_b16 a[142:143], v6 offset:1536
 v_mfma_f32_16x16x32_bf16 v[184:187], a[128:131], a[56:59], v[184:187]
 buffer_load_dwordx4 a[28:31], v13, s[4:7], s23 offen offset:2048 sc1
 v_mfma_f32_16x16x32_bf16 v[184:187], a[152:155], a[40:43], v[184:187]
 s_mov_b32 s21, 6422528
 v_mfma_f32_16x16x32_bf16 v[128:131], a[152:155], a[36:39], v[128:131]
 ds_read_b64_tr_b16 a[144:145], v6 offset:8704
 s_add_u32 m0, s19, 65536
 v_mfma_f32_16x16x32_bf16 v[128:131], a[128:131], a[52:55], v[128:131]
 ds_read_b64_tr_b16 a[146:147], v6 offset:9728
 s_waitcnt lgkmcnt(4)
 v_mfma_f32_16x16x32_bf16 v[72:75], a[128:131], a[48:51], v[72:75]
 v_mfma_f32_16x16x32_bf16 v[72:75], a[152:155], a[32:35], v[72:75]
 v_mfma_f32_16x16x32_bf16 v[76:79], a[132:135], a[32:35], v[76:79]
 ds_read_b64_tr_b16 a[148:149], v6 offset:16896
 v_mfma_f32_16x16x32_bf16 v[76:79], a[136:139], a[48:51], v[76:79]
 ds_read_b64_tr_b16 a[150:151], v6 offset:17920
 v_mfma_f32_16x16x32_bf16 v[132:135], a[136:139], a[52:55], v[132:135]
 buffer_load_dwordx4 v8, s[12:15], s21 offen lds
 v_mfma_f32_16x16x32_bf16 v[132:135], a[132:135], a[36:39], v[132:135]
 v_mfma_f32_16x16x32_bf16 v[188:191], a[132:135], a[40:43], v[188:191]
 ds_read_b64_tr_b16 a[152:153], v6 offset:25088
 v_mfma_f32_16x16x32_bf16 v[188:191], a[136:139], a[56:59], v[188:191]
 ds_read_b64_tr_b16 a[154:155], v6 offset:26112
 s_waitcnt lgkmcnt(4)
 v_mfma_f32_16x16x32_bf16 v[244:247], a[136:139], a[60:63], v[244:247]
 buffer_load_dwordx4 v9, s[12:15], s21 offen offset:1024 lds
 v_mfma_f32_16x16x32_bf16 v[244:247], a[132:135], a[44:47], v[244:247]
 v_add_u32 v6, -131072, v6
 v_mfma_f32_16x16x32_bf16 v[248:251], a[140:143], a[44:47], v[248:251]
 s_waitcnt vmcnt(26)
 s_barrier
 ds_read_b64_tr_b16 a[128:129], v4
 v_mfma_f32_16x16x32_bf16 v[248:251], a[144:147], a[60:63], v[248:251]
 ds_read_b64_tr_b16 a[130:131], v4 offset:1024
 v_mfma_f32_16x16x32_bf16 v[192:195], a[144:147], a[56:59], v[192:195]
 v_mfma_f32_16x16x32_bf16 v[192:195], a[140:143], a[40:43], v[192:195]
 v_mfma_f32_16x16x32_bf16 v[136:139], a[140:143], a[36:39], v[136:139]
 ds_read_b64_tr_b16 a[132:133], v4 offset:8192
 v_mfma_f32_16x16x32_bf16 v[136:139], a[144:147], a[52:55], v[136:139]
 ds_read_b64_tr_b16 a[134:135], v4 offset:9216
 s_waitcnt lgkmcnt(4)
 v_mfma_f32_16x16x32_bf16 v[80:83], a[144:147], a[48:51], v[80:83]
 buffer_load_dwordx4 v10, s[12:15], s21 offen offset:2048 lds
 v_mfma_f32_16x16x32_bf16 v[80:83], a[140:143], a[32:35], v[80:83]
 v_mfma_f32_16x16x32_bf16 v[84:87], a[148:151], a[32:35], v[84:87]
 ds_read_b64_tr_b16 a[136:137], v4 offset:16384
 v_mfma_f32_16x16x32_bf16 v[84:87], a[152:155], a[48:51], v[84:87]
 ds_read_b64_tr_b16 a[138:139], v4 offset:17408
 v_mfma_f32_16x16x32_bf16 v[140:143], a[152:155], a[52:55], v[140:143]
 buffer_load_dwordx4 v11, s[12:15], s21 offen offset:3072 lds
 v_mfma_f32_16x16x32_bf16 v[140:143], a[148:151], a[36:39], v[140:143]
 s_add_u32 m0, s19, 81920
 v_mfma_f32_16x16x32_bf16 v[196:199], a[148:151], a[40:43], v[196:199]
 ds_read_b64_tr_b16 a[140:141], v4 offset:24576
 s_add_u32 s26, s22, 327680
 v_mfma_f32_16x16x32_bf16 v[196:199], a[152:155], a[56:59], v[196:199]
 ds_read_b64_tr_b16 a[142:143], v4 offset:25600
 s_waitcnt vmcnt(20) lgkmcnt(4)
 v_mfma_f32_16x16x32_bf16 v[252:255], a[152:155], a[60:63], v[252:255]
 v_mfma_f32_16x16x32_bf16 v[252:255], a[148:151], a[44:47], v[252:255]
 v_mfma_f32_16x16x32_bf16 v[200:203], a[128:131], a[76:79], v[200:203]
 ds_read_b64_tr_b16 a[144:145], v5
 v_mfma_f32_16x16x32_bf16 v[200:203], a[132:135], a[92:95], v[200:203]
 ds_read_b64_tr_b16 a[146:147], v5 offset:1024
 v_mfma_f32_16x16x32_bf16 v[144:147], a[132:135], a[88:91], v[144:147]
 buffer_load_dwordx4 v8, s[8:11], s21 offen lds
 v_mfma_f32_16x16x32_bf16 v[144:147], a[128:131], a[72:75], v[144:147]
 v_mfma_f32_16x16x32_bf16 v[88:91], a[128:131], a[68:71], v[88:91]
 ds_read_b64_tr_b16 a[148:149], v5 offset:8192
 v_mfma_f32_16x16x32_bf16 v[88:91], a[132:135], a[84:87], v[88:91]
 ds_read_b64_tr_b16 a[150:151], v5 offset:9216
 s_waitcnt lgkmcnt(4)
 v_mfma_f32_16x16x32_bf16 v[32:35], a[132:135], a[80:83], v[32:35]
 buffer_load_dwordx4 v9, s[8:11], s21 offen offset:1024 lds
 v_mfma_f32_16x16x32_bf16 v[32:35], a[128:131], a[64:67], v[32:35]
 v_mfma_f32_16x16x32_bf16 v[36:39], a[136:139], a[64:67], v[36:39]
 ds_read_b64_tr_b16 a[152:153], v5 offset:16384
 v_mfma_f32_16x16x32_bf16 v[36:39], a[140:143], a[80:83], v[36:39]
 ds_read_b64_tr_b16 a[154:155], v5 offset:17408
 v_mfma_f32_16x16x32_bf16 v[92:95], a[140:143], a[84:87], v[92:95]
 buffer_load_dwordx4 v10, s[8:11], s21 offen offset:2048 lds
 v_mfma_f32_16x16x32_bf16 v[92:95], a[136:139], a[68:71], v[92:95]
 v_mfma_f32_16x16x32_bf16 v[148:151], a[136:139], a[72:75], v[148:151]
 ds_read_b64_tr_b16 a[128:129], v5 offset:24576
 v_mfma_f32_16x16x32_bf16 v[148:151], a[140:143], a[88:91], v[148:151]
 ds_read_b64_tr_b16 a[130:131], v5 offset:25600
 s_waitcnt lgkmcnt(4)
 v_mfma_f32_16x16x32_bf16 v[204:207], a[140:143], a[92:95], v[204:207]
 buffer_load_dwordx4 v11, s[8:11], s21 offen offset:3072 lds
 v_mfma_f32_16x16x32_bf16 v[204:207], a[136:139], a[76:79], v[204:207]
 s_mov_b32 s23, 21000192
 v_mfma_f32_16x16x32_bf16 v[208:211], a[144:147], a[76:79], v[208:211]
 ds_read_b64_tr_b16 a[132:133], v6
 v_mfma_f32_16x16x32_bf16 v[208:211], a[148:151], a[92:95], v[208:211]
 ds_read_b64_tr_b16 a[134:135], v6 offset:1024
 v_mfma_f32_16x16x32_bf16 v[152:155], a[148:151], a[88:91], v[152:155]
 v_mfma_f32_16x16x32_bf16 v[152:155], a[144:147], a[72:75], v[152:155]
 v_mfma_f32_16x16x32_bf16 v[96:99], a[144:147], a[68:71], v[96:99]
 ds_read_b64_tr_b16 a[136:137], v6 offset:8192
 v_mfma_f32_16x16x32_bf16 v[96:99], a[148:151], a[84:87], v[96:99]
 ds_read_b64_tr_b16 a[138:139], v6 offset:9216
 s_waitcnt lgkmcnt(4)
 v_mfma_f32_16x16x32_bf16 v[40:43], a[148:151], a[80:83], v[40:43]
 buffer_load_dword v16, v14, s[4:7], s30 offen sc1
 v_mfma_f32_16x16x32_bf16 v[40:43], a[144:147], a[64:67], v[40:43]
 v_mfma_f32_16x16x32_bf16 v[44:47], a[152:155], a[64:67], v[44:47]
 ds_read_b64_tr_b16 a[140:141], v6 offset:16384
 v_mfma_f32_16x16x32_bf16 v[44:47], a[128:131], a[80:83], v[44:47]
 ds_read_b64_tr_b16 a[142:143], v6 offset:17408
 v_mfma_f32_16x16x32_bf16 v[100:103], a[128:131], a[84:87], v[100:103]
 buffer_load_dwordx4 a[32:35], v2, s[4:7], s23 offen sc1
 v_mfma_f32_16x16x32_bf16 v[100:103], a[152:155], a[68:71], v[100:103]
 v_mfma_f32_16x16x32_bf16 v[156:159], a[152:155], a[72:75], v[156:159]
 ds_read_b64_tr_b16 a[144:145], v6 offset:24576
 v_mfma_f32_16x16x32_bf16 v[156:159], a[128:131], a[88:91], v[156:159]
 ds_read_b64_tr_b16 a[146:147], v6 offset:25600
 s_waitcnt lgkmcnt(4)
 v_mfma_f32_16x16x32_bf16 v[212:215], a[128:131], a[92:95], v[212:215]
 buffer_load_dwordx4 a[36:39], v3, s[4:7], s23 offen sc1
 v_mfma_f32_16x16x32_bf16 v[212:215], a[152:155], a[76:79], v[212:215]
 v_mfma_f32_16x16x32_bf16 v[216:219], a[132:135], a[76:79], v[216:219]
 ds_read_b64_tr_b16 a[148:149], v7
 v_mfma_f32_16x16x32_bf16 v[216:219], a[136:139], a[92:95], v[216:219]
 ds_read_b64_tr_b16 a[150:151], v7 offset:1024
 v_mfma_f32_16x16x32_bf16 v[160:163], a[136:139], a[88:91], v[160:163]
 buffer_load_dwordx4 a[40:43], v12, s[4:7], s23 offen sc1
 v_mfma_f32_16x16x32_bf16 v[160:163], a[132:135], a[72:75], v[160:163]
 v_mfma_f32_16x16x32_bf16 v[104:107], a[132:135], a[68:71], v[104:107]
 ds_read_b64_tr_b16 a[152:153], v7 offset:8192
 v_mfma_f32_16x16x32_bf16 v[104:107], a[136:139], a[84:87], v[104:107]
 ds_read_b64_tr_b16 a[154:155], v7 offset:9216
 s_waitcnt lgkmcnt(4)
 v_mfma_f32_16x16x32_bf16 v[48:51], a[136:139], a[80:83], v[48:51]
 v_mfma_f32_16x16x32_bf16 v[48:51], a[132:135], a[64:67], v[48:51]
 v_mfma_f32_16x16x32_bf16 v[52:55], a[140:143], a[64:67], v[52:55]
 ds_read_b64_tr_b16 a[128:129], v7 offset:16384
 v_mfma_f32_16x16x32_bf16 v[52:55], a[144:147], a[80:83], v[52:55]
 ds_read_b64_tr_b16 a[130:131], v7 offset:17408
 v_mfma_f32_16x16x32_bf16 v[108:111], a[144:147], a[84:87], v[108:111]
 buffer_load_dwordx4 a[44:47], v13, s[4:7], s23 offen sc1
 v_mfma_f32_16x16x32_bf16 v[108:111], a[140:143], a[68:71], v[108:111]
 v_mfma_f32_16x16x32_bf16 v[164:167], a[140:143], a[72:75], v[164:167]
 ds_read_b64_tr_b16 a[132:133], v7 offset:24576
 v_mfma_f32_16x16x32_bf16 v[164:167], a[144:147], a[88:91], v[164:167]
 ds_read_b64_tr_b16 a[134:135], v7 offset:25600
 s_waitcnt lgkmcnt(4)
 v_mfma_f32_16x16x32_bf16 v[220:223], a[144:147], a[92:95], v[220:223]
 buffer_load_dwordx4 a[48:51], v2, s[4:7], s23 offen offset:2048 sc1
 v_mfma_f32_16x16x32_bf16 v[220:223], a[140:143], a[76:79], v[220:223]
 v_mfma_f32_16x16x32_bf16 v[224:227], a[148:151], a[76:79], v[224:227]
 ds_read_b64_tr_b16 a[136:137], v4 offset:512
 v_mfma_f32_16x16x32_bf16 v[224:227], a[152:155], a[92:95], v[224:227]
 ds_read_b64_tr_b16 a[138:139], v4 offset:1536
 v_mfma_f32_16x16x32_bf16 v[168:171], a[152:155], a[88:91], v[168:171]
 buffer_load_dwordx4 a[52:55], v3, s[4:7], s23 offen offset:2048 sc1
 v_mfma_f32_16x16x32_bf16 v[168:171], a[148:151], a[72:75], v[168:171]
 v_mfma_f32_16x16x32_bf16 v[112:115], a[148:151], a[68:71], v[112:115]
 ds_read_b64_tr_b16 a[140:141], v4 offset:8704
 v_mfma_f32_16x16x32_bf16 v[112:115], a[152:155], a[84:87], v[112:115]
L_hop_13:
 s_cbranch_execz L_ret_3
 ds_read_b64_tr_b16 a[142:143], v4 offset:9728
 s_waitcnt lgkmcnt(4)
 v_mfma_f32_16x16x32_bf16 v[56:59], a[152:155], a[80:83], v[56:59]
 v_mfma_f32_16x16x32_bf16 v[56:59], a[148:151], a[64:67], v[56:59]
 v_mfma_f32_16x16x32_bf16 v[60:63], a[128:131], a[64:67], v[60:63]
 ds_read_b64_tr_b16 a[144:145], v4 offset:16896
 v_mfma_f32_16x16x32_bf16 v[60:63], a[132:135], a[80:83], v[60:63]
 ds_read_b64_tr_b16 a[146:147], v4 offset:17920
 v_mfma_f32_16x16x32_bf16 v[116:119], a[132:135], a[84:87], v[116:119]
 buffer_load_dword v17, v14, s[4:7], s30 offen offset:256 sc1
 v_mfma_f32_16x16x32_bf16 v[116:119], a[128:131], a[68:71], v[116:119]
 v_mfma_f32_16x16x32_bf16 v[172:175], a[128:131], a[72:75], v[172:175]
 ds_read_b64_tr_b16 a[148:149], v4 offset:25088
 v_mfma_f32_16x16x32_bf16 v[172:175], a[132:135], a[88:91], v[172:175]
 ds_read_b64_tr_b16 a[150:151], v4 offset:26112
 s_waitcnt lgkmcnt(4)
 v_mfma_f32_16x16x32_bf16 v[228:231], a[132:135], a[92:95], v[228:231]
 buffer_load_dwordx4 a[56:59], v12, s[4:7], s23 offen offset:2048 sc1
 v_mfma_f32_16x16x32_bf16 v[228:231], a[128:131], a[76:79], v[228:231]
 v_mfma_f32_16x16x32_bf16 v[232:235], a[136:139], a[76:79], v[232:235]
 ds_read_b64_tr_b16 a[152:153], v5 offset:512
 v_mfma_f32_16x16x32_bf16 v[232:235], a[140:143], a[92:95], v[232:235]
 ds_read_b64_tr_b16 a[154:155], v5 offset:1536
 v_mfma_f32_16x16x32_bf16 v[176:179], a[140:143], a[88:91], v[176:179]
 buffer_load_dwordx4 a[60:63], v13, s[4:7], s23 offen offset:2048 sc1
 v_mfma_f32_16x16x32_bf16 v[176:179], a[136:139], a[72:75], v[176:179]
 s_mov_b32 s21, 229376
 v_mfma_f32_16x16x32_bf16 v[120:123], a[136:139], a[68:71], v[120:123]
 ds_read_b64_tr_b16 a[128:129], v5 offset:8704
 s_add_u32 m0, s19, 98304
 v_mfma_f32_16x16x32_bf16 v[120:123], a[140:143], a[84:87], v[120:123]
 ds_read_b64_tr_b16 a[130:131], v5 offset:9728
 s_waitcnt lgkmcnt(4)
 v_mfma_f32_16x16x32_bf16 v[64:67], a[140:143], a[80:83], v[64:67]
 buffer_load_dwordx4 v8, s[12:15], s21 offen lds
 v_mfma_f32_16x16x32_bf16 v[64:67], a[136:139], a[64:67], v[64:67]
 v_mfma_f32_16x16x32_bf16 v[68:71], a[144:147], a[64:67], v[68:71]
 ds_read_b64_tr_b16 a[132:133], v5 offset:16896
 v_mfma_f32_16x16x32_bf16 v[68:71], a[148:151], a[80:83], v[68:71]
 ds_read_b64_tr_b16 a[134:135], v5 offset:17920
 v_mfma_f32_16x16x32_bf16 v[124:127], a[148:151], a[84:87], v[124:127]
 v_mfma_f32_16x16x32_bf16 v[124:127], a[144:147], a[68:71], v[124:127]
 v_mfma_f32_16x16x32_bf16 v[180:183], a[144:147], a[72:75], v[180:183]
 ds_read_b64_tr_b16 a[136:137], v5 offset:25088
 v_mfma_f32_16x16x32_bf16 v[180:183], a[148:151], a[88:91], v[180:183]
 ds_read_b64_tr_b16 a[138:139], v5 offset:26112
 s_waitcnt lgkmcnt(4)
 v_mfma_f32_16x16x32_bf16 v[236:239], a[148:151], a[92:95], v[236:239]
 buffer_load_dword v18, v14, s[4:7], s30 offen offset:512 sc1
 v_mfma_f32_16x16x32_bf16 v[236:239], a[144:147], a[76:79], v[236:239]
 v_mfma_f32_16x16x32_bf16 v[240:243], a[152:155], a[76:79], v[240:243]
 ds_read_b64_tr_b16 a[140:141], v6 offset:512
 v_mfma_f32_16x16x32_bf16 v[240:243], a[128:131], a[92:95], v[240:243]
 ds_read_b64_tr_b16 a[142:143], v6 offset:1536
 v_mfma_f32_16x16x32_bf16 v[184:187], a[128:131], a[88:91], v[184:187]
 buffer_load_dwordx4 v9, s[12:15], s21 offen offset:1024 lds
 v_mfma_f32_16x16x32_bf16 v[184:187], a[152:155], a[72:75], v[184:187]
 v_mfma_f32_16x16x32_bf16 v[128:131], a[152:155], a[68:71], v[128:131]
 ds_read_b64_tr_b16 a[144:145], v6 offset:8704
 v_mfma_f32_16x16x32_bf16 v[128:131], a[128:131], a[84:87], v[128:131]
 ds_read_b64_tr_b16 a[146:147], v6 offset:9728
 s_waitcnt lgkmcnt(4)
 v_mfma_f32_16x16x32_bf16 v[72:75], a[128:131], a[80:83], v[72:75]
 buffer_load_dwordx4 v10, s[12:15], s21 offen offset:2048 lds
 v_mfma_f32_16x16x32_bf16 v[72:75], a[152:155], a[64:67], v[72:75]
 v_mfma_f32_16x16x32_bf16 v[76:79], a[132:135], a[64:67], v[76:79]
 ds_read_b64_tr_b16 a[148:149], v6 offset:16896
 v_mfma_f32_16x16x32_bf16 v[76:79], a[136:139], a[80:83], v[76:79]
 ds_read_b64_tr_b16 a[150:151], v6 offset:17920
 v_mfma_f32_16x16x32_bf16 v[132:135], a[136:139], a[84:87], v[132:135]
 buffer_load_dwordx4 v11, s[12:15], s21 offen offset:3072 lds
 v_mfma_f32_16x16x32_bf16 v[132:135], a[132:135], a[68:71], v[132:135]
 s_add_u32 m0, s19, 114688
 v_mfma_f32_16x16x32_bf16 v[188:191], a[132:135], a[72:75], v[188:191]
 ds_read_b64_tr_b16 a[152:153], v6 offset:25088
 v_mfma_f32_16x16x32_bf16 v[188:191], a[136:139], a[88:91], v[188:191]
 ds_read_b64_tr_b16 a[154:155], v6 offset:26112
 s_waitcnt lgkmcnt(4)
 v_mfma_f32_16x16x32_bf16 v[244:247], a[136:139], a[92:95], v[244:247]
 v_mfma_f32_16x16x32_bf16 v[244:247], a[132:135], a[76:79], v[244:247]
 v_mfma_f32_16x16x32_bf16 v[248:251], a[140:143], a[76:79], v[248:251]
 s_waitcnt vmcnt(31)
 s_barrier
 ds_read_b64_tr_b16 a[128:129], v4 offset:32768
 v_mfma_f32_16x16x32_bf16 v[248:251], a[144:147], a[92:95], v[248:251]
 ds_read_b64_tr_b16 a[130:131], v4 offset:33792
 v_mfma_f32_16x16x32_bf16 v[192:195], a[144:147], a[88:91], v[192:195]
 buffer_load_dwordx4 v8, s[8:11], s21 offen lds
 v_mfma_f32_16x16x32_bf16 v[192:195], a[140:143], a[72:75], v[192:195]
 v_mfma_f32_16x16x32_bf16 v[136:139], a[140:143], a[68:71], v[136:139]
 ds_read_b64_tr_b16 a[132:133], v4 offset:40960
 v_mfma_f32_16x16x32_bf16 v[136:139], a[144:147], a[84:87], v[136:139]
 ds_read_b64_tr_b16 a[134:135], v4 offset:41984
 s_waitcnt lgkmcnt(4)
 v_mfma_f32_16x16x32_bf16 v[80:83], a[144:147], a[80:83], v[80:83]
 buffer_load_dwordx4 v9, s[8:11], s21 offen offset:1024 lds
 v_mfma_f32_16x16x32_bf16 v[80:83], a[140:143], a[64:67], v[80:83]
 v_mfma_f32_16x16x32_bf16 v[84:87], a[148:151], a[64:67], v[84:87]
 ds_read_b64_tr_b16 a[136:137], v4 offset:49152
 v_mfma_f32_16x16x32_bf16 v[84:87], a[152:155], a[80:83], v[84:87]
 ds_read_b64_tr_b16 a[138:139], v4 offset:50176
 v_mfma_f32_16x16x32_bf16 v[140:143], a[152:155], a[84:87], v[140:143]
 buffer_load_dwordx4 v10, s[8:11], s21 offen offset:2048 lds
 v_mfma_f32_16x16x32_bf16 v[140:143], a[148:151], a[68:71], v[140:143]
 v_mfma_f32_16x16x32_bf16 v[196:199], a[148:151], a[72:75], v[196:199]
 ds_read_b64_tr_b16 a[140:141], v4 offset:57344
 v_mfma_f32_16x16x32_bf16 v[196:199], a[152:155], a[88:91], v[196:199]
 ds_read_b64_tr_b16 a[142:143], v4 offset:58368
 s_waitcnt vmcnt(26) lgkmcnt(4)
 v_mfma_f32_16x16x32_bf16 v[252:255], a[152:155], a[92:95], v[252:255]
 v_mfma_f32_16x16x32_bf16 v[252:255], a[148:151], a[76:79], v[252:255]
 v_mfma_f32_16x16x32_bf16 v[200:203], a[128:131], a[12:15], v[200:203]
 ds_read_b64_tr_b16 a[144:145], v5 offset:32768
 v_mfma_f32_16x16x32_bf16 v[200:203], a[132:135], a[28:31], v[200:203]
 ds_read_b64_tr_b16 a[146:147], v5 offset:33792
 v_mfma_f32_16x16x32_bf16 v[144:147], a[132:135], a[24:27], v[144:147]
 buffer_load_dwordx4 v11, s[8:11], s21 offen offset:3072 lds
 v_mfma_f32_16x16x32_bf16 v[144:147], a[128:131], a[8:11], v[144:147]
 s_mov_b32 s23, 20972544
 v_mfma_f32_16x16x32_bf16 v[88:91], a[128:131], a[4:7], v[88:91]
 ds_read_b64_tr_b16 a[148:149], v5 offset:40960
 v_mfma_f32_16x16x32_bf16 v[88:91], a[132:135], a[20:23], v[88:91]
 ds_read_b64_tr_b16 a[150:151], v5 offset:41984
 s_waitcnt lgkmcnt(4)
 v_mfma_f32_16x16x32_bf16 v[32:35], a[132:135], a[16:19], v[32:35]
 buffer_load_dwordx4 a[64:67], v2, s[4:7], s23 offen sc1
 v_mfma_f32_16x16x32_bf16 v[32:35], a[128:131], a[0:3], v[32:35]
 v_mfma_f32_16x16x32_bf16 v[36:39], a[136:139], a[0:3], v[36:39]
 ds_read_b64_tr_b16 a[152:153], v5 offset:49152
 v_mfma_f32_16x16x32_bf16 v[36:39], a[140:143], a[16:19], v[36:39]
 ds_read_b64_tr_b16 a[154:155], v5 offset:50176
 v_mfma_f32_16x16x32_bf16 v[92:95], a[140:143], a[20:23], v[92:95]
 buffer_load_dwordx4 a[68:71], v3, s[4:7], s23 offen sc1
 v_mfma_f32_16x16x32_bf16 v[92:95], a[136:139], a[4:7], v[92:95]
 v_mfma_f32_16x16x32_bf16 v[148:151], a[136:139], a[8:11], v[148:151]
 ds_read_b64_tr_b16 a[128:129], v5 offset:57344
 v_mfma_f32_16x16x32_bf16 v[148:151], a[140:143], a[24:27], v[148:151]
 ds_read_b64_tr_b16 a[130:131], v5 offset:58368
 s_waitcnt lgkmcnt(4)
 v_mfma_f32_16x16x32_bf16 v[204:207], a[140:143], a[28:31], v[204:207]
 buffer_load_dwordx4 a[72:75], v12, s[4:7], s23 offen sc1
 v_mfma_f32_16x16x32_bf16 v[204:207], a[136:139], a[12:15], v[204:207]
 v_mfma_f32_16x16x32_bf16 v[208:211], a[144:147], a[12:15], v[208:211]
 ds_read_b64_tr_b16 a[132:133], v6 offset:32768
 v_mfma_f32_16x16x32_bf16 v[208:211], a[148:151], a[28:31], v[208:211]
 ds_read_b64_tr_b16 a[134:135], v6 offset:33792
 v_mfma_f32_16x16x32_bf16 v[152:155], a[148:151], a[24:27], v[152:155]
 v_mfma_f32_16x16x32_bf16 v[152:155], a[144:147], a[8:11], v[152:155]
 v_mfma_f32_16x16x32_bf16 v[96:99], a[144:147], a[4:7], v[96:99]
 ds_read_b64_tr_b16 a[136:137], v6 offset:40960
 v_mfma_f32_16x16x32_bf16 v[96:99], a[148:151], a[20:23], v[96:99]
 ds_read_b64_tr_b16 a[138:139], v6 offset:41984
 s_waitcnt lgkmcnt(4)
 v_mfma_f32_16x16x32_bf16 v[40:43], a[148:151], a[16:19], v[40:43]
 buffer_load_dword v19, v14, s[4:7], s30 offen offset:768 sc1
 v_mfma_f32_16x16x32_bf16 v[40:43], a[144:147], a[0:3], v[40:43]
 v_mfma_f32_16x16x32_bf16 v[44:47], a[152:155], a[0:3], v[44:47]
 ds_read_b64_tr_b16 a[140:141], v6 offset:49152
 v_mfma_f32_16x16x32_bf16 v[44:47], a[128:131], a[16:19], v[44:47]
 ds_read_b64_tr_b16 a[142:143], v6 offset:50176
 v_mfma_f32_16x16x32_bf16 v[100:103], a[128:131], a[20:23], v[100:103]
 buffer_load_dwordx4 a[76:79], v13, s[4:7], s23 offen sc1
 v_mfma_f32_16x16x32_bf16 v[100:103], a[152:155], a[4:7], v[100:103]
 v_mfma_f32_16x16x32_bf16 v[156:159], a[152:155], a[8:11], v[156:159]
 ds_read_b64_tr_b16 a[144:145], v6 offset:57344
 v_mfma_f32_16x16x32_bf16 v[156:159], a[128:131], a[24:27], v[156:159]
 ds_read_b64_tr_b16 a[146:147], v6 offset:58368
 s_waitcnt lgkmcnt(4)
 v_mfma_f32_16x16x32_bf16 v[212:215], a[128:131], a[28:31], v[212:215]
 buffer_load_dwordx4 a[80:83], v2, s[4:7], s23 offen offset:2048 sc1
 v_mfma_f32_16x16x32_bf16 v[212:215], a[152:155], a[12:15], v[212:215]
 v_mfma_f32_16x16x32_bf16 v[216:219], a[132:135], a[12:15], v[216:219]
 ds_read_b64_tr_b16 a[148:149], v7 offset:32768
 v_mfma_f32_16x16x32_bf16 v[216:219], a[136:139], a[28:31], v[216:219]
 ds_read_b64_tr_b16 a[150:151], v7 offset:33792
 v_mfma_f32_16x16x32_bf16 v[160:163], a[136:139], a[24:27], v[160:163]
 buffer_load_dwordx4 a[84:87], v3, s[4:7], s23 offen offset:2048 sc1
 v_mfma_f32_16x16x32_bf16 v[160:163], a[132:135], a[8:11], v[160:163]
 v_mfma_f32_16x16x32_bf16 v[104:107], a[132:135], a[4:7], v[104:107]
 ds_read_b64_tr_b16 a[152:153], v7 offset:40960
 v_mfma_f32_16x16x32_bf16 v[104:107], a[136:139], a[20:23], v[104:107]
 ds_read_b64_tr_b16 a[154:155], v7 offset:41984
 s_waitcnt lgkmcnt(4)
 v_mfma_f32_16x16x32_bf16 v[48:51], a[136:139], a[16:19], v[48:51]
 v_mfma_f32_16x16x32_bf16 v[48:51], a[132:135], a[0:3], v[48:51]
 v_mfma_f32_16x16x32_bf16 v[52:55], a[140:143], a[0:3], v[52:55]
 ds_read_b64_tr_b16 a[128:129], v7 offset:49152
 v_mfma_f32_16x16x32_bf16 v[52:55], a[144:147], a[16:19], v[52:55]
 ds_read_b64_tr_b16 a[130:131], v7 offset:50176
 v_mfma_f32_16x16x32_bf16 v[108:111], a[144:147], a[20:23], v[108:111]
 buffer_load_dwordx4 a[88:91], v12, s[4:7], s23 offen offset:2048 sc1
 v_mfma_f32_16x16x32_bf16 v[108:111], a[140:143], a[4:7], v[108:111]
 v_mfma_f32_16x16x32_bf16 v[164:167], a[140:143], a[8:11], v[164:167]
 ds_read_b64_tr_b16 a[132:133], v7 offset:57344
 v_mfma_f32_16x16x32_bf16 v[164:167], a[144:147], a[24:27], v[164:167]
 ds_read_b64_tr_b16 a[134:135], v7 offset:58368
 s_waitcnt lgkmcnt(4)
 v_mfma_f32_16x16x32_bf16 v[220:223], a[144:147], a[28:31], v[220:223]
 buffer_load_dwordx4 a[92:95], v13, s[4:7], s23 offen offset:2048 sc1
 v_mfma_f32_16x16x32_bf16 v[220:223], a[140:143], a[12:15], v[220:223]
 v_add_u32 v7, 65536, v7
 s_mov_b32 s21, 1146880
 v_mfma_f32_16x16x32_bf16 v[224:227], a[148:151], a[12:15], v[224:227]
 ds_read_b64_tr_b16 a[136:137], v4 offset:33280
 v_mfma_f32_16x16x32_bf16 v[224:227], a[152:155], a[28:31], v[224:227]
 ds_read_b64_tr_b16 a[138:139], v4 offset:34304
 v_mfma_f32_16x16x32_bf16 v[168:171], a[152:155], a[24:27], v[168:171]
 buffer_load_dword v20, v14, s[4:7], s30 offen offset:1024 sc1
 v_mfma_f32_16x16x32_bf16 v[168:171], a[148:151], a[8:11], v[168:171]
 s_add_u32 m0, s19, 131072
 v_mfma_f32_16x16x32_bf16 v[112:115], a[148:151], a[4:7], v[112:115]
 ds_read_b64_tr_b16 a[140:141], v4 offset:41472
 v_mfma_f32_16x16x32_bf16 v[112:115], a[152:155], a[20:23], v[112:115]
 ds_read_b64_tr_b16 a[142:143], v4 offset:42496
 s_waitcnt lgkmcnt(4)
 v_mfma_f32_16x16x32_bf16 v[56:59], a[152:155], a[16:19], v[56:59]
 v_mfma_f32_16x16x32_bf16 v[56:59], a[148:151], a[0:3], v[56:59]
 v_mfma_f32_16x16x32_bf16 v[60:63], a[128:131], a[0:3], v[60:63]
 ds_read_b64_tr_b16 a[144:145], v4 offset:49664
 v_mfma_f32_16x16x32_bf16 v[60:63], a[132:135], a[16:19], v[60:63]
 ds_read_b64_tr_b16 a[146:147], v4 offset:50688
 v_mfma_f32_16x16x32_bf16 v[116:119], a[132:135], a[20:23], v[116:119]
 buffer_load_dwordx4 v8, s[12:15], s21 offen lds
 v_mfma_f32_16x16x32_bf16 v[116:119], a[128:131], a[4:7], v[116:119]
 v_mfma_f32_16x16x32_bf16 v[172:175], a[128:131], a[8:11], v[172:175]
 ds_read_b64_tr_b16 a[148:149], v4 offset:57856
 v_mfma_f32_16x16x32_bf16 v[172:175], a[132:135], a[24:27], v[172:175]
 ds_read_b64_tr_b16 a[150:151], v4 offset:58880
 s_waitcnt lgkmcnt(4)
 v_mfma_f32_16x16x32_bf16 v[228:231], a[132:135], a[28:31], v[228:231]
 buffer_load_dwordx4 v9, s[12:15], s21 offen offset:1024 lds
 v_mfma_f32_16x16x32_bf16 v[228:231], a[128:131], a[12:15], v[228:231]
 v_add_u32 v4, 65536, v4
 v_mfma_f32_16x16x32_bf16 v[232:235], a[136:139], a[12:15], v[232:235]
 ds_read_b64_tr_b16 a[152:153], v5 offset:33280
 v_mfma_f32_16x16x32_bf16 v[232:235], a[140:143], a[28:31], v[232:235]
 ds_read_b64_tr_b16 a[154:155], v5 offset:34304
 v_mfma_f32_16x16x32_bf16 v[176:179], a[140:143], a[24:27], v[176:179]
 buffer_load_dwordx4 v10, s[12:15], s21 offen offset:2048 lds
 v_mfma_f32_16x16x32_bf16 v[176:179], a[136:139], a[8:11], v[176:179]
 v_mfma_f32_16x16x32_bf16 v[120:123], a[136:139], a[4:7], v[120:123]
 ds_read_b64_tr_b16 a[128:129], v5 offset:41472
 v_mfma_f32_16x16x32_bf16 v[120:123], a[140:143], a[20:23], v[120:123]
 ds_read_b64_tr_b16 a[130:131], v5 offset:42496
 s_waitcnt lgkmcnt(4)
 v_mfma_f32_16x16x32_bf16 v[64:67], a[140:143], a[16:19], v[64:67]
 buffer_load_dwordx4 v11, s[12:15], s21 offen offset:3072 lds
 v_mfma_f32_16x16x32_bf16 v[64:67], a[136:139], a[0:3], v[64:67]
 v_mfma_f32_16x16x32_bf16 v[68:71], a[144:147], a[0:3], v[68:71]
 ds_read_b64_tr_b16 a[132:133], v5 offset:49664
 v_mfma_f32_16x16x32_bf16 v[68:71], a[148:151], a[16:19], v[68:71]
 ds_read_b64_tr_b16 a[134:135], v5 offset:50688
 v_mfma_f32_16x16x32_bf16 v[124:127], a[148:151], a[20:23], v[124:127]
 v_mfma_f32_16x16x32_bf16 v[124:127], a[144:147], a[4:7], v[124:127]
 v_mfma_f32_16x16x32_bf16 v[180:183], a[144:147], a[8:11], v[180:183]
 ds_read_b64_tr_b16 a[136:137], v5 offset:57856
 v_mfma_f32_16x16x32_bf16 v[180:183], a[148:151], a[24:27], v[180:183]
 ds_read_b64_tr_b16 a[138:139], v5 offset:58880
 s_waitcnt lgkmcnt(4)
 v_mfma_f32_16x16x32_bf16 v[236:239], a[148:151], a[28:31], v[236:239]
 buffer_load_dword v21, v14, s[4:7], s30 offen offset:1280 sc1
 v_mfma_f32_16x16x32_bf16 v[236:239], a[144:147], a[12:15], v[236:239]
 v_add_u32 v5, 65536, v5
 s_add_u32 m0, s19, 147456
 v_mfma_f32_16x16x32_bf16 v[240:243], a[152:155], a[12:15], v[240:243]
 ds_read_b64_tr_b16 a[140:141], v6 offset:33280
 v_mfma_f32_16x16x32_bf16 v[240:243], a[128:131], a[28:31], v[240:243]
 ds_read_b64_tr_b16 a[142:143], v6 offset:34304
 v_mfma_f32_16x16x32_bf16 v[184:187], a[128:131], a[24:27], v[184:187]
 buffer_load_dwordx4 v8, s[8:11], s21 offen lds
 v_mfma_f32_16x16x32_bf16 v[184:187], a[152:155], a[8:11], v[184:187]
 v_mfma_f32_16x16x32_bf16 v[128:131], a[152:155], a[4:7], v[128:131]
 ds_read_b64_tr_b16 a[144:145], v6 offset:41472
 v_mfma_f32_16x16x32_bf16 v[128:131], a[128:131], a[20:23], v[128:131]
 ds_read_b64_tr_b16 a[146:147], v6 offset:42496
 s_waitcnt lgkmcnt(4)
 v_mfma_f32_16x16x32_bf16 v[72:75], a[128:131], a[16:19], v[72:75]
 buffer_load_dwordx4 v9, s[8:11], s21 offen offset:1024 lds
 v_mfma_f32_16x16x32_bf16 v[72:75], a[152:155], a[0:3], v[72:75]
 v_mfma_f32_16x16x32_bf16 v[76:79], a[132:135], a[0:3], v[76:79]
 ds_read_b64_tr_b16 a[148:149], v6 offset:49664
 v_mfma_f32_16x16x32_bf16 v[76:79], a[136:139], a[16:19], v[76:79]
 ds_read_b64_tr_b16 a[150:151], v6 offset:50688
 v_mfma_f32_16x16x32_bf16 v[132:135], a[136:139], a[20:23], v[132:135]
 buffer_load_dwordx4 v10, s[8:11], s21 offen offset:2048 lds
 v_mfma_f32_16x16x32_bf16 v[132:135], a[132:135], a[4:7], v[132:135]
 v_mfma_f32_16x16x32_bf16 v[188:191], a[132:135], a[8:11], v[188:191]
 ds_read_b64_tr_b16 a[152:153], v6 offset:57856
 v_mfma_f32_16x16x32_bf16 v[188:191], a[136:139], a[24:27], v[188:191]
 ds_read_b64_tr_b16 a[154:155], v6 offset:58880
 s_waitcnt lgkmcnt(4)
 v_mfma_f32_16x16x32_bf16 v[244:247], a[136:139], a[28:31], v[244:247]
 v_mfma_f32_16x16x32_bf16 v[244:247], a[132:135], a[12:15], v[244:247]
 v_add_u32 v6, 65536, v6
 v_mfma_f32_16x16x32_bf16 v[248:251], a[140:143], a[12:15], v[248:251]
 s_waitcnt vmcnt(37)
 s_barrier
 ds_read_b64_tr_b16 a[128:129], v4
 v_mfma_f32_16x16x32_bf16 v[248:251], a[144:147], a[28:31], v[248:251]
 ds_read_b64_tr_b16 a[130:131], v4 offset:1024
 v_mfma_f32_16x16x32_bf16 v[192:195], a[144:147], a[24:27], v[192:195]
 buffer_load_dwordx4 v11, s[8:11], s21 offen offset:3072 lds
 v_mfma_f32_16x16x32_bf16 v[192:195], a[140:143], a[8:11], v[192:195]
 v_mfma_f32_16x16x32_bf16 v[136:139], a[140:143], a[4:7], v[136:139]
 ds_read_b64_tr_b16 a[132:133], v4 offset:8192
 v_mfma_f32_16x16x32_bf16 v[136:139], a[144:147], a[20:23], v[136:139]
 ds_read_b64_tr_b16 a[134:135], v4 offset:9216
 s_waitcnt lgkmcnt(4)
 v_mfma_f32_16x16x32_bf16 v[80:83], a[144:147], a[16:19], v[80:83]
 buffer_load_dwordx4 a[96:99], v1, s[4:7], s26 offen sc1
 v_mfma_f32_16x16x32_bf16 v[80:83], a[140:143], a[0:3], v[80:83]
 v_mfma_f32_16x16x32_bf16 v[84:87], a[148:151], a[0:3], v[84:87]
 ds_read_b64_tr_b16 a[136:137], v4 offset:16384
 v_mfma_f32_16x16x32_bf16 v[84:87], a[152:155], a[16:19], v[84:87]
 ds_read_b64_tr_b16 a[138:139], v4 offset:17408
 v_mfma_f32_16x16x32_bf16 v[140:143], a[152:155], a[20:23], v[140:143]
 buffer_load_dwordx4 a[100:103], v1, s[4:7], s26 offen offset:1024 sc1
 v_mfma_f32_16x16x32_bf16 v[140:143], a[148:151], a[4:7], v[140:143]
 v_mfma_f32_16x16x32_bf16 v[196:199], a[148:151], a[8:11], v[196:199]
 ds_read_b64_tr_b16 a[140:141], v4 offset:24576
 v_mfma_f32_16x16x32_bf16 v[196:199], a[152:155], a[24:27], v[196:199]
 ds_read_b64_tr_b16 a[142:143], v4 offset:25600
 s_waitcnt vmcnt(30) lgkmcnt(4)
 v_mfma_f32_16x16x32_bf16 v[252:255], a[152:155], a[28:31], v[252:255]
 v_mfma_f32_16x16x32_bf16 v[252:255], a[148:151], a[12:15], v[252:255]
 v_mfma_f32_16x16x32_bf16 v[200:203], a[128:131], a[44:47], v[200:203]
 ds_read_b64_tr_b16 a[144:145], v5
 s_mov_b32 s23, 20976640
 v_mfma_f32_16x16x32_bf16 v[200:203], a[132:135], a[60:63], v[200:203]
 ds_read_b64_tr_b16 a[146:147], v5 offset:1024
 v_mfma_f32_16x16x32_bf16 v[144:147], a[132:135], a[56:59], v[144:147]
 buffer_load_dwordx4 a[0:3], v2, s[4:7], s23 offen sc1
 v_mfma_f32_16x16x32_bf16 v[144:147], a[128:131], a[40:43], v[144:147]
 v_mfma_f32_16x16x32_bf16 v[88:91], a[128:131], a[36:39], v[88:91]
 ds_read_b64_tr_b16 a[148:149], v5 offset:8192
 v_mfma_f32_16x16x32_bf16 v[88:91], a[132:135], a[52:55], v[88:91]
 ds_read_b64_tr_b16 a[150:151], v5 offset:9216
 s_waitcnt lgkmcnt(4)
 v_mfma_f32_16x16x32_bf16 v[32:35], a[132:135], a[48:51], v[32:35]
 buffer_load_dwordx4 a[4:7], v3, s[4:7], s23 offen sc1
 v_mfma_f32_16x16x32_bf16 v[32:35], a[128:131], a[32:35], v[32:35]
 v_mfma_f32_16x16x32_bf16 v[36:39], a[136:139], a[32:35], v[36:39]
 ds_read_b64_tr_b16 a[152:153], v5 offset:16384
 v_mfma_f32_16x16x32_bf16 v[36:39], a[140:143], a[48:51], v[36:39]
 ds_read_b64_tr_b16 a[154:155], v5 offset:17408
 v_mfma_f32_16x16x32_bf16 v[92:95], a[140:143], a[52:55], v[92:95]
 buffer_load_dwordx4 a[8:11], v12, s[4:7], s23 offen sc1
 v_mfma_f32_16x16x32_bf16 v[92:95], a[136:139], a[36:39], v[92:95]
 v_mfma_f32_16x16x32_bf16 v[148:151], a[136:139], a[40:43], v[148:151]
 ds_read_b64_tr_b16 a[128:129], v5 offset:24576
 v_mfma_f32_16x16x32_bf16 v[148:151], a[140:143], a[56:59], v[148:151]
 ds_read_b64_tr_b16 a[130:131], v5 offset:25600
 s_waitcnt lgkmcnt(4)
 v_mfma_f32_16x16x32_bf16 v[204:207], a[140:143], a[60:63], v[204:207]
 buffer_load_dwordx4 a[12:15], v13, s[4:7], s23 offen sc1
 v_mfma_f32_16x16x32_bf16 v[204:207], a[136:139], a[44:47], v[204:207]
 v_mfma_f32_16x16x32_bf16 v[208:211], a[144:147], a[44:47], v[208:211]
 ds_read_b64_tr_b16 a[132:133], v6
 v_mfma_f32_16x16x32_bf16 v[208:211], a[148:151], a[60:63], v[208:211]
 ds_read_b64_tr_b16 a[134:135], v6 offset:1024
 v_mfma_f32_16x16x32_bf16 v[152:155], a[148:151], a[56:59], v[152:155]
 v_mfma_f32_16x16x32_bf16 v[152:155], a[144:147], a[40:43], v[152:155]
 v_mfma_f32_16x16x32_bf16 v[96:99], a[144:147], a[36:39], v[96:99]
 ds_read_b64_tr_b16 a[136:137], v6 offset:8192
 v_mfma_f32_16x16x32_bf16 v[96:99], a[148:151], a[52:55], v[96:99]
 ds_read_b64_tr_b16 a[138:139], v6 offset:9216
 s_waitcnt lgkmcnt(4)
 v_mfma_f32_16x16x32_bf16 v[40:43], a[148:151], a[48:51], v[40:43]
 buffer_load_dwordx4 a[16:19], v2, s[4:7], s23 offen offset:2048 sc1
 v_mfma_f32_16x16x32_bf16 v[40:43], a[144:147], a[32:35], v[40:43]
 v_mfma_f32_16x16x32_bf16 v[44:47], a[152:155], a[32:35], v[44:47]
 ds_read_b64_tr_b16 a[140:141], v6 offset:16384
 v_mfma_f32_16x16x32_bf16 v[44:47], a[128:131], a[48:51], v[44:47]
 ds_read_b64_tr_b16 a[142:143], v6 offset:17408
 v_mfma_f32_16x16x32_bf16 v[100:103], a[128:131], a[52:55], v[100:103]
 buffer_load_dword v22, v14, s[4:7], s30 offen offset:1536 sc1
 v_mfma_f32_16x16x32_bf16 v[100:103], a[152:155], a[36:39], v[100:103]
 v_mfma_f32_16x16x32_bf16 v[156:159], a[152:155], a[40:43], v[156:159]
 ds_read_b64_tr_b16 a[144:145], v6 offset:24576
 v_mfma_f32_16x16x32_bf16 v[156:159], a[128:131], a[56:59], v[156:159]
 ds_read_b64_tr_b16 a[146:147], v6 offset:25600
 s_waitcnt lgkmcnt(4)
 v_mfma_f32_16x16x32_bf16 v[212:215], a[128:131], a[60:63], v[212:215]
 buffer_load_dwordx4 a[20:23], v3, s[4:7], s23 offen offset:2048 sc1
 v_mfma_f32_16x16x32_bf16 v[212:215], a[152:155], a[44:47], v[212:215]
 v_mfma_f32_16x16x32_bf16 v[216:219], a[132:135], a[44:47], v[216:219]
 ds_read_b64_tr_b16 a[148:149], v7
 v_mfma_f32_16x16x32_bf16 v[216:219], a[136:139], a[60:63], v[216:219]
 ds_read_b64_tr_b16 a[150:151], v7 offset:1024
 v_mfma_f32_16x16x32_bf16 v[160:163], a[136:139], a[56:59], v[160:163]
 buffer_load_dwordx4 a[24:27], v12, s[4:7], s23 offen offset:2048 sc1
 v_mfma_f32_16x16x32_bf16 v[160:163], a[132:135], a[40:43], v[160:163]
 v_mfma_f32_16x16x32_bf16 v[104:107], a[132:135], a[36:39], v[104:107]
 ds_read_b64_tr_b16 a[152:153], v7 offset:8192
 v_mfma_f32_16x16x32_bf16 v[104:107], a[136:139], a[52:55], v[104:107]
 ds_read_b64_tr_b16 a[154:155], v7 offset:9216
 s_waitcnt lgkmcnt(4)
 v_mfma_f32_16x16x32_bf16 v[48:51], a[136:139], a[48:51], v[48:51]
 v_mfma_f32_16x16x32_bf16 v[48:51], a[132:135], a[32:35], v[48:51]
 v_mfma_f32_16x16x32_bf16 v[52:55], a[140:143], a[32:35], v[52:55]
 ds_read_b64_tr_b16 a[128:129], v7 offset:16384
 v_mfma_f32_16x16x32_bf16 v[52:55], a[144:147], a[48:51], v[52:55]
 ds_read_b64_tr_b16 a[130:131], v7 offset:17408
 v_mfma_f32_16x16x32_bf16 v[108:111], a[144:147], a[52:55], v[108:111]
 buffer_load_dwordx4 a[28:31], v13, s[4:7], s23 offen offset:2048 sc1
 v_mfma_f32_16x16x32_bf16 v[108:111], a[140:143], a[36:39], v[108:111]
 s_mov_b32 s21, 2064384
 v_mfma_f32_16x16x32_bf16 v[164:167], a[140:143], a[40:43], v[164:167]
 ds_read_b64_tr_b16 a[132:133], v7 offset:24576
 s_add_u32 m0, s19, 0
 v_mfma_f32_16x16x32_bf16 v[164:167], a[144:147], a[56:59], v[164:167]
 ds_read_b64_tr_b16 a[134:135], v7 offset:25600
 s_waitcnt lgkmcnt(4)
 v_mfma_f32_16x16x32_bf16 v[220:223], a[144:147], a[60:63], v[220:223]
 buffer_load_dword v23, v14, s[4:7], s30 offen offset:1792 sc1
 v_mfma_f32_16x16x32_bf16 v[220:223], a[140:143], a[44:47], v[220:223]
 v_mfma_f32_16x16x32_bf16 v[224:227], a[148:151], a[44:47], v[224:227]
 ds_read_b64_tr_b16 a[136:137], v4 offset:512
 v_mfma_f32_16x16x32_bf16 v[224:227], a[152:155], a[60:63], v[224:227]
 ds_read_b64_tr_b16 a[138:139], v4 offset:1536
 v_mfma_f32_16x16x32_bf16 v[168:171], a[152:155], a[56:59], v[168:171]
 buffer_load_dwordx4 v8, s[12:15], s21 offen lds
 v_mfma_f32_16x16x32_bf16 v[168:171], a[148:151], a[40:43], v[168:171]
 v_mfma_f32_16x16x32_bf16 v[112:115], a[148:151], a[36:39], v[112:115]
 ds_read_b64_tr_b16 a[140:141], v4 offset:8704
 v_mfma_f32_16x16x32_bf16 v[112:115], a[152:155], a[52:55], v[112:115]
 ds_read_b64_tr_b16 a[142:143], v4 offset:9728
 s_waitcnt lgkmcnt(4)
 v_mfma_f32_16x16x32_bf16 v[56:59], a[152:155], a[48:51], v[56:59]
 v_mfma_f32_16x16x32_bf16 v[56:59], a[148:151], a[32:35], v[56:59]
 v_mfma_f32_16x16x32_bf16 v[60:63], a[128:131], a[32:35], v[60:63]
 ds_read_b64_tr_b16 a[144:145], v4 offset:16896
 v_mfma_f32_16x16x32_bf16 v[60:63], a[132:135], a[48:51], v[60:63]
 ds_read_b64_tr_b16 a[146:147], v4 offset:17920
 v_mfma_f32_16x16x32_bf16 v[116:119], a[132:135], a[52:55], v[116:119]
 buffer_load_dwordx4 v9, s[12:15], s21 offen offset:1024 lds
 v_mfma_f32_16x16x32_bf16 v[116:119], a[128:131], a[36:39], v[116:119]
 v_mfma_f32_16x16x32_bf16 v[172:175], a[128:131], a[40:43], v[172:175]
 ds_read_b64_tr_b16 a[148:149], v4 offset:25088
 v_mfma_f32_16x16x32_bf16 v[172:175], a[132:135], a[56:59], v[172:175]
 ds_read_b64_tr_b16 a[150:151], v4 offset:26112
 s_waitcnt lgkmcnt(4)
 v_mfma_f32_16x16x32_bf16 v[228:231], a[132:135], a[60:63], v[228:231]
 buffer_load_dwordx4 v10, s[12:15], s21 offen offset:2048 lds
 v_mfma_f32_16x16x32_bf16 v[228:231], a[128:131], a[44:47], v[228:231]
 v_mfma_f32_16x16x32_bf16 v[232:235], a[136:139], a[44:47], v[232:235]
 ds_read_b64_tr_b16 a[152:153], v5 offset:512
 v_mfma_f32_16x16x32_bf16 v[232:235], a[140:143], a[60:63], v[232:235]
 ds_read_b64_tr_b16 a[154:155], v5 offset:1536
 v_mfma_f32_16x16x32_bf16 v[176:179], a[140:143], a[56:59], v[176:179]
 buffer_load_dwordx4 v11, s[12:15], s21 offen offset:3072 lds
 v_mfma_f32_16x16x32_bf16 v[176:179], a[136:139], a[40:43], v[176:179]
 s_add_u32 m0, s19, 16384
 v_mfma_f32_16x16x32_bf16 v[120:123], a[136:139], a[36:39], v[120:123]
 ds_read_b64_tr_b16 a[128:129], v5 offset:8704
 v_mfma_f32_16x16x32_bf16 v[120:123], a[140:143], a[52:55], v[120:123]
 ds_read_b64_tr_b16 a[130:131], v5 offset:9728
 s_waitcnt lgkmcnt(4)
 v_mfma_f32_16x16x32_bf16 v[64:67], a[140:143], a[48:51], v[64:67]
 buffer_load_dwordx4 v8, s[8:11], s21 offen lds
 v_mfma_f32_16x16x32_bf16 v[64:67], a[136:139], a[32:35], v[64:67]
 v_mfma_f32_16x16x32_bf16 v[68:71], a[144:147], a[32:35], v[68:71]
 ds_read_b64_tr_b16 a[132:133], v5 offset:16896
 v_mfma_f32_16x16x32_bf16 v[68:71], a[148:151], a[48:51], v[68:71]
 ds_read_b64_tr_b16 a[134:135], v5 offset:17920
 v_mfma_f32_16x16x32_bf16 v[124:127], a[148:151], a[52:55], v[124:127]
 v_mfma_f32_16x16x32_bf16 v[124:127], a[144:147], a[36:39], v[124:127]
 v_mfma_f32_16x16x32_bf16 v[180:183], a[144:147], a[40:43], v[180:183]
 ds_read_b64_tr_b16 a[136:137], v5 offset:25088
 v_mfma_f32_16x16x32_bf16 v[180:183], a[148:151], a[56:59], v[180:183]
 ds_read_b64_tr_b16 a[138:139], v5 offset:26112
 s_waitcnt lgkmcnt(4)
 v_mfma_f32_16x16x32_bf16 v[236:239], a[148:151], a[60:63], v[236:239]
 buffer_load_dword v24, v14, s[4:7], s30 offen offset:2048 sc1
 v_mfma_f32_16x16x32_bf16 v[236:239], a[144:147], a[44:47], v[236:239]
 v_mfma_f32_16x16x32_bf16 v[240:243], a[152:155], a[44:47], v[240:243]
 ds_read_b64_tr_b16 a[140:141], v6 offset:512
 v_mfma_f32_16x16x32_bf16 v[240:243], a[128:131], a[60:63], v[240:243]
 ds_read_b64_tr_b16 a[142:143], v6 offset:1536
 v_mfma_f32_16x16x32_bf16 v[184:187], a[128:131], a[56:59], v[184:187]
 buffer_load_dwordx4 v9, s[8:11], s21 offen offset:1024 lds
 v_mfma_f32_16x16x32_bf16 v[184:187], a[152:155], a[40:43], v[184:187]
 v_mfma_f32_16x16x32_bf16 v[128:131], a[152:155], a[36:39], v[128:131]
 ds_read_b64_tr_b16 a[144:145], v6 offset:8704
 v_mfma_f32_16x16x32_bf16 v[128:131], a[128:131], a[52:55], v[128:131]
 ds_read_b64_tr_b16 a[146:147], v6 offset:9728
 s_waitcnt lgkmcnt(4)
 v_mfma_f32_16x16x32_bf16 v[72:75], a[128:131], a[48:51], v[72:75]
 buffer_load_dwordx4 v10, s[8:11], s21 offen offset:2048 lds
 v_mfma_f32_16x16x32_bf16 v[72:75], a[152:155], a[32:35], v[72:75]
 v_mfma_f32_16x16x32_bf16 v[76:79], a[132:135], a[32:35], v[76:79]
 ds_read_b64_tr_b16 a[148:149], v6 offset:16896
 v_mfma_f32_16x16x32_bf16 v[76:79], a[136:139], a[48:51], v[76:79]
 ds_read_b64_tr_b16 a[150:151], v6 offset:17920
 v_mfma_f32_16x16x32_bf16 v[132:135], a[136:139], a[52:55], v[132:135]
 buffer_load_dwordx4 v11, s[8:11], s21 offen offset:3072 lds
 v_mfma_f32_16x16x32_bf16 v[132:135], a[132:135], a[36:39], v[132:135]
 v_mfma_f32_16x16x32_bf16 v[188:191], a[132:135], a[40:43], v[188:191]
 ds_read_b64_tr_b16 a[152:153], v6 offset:25088
 v_mfma_f32_16x16x32_bf16 v[188:191], a[136:139], a[56:59], v[188:191]
 ds_read_b64_tr_b16 a[154:155], v6 offset:26112
 s_waitcnt lgkmcnt(4)
 v_mfma_f32_16x16x32_bf16 v[244:247], a[136:139], a[60:63], v[244:247]
 v_mfma_f32_16x16x32_bf16 v[244:247], a[132:135], a[44:47], v[244:247]
 v_mfma_f32_16x16x32_bf16 v[248:251], a[140:143], a[44:47], v[248:251]
 s_waitcnt vmcnt(40)
 s_barrier
 ds_read_b64_tr_b16 a[128:129], v4 offset:32768
 v_mfma_f32_16x16x32_bf16 v[248:251], a[144:147], a[60:63], v[248:251]
 ds_read_b64_tr_b16 a[130:131], v4 offset:33792
 v_mfma_f32_16x16x32_bf16 v[192:195], a[144:147], a[56:59], v[192:195]
 buffer_load_dwordx4 a[104:107], v1, s[4:7], s26 offen offset:2048 sc1
 v_mfma_f32_16x16x32_bf16 v[192:195], a[140:143], a[40:43], v[192:195]
 v_mfma_f32_16x16x32_bf16 v[136:139], a[140:143], a[36:39], v[136:139]
 ds_read_b64_tr_b16 a[132:133], v4 offset:40960
 v_mfma_f32_16x16x32_bf16 v[136:139], a[144:147], a[52:55], v[136:139]
 ds_read_b64_tr_b16 a[134:135], v4 offset:41984
 s_waitcnt lgkmcnt(4)
 v_mfma_f32_16x16x32_bf16 v[80:83], a[144:147], a[48:51], v[80:83]
 buffer_load_dwordx4 a[108:111], v1, s[4:7], s26 offen offset:3072 sc1
 v_mfma_f32_16x16x32_bf16 v[80:83], a[140:143], a[32:35], v[80:83]
 s_add_u32 s26, s22, 589824
 v_mfma_f32_16x16x32_bf16 v[84:87], a[148:151], a[32:35], v[84:87]
 ds_read_b64_tr_b16 a[136:137], v4 offset:49152
 v_mfma_f32_16x16x32_bf16 v[84:87], a[152:155], a[48:51], v[84:87]
 ds_read_b64_tr_b16 a[138:139], v4 offset:50176
 v_mfma_f32_16x16x32_bf16 v[140:143], a[152:155], a[52:55], v[140:143]
 buffer_load_dwordx4 a[112:115], v1, s[4:7], s26 offen sc1
 v_mfma_f32_16x16x32_bf16 v[140:143], a[148:151], a[36:39], v[140:143]
 v_mfma_f32_16x16x32_bf16 v[196:199], a[148:151], a[40:43], v[196:199]
 ds_read_b64_tr_b16 a[140:141], v4 offset:57344
 v_mfma_f32_16x16x32_bf16 v[196:199], a[152:155], a[56:59], v[196:199]
L_hop_14:
 s_cbranch_execz L_ret_4
 ds_read_b64_tr_b16 a[142:143], v4 offset:58368
 s_waitcnt vmcnt(34) lgkmcnt(4)
 v_mfma_f32_16x16x32_bf16 v[252:255], a[152:155], a[60:63], v[252:255]
 v_mfma_f32_16x16x32_bf16 v[252:255], a[148:151], a[44:47], v[252:255]
 v_mfma_f32_16x16x32_bf16 v[200:203], a[128:131], a[76:79], v[200:203]
 ds_read_b64_tr_b16 a[144:145], v5 offset:32768
 s_mov_b32 s23, 20980736
 v_mfma_f32_16x16x32_bf16 v[200:203], a[132:135], a[92:95], v[200:203]
 ds_read_b64_tr_b16 a[146:147], v5 offset:33792
 v_mfma_f32_16x16x32_bf16 v[144:147], a[132:135], a[88:91], v[144:147]
 buffer_load_dwordx4 a[32:35], v2, s[4:7], s23 offen sc1
 v_mfma_f32_16x16x32_bf16 v[144:147], a[128:131], a[72:75], v[144:147]
 v_mfma_f32_16x16x32_bf16 v[88:91], a[128:131], a[68:71], v[88:91]
 ds_read_b64_tr_b16 a[148:149], v5 offset:40960
 v_mfma_f32_16x16x32_bf16 v[88:91], a[132:135], a[84:87], v[88:91]
 ds_read_b64_tr_b16 a[150:151], v5 offset:41984
 s_waitcnt lgkmcnt(4)
 v_mfma_f32_16x16x32_bf16 v[32:35], a[132:135], a[80:83], v[32:35]
 buffer_load_dwordx4 a[36:39], v3, s[4:7], s23 offen sc1
 v_mfma_f32_16x16x32_bf16 v[32:35], a[128:131], a[64:67], v[32:35]
 v_mfma_f32_16x16x32_bf16 v[36:39], a[136:139], a[64:67], v[36:39]
 ds_read_b64_tr_b16 a[152:153], v5 offset:49152
 v_mfma_f32_16x16x32_bf16 v[36:39], a[140:143], a[80:83], v[36:39]
 ds_read_b64_tr_b16 a[154:155], v5 offset:50176
 v_mfma_f32_16x16x32_bf16 v[92:95], a[140:143], a[84:87], v[92:95]
 buffer_load_dwordx4 a[40:43], v12, s[4:7], s23 offen sc1
 v_mfma_f32_16x16x32_bf16 v[92:95], a[136:139], a[68:71], v[92:95]
 v_mfma_f32_16x16x32_bf16 v[148:151], a[136:139], a[72:75], v[148:151]
 ds_read_b64_tr_b16 a[128:129], v5 offset:57344
 v_mfma_f32_16x16x32_bf16 v[148:151], a[140:143], a[88:91], v[148:151]
 ds_read_b64_tr_b16 a[130:131], v5 offset:58368
 s_waitcnt lgkmcnt(4)
 v_mfma_f32_16x16x32_bf16 v[204:207], a[140:143], a[92:95], v[204:207]
 buffer_load_dwordx4 a[44:47], v13, s[4:7], s23 offen sc1
 v_mfma_f32_16x16x32_bf16 v[204:207], a[136:139], a[76:79], v[204:207]
 v_mfma_f32_16x16x32_bf16 v[208:211], a[144:147], a[76:79], v[208:211]
 ds_read_b64_tr_b16 a[132:133], v6 offset:32768
 v_mfma_f32_16x16x32_bf16 v[208:211], a[148:151], a[92:95], v[208:211]
 ds_read_b64_tr_b16 a[134:135], v6 offset:33792
 v_mfma_f32_16x16x32_bf16 v[152:155], a[148:151], a[88:91], v[152:155]
 v_mfma_f32_16x16x32_bf16 v[152:155], a[144:147], a[72:75], v[152:155]
 v_mfma_f32_16x16x32_bf16 v[96:99], a[144:147], a[68:71], v[96:99]
 ds_read_b64_tr_b16 a[136:137], v6 offset:40960
 v_mfma_f32_16x16x32_bf16 v[96:99], a[148:151], a[84:87], v[96:99]
 ds_read_b64_tr_b16 a[138:139], v6 offset:41984
 s_waitcnt lgkmcnt(4)
 v_mfma_f32_16x16x32_bf16 v[40:43], a[148:151], a[80:83], v[40:43]
 buffer_load_dwordx4 a[48:51], v2, s[4:7], s23 offen offset:2048 sc1
 v_mfma_f32_16x16x32_bf16 v[40:43], a[144:147], a[64:67], v[40:43]
 v_mfma_f32_16x16x32_bf16 v[44:47], a[152:155], a[64:67], v[44:47]
 ds_read_b64_tr_b16 a[140:141], v6 offset:49152
 v_mfma_f32_16x16x32_bf16 v[44:47], a[128:131], a[80:83], v[44:47]
 ds_read_b64_tr_b16 a[142:143], v6 offset:50176
 v_mfma_f32_16x16x32_bf16 v[100:103], a[128:131], a[84:87], v[100:103]
 buffer_load_dword v25, v14, s[4:7], s30 offen offset:2304 sc1
 v_mfma_f32_16x16x32_bf16 v[100:103], a[152:155], a[68:71], v[100:103]
 v_mfma_f32_16x16x32_bf16 v[156:159], a[152:155], a[72:75], v[156:159]
 ds_read_b64_tr_b16 a[144:145], v6 offset:57344
 v_mfma_f32_16x16x32_bf16 v[156:159], a[128:131], a[88:91], v[156:159]
 ds_read_b64_tr_b16 a[146:147], v6 offset:58368
 s_waitcnt lgkmcnt(4)
 v_mfma_f32_16x16x32_bf16 v[212:215], a[128:131], a[92:95], v[212:215]
 buffer_load_dwordx4 a[52:55], v3, s[4:7], s23 offen offset:2048 sc1
 v_mfma_f32_16x16x32_bf16 v[212:215], a[152:155], a[76:79], v[212:215]
 v_mfma_f32_16x16x32_bf16 v[216:219], a[132:135], a[76:79], v[216:219]
 ds_read_b64_tr_b16 a[148:149], v7 offset:32768
 v_mfma_f32_16x16x32_bf16 v[216:219], a[136:139], a[92:95], v[216:219]
 ds_read_b64_tr_b16 a[150:151], v7 offset:33792
 v_mfma_f32_16x16x32_bf16 v[160:163], a[136:139], a[88:91], v[160:163]
 buffer_load_dwordx4 a[56:59], v12, s[4:7], s23 offen offset:2048 sc1
 v_mfma_f32_16x16x32_bf16 v[160:163], a[132:135], a[72:75], v[160:163]
 v_mfma_f32_16x16x32_bf16 v[104:107], a[132:135], a[68:71], v[104:107]
 ds_read_b64_tr_b16 a[152:153], v7 offset:40960
 v_mfma_f32_16x16x32_bf16 v[104:107], a[136:139], a[84:87], v[104:107]
 ds_read_b64_tr_b16 a[154:155], v7 offset:41984
 s_waitcnt lgkmcnt(4)
 v_mfma_f32_16x16x32_bf16 v[48:51], a[136:139], a[80:83], v[48:51]
 v_mfma_f32_16x16x32_bf16 v[48:51], a[132:135], a[64:67], v[48:51]
 v_mfma_f32_16x16x32_bf16 v[52:55], a[140:143], a[64:67], v[52:55]
 ds_read_b64_tr_b16 a[128:129], v7 offset:49152
 v_mfma_f32_16x16x32_bf16 v[52:55], a[144:147], a[80:83], v[52:55]
 ds_read_b64_tr_b16 a[130:131], v7 offset:50176
 v_mfma_f32_16x16x32_bf16 v[108:111], a[144:147], a[84:87], v[108:111]
 buffer_load_dwordx4 a[60:63], v13, s[4:7], s23 offen offset:2048 sc1
 v_mfma_f32_16x16x32_bf16 v[108:111], a[140:143], a[68:71], v[108:111]
 s_mov_b32 s21, 2981888
 v_mfma_f32_16x16x32_bf16 v[164:167], a[140:143], a[72:75], v[164:167]
 ds_read_b64_tr_b16 a[132:133], v7 offset:57344
 s_add_u32 m0, s19, 32768
 v_mfma_f32_16x16x32_bf16 v[164:167], a[144:147], a[88:91], v[164:167]
 ds_read_b64_tr_b16 a[134:135], v7 offset:58368
 s_waitcnt lgkmcnt(4)
 v_mfma_f32_16x16x32_bf16 v[220:223], a[144:147], a[92:95], v[220:223]
 buffer_load_dword v26, v14, s[4:7], s30 offen offset:2560 sc1
 v_mfma_f32_16x16x32_bf16 v[220:223], a[140:143], a[76:79], v[220:223]
 v_add_u32 v7, 65536, v7
 v_mfma_f32_16x16x32_bf16 v[224:227], a[148:151], a[76:79], v[224:227]
 ds_read_b64_tr_b16 a[136:137], v4 offset:33280
 v_mfma_f32_16x16x32_bf16 v[224:227], a[152:155], a[92:95], v[224:227]
 ds_read_b64_tr_b16 a[138:139], v4 offset:34304
 v_mfma_f32_16x16x32_bf16 v[168:171], a[152:155], a[88:91], v[168:171]
 buffer_load_dwordx4 v8, s[12:15], s21 offen lds
 v_mfma_f32_16x16x32_bf16 v[168:171], a[148:151], a[72:75], v[168:171]
 v_mfma_f32_16x16x32_bf16 v[112:115], a[148:151], a[68:71], v[112:115]
 ds_read_b64_tr_b16 a[140:141], v4 offset:41472
 v_mfma_f32_16x16x32_bf16 v[112:115], a[152:155], a[84:87], v[112:115]
 ds_read_b64_tr_b16 a[142:143], v4 offset:42496
 s_waitcnt lgkmcnt(4)
 v_mfma_f32_16x16x32_bf16 v[56:59], a[152:155], a[80:83], v[56:59]
 v_mfma_f32_16x16x32_bf16 v[56:59], a[148:151], a[64:67], v[56:59]
 v_mfma_f32_16x16x32_bf16 v[60:63], a[128:131], a[64:67], v[60:63]
 ds_read_b64_tr_b16 a[144:145], v4 offset:49664
 v_mfma_f32_16x16x32_bf16 v[60:63], a[132:135], a[80:83], v[60:63]
 ds_read_b64_tr_b16 a[146:147], v4 offset:50688
 v_mfma_f32_16x16x32_bf16 v[116:119], a[132:135], a[84:87], v[116:119]
 buffer_load_dwordx4 v9, s[12:15], s21 offen offset:1024 lds
 v_mfma_f32_16x16x32_bf16 v[116:119], a[128:131], a[68:71], v[116:119]
 v_mfma_f32_16x16x32_bf16 v[172:175], a[128:131], a[72:75], v[172:175]
 ds_read_b64_tr_b16 a[148:149], v4 offset:57856
 v_mfma_f32_16x16x32_bf16 v[172:175], a[132:135], a[88:91], v[172:175]
 ds_read_b64_tr_b16 a[150:151], v4 offset:58880
 s_waitcnt lgkmcnt(4)
 v_mfma_f32_16x16x32_bf16 v[228:231], a[132:135], a[92:95], v[228:231]
 buffer_load_dwordx4 v10, s[12:15], s21 offen offset:2048 lds
 v_mfma_f32_16x16x32_bf16 v[228:231], a[128:131], a[76:79], v[228:231]
 v_add_u32 v4, 65536, v4
 v_mfma_f32_16x16x32_bf16 v[232:235], a[136:139], a[76:79], v[232:235]
 ds_read_b64_tr_b16 a[152:153], v5 offset:33280
 v_mfma_f32_16x16x32_bf16 v[232:235], a[140:143], a[92:95], v[232:235]
 ds_read_b64_tr_b16 a[154:155], v5 offset:34304
 v_mfma_f32_16x16x32_bf16 v[176:179], a[140:143], a[88:91], v[176:179]
 buffer_load_dwordx4 v11, s[12:15], s21 offen offset:3072 lds
 v_mfma_f32_16x16x32_bf16 v[176:179], a[136:139], a[72:75], v[176:179]
 s_add_u32 m0, s19, 49152
 v_mfma_f32_16x16x32_bf16 v[120:123], a[136:139], a[68:71], v[120:123]
 ds_read_b64_tr_b16 a[128:129], v5 offset:41472
 v_mfma_f32_16x16x32_bf16 v[120:123], a[140:143], a[84:87], v[120:123]
 ds_read_b64_tr_b16 a[130:131], v5 offset:42496
 s_waitcnt lgkmcnt(4)
 v_mfma_f32_16x16x32_bf16 v[64:67], a[140:143], a[80:83], v[64:67]
 buffer_load_dwordx4 v8, s[8:11], s21 offen lds
 v_mfma_f32_16x16x32_bf16 v[64:67], a[136:139], a[64:67], v[64:67]
 v_mfma_f32_16x16x32_bf16 v[68:71], a[144:147], a[64:67], v[68:71]
 ds_read_b64_tr_b16 a[132:133], v5 offset:49664
 v_mfma_f32_16x16x32_bf16 v[68:71], a[148:151], a[80:83], v[68:71]
 ds_read_b64_tr_b16 a[134:135], v5 offset:50688
 v_mfma_f32_16x16x32_bf16 v[124:127], a[148:151], a[84:87], v[124:127]
 v_mfma_f32_16x16x32_bf16 v[124:127], a[144:147], a[68:71], v[124:127]
 v_mfma_f32_16x16x32_bf16 v[180:183], a[144:147], a[72:75], v[180:183]
 ds_read_b64_tr_b16 a[136:137], v5 offset:57856
 v_mfma_f32_16x16x32_bf16 v[180:183], a[148:151], a[88:91], v[180:183]
 ds_read_b64_tr_b16 a[138:139], v5 offset:58880
 s_waitcnt lgkmcnt(4)
 v_mfma_f32_16x16x32_bf16 v[236:239], a[148:151], a[92:95], v[236:239]
 buffer_load_dword v27, v14, s[4:7], s30 offen offset:2816 sc1
 v_mfma_f32_16x16x32_bf16 v[236:239], a[144:147], a[76:79], v[236:239]
 v_add_u32 v5, 65536, v5
 v_mfma_f32_16x16x32_bf16 v[240:243], a[152:155], a[76:79], v[240:243]
 ds_read_b64_tr_b16 a[140:141], v6 offset:33280
 v_mfma_f32_16x16x32_bf16 v[240:243], a[128:131], a[92:95], v[240:243]
 ds_read_b64_tr_b16 a[142:143], v6 offset:34304
 v_mfma_f32_16x16x32_bf16 v[184:187], a[128:131], a[88:91], v[184:187]
 buffer_load_dwordx4 v9, s[8:11], s21 offen offset:1024 lds
 v_mfma_f32_16x16x32_bf16 v[184:187], a[152:155], a[72:75], v[184:187]
 v_mfma_f32_16x16x32_bf16 v[128:131], a[152:155], a[68:71], v[128:131]
 ds_read_b64_tr_b16 a[144:145], v6 offset:41472
 v_mfma_f32_16x16x32_bf16 v[128:131], a[128:131], a[84:87], v[128:131]
 ds_read_b64_tr_b16 a[146:147], v6 offset:42496
 s_waitcnt lgkmcnt(4)
 v_mfma_f32_16x16x32_bf16 v[72:75], a[128:131], a[80:83], v[72:75]
 buffer_load_dwordx4 v10, s[8:11], s21 offen offset:2048 lds
 v_mfma_f32_16x16x32_bf16 v[72:75], a[152:155], a[64:67], v[72:75]
 v_mfma_f32_16x16x32_bf16 v[76:79], a[132:135], a[64:67], v[76:79]
 ds_read_b64_tr_b16 a[148:149], v6 offset:49664
 v_mfma_f32_16x16x32_bf16 v[76:79], a[136:139], a[80:83], v[76:79]
 ds_read_b64_tr_b16 a[150:151], v6 offset:50688
 v_mfma_f32_16x16x32_bf16 v[132:135], a[136:139], a[84:87], v[132:135]
 buffer_load_dwordx4 v11, s[8:11], s21 offen offset:3072 lds
 v_mfma_f32_16x16x32_bf16 v[132:135], a[132:135], a[68:71], v[132:135]
 v_mfma_f32_16x16x32_bf16 v[188:191], a[132:135], a[72:75], v[188:191]
 ds_read_b64_tr_b16 a[152:153], v6 offset:57856
 v_mfma_f32_16x16x32_bf16 v[188:191], a[136:139], a[88:91], v[188:191]
 ds_read_b64_tr_b16 a[154:155], v6 offset:58880
 s_waitcnt lgkmcnt(4)
 v_mfma_f32_16x16x32_bf16 v[244:247], a[136:139], a[92:95], v[244:247]
 v_mfma_f32_16x16x32_bf16 v[244:247], a[132:135], a[76:79], v[244:247]
 v_add_u32 v6, 65536, v6
 v_mfma_f32_16x16x32_bf16 v[248:251], a[140:143], a[76:79], v[248:251]
 s_waitcnt vmcnt(43)
 s_barrier
 ds_read_b64_tr_b16 a[128:129], v4
 v_mfma_f32_16x16x32_bf16 v[248:251], a[144:147], a[92:95], v[248:251]
 ds_read_b64_tr_b16 a[130:131], v4 offset:1024
 v_mfma_f32_16x16x32_bf16 v[192:195], a[144:147], a[88:91], v[192:195]
 buffer_load_dwordx4 a[116:119], v1, s[4:7], s26 offen offset:1024 sc1
 v_mfma_f32_16x16x32_bf16 v[192:195], a[140:143], a[72:75], v[192:195]
 v_mfma_f32_16x16x32_bf16 v[136:139], a[140:143], a[68:71], v[136:139]
 ds_read_b64_tr_b16 a[132:133], v4 offset:8192
 v_mfma_f32_16x16x32_bf16 v[136:139], a[144:147], a[84:87], v[136:139]
 ds_read_b64_tr_b16 a[134:135], v4 offset:9216
 s_waitcnt lgkmcnt(4)
 v_mfma_f32_16x16x32_bf16 v[80:83], a[144:147], a[80:83], v[80:83]
 buffer_load_dwordx4 a[120:123], v1, s[4:7], s26 offen offset:2048 sc1
 v_mfma_f32_16x16x32_bf16 v[80:83], a[140:143], a[64:67], v[80:83]
 v_mfma_f32_16x16x32_bf16 v[84:87], a[148:151], a[64:67], v[84:87]
 ds_read_b64_tr_b16 a[136:137], v4 offset:16384
 v_mfma_f32_16x16x32_bf16 v[84:87], a[152:155], a[80:83], v[84:87]
 ds_read_b64_tr_b16 a[138:139], v4 offset:17408
 v_mfma_f32_16x16x32_bf16 v[140:143], a[152:155], a[84:87], v[140:143]
 buffer_load_dwordx4 a[124:127], v1, s[4:7], s26 offen offset:3072 sc1
 v_mfma_f32_16x16x32_bf16 v[140:143], a[148:151], a[68:71], v[140:143]
 s_add_u32 s26, s22, 720896
 v_mfma_f32_16x16x32_bf16 v[196:199], a[148:151], a[72:75], v[196:199]
 ds_read_b64_tr_b16 a[140:141], v4 offset:24576
 v_mfma_f32_16x16x32_bf16 v[196:199], a[152:155], a[88:91], v[196:199]
 ds_read_b64_tr_b16 a[142:143], v4 offset:25600
 s_waitcnt vmcnt(35) lgkmcnt(4)
 v_mfma_f32_16x16x32_bf16 v[252:255], a[152:155], a[92:95], v[252:255]
 v_mfma_f32_16x16x32_bf16 v[252:255], a[148:151], a[76:79], v[252:255]
 v_mfma_f32_16x16x32_bf16 v[200:203], a[128:131], a[12:15], v[200:203]
 ds_read_b64_tr_b16 a[144:145], v5
 s_mov_b32 s23, 20984832
 v_mfma_f32_16x16x32_bf16 v[200:203], a[132:135], a[28:31], v[200:203]
 ds_read_b64_tr_b16 a[146:147], v5 offset:1024
 v_mfma_f32_16x16x32_bf16 v[144:147], a[132:135], a[24:27], v[144:147]
 buffer_load_dwordx4 a[64:67], v2, s[4:7], s23 offen sc1
 v_mfma_f32_16x16x32_bf16 v[144:147], a[128:131], a[8:11], v[144:147]
 v_mfma_f32_16x16x32_bf16 v[88:91], a[128:131], a[4:7], v[88:91]
 ds_read_b64_tr_b16 a[148:149], v5 offset:8192
 v_mfma_f32_16x16x32_bf16 v[88:91], a[132:135], a[20:23], v[88:91]
 ds_read_b64_tr_b16 a[150:151], v5 offset:9216
 s_waitcnt lgkmcnt(4)
 v_mfma_f32_16x16x32_bf16 v[32:35], a[132:135], a[16:19], v[32:35]
 buffer_load_dwordx4 a[68:71], v3, s[4:7], s23 offen sc1
 v_mfma_f32_16x16x32_bf16 v[32:35], a[128:131], a[0:3], v[32:35]
 v_mfma_f32_16x16x32_bf16 v[36:39], a[136:139], a[0:3], v[36:39]
 ds_read_b64_tr_b16 a[152:153], v5 offset:16384
 v_mfma_f32_16x16x32_bf16 v[36:39], a[140:143], a[16:19], v[36:39]
 ds_read_b64_tr_b16 a[154:155], v5 offset:17408
 v_mfma_f32_16x16x32_bf16 v[92:95], a[140:143], a[20:23], v[92:95]
 buffer_load_dwordx4 a[72:75], v12, s[4:7], s23 offen sc1
 v_mfma_f32_16x16x32_bf16 v[92:95], a[136:139], a[4:7], v[92:95]
 v_mfma_f32_16x16x32_bf16 v[148:151], a[136:139], a[8:11], v[148:151]
 ds_read_b64_tr_b16 a[128:129], v5 offset:24576
 v_mfma_f32_16x16x32_bf16 v[148:151], a[140:143], a[24:27], v[148:151]
 ds_read_b64_tr_b16 a[130:131], v5 offset:25600
 s_waitcnt lgkmcnt(4)
 v_mfma_f32_16x16x32_bf16 v[204:207], a[140:143], a[28:31], v[204:207]
 buffer_load_dwordx4 a[76:79], v13, s[4:7], s23 offen sc1
 v_mfma_f32_16x16x32_bf16 v[204:207], a[136:139], a[12:15], v[204:207]
 v_mfma_f32_16x16x32_bf16 v[208:211], a[144:147], a[12:15], v[208:211]
 ds_read_b64_tr_b16 a[132:133], v6
 v_mfma_f32_16x16x32_bf16 v[208:211], a[148:151], a[28:31], v[208:211]
 ds_read_b64_tr_b16 a[134:135], v6 offset:1024
 v_mfma_f32_16x16x32_bf16 v[152:155], a[148:151], a[24:27], v[152:155]
 v_mfma_f32_16x16x32_bf16 v[152:155], a[144:147], a[8:11], v[152:155]
 v_mfma_f32_16x16x32_bf16 v[96:99], a[144:147], a[4:7], v[96:99]
 ds_read_b64_tr_b16 a[136:137], v6 offset:8192
 v_mfma_f32_16x16x32_bf16 v[96:99], a[148:151], a[20:23], v[96:99]
 ds_read_b64_tr_b16 a[138:139], v6 offset:9216
 s_waitcnt lgkmcnt(4)
 v_mfma_f32_16x16x32_bf16 v[40:43], a[148:151], a[16:19], v[40:43]
 buffer_load_dword v28, v14, s[4:7], s30 offen offset:3072 sc1
 v_mfma_f32_16x16x32_bf16 v[40:43], a[144:147], a[0:3], v[40:43]
 v_mfma_f32_16x16x32_bf16 v[44:47], a[152:155], a[0:3], v[44:47]
 ds_read_b64_tr_b16 a[140:141], v6 offset:16384
 v_mfma_f32_16x16x32_bf16 v[44:47], a[128:131], a[16:19], v[44:47]
 ds_read_b64_tr_b16 a[142:143], v6 offset:17408
 v_mfma_f32_16x16x32_bf16 v[100:103], a[128:131], a[20:23], v[100:103]
 buffer_load_dwordx4 a[80:83], v2, s[4:7], s23 offen offset:2048 sc1
 v_mfma_f32_16x16x32_bf16 v[100:103], a[152:155], a[4:7], v[100:103]
 v_mfma_f32_16x16x32_bf16 v[156:159], a[152:155], a[8:11], v[156:159]
 ds_read_b64_tr_b16 a[144:145], v6 offset:24576
 v_mfma_f32_16x16x32_bf16 v[156:159], a[128:131], a[24:27], v[156:159]
 ds_read_b64_tr_b16 a[146:147], v6 offset:25600
 s_waitcnt lgkmcnt(4)
 v_mfma_f32_16x16x32_bf16 v[212:215], a[128:131], a[28:31], v[212:215]
 buffer_load_dwordx4 a[84:87], v3, s[4:7], s23 offen offset:2048 sc1
 v_mfma_f32_16x16x32_bf16 v[212:215], a[152:155], a[12:15], v[212:215]
 v_mfma_f32_16x16x32_bf16 v[216:219], a[132:135], a[12:15], v[216:219]
 ds_read_b64_tr_b16 a[148:149], v7
 v_mfma_f32_16x16x32_bf16 v[216:219], a[136:139], a[28:31], v[216:219]
 ds_read_b64_tr_b16 a[150:151], v7 offset:1024
 v_mfma_f32_16x16x32_bf16 v[160:163], a[136:139], a[24:27], v[160:163]
 buffer_load_dwordx4 a[88:91], v12, s[4:7], s23 offen offset:2048 sc1
 v_mfma_f32_16x16x32_bf16 v[160:163], a[132:135], a[8:11], v[160:163]
 v_mfma_f32_16x16x32_bf16 v[104:107], a[132:135], a[4:7], v[104:107]
 ds_read_b64_tr_b16 a[152:153], v7 offset:8192
 v_mfma_f32_16x16x32_bf16 v[104:107], a[136:139], a[20:23], v[104:107]
 ds_read_b64_tr_b16 a[154:155], v7 offset:9216
 s_waitcnt lgkmcnt(4)
 v_mfma_f32_16x16x32_bf16 v[48:51], a[136:139], a[16:19], v[48:51]
 v_mfma_f32_16x16x32_bf16 v[48:51], a[132:135], a[0:3], v[48:51]
 v_mfma_f32_16x16x32_bf16 v[52:55], a[140:143], a[0:3], v[52:55]
 ds_read_b64_tr_b16 a[128:129], v7 offset:16384
 v_mfma_f32_16x16x32_bf16 v[52:55], a[144:147], a[16:19], v[52:55]
 ds_read_b64_tr_b16 a[130:131], v7 offset:17408
 v_mfma_f32_16x16x32_bf16 v[108:111], a[144:147], a[20:23], v[108:111]
 buffer_load_dwordx4 a[92:95], v13, s[4:7], s23 offen offset:2048 sc1
 v_mfma_f32_16x16x32_bf16 v[108:111], a[140:143], a[4:7], v[108:111]
 s_mov_b32 s21, 3899392
 v_mfma_f32_16x16x32_bf16 v[164:167], a[140:143], a[8:11], v[164:167]
 ds_read_b64_tr_b16 a[132:133], v7 offset:24576
 s_add_u32 m0, s19, 65536
 v_mfma_f32_16x16x32_bf16 v[164:167], a[144:147], a[24:27], v[164:167]
 ds_read_b64_tr_b16 a[134:135], v7 offset:25600
 s_waitcnt lgkmcnt(4)
 v_mfma_f32_16x16x32_bf16 v[220:223], a[144:147], a[28:31], v[220:223]
 buffer_load_dword v29, v14, s[4:7], s30 offen offset:3328 sc1
 v_mfma_f32_16x16x32_bf16 v[220:223], a[140:143], a[12:15], v[220:223]
 v_add_u32 v7, -131072, v7
 v_mfma_f32_16x16x32_bf16 v[224:227], a[148:151], a[12:15], v[224:227]
 ds_read_b64_tr_b16 a[136:137], v4 offset:512
 v_mfma_f32_16x16x32_bf16 v[224:227], a[152:155], a[28:31], v[224:227]
 ds_read_b64_tr_b16 a[138:139], v4 offset:1536
 v_mfma_f32_16x16x32_bf16 v[168:171], a[152:155], a[24:27], v[168:171]
 buffer_load_dwordx4 v8, s[12:15], s21 offen lds
 v_mfma_f32_16x16x32_bf16 v[168:171], a[148:151], a[8:11], v[168:171]
 v_mfma_f32_16x16x32_bf16 v[112:115], a[148:151], a[4:7], v[112:115]
 ds_read_b64_tr_b16 a[140:141], v4 offset:8704
 v_mfma_f32_16x16x32_bf16 v[112:115], a[152:155], a[20:23], v[112:115]
 ds_read_b64_tr_b16 a[142:143], v4 offset:9728
 s_waitcnt lgkmcnt(4)
 v_mfma_f32_16x16x32_bf16 v[56:59], a[152:155], a[16:19], v[56:59]
 v_mfma_f32_16x16x32_bf16 v[56:59], a[148:151], a[0:3], v[56:59]
 v_mfma_f32_16x16x32_bf16 v[60:63], a[128:131], a[0:3], v[60:63]
 ds_read_b64_tr_b16 a[144:145], v4 offset:16896
 v_mfma_f32_16x16x32_bf16 v[60:63], a[132:135], a[16:19], v[60:63]
 ds_read_b64_tr_b16 a[146:147], v4 offset:17920
 v_mfma_f32_16x16x32_bf16 v[116:119], a[132:135], a[20:23], v[116:119]
 buffer_load_dwordx4 v9, s[12:15], s21 offen offset:1024 lds
 v_mfma_f32_16x16x32_bf16 v[116:119], a[128:131], a[4:7], v[116:119]
 v_mfma_f32_16x16x32_bf16 v[172:175], a[128:131], a[8:11], v[172:175]
 ds_read_b64_tr_b16 a[148:149], v4 offset:25088
 v_mfma_f32_16x16x32_bf16 v[172:175], a[132:135], a[24:27], v[172:175]
 ds_read_b64_tr_b16 a[150:151], v4 offset:26112
 s_waitcnt lgkmcnt(4)
 v_mfma_f32_16x16x32_bf16 v[228:231], a[132:135], a[28:31], v[228:231]
 buffer_load_dwordx4 v10, s[12:15], s21 offen offset:2048 lds
 v_mfma_f32_16x16x32_bf16 v[228:231], a[128:131], a[12:15], v[228:231]
 v_add_u32 v4, -131072, v4
 v_mfma_f32_16x16x32_bf16 v[232:235], a[136:139], a[12:15], v[232:235]
 ds_read_b64_tr_b16 a[152:153], v5 offset:512
 v_mfma_f32_16x16x32_bf16 v[232:235], a[140:143], a[28:31], v[232:235]
 ds_read_b64_tr_b16 a[154:155], v5 offset:1536
 v_mfma_f32_16x16x32_bf16 v[176:179], a[140:143], a[24:27], v[176:179]
 buffer_load_dwordx4 v11, s[12:15], s21 offen offset:3072 lds
 v_mfma_f32_16x16x32_bf16 v[176:179], a[136:139], a[8:11], v[176:179]
 s_add_u32 m0, s19, 81920
 v_mfma_f32_16x16x32_bf16 v[120:123], a[136:139], a[4:7], v[120:123]
 ds_read_b64_tr_b16 a[128:129], v5 offset:8704
 v_mfma_f32_16x16x32_bf16 v[120:123], a[140:143], a[20:23], v[120:123]
 ds_read_b64_tr_b16 a[130:131], v5 offset:9728
 s_waitcnt lgkmcnt(4)
 v_mfma_f32_16x16x32_bf16 v[64:67], a[140:143], a[16:19], v[64:67]
 buffer_load_dword v30, v14, s[4:7], s30 offen offset:3584 sc1
 v_mfma_f32_16x16x32_bf16 v[64:67], a[136:139], a[0:3], v[64:67]
 v_mfma_f32_16x16x32_bf16 v[68:71], a[144:147], a[0:3], v[68:71]
 ds_read_b64_tr_b16 a[132:133], v5 offset:16896
 v_mfma_f32_16x16x32_bf16 v[68:71], a[148:151], a[16:19], v[68:71]
 ds_read_b64_tr_b16 a[134:135], v5 offset:17920
 v_mfma_f32_16x16x32_bf16 v[124:127], a[148:151], a[20:23], v[124:127]
 v_mfma_f32_16x16x32_bf16 v[124:127], a[144:147], a[4:7], v[124:127]
 v_mfma_f32_16x16x32_bf16 v[180:183], a[144:147], a[8:11], v[180:183]
 ds_read_b64_tr_b16 a[136:137], v5 offset:25088
 v_mfma_f32_16x16x32_bf16 v[180:183], a[148:151], a[24:27], v[180:183]
 ds_read_b64_tr_b16 a[138:139], v5 offset:26112
 s_waitcnt lgkmcnt(4)
 v_mfma_f32_16x16x32_bf16 v[236:239], a[148:151], a[28:31], v[236:239]
 buffer_load_dwordx4 v8, s[8:11], s21 offen lds
 v_mfma_f32_16x16x32_bf16 v[236:239], a[144:147], a[12:15], v[236:239]
 v_add_u32 v5, -131072, v5
 v_mfma_f32_16x16x32_bf16 v[240:243], a[152:155], a[12:15], v[240:243]
 ds_read_b64_tr_b16 a[140:141], v6 offset:512
 v_mfma_f32_16x16x32_bf16 v[240:243], a[128:131], a[28:31], v[240:243]
 ds_read_b64_tr_b16 a[142:143], v6 offset:1536
 v_mfma_f32_16x16x32_bf16 v[184:187], a[128:131], a[24:27], v[184:187]
 buffer_load_dwordx4 v9, s[8:11], s21 offen offset:1024 lds
 v_mfma_f32_16x16x32_bf16 v[184:187], a[152:155], a[8:11], v[184:187]
 v_mfma_f32_16x16x32_bf16 v[128:131], a[152:155], a[4:7], v[128:131]
 ds_read_b64_tr_b16 a[144:145], v6 offset:8704
 v_mfma_f32_16x16x32_bf16 v[128:131], a[128:131], a[20:23], v[128:131]
 ds_read_b64_tr_b16 a[146:147], v6 offset:9728
 s_waitcnt lgkmcnt(4)
 v_mfma_f32_16x16x32_bf16 v[72:75], a[128:131], a[16:19], v[72:75]
 buffer_load_dwordx4 v10, s[8:11], s21 offen offset:2048 lds
 v_mfma_f32_16x16x32_bf16 v[72:75], a[152:155], a[0:3], v[72:75]
 v_mfma_f32_16x16x32_bf16 v[76:79], a[132:135], a[0:3], v[76:79]
 ds_read_b64_tr_b16 a[148:149], v6 offset:16896
 v_mfma_f32_16x16x32_bf16 v[76:79], a[136:139], a[16:19], v[76:79]
 ds_read_b64_tr_b16 a[150:151], v6 offset:17920
 v_mfma_f32_16x16x32_bf16 v[132:135], a[136:139], a[20:23], v[132:135]
 buffer_load_dwordx4 v11, s[8:11], s21 offen offset:3072 lds
 v_mfma_f32_16x16x32_bf16 v[132:135], a[132:135], a[4:7], v[132:135]
 v_mfma_f32_16x16x32_bf16 v[188:191], a[132:135], a[8:11], v[188:191]
 ds_read_b64_tr_b16 a[152:153], v6 offset:25088
 v_mfma_f32_16x16x32_bf16 v[188:191], a[136:139], a[24:27], v[188:191]
 ds_read_b64_tr_b16 a[154:155], v6 offset:26112
 s_waitcnt lgkmcnt(4)
 v_mfma_f32_16x16x32_bf16 v[244:247], a[136:139], a[28:31], v[244:247]
 v_mfma_f32_16x16x32_bf16 v[244:247], a[132:135], a[12:15], v[244:247]
 v_add_u32 v6, -131072, v6
 v_mfma_f32_16x16x32_bf16 v[248:251], a[140:143], a[12:15], v[248:251]
 s_waitcnt vmcnt(44)
 s_barrier
 ds_read_b64_tr_b16 a[128:129], v4
 v_mfma_f32_16x16x32_bf16 v[248:251], a[144:147], a[28:31], v[248:251]
 ds_read_b64_tr_b16 a[130:131], v4 offset:1024
 v_mfma_f32_16x16x32_bf16 v[192:195], a[144:147], a[24:27], v[192:195]
 buffer_load_dwordx4 a[156:159], v1, s[4:7], s26 offen sc1
 v_mfma_f32_16x16x32_bf16 v[192:195], a[140:143], a[8:11], v[192:195]
 v_mfma_f32_16x16x32_bf16 v[136:139], a[140:143], a[4:7], v[136:139]
 ds_read_b64_tr_b16 a[132:133], v4 offset:8192
 v_mfma_f32_16x16x32_bf16 v[136:139], a[144:147], a[20:23], v[136:139]
 ds_read_b64_tr_b16 a[134:135], v4 offset:9216
 s_waitcnt lgkmcnt(4)
 v_mfma_f32_16x16x32_bf16 v[80:83], a[144:147], a[16:19], v[80:83]
 buffer_load_dwordx4 a[160:163], v1, s[4:7], s26 offen offset:1024 sc1
 v_mfma_f32_16x16x32_bf16 v[80:83], a[140:143], a[0:3], v[80:83]
 v_mfma_f32_16x16x32_bf16 v[84:87], a[148:151], a[0:3], v[84:87]
 ds_read_b64_tr_b16 a[136:137], v4 offset:16384
 v_mfma_f32_16x16x32_bf16 v[84:87], a[152:155], a[16:19], v[84:87]
 ds_read_b64_tr_b16 a[138:139], v4 offset:17408
 v_mfma_f32_16x16x32_bf16 v[140:143], a[152:155], a[20:23], v[140:143]
 buffer_load_dwordx4 a[164:167], v1, s[4:7], s26 offen offset:2048 sc1
 v_mfma_f32_16x16x32_bf16 v[140:143], a[148:151], a[4:7], v[140:143]
 v_mfma_f32_16x16x32_bf16 v[196:199], a[148:151], a[8:11], v[196:199]
 ds_read_b64_tr_b16 a[140:141], v4 offset:24576
 v_mfma_f32_16x16x32_bf16 v[196:199], a[152:155], a[24:27], v[196:199]
 ds_read_b64_tr_b16 a[142:143], v4 offset:25600
 s_waitcnt vmcnt(35) lgkmcnt(4)
 v_mfma_f32_16x16x32_bf16 v[252:255], a[152:155], a[28:31], v[252:255]
 v_mfma_f32_16x16x32_bf16 v[252:255], a[148:151], a[12:15], v[252:255]
 v_mfma_f32_16x16x32_bf16 v[200:203], a[128:131], a[44:47], v[200:203]
 ds_read_b64_tr_b16 a[144:145], v5
 s_mov_b32 s23, 20988928
 v_mfma_f32_16x16x32_bf16 v[200:203], a[132:135], a[60:63], v[200:203]
 ds_read_b64_tr_b16 a[146:147], v5 offset:1024
 v_mfma_f32_16x16x32_bf16 v[144:147], a[132:135], a[56:59], v[144:147]
 buffer_load_dwordx4 a[0:3], v2, s[4:7], s23 offen sc1
 v_mfma_f32_16x16x32_bf16 v[144:147], a[128:131], a[40:43], v[144:147]
 v_mfma_f32_16x16x32_bf16 v[88:91], a[128:131], a[36:39], v[88:91]
 ds_read_b64_tr_b16 a[148:149], v5 offset:8192
 v_mfma_f32_16x16x32_bf16 v[88:91], a[132:135], a[52:55], v[88:91]
 ds_read_b64_tr_b16 a[150:151], v5 offset:9216
 s_waitcnt lgkmcnt(4)
 v_mfma_f32_16x16x32_bf16 v[32:35], a[132:135], a[48:51], v[32:35]
 buffer_load_dwordx4 a[4:7], v3, s[4:7], s23 offen sc1
 v_mfma_f32_16x16x32_bf16 v[32:35], a[128:131], a[32:35], v[32:35]
 v_mfma_f32_16x16x32_bf16 v[36:39], a[136:139], a[32:35], v[36:39]
 ds_read_b64_tr_b16 a[152:153], v5 offset:16384
 v_mfma_f32_16x16x32_bf16 v[36:39], a[140:143], a[48:51], v[36:39]
 ds_read_b64_tr_b16 a[154:155], v5 offset:17408
 v_mfma_f32_16x16x32_bf16 v[92:95], a[140:143], a[52:55], v[92:95]
 buffer_load_dwordx4 a[8:11], v12, s[4:7], s23 offen sc1
 v_mfma_f32_16x16x32_bf16 v[92:95], a[136:139], a[36:39], v[92:95]
 v_mfma_f32_16x16x32_bf16 v[148:151], a[136:139], a[40:43], v[148:151]
 ds_read_b64_tr_b16 a[128:129], v5 offset:24576
 v_mfma_f32_16x16x32_bf16 v[148:151], a[140:143], a[56:59], v[148:151]
 ds_read_b64_tr_b16 a[130:131], v5 offset:25600
 s_waitcnt lgkmcnt(4)
 v_mfma_f32_16x16x32_bf16 v[204:207], a[140:143], a[60:63], v[204:207]
 v_mfma_f32_16x16x32_bf16 v[204:207], a[136:139], a[44:47], v[204:207]
 v_mfma_f32_16x16x32_bf16 v[208:211], a[144:147], a[44:47], v[208:211]
 ds_read_b64_tr_b16 a[132:133], v6
 v_mfma_f32_16x16x32_bf16 v[208:211], a[148:151], a[60:63], v[208:211]
 ds_read_b64_tr_b16 a[134:135], v6 offset:1024
 v_mfma_f32_16x16x32_bf16 v[152:155], a[148:151], a[56:59], v[152:155]
 buffer_load_dwordx4 a[12:15], v13, s[4:7], s23 offen sc1
 v_mfma_f32_16x16x32_bf16 v[152:155], a[144:147], a[40:43], v[152:155]
 v_mfma_f32_16x16x32_bf16 v[96:99], a[144:147], a[36:39], v[96:99]
 ds_read_b64_tr_b16 a[136:137], v6 offset:8192
 v_mfma_f32_16x16x32_bf16 v[96:99], a[148:151], a[52:55], v[96:99]
 ds_read_b64_tr_b16 a[138:139], v6 offset:9216
 s_waitcnt lgkmcnt(4)
 v_mfma_f32_16x16x32_bf16 v[40:43], a[148:151], a[48:51], v[40:43]
 buffer_load_dwordx4 a[16:19], v2, s[4:7], s23 offen offset:2048 sc1
 v_mfma_f32_16x16x32_bf16 v[40:43], a[144:147], a[32:35], v[40:43]
 v_mfma_f32_16x16x32_bf16 v[44:47], a[152:155], a[32:35], v[44:47]
 ds_read_b64_tr_b16 a[140:141], v6 offset:16384
 v_mfma_f32_16x16x32_bf16 v[44:47], a[128:131], a[48:51], v[44:47]
 ds_read_b64_tr_b16 a[142:143], v6 offset:17408
 v_mfma_f32_16x16x32_bf16 v[100:103], a[128:131], a[52:55], v[100:103]
 v_mfma_f32_16x16x32_bf16 v[100:103], a[152:155], a[36:39], v[100:103]
 v_mfma_f32_16x16x32_bf16 v[156:159], a[152:155], a[40:43], v[156:159]
 ds_read_b64_tr_b16 a[144:145], v6 offset:24576
 v_mfma_f32_16x16x32_bf16 v[156:159], a[128:131], a[56:59], v[156:159]
 ds_read_b64_tr_b16 a[146:147], v6 offset:25600
 s_waitcnt lgkmcnt(4)
 v_mfma_f32_16x16x32_bf16 v[212:215], a[128:131], a[60:63], v[212:215]
 buffer_load_dword v31, v14, s[4:7], s30 offen offset:3840 sc1
 v_mfma_f32_16x16x32_bf16 v[212:215], a[152:155], a[44:47], v[212:215]
 v_mfma_f32_16x16x32_bf16 v[216:219], a[132:135], a[44:47], v[216:219]
 ds_read_b64_tr_b16 a[148:149], v7
 v_mfma_f32_16x16x32_bf16 v[216:219], a[136:139], a[60:63], v[216:219]
 ds_read_b64_tr_b16 a[150:151], v7 offset:1024
 v_mfma_f32_16x16x32_bf16 v[160:163], a[136:139], a[56:59], v[160:163]
 buffer_load_dwordx4 a[20:23], v3, s[4:7], s23 offen offset:2048 sc1
 v_mfma_f32_16x16x32_bf16 v[160:163], a[132:135], a[40:43], v[160:163]
 v_mfma_f32_16x16x32_bf16 v[104:107], a[132:135], a[36:39], v[104:107]
 ds_read_b64_tr_b16 a[152:153], v7 offset:8192
 v_mfma_f32_16x16x32_bf16 v[104:107], a[136:139], a[52:55], v[104:107]
 ds_read_b64_tr_b16 a[154:155], v7 offset:9216
 s_waitcnt lgkmcnt(4)
 v_mfma_f32_16x16x32_bf16 v[48:51], a[136:139], a[48:51], v[48:51]
 buffer_load_dwordx4 a[24:27], v12, s[4:7], s23 offen offset:2048 sc1
 v_mfma_f32_16x16x32_bf16 v[48:51], a[132:135], a[32:35], v[48:51]
 v_mfma_f32_16x16x32_bf16 v[52:55], a[140:143], a[32:35], v[52:55]
 ds_read_b64_tr_b16 a[128:129], v7 offset:16384
 v_mfma_f32_16x16x32_bf16 v[52:55], a[144:147], a[48:51], v[52:55]
 ds_read_b64_tr_b16 a[130:131], v7 offset:17408
 v_mfma_f32_16x16x32_bf16 v[108:111], a[144:147], a[52:55], v[108:111]
 v_mfma_f32_16x16x32_bf16 v[108:111], a[140:143], a[36:39], v[108:111]
 v_mfma_f32_16x16x32_bf16 v[164:167], a[140:143], a[40:43], v[164:167]
 ds_read_b64_tr_b16 a[132:133], v7 offset:24576
 v_mfma_f32_16x16x32_bf16 v[164:167], a[144:147], a[56:59], v[164:167]
 ds_read_b64_tr_b16 a[134:135], v7 offset:25600
 s_waitcnt lgkmcnt(4)
 v_mfma_f32_16x16x32_bf16 v[220:223], a[144:147], a[60:63], v[220:223]
 buffer_load_dwordx4 a[28:31], v13, s[4:7], s23 offen offset:2048 sc1
 v_mfma_f32_16x16x32_bf16 v[220:223], a[140:143], a[44:47], v[220:223]
 s_mov_b32 s21, 4816896
 v_mfma_f32_16x16x32_bf16 v[224:227], a[148:151], a[44:47], v[224:227]
 ds_read_b64_tr_b16 a[136:137], v4 offset:512
 s_add_u32 m0, s19, 98304
 v_mfma_f32_16x16x32_bf16 v[224:227], a[152:155], a[60:63], v[224:227]
 ds_read_b64_tr_b16 a[138:139], v4 offset:1536
 v_mfma_f32_16x16x32_bf16 v[168:171], a[152:155], a[56:59], v[168:171]
 buffer_load_dwordx4 v8, s[12:15], s21 offen lds
 v_mfma_f32_16x16x32_bf16 v[168:171], a[148:151], a[40:43], v[168:171]
 v_mfma_f32_16x16x32_bf16 v[112:115], a[148:151], a[36:39], v[112:115]
L_hop_15:
 s_cbranch_execz L_ret_5
 ds_read_b64_tr_b16 a[140:141], v4 offset:8704
 v_mfma_f32_16x16x32_bf16 v[112:115], a[152:155], a[52:55], v[112:115]
 ds_read_b64_tr_b16 a[142:143], v4 offset:9728
 s_waitcnt lgkmcnt(4)
 v_mfma_f32_16x16x32_bf16 v[56:59], a[152:155], a[48:51], v[56:59]
 v_mfma_f32_16x16x32_bf16 v[56:59], a[148:151], a[32:35], v[56:59]
 v_mfma_f32_16x16x32_bf16 v[60:63], a[128:131], a[32:35], v[60:63]
 ds_read_b64_tr_b16 a[144:145], v4 offset:16896
 v_mfma_f32_16x16x32_bf16 v[60:63], a[132:135], a[48:51], v[60:63]
 ds_read_b64_tr_b16 a[146:147], v4 offset:17920
 v_mfma_f32_16x16x32_bf16 v[116:119], a[132:135], a[52:55], v[116:119]
 buffer_load_dwordx4 v9, s[12:15], s21 offen offset:1024 lds
 v_mfma_f32_16x16x32_bf16 v[116:119], a[128:131], a[36:39], v[116:119]
 v_mfma_f32_16x16x32_bf16 v[172:175], a[128:131], a[40:43], v[172:175]
 ds_read_b64_tr_b16 a[148:149], v4 offset:25088
 v_mfma_f32_16x16x32_bf16 v[172:175], a[132:135], a[56:59], v[172:175]
 ds_read_b64_tr_b16 a[150:151], v4 offset:26112
 s_waitcnt lgkmcnt(4)
 v_mfma_f32_16x16x32_bf16 v[228:231], a[132:135], a[60:63], v[228:231]
 buffer_load_dwordx4 v10, s[12:15], s21 offen offset:2048 lds
 v_mfma_f32_16x16x32_bf16 v[228:231], a[128:131], a[44:47], v[228:231]
 v_mfma_f32_16x16x32_bf16 v[232:235], a[136:139], a[44:47], v[232:235]
 ds_read_b64_tr_b16 a[152:153], v5 offset:512
 v_mfma_f32_16x16x32_bf16 v[232:235], a[140:143], a[60:63], v[232:235]
 ds_read_b64_tr_b16 a[154:155], v5 offset:1536
 v_mfma_f32_16x16x32_bf16 v[176:179], a[140:143], a[56:59], v[176:179]
 buffer_load_dwordx4 v11, s[12:15], s21 offen offset:3072 lds
 v_mfma_f32_16x16x32_bf16 v[176:179], a[136:139], a[40:43], v[176:179]
 s_add_u32 m0, s19, 114688
 v_mfma_f32_16x16x32_bf16 v[120:123], a[136:139], a[36:39], v[120:123]
 ds_read_b64_tr_b16 a[128:129], v5 offset:8704
 v_mfma_f32_16x16x32_bf16 v[120:123], a[140:143], a[52:55], v[120:123]
 ds_read_b64_tr_b16 a[130:131], v5 offset:9728
 s_waitcnt lgkmcnt(4)
 v_mfma_f32_16x16x32_bf16 v[64:67], a[140:143], a[48:51], v[64:67]
 v_mfma_f32_16x16x32_bf16 v[64:67], a[136:139], a[32:35], v[64:67]
 v_mfma_f32_16x16x32_bf16 v[68:71], a[144:147], a[32:35], v[68:71]
 ds_read_b64_tr_b16 a[132:133], v5 offset:16896
 v_mfma_f32_16x16x32_bf16 v[68:71], a[148:151], a[48:51], v[68:71]
 ds_read_b64_tr_b16 a[134:135], v5 offset:17920
 v_mfma_f32_16x16x32_bf16 v[124:127], a[148:151], a[52:55], v[124:127]
 buffer_load_dwordx4 v8, s[8:11], s21 offen lds
 v_mfma_f32_16x16x32_bf16 v[124:127], a[144:147], a[36:39], v[124:127]
 v_mfma_f32_16x16x32_bf16 v[180:183], a[144:147], a[40:43], v[180:183]
 ds_read_b64_tr_b16 a[136:137], v5 offset:25088
 v_mfma_f32_16x16x32_bf16 v[180:183], a[148:151], a[56:59], v[180:183]
 ds_read_b64_tr_b16 a[138:139], v5 offset:26112
 s_waitcnt lgkmcnt(4)
 v_mfma_f32_16x16x32_bf16 v[236:239], a[148:151], a[60:63], v[236:239]
 buffer_load_dwordx4 v9, s[8:11], s21 offen offset:1024 lds
 v_mfma_f32_16x16x32_bf16 v[236:239], a[144:147], a[44:47], v[236:239]
 v_mfma_f32_16x16x32_bf16 v[240:243], a[152:155], a[44:47], v[240:243]
 ds_read_b64_tr_b16 a[140:141], v6 offset:512
 v_mfma_f32_16x16x32_bf16 v[240:243], a[128:131], a[60:63], v[240:243]
 ds_read_b64_tr_b16 a[142:143], v6 offset:1536
 v_mfma_f32_16x16x32_bf16 v[184:187], a[128:131], a[56:59], v[184:187]
 v_mfma_f32_16x16x32_bf16 v[184:187], a[152:155], a[40:43], v[184:187]
 v_mfma_f32_16x16x32_bf16 v[128:131], a[152:155], a[36:39], v[128:131]
 ds_read_b64_tr_b16 a[144:145], v6 offset:8704
 v_mfma_f32_16x16x32_bf16 v[128:131], a[128:131], a[52:55], v[128:131]
 ds_read_b64_tr_b16 a[146:147], v6 offset:9728
 s_waitcnt lgkmcnt(4)
 v_mfma_f32_16x16x32_bf16 v[72:75], a[128:131], a[48:51], v[72:75]
 buffer_load_dwordx4 v10, s[8:11], s21 offen offset:2048 lds
 v_mfma_f32_16x16x32_bf16 v[72:75], a[152:155], a[32:35], v[72:75]
 v_mfma_f32_16x16x32_bf16 v[76:79], a[132:135], a[32:35], v[76:79]
 ds_read_b64_tr_b16 a[148:149], v6 offset:16896
 v_mfma_f32_16x16x32_bf16 v[76:79], a[136:139], a[48:51], v[76:79]
 ds_read_b64_tr_b16 a[150:151], v6 offset:17920
 v_mfma_f32_16x16x32_bf16 v[132:135], a[136:139], a[52:55], v[132:135]
 buffer_load_dwordx4 v11, s[8:11], s21 offen offset:3072 lds
 v_mfma_f32_16x16x32_bf16 v[132:135], a[132:135], a[36:39], v[132:135]
 v_mfma_f32_16x16x32_bf16 v[188:191], a[132:135], a[40:43], v[188:191]
 ds_read_b64_tr_b16 a[152:153], v6 offset:25088
 v_mfma_f32_16x16x32_bf16 v[188:191], a[136:139], a[56:59], v[188:191]
 ds_read_b64_tr_b16 a[154:155], v6 offset:26112
 s_waitcnt lgkmcnt(4)
 v_mfma_f32_16x16x32_bf16 v[244:247], a[136:139], a[60:63], v[244:247]
 buffer_load_dwordx4 a[168:171], v1, s[4:7], s26 offen offset:3072 sc1
 v_mfma_f32_16x16x32_bf16 v[244:247], a[132:135], a[44:47], v[244:247]
 s_add_u32 s26, s22, 983040
 v_mfma_f32_16x16x32_bf16 v[248:251], a[140:143], a[44:47], v[248:251]
 s_waitcnt vmcnt(43)
 s_barrier
 ds_read_b64_tr_b16 a[128:129], v4 offset:32768
 v_mfma_f32_16x16x32_bf16 v[248:251], a[144:147], a[60:63], v[248:251]
 ds_read_b64_tr_b16 a[130:131], v4 offset:33792
 v_mfma_f32_16x16x32_bf16 v[192:195], a[144:147], a[56:59], v[192:195]
 v_mfma_f32_16x16x32_bf16 v[192:195], a[140:143], a[40:43], v[192:195]
 v_mfma_f32_16x16x32_bf16 v[136:139], a[140:143], a[36:39], v[136:139]
 ds_read_b64_tr_b16 a[132:133], v4 offset:40960
 v_mfma_f32_16x16x32_bf16 v[136:139], a[144:147], a[52:55], v[136:139]
 ds_read_b64_tr_b16 a[134:135], v4 offset:41984
 s_waitcnt lgkmcnt(4)
 v_mfma_f32_16x16x32_bf16 v[80:83], a[144:147], a[48:51], v[80:83]
 buffer_load_dwordx4 a[172:175], v1, s[4:7], s26 offen sc1
 v_mfma_f32_16x16x32_bf16 v[80:83], a[140:143], a[32:35], v[80:83]
 v_mfma_f32_16x16x32_bf16 v[84:87], a[148:151], a[32:35], v[84:87]
 ds_read_b64_tr_b16 a[136:137], v4 offset:49152
 v_mfma_f32_16x16x32_bf16 v[84:87], a[152:155], a[48:51], v[84:87]
 ds_read_b64_tr_b16 a[138:139], v4 offset:50176
 v_mfma_f32_16x16x32_bf16 v[140:143], a[152:155], a[52:55], v[140:143]
 buffer_load_dwordx4 a[176:179], v1, s[4:7], s26 offen offset:1024 sc1
 v_mfma_f32_16x16x32_bf16 v[140:143], a[148:151], a[36:39], v[140:143]
 v_mfma_f32_16x16x32_bf16 v[196:199], a[148:151], a[40:43], v[196:199]
 ds_read_b64_tr_b16 a[140:141], v4 offset:57344
 v_mfma_f32_16x16x32_bf16 v[196:199], a[152:155], a[56:59], v[196:199]
 ds_read_b64_tr_b16 a[142:143], v4 offset:58368
 s_waitcnt vmcnt(33) lgkmcnt(4)
 v_mfma_f32_16x16x32_bf16 v[252:255], a[152:155], a[60:63], v[252:255]
 v_mfma_f32_16x16x32_bf16 v[252:255], a[148:151], a[44:47], v[252:255]
 v_mfma_f32_16x16x32_bf16 v[200:203], a[128:131], a[76:79], v[200:203]
 ds_read_b64_tr_b16 a[144:145], v5 offset:32768
 s_mov_b32 s23, 20993024
 v_mfma_f32_16x16x32_bf16 v[200:203], a[132:135], a[92:95], v[200:203]
 ds_read_b64_tr_b16 a[146:147], v5 offset:33792
 v_mfma_f32_16x16x32_bf16 v[144:147], a[132:135], a[88:91], v[144:147]
 buffer_load_dwordx4 a[32:35], v2, s[4:7], s23 offen sc1
 v_mfma_f32_16x16x32_bf16 v[144:147], a[128:131], a[72:75], v[144:147]
 v_mfma_f32_16x16x32_bf16 v[88:91], a[128:131], a[68:71], v[88:91]
 ds_read_b64_tr_b16 a[148:149], v5 offset:40960
 v_mfma_f32_16x16x32_bf16 v[88:91], a[132:135], a[84:87], v[88:91]
 ds_read_b64_tr_b16 a[150:151], v5 offset:41984
 s_waitcnt lgkmcnt(4)
 v_mfma_f32_16x16x32_bf16 v[32:35], a[132:135], a[80:83], v[32:35]
 buffer_load_dwordx4 a[36:39], v3, s[4:7], s23 offen sc1
 v_mfma_f32_16x16x32_bf16 v[32:35], a[128:131], a[64:67], v[32:35]
 v_mfma_f32_16x16x32_bf16 v[36:39], a[136:139], a[64:67], v[36:39]
 ds_read_b64_tr_b16 a[152:153], v5 offset:49152
 v_mfma_f32_16x16x32_bf16 v[36:39], a[140:143], a[80:83], v[36:39]
 ds_read_b64_tr_b16 a[154:155], v5 offset:50176
 v_mfma_f32_16x16x32_bf16 v[92:95], a[140:143], a[84:87], v[92:95]
 buffer_load_dwordx4 a[40:43], v12, s[4:7], s23 offen sc1
 v_mfma_f32_16x16x32_bf16 v[92:95], a[136:139], a[68:71], v[92:95]
 v_mfma_f32_16x16x32_bf16 v[148:151], a[136:139], a[72:75], v[148:151]
 ds_read_b64_tr_b16 a[128:129], v5 offset:57344
 v_mfma_f32_16x16x32_bf16 v[148:151], a[140:143], a[88:91], v[148:151]
 ds_read_b64_tr_b16 a[130:131], v5 offset:58368
 s_waitcnt lgkmcnt(4)
 v_mfma_f32_16x16x32_bf16 v[204:207], a[140:143], a[92:95], v[204:207]
 v_mfma_f32_16x16x32_bf16 v[204:207], a[136:139], a[76:79], v[204:207]
 v_mfma_f32_16x16x32_bf16 v[208:211], a[144:147], a[76:79], v[208:211]
 ds_read_b64_tr_b16 a[132:133], v6 offset:32768
 v_mfma_f32_16x16x32_bf16 v[208:211], a[148:151], a[92:95], v[208:211]
 ds_read_b64_tr_b16 a[134:135], v6 offset:33792
 v_mfma_f32_16x16x32_bf16 v[152:155], a[148:151], a[88:91], v[152:155]
 buffer_load_dwordx4 a[44:47], v13, s[4:7], s23 offen sc1
 v_mfma_f32_16x16x32_bf16 v[152:155], a[144:147], a[72:75], v[152:155]
 v_mfma_f32_16x16x32_bf16 v[96:99], a[144:147], a[68:71], v[96:99]
 ds_read_b64_tr_b16 a[136:137], v6 offset:40960
 v_mfma_f32_16x16x32_bf16 v[96:99], a[148:151], a[84:87], v[96:99]
 ds_read_b64_tr_b16 a[138:139], v6 offset:41984
 s_waitcnt lgkmcnt(4)
 v_mfma_f32_16x16x32_bf16 v[40:43], a[148:151], a[80:83], v[40:43]
 buffer_load_dwordx4 a[48:51], v2, s[4:7], s23 offen offset:2048 sc1
 v_mfma_f32_16x16x32_bf16 v[40:43], a[144:147], a[64:67], v[40:43]
 v_mfma_f32_16x16x32_bf16 v[44:47], a[152:155], a[64:67], v[44:47]
 ds_read_b64_tr_b16 a[140:141], v6 offset:49152
 v_mfma_f32_16x16x32_bf16 v[44:47], a[128:131], a[80:83], v[44:47]
 ds_read_b64_tr_b16 a[142:143], v6 offset:50176
 v_mfma_f32_16x16x32_bf16 v[100:103], a[128:131], a[84:87], v[100:103]
 v_mfma_f32_16x16x32_bf16 v[100:103], a[152:155], a[68:71], v[100:103]
 v_mfma_f32_16x16x32_bf16 v[156:159], a[152:155], a[72:75], v[156:159]
 ds_read_b64_tr_b16 a[144:145], v6 offset:57344
 v_mfma_f32_16x16x32_bf16 v[156:159], a[128:131], a[88:91], v[156:159]
 ds_read_b64_tr_b16 a[146:147], v6 offset:58368
 s_waitcnt lgkmcnt(4)
 v_mfma_f32_16x16x32_bf16 v[212:215], a[128:131], a[92:95], v[212:215]
 buffer_load_dwordx4 a[52:55], v3, s[4:7], s23 offen offset:2048 sc1
 v_mfma_f32_16x16x32_bf16 v[212:215], a[152:155], a[76:79], v[212:215]
 v_mfma_f32_16x16x32_bf16 v[216:219], a[132:135], a[76:79], v[216:219]
 ds_read_b64_tr_b16 a[148:149], v7 offset:32768
 v_mfma_f32_16x16x32_bf16 v[216:219], a[136:139], a[92:95], v[216:219]
 ds_read_b64_tr_b16 a[150:151], v7 offset:33792
 v_mfma_f32_16x16x32_bf16 v[160:163], a[136:139], a[88:91], v[160:163]
 buffer_load_dwordx4 a[56:59], v12, s[4:7], s23 offen offset:2048 sc1
 v_mfma_f32_16x16x32_bf16 v[160:163], a[132:135], a[72:75], v[160:163]
 v_mfma_f32_16x16x32_bf16 v[104:107], a[132:135], a[68:71], v[104:107]
 ds_read_b64_tr_b16 a[152:153], v7 offset:40960
 v_mfma_f32_16x16x32_bf16 v[104:107], a[136:139], a[84:87], v[104:107]
 ds_read_b64_tr_b16 a[154:155], v7 offset:41984
 s_waitcnt lgkmcnt(4)
 v_mfma_f32_16x16x32_bf16 v[48:51], a[136:139], a[80:83], v[48:51]
 v_mfma_f32_16x16x32_bf16 v[48:51], a[132:135], a[64:67], v[48:51]
 v_mfma_f32_16x16x32_bf16 v[52:55], a[140:143], a[64:67], v[52:55]
 ds_read_b64_tr_b16 a[128:129], v7 offset:49152
 v_mfma_f32_16x16x32_bf16 v[52:55], a[144:147], a[80:83], v[52:55]
 ds_read_b64_tr_b16 a[130:131], v7 offset:50176
 v_mfma_f32_16x16x32_bf16 v[108:111], a[144:147], a[84:87], v[108:111]
 buffer_load_dwordx4 a[60:63], v13, s[4:7], s23 offen offset:2048 sc1
 v_mfma_f32_16x16x32_bf16 v[108:111], a[140:143], a[68:71], v[108:111]
 s_mov_b32 s21, 5734400
 v_mfma_f32_16x16x32_bf16 v[164:167], a[140:143], a[72:75], v[164:167]
 ds_read_b64_tr_b16 a[132:133], v7 offset:57344
 s_add_u32 m0, s19, 131072
 v_mfma_f32_16x16x32_bf16 v[164:167], a[144:147], a[88:91], v[164:167]
 ds_read_b64_tr_b16 a[134:135], v7 offset:58368
 s_waitcnt lgkmcnt(4)
 v_mfma_f32_16x16x32_bf16 v[220:223], a[144:147], a[92:95], v[220:223]
 buffer_load_dwordx4 v8, s[12:15], s21 offen lds
 v_mfma_f32_16x16x32_bf16 v[220:223], a[140:143], a[76:79], v[220:223]
 v_add_u32 v7, 65536, v7
 v_mfma_f32_16x16x32_bf16 v[224:227], a[148:151], a[76:79], v[224:227]
 ds_read_b64_tr_b16 a[136:137], v4 offset:33280
 v_mfma_f32_16x16x32_bf16 v[224:227], a[152:155], a[92:95], v[224:227]
 ds_read_b64_tr_b16 a[138:139], v4 offset:34304
 v_mfma_f32_16x16x32_bf16 v[168:171], a[152:155], a[88:91], v[168:171]
 v_mfma_f32_16x16x32_bf16 v[168:171], a[148:151], a[72:75], v[168:171]
 v_mfma_f32_16x16x32_bf16 v[112:115], a[148:151], a[68:71], v[112:115]
 ds_read_b64_tr_b16 a[140:141], v4 offset:41472
 v_mfma_f32_16x16x32_bf16 v[112:115], a[152:155], a[84:87], v[112:115]
 ds_read_b64_tr_b16 a[142:143], v4 offset:42496
 s_waitcnt lgkmcnt(4)
 v_mfma_f32_16x16x32_bf16 v[56:59], a[152:155], a[80:83], v[56:59]
 buffer_load_dwordx4 v9, s[12:15], s21 offen offset:1024 lds
 v_mfma_f32_16x16x32_bf16 v[56:59], a[148:151], a[64:67], v[56:59]
 v_mfma_f32_16x16x32_bf16 v[60:63], a[128:131], a[64:67], v[60:63]
 ds_read_b64_tr_b16 a[144:145], v4 offset:49664
 v_mfma_f32_16x16x32_bf16 v[60:63], a[132:135], a[80:83], v[60:63]
 ds_read_b64_tr_b16 a[146:147], v4 offset:50688
 v_mfma_f32_16x16x32_bf16 v[116:119], a[132:135], a[84:87], v[116:119]
 buffer_load_dwordx4 v10, s[12:15], s21 offen offset:2048 lds
 v_mfma_f32_16x16x32_bf16 v[116:119], a[128:131], a[68:71], v[116:119]
 v_mfma_f32_16x16x32_bf16 v[172:175], a[128:131], a[72:75], v[172:175]
 ds_read_b64_tr_b16 a[148:149], v4 offset:57856
 v_mfma_f32_16x16x32_bf16 v[172:175], a[132:135], a[88:91], v[172:175]
 ds_read_b64_tr_b16 a[150:151], v4 offset:58880
 s_waitcnt lgkmcnt(4)
 v_mfma_f32_16x16x32_bf16 v[228:231], a[132:135], a[92:95], v[228:231]
 v_mfma_f32_16x16x32_bf16 v[228:231], a[128:131], a[76:79], v[228:231]
 v_add_u32 v4, 65536, v4
 v_mfma_f32_16x16x32_bf16 v[232:235], a[136:139], a[76:79], v[232:235]
 ds_read_b64_tr_b16 a[152:153], v5 offset:33280
 v_mfma_f32_16x16x32_bf16 v[232:235], a[140:143], a[92:95], v[232:235]
 ds_read_b64_tr_b16 a[154:155], v5 offset:34304
 v_mfma_f32_16x16x32_bf16 v[176:179], a[140:143], a[88:91], v[176:179]
 buffer_load_dwordx4 v11, s[12:15], s21 offen offset:3072 lds
 v_mfma_f32_16x16x32_bf16 v[176:179], a[136:139], a[72:75], v[176:179]
 s_add_u32 m0, s19, 147456
 v_mfma_f32_16x16x32_bf16 v[120:123], a[136:139], a[68:71], v[120:123]
 ds_read_b64_tr_b16 a[128:129], v5 offset:41472
 v_mfma_f32_16x16x32_bf16 v[120:123], a[140:143], a[84:87], v[120:123]
 ds_read_b64_tr_b16 a[130:131], v5 offset:42496
 s_waitcnt lgkmcnt(4)
 v_mfma_f32_16x16x32_bf16 v[64:67], a[140:143], a[80:83], v[64:67]
 buffer_load_dwordx4 v8, s[8:11], s21 offen lds
 v_mfma_f32_16x16x32_bf16 v[64:67], a[136:139], a[64:67], v[64:67]
 v_mfma_f32_16x16x32_bf16 v[68:71], a[144:147], a[64:67], v[68:71]
 ds_read_b64_tr_b16 a[132:133], v5 offset:49664
 v_mfma_f32_16x16x32_bf16 v[68:71], a[148:151], a[80:83], v[68:71]
 ds_read_b64_tr_b16 a[134:135], v5 offset:50688
 v_mfma_f32_16x16x32_bf16 v[124:127], a[148:151], a[84:87], v[124:127]
 v_mfma_f32_16x16x32_bf16 v[124:127], a[144:147], a[68:71], v[124:127]
 v_mfma_f32_16x16x32_bf16 v[180:183], a[144:147], a[72:75], v[180:183]
 ds_read_b64_tr_b16 a[136:137], v5 offset:57856
 v_mfma_f32_16x16x32_bf16 v[180:183], a[148:151], a[88:91], v[180:183]
 ds_read_b64_tr_b16 a[138:139], v5 offset:58880
 s_waitcnt lgkmcnt(4)
 v_mfma_f32_16x16x32_bf16 v[236:239], a[148:151], a[92:95], v[236:239]
 buffer_load_dwordx4 v9, s[8:11], s21 offen offset:1024 lds
 v_mfma_f32_16x16x32_bf16 v[236:239], a[144:147], a[76:79], v[236:239]
 v_add_u32 v5, 65536, v5
 v_mfma_f32_16x16x32_bf16 v[240:243], a[152:155], a[76:79], v[240:243]
 ds_read_b64_tr_b16 a[140:141], v6 offset:33280
 v_mfma_f32_16x16x32_bf16 v[240:243], a[128:131], a[92:95], v[240:243]
 ds_read_b64_tr_b16 a[142:143], v6 offset:34304
 v_mfma_f32_16x16x32_bf16 v[184:187], a[128:131], a[88:91], v[184:187]
 buffer_load_dwordx4 v10, s[8:11], s21 offen offset:2048 lds
 v_mfma_f32_16x16x32_bf16 v[184:187], a[152:155], a[72:75], v[184:187]
 v_mfma_f32_16x16x32_bf16 v[128:131], a[152:155], a[68:71], v[128:131]
 ds_read_b64_tr_b16 a[144:145], v6 offset:41472
 v_mfma_f32_16x16x32_bf16 v[128:131], a[128:131], a[84:87], v[128:131]
 ds_read_b64_tr_b16 a[146:147], v6 offset:42496
 s_waitcnt lgkmcnt(4)
 v_mfma_f32_16x16x32_bf16 v[72:75], a[128:131], a[80:83], v[72:75]
 v_mfma_f32_16x16x32_bf16 v[72:75], a[152:155], a[64:67], v[72:75]
 v_mfma_f32_16x16x32_bf16 v[76:79], a[132:135], a[64:67], v[76:79]
 ds_read_b64_tr_b16 a[148:149], v6 offset:49664
 v_mfma_f32_16x16x32_bf16 v[76:79], a[136:139], a[80:83], v[76:79]
 ds_read_b64_tr_b16 a[150:151], v6 offset:50688
 v_mfma_f32_16x16x32_bf16 v[132:135], a[136:139], a[84:87], v[132:135]
 buffer_load_dwordx4 v11, s[8:11], s21 offen offset:3072 lds
 v_mfma_f32_16x16x32_bf16 v[132:135], a[132:135], a[68:71], v[132:135]
 v_mfma_f32_16x16x32_bf16 v[188:191], a[132:135], a[72:75], v[188:191]
 ds_read_b64_tr_b16 a[152:153], v6 offset:57856
 v_mfma_f32_16x16x32_bf16 v[188:191], a[136:139], a[88:91], v[188:191]
 ds_read_b64_tr_b16 a[154:155], v6 offset:58880
 s_waitcnt lgkmcnt(4)
 v_mfma_f32_16x16x32_bf16 v[244:247], a[136:139], a[92:95], v[244:247]
 buffer_load_dwordx4 a[180:183], v1, s[4:7], s26 offen offset:2048 sc1
 v_mfma_f32_16x16x32_bf16 v[244:247], a[132:135], a[76:79], v[244:247]
 v_add_u32 v6, 65536, v6
 v_mfma_f32_16x16x32_bf16 v[248:251], a[140:143], a[76:79], v[248:251]
 s_waitcnt vmcnt(40)
 s_barrier
 ds_read_b64_tr_b16 a[128:129], v4
 v_mfma_f32_16x16x32_bf16 v[248:251], a[144:147], a[92:95], v[248:251]
 ds_read_b64_tr_b16 a[130:131], v4 offset:1024
 v_mfma_f32_16x16x32_bf16 v[192:195], a[144:147], a[88:91], v[192:195]
 v_mfma_f32_16x16x32_bf16 v[192:195], a[140:143], a[72:75], v[192:195]
 v_mfma_f32_16x16x32_bf16 v[136:139], a[140:143], a[68:71], v[136:139]
 ds_read_b64_tr_b16 a[132:133], v4 offset:8192
 v_mfma_f32_16x16x32_bf16 v[136:139], a[144:147], a[84:87], v[136:139]
 ds_read_b64_tr_b16 a[134:135], v4 offset:9216
 s_waitcnt lgkmcnt(4)
 v_mfma_f32_16x16x32_bf16 v[80:83], a[144:147], a[80:83], v[80:83]
 buffer_load_dwordx4 a[184:187], v1, s[4:7], s26 offen offset:3072 sc1
 v_mfma_f32_16x16x32_bf16 v[80:83], a[140:143], a[64:67], v[80:83]
 s_add_u32 s26, s22, 1114112
 v_mfma_f32_16x16x32_bf16 v[84:87], a[148:151], a[64:67], v[84:87]
 ds_read_b64_tr_b16 a[136:137], v4 offset:16384
 v_mfma_f32_16x16x32_bf16 v[84:87], a[152:155], a[80:83], v[84:87]
 ds_read_b64_tr_b16 a[138:139], v4 offset:17408
 v_mfma_f32_16x16x32_bf16 v[140:143], a[152:155], a[84:87], v[140:143]
 buffer_load_dwordx4 a[188:191], v1, s[4:7], s26 offen sc1
 v_mfma_f32_16x16x32_bf16 v[140:143], a[148:151], a[68:71], v[140:143]
 v_mfma_f32_16x16x32_bf16 v[196:199], a[148:151], a[72:75], v[196:199]
 ds_read_b64_tr_b16 a[140:141], v4 offset:24576
 v_mfma_f32_16x16x32_bf16 v[196:199], a[152:155], a[88:91], v[196:199]
 ds_read_b64_tr_b16 a[142:143], v4 offset:25600
 s_waitcnt vmcnt(30) lgkmcnt(4)
 v_mfma_f32_16x16x32_bf16 v[252:255], a[152:155], a[92:95], v[252:255]
 v_mfma_f32_16x16x32_bf16 v[252:255], a[148:151], a[76:79], v[252:255]
 v_mfma_f32_16x16x32_bf16 v[200:203], a[128:131], a[12:15], v[200:203]
 ds_read_b64_tr_b16 a[144:145], v5
 s_mov_b32 s23, 20997120
 v_mfma_f32_16x16x32_bf16 v[200:203], a[132:135], a[28:31], v[200:203]
 ds_read_b64_tr_b16 a[146:147], v5 offset:1024
 v_add_f32 v16, v16, v17
 v_mfma_f32_16x16x32_bf16 v[144:147], a[132:135], a[24:27], v[144:147]
 buffer_load_dwordx4 a[64:67], v2, s[4:7], s23 offen sc1
 v_mfma_f32_16x16x32_bf16 v[144:147], a[128:131], a[8:11], v[144:147]
 v_add_f32 v18, v18, v19
 v_add_f32 v20, v20, v21
 v_mfma_f32_16x16x32_bf16 v[88:91], a[128:131], a[4:7], v[88:91]
 ds_read_b64_tr_b16 a[148:149], v5 offset:8192
 v_add_f32 v16, v16, v18
 v_mfma_f32_16x16x32_bf16 v[88:91], a[132:135], a[20:23], v[88:91]
 ds_read_b64_tr_b16 a[150:151], v5 offset:9216
 s_waitcnt lgkmcnt(4)
 v_mfma_f32_16x16x32_bf16 v[32:35], a[132:135], a[16:19], v[32:35]
 buffer_load_dwordx4 a[68:71], v3, s[4:7], s23 offen sc1
 v_mfma_f32_16x16x32_bf16 v[32:35], a[128:131], a[0:3], v[32:35]
 v_mov_b32 v14, v16
 v_add_f32 v22, v22, v23
 v_mfma_f32_16x16x32_bf16 v[36:39], a[136:139], a[0:3], v[36:39]
 ds_read_b64_tr_b16 a[152:153], v5 offset:16384
 v_add_f32 v20, v20, v22
 v_mfma_f32_16x16x32_bf16 v[36:39], a[140:143], a[16:19], v[36:39]
 ds_read_b64_tr_b16 a[154:155], v5 offset:17408
 v_add_f32 v24, v24, v25
 v_mfma_f32_16x16x32_bf16 v[92:95], a[140:143], a[20:23], v[92:95]
 buffer_load_dwordx4 a[72:75], v12, s[4:7], s23 offen sc1
 v_mfma_f32_16x16x32_bf16 v[92:95], a[136:139], a[4:7], v[92:95]
 v_permlane16_swap_b32 v16, v14
 v_mfma_f32_16x16x32_bf16 v[148:151], a[136:139], a[8:11], v[148:151]
 ds_read_b64_tr_b16 a[128:129], v5 offset:24576
 v_add_f32 v16, v16, v14
 v_mfma_f32_16x16x32_bf16 v[148:151], a[140:143], a[24:27], v[148:151]
 ds_read_b64_tr_b16 a[130:131], v5 offset:25600
 s_waitcnt lgkmcnt(4)
 v_mfma_f32_16x16x32_bf16 v[204:207], a[140:143], a[28:31], v[204:207]
 v_mov_b32 v14, v16
 v_add_f32 v26, v26, v27
 v_mfma_f32_16x16x32_bf16 v[204:207], a[136:139], a[12:15], v[204:207]
 v_add_f32 v24, v24, v26
 v_add_f32 v28, v28, v29
 v_mfma_f32_16x16x32_bf16 v[208:211], a[144:147], a[12:15], v[208:211]
 ds_read_b64_tr_b16 a[132:133], v6
 v_add_f32 v30, v30, v31
 v_mfma_f32_16x16x32_bf16 v[208:211], a[148:151], a[28:31], v[208:211]
 ds_read_b64_tr_b16 a[134:135], v6 offset:1024
 v_add_f32 v28, v28, v30
 v_mfma_f32_16x16x32_bf16 v[152:155], a[148:151], a[24:27], v[152:155]
 buffer_load_dwordx4 a[76:79], v13, s[4:7], s23 offen sc1
 v_mfma_f32_16x16x32_bf16 v[152:155], a[144:147], a[8:11], v[152:155]
 v_permlane32_swap_b32 v16, v14
 v_mfma_f32_16x16x32_bf16 v[96:99], a[144:147], a[4:7], v[96:99]
 ds_read_b64_tr_b16 a[136:137], v6 offset:8192
 v_add_f32 v16, v16, v14
 v_mfma_f32_16x16x32_bf16 v[96:99], a[148:151], a[20:23], v[96:99]
 ds_read_b64_tr_b16 a[138:139], v6 offset:9216
 s_waitcnt lgkmcnt(4)
 v_mfma_f32_16x16x32_bf16 v[40:43], a[148:151], a[16:19], v[40:43]
 buffer_load_dwordx4 a[80:83], v2, s[4:7], s23 offen offset:2048 sc1
 v_mfma_f32_16x16x32_bf16 v[40:43], a[144:147], a[0:3], v[40:43]
 v_mov_b32 v14, 0x3727c5ac
 v_mfma_f32_16x16x32_bf16 v[44:47], a[152:155], a[0:3], v[44:47]
 ds_read_b64_tr_b16 a[140:141], v6 offset:16384
 v_fmac_f32 v14, 0x3a800000, v16
 v_mfma_f32_16x16x32_bf16 v[44:47], a[128:131], a[16:19], v[44:47]
 ds_read_b64_tr_b16 a[142:143], v6 offset:17408
 v_mfma_f32_16x16x32_bf16 v[100:103], a[128:131], a[20:23], v[100:103]
 v_rsq_f32 v14, v14
 v_mfma_f32_16x16x32_bf16 v[100:103], a[152:155], a[4:7], v[100:103]
 v_mul_f32 v16, 0xbfb8aa3b, v14
 v_mfma_f32_16x16x32_bf16 v[156:159], a[152:155], a[8:11], v[156:159]
 ds_read_b64_tr_b16 a[144:145], v6 offset:24576
 v_mov_b32 v14, v20
 v_mfma_f32_16x16x32_bf16 v[156:159], a[128:131], a[24:27], v[156:159]
 ds_read_b64_tr_b16 a[146:147], v6 offset:25600
 s_waitcnt lgkmcnt(4)
 v_mfma_f32_16x16x32_bf16 v[212:215], a[128:131], a[28:31], v[212:215]
 buffer_load_dwordx4 a[84:87], v3, s[4:7], s23 offen offset:2048 sc1
 v_mfma_f32_16x16x32_bf16 v[212:215], a[152:155], a[12:15], v[212:215]
 v_permlane16_swap_b32 v20, v14
 v_mfma_f32_16x16x32_bf16 v[216:219], a[132:135], a[12:15], v[216:219]
 ds_read_b64_tr_b16 a[148:149], v7
 v_add_f32 v20, v20, v14
 v_mfma_f32_16x16x32_bf16 v[216:219], a[136:139], a[28:31], v[216:219]
 ds_read_b64_tr_b16 a[150:151], v7 offset:1024
 v_mov_b32 v14, v20
 v_mfma_f32_16x16x32_bf16 v[160:163], a[136:139], a[24:27], v[160:163]
 buffer_load_dwordx4 a[88:91], v12, s[4:7], s23 offen offset:2048 sc1
 v_mfma_f32_16x16x32_bf16 v[160:163], a[132:135], a[8:11], v[160:163]
 v_permlane32_swap_b32 v20, v14
 v_mfma_f32_16x16x32_bf16 v[104:107], a[132:135], a[4:7], v[104:107]
 ds_read_b64_tr_b16 a[152:153], v7 offset:8192
 v_add_f32 v20, v20, v14
 v_mfma_f32_16x16x32_bf16 v[104:107], a[136:139], a[20:23], v[104:107]
 ds_read_b64_tr_b16 a[154:155], v7 offset:9216
 s_waitcnt lgkmcnt(4)
 v_mfma_f32_16x16x32_bf16 v[48:51], a[136:139], a[16:19], v[48:51]
 v_mov_b32 v14, 0x3727c5ac
 v_mfma_f32_16x16x32_bf16 v[48:51], a[132:135], a[0:3], v[48:51]
 v_fmac_f32 v14, 0x3a800000, v20
 v_mfma_f32_16x16x32_bf16 v[52:55], a[140:143], a[0:3], v[52:55]
 ds_read_b64_tr_b16 a[128:129], v7 offset:16384
 v_mfma_f32_16x16x32_bf16 v[52:55], a[144:147], a[16:19], v[52:55]
 ds_read_b64_tr_b16 a[130:131], v7 offset:17408
 v_mfma_f32_16x16x32_bf16 v[108:111], a[144:147], a[20:23], v[108:111]
 buffer_load_dwordx4 a[92:95], v13, s[4:7], s23 offen offset:2048 sc1
 v_mfma_f32_16x16x32_bf16 v[108:111], a[140:143], a[4:7], v[108:111]
 s_mov_b32 s21, 6651904
 v_mfma_f32_16x16x32_bf16 v[164:167], a[140:143], a[8:11], v[164:167]
 ds_read_b64_tr_b16 a[132:133], v7 offset:24576
 s_add_u32 m0, s19, 0
 v_mfma_f32_16x16x32_bf16 v[164:167], a[144:147], a[24:27], v[164:167]
 ds_read_b64_tr_b16 a[134:135], v7 offset:25600
 s_waitcnt lgkmcnt(4)
 v_mfma_f32_16x16x32_bf16 v[220:223], a[144:147], a[28:31], v[220:223]
 buffer_load_dwordx4 v8, s[12:15], s21 offen lds
 v_mfma_f32_16x16x32_bf16 v[220:223], a[140:143], a[12:15], v[220:223]
 v_rsq_f32 v14, v14
 v_mfma_f32_16x16x32_bf16 v[224:227], a[148:151], a[12:15], v[224:227]
 ds_read_b64_tr_b16 a[136:137], v4 offset:512
 v_mul_f32 v18, 0xbfb8aa3b, v14
 v_mfma_f32_16x16x32_bf16 v[224:227], a[152:155], a[28:31], v[224:227]
 ds_read_b64_tr_b16 a[138:139], v4 offset:1536
 v_mov_b32 v14, v24
 v_mfma_f32_16x16x32_bf16 v[168:171], a[152:155], a[24:27], v[168:171]
 v_mfma_f32_16x16x32_bf16 v[168:171], a[148:151], a[8:11], v[168:171]
 v_permlane16_swap_b32 v24, v14
 v_mfma_f32_16x16x32_bf16 v[112:115], a[148:151], a[4:7], v[112:115]
 ds_read_b64_tr_b16 a[140:141], v4 offset:8704
 v_add_f32 v24, v24, v14
 v_mfma_f32_16x16x32_bf16 v[112:115], a[152:155], a[20:23], v[112:115]
 ds_read_b64_tr_b16 a[142:143], v4 offset:9728
 s_waitcnt lgkmcnt(4)
 v_mfma_f32_16x16x32_bf16 v[56:59], a[152:155], a[16:19], v[56:59]
 buffer_load_dwordx4 v9, s[12:15], s21 offen offset:1024 lds
 v_mfma_f32_16x16x32_bf16 v[56:59], a[148:151], a[0:3], v[56:59]
 v_mov_b32 v14, v24
 v_mfma_f32_16x16x32_bf16 v[60:63], a[128:131], a[0:3], v[60:63]
 ds_read_b64_tr_b16 a[144:145], v4 offset:16896
 v_mfma_f32_16x16x32_bf16 v[60:63], a[132:135], a[16:19], v[60:63]
 ds_read_b64_tr_b16 a[146:147], v4 offset:17920
 v_mfma_f32_16x16x32_bf16 v[116:119], a[132:135], a[20:23], v[116:119]
 buffer_load_dwordx4 v10, s[12:15], s21 offen offset:2048 lds
 v_mfma_f32_16x16x32_bf16 v[116:119], a[128:131], a[4:7], v[116:119]
 v_permlane32_swap_b32 v24, v14
 v_mfma_f32_16x16x32_bf16 v[172:175], a[128:131], a[8:11], v[172:175]
 ds_read_b64_tr_b16 a[148:149], v4 offset:25088
 v_add_f32 v24, v24, v14
 v_mfma_f32_16x16x32_bf16 v[172:175], a[132:135], a[24:27], v[172:175]
 ds_read_b64_tr_b16 a[150:151], v4 offset:26112
 s_waitcnt lgkmcnt(4)
 v_mfma_f32_16x16x32_bf16 v[228:231], a[132:135], a[28:31], v[228:231]
 v_mov_b32 v14, 0x3727c5ac
 v_mfma_f32_16x16x32_bf16 v[228:231], a[128:131], a[12:15], v[228:231]
 v_fmac_f32 v14, 0x3a800000, v24
 v_mfma_f32_16x16x32_bf16 v[232:235], a[136:139], a[12:15], v[232:235]
 ds_read_b64_tr_b16 a[152:153], v5 offset:512
 v_mfma_f32_16x16x32_bf16 v[232:235], a[140:143], a[28:31], v[232:235]
 ds_read_b64_tr_b16 a[154:155], v5 offset:1536
 v_mfma_f32_16x16x32_bf16 v[176:179], a[140:143], a[24:27], v[176:179]
 buffer_load_dwordx4 v11, s[12:15], s21 offen offset:3072 lds
 v_mfma_f32_16x16x32_bf16 v[176:179], a[136:139], a[8:11], v[176:179]
 s_add_u32 m0, s19, 16384
 v_mfma_f32_16x16x32_bf16 v[120:123], a[136:139], a[4:7], v[120:123]
 ds_read_b64_tr_b16 a[128:129], v5 offset:8704
 v_mfma_f32_16x16x32_bf16 v[120:123], a[140:143], a[20:23], v[120:123]
 ds_read_b64_tr_b16 a[130:131], v5 offset:9728
 s_waitcnt lgkmcnt(4)
 v_mfma_f32_16x16x32_bf16 v[64:67], a[140:143], a[16:19], v[64:67]
 buffer_load_dwordx4 v8, s[8:11], s21 offen lds
 v_mfma_f32_16x16x32_bf16 v[64:67], a[136:139], a[0:3], v[64:67]
 v_rsq_f32 v14, v14
 v_mfma_f32_16x16x32_bf16 v[68:71], a[144:147], a[0:3], v[68:71]
 ds_read_b64_tr_b16 a[132:133], v5 offset:16896
 v_mul_f32 v20, 0xbfb8aa3b, v14
 v_mfma_f32_16x16x32_bf16 v[68:71], a[148:151], a[16:19], v[68:71]
 ds_read_b64_tr_b16 a[134:135], v5 offset:17920
 v_mov_b32 v14, v28
 v_mfma_f32_16x16x32_bf16 v[124:127], a[148:151], a[20:23], v[124:127]
 v_mfma_f32_16x16x32_bf16 v[124:127], a[144:147], a[4:7], v[124:127]
 v_permlane16_swap_b32 v28, v14
 v_mfma_f32_16x16x32_bf16 v[180:183], a[144:147], a[8:11], v[180:183]
 ds_read_b64_tr_b16 a[136:137], v5 offset:25088
 v_add_f32 v28, v28, v14
 v_mfma_f32_16x16x32_bf16 v[180:183], a[148:151], a[24:27], v[180:183]
 ds_read_b64_tr_b16 a[138:139], v5 offset:26112
 s_waitcnt lgkmcnt(4)
 v_mfma_f32_16x16x32_bf16 v[236:239], a[148:151], a[28:31], v[236:239]
 buffer_load_dwordx4 v9, s[8:11], s21 offen offset:1024 lds
 v_mfma_f32_16x16x32_bf16 v[236:239], a[144:147], a[12:15], v[236:239]
 v_mov_b32 v14, v28
 v_mfma_f32_16x16x32_bf16 v[240:243], a[152:155], a[12:15], v[240:243]
 ds_read_b64_tr_b16 a[140:141], v6 offset:512
 v_mfma_f32_16x16x32_bf16 v[240:243], a[128:131], a[28:31], v[240:243]
 ds_read_b64_tr_b16 a[142:143], v6 offset:1536
 v_mfma_f32_16x16x32_bf16 v[184:187], a[128:131], a[24:27], v[184:187]
 buffer_load_dwordx4 v10, s[8:11], s21 offen offset:2048 lds
 v_mfma_f32_16x16x32_bf16 v[184:187], a[152:155], a[8:11], v[184:187]
 v_permlane32_swap_b32 v28, v14
 v_mfma_f32_16x16x32_bf16 v[128:131], a[152:155], a[4:7], v[128:131]
 ds_read_b64_tr_b16 a[144:145], v6 offset:8704
 v_add_f32 v28, v28, v14
 v_mfma_f32_16x16x32_bf16 v[128:131], a[128:131], a[20:23], v[128:131]
 ds_read_b64_tr_b16 a[146:147], v6 offset:9728
 s_waitcnt lgkmcnt(4)
 v_mfma_f32_16x16x32_bf16 v[72:75], a[128:131], a[16:19], v[72:75]
 v_mov_b32 v14, 0x3727c5ac
 v_mfma_f32_16x16x32_bf16 v[72:75], a[152:155], a[0:3], v[72:75]
 v_fmac_f32 v14, 0x3a800000, v28
 v_mfma_f32_16x16x32_bf16 v[76:79], a[132:135], a[0:3], v[76:79]
 ds_read_b64_tr_b16 a[148:149], v6 offset:16896
 v_mfma_f32_16x16x32_bf16 v[76:79], a[136:139], a[16:19], v[76:79]
 ds_read_b64_tr_b16 a[150:151], v6 offset:17920
 v_mfma_f32_16x16x32_bf16 v[132:135], a[136:139], a[20:23], v[132:135]
 buffer_load_dwordx4 v11, s[8:11], s21 offen offset:3072 lds
 v_mfma_f32_16x16x32_bf16 v[132:135], a[132:135], a[4:7], v[132:135]
 v_rsq_f32 v14, v14
 v_mfma_f32_16x16x32_bf16 v[188:191], a[132:135], a[8:11], v[188:191]
 ds_read_b64_tr_b16 a[152:153], v6 offset:25088
 v_mul_f32 v22, 0xbfb8aa3b, v14
 v_mfma_f32_16x16x32_bf16 v[188:191], a[136:139], a[24:27], v[188:191]
 ds_read_b64_tr_b16 a[154:155], v6 offset:26112
 s_waitcnt lgkmcnt(4)
 v_mfma_f32_16x16x32_bf16 v[244:247], a[136:139], a[28:31], v[244:247]
 buffer_load_dwordx4 a[192:195], v1, s[4:7], s26 offen offset:1024 sc1
 v_mfma_f32_16x16x32_bf16 v[244:247], a[132:135], a[12:15], v[244:247]
L_hop_16:
 s_cbranch_execz L_ret_6
 v_mfma_f32_16x16x32_bf16 v[248:251], a[140:143], a[12:15], v[248:251]
 s_waitcnt vmcnt(39)
 s_barrier
 ds_read_b64_tr_b16 a[128:129], v4 offset:32768
 v_mfma_f32_16x16x32_bf16 v[248:251], a[144:147], a[28:31], v[248:251]
 ds_read_b64_tr_b16 a[130:131], v4 offset:33792
 v_mfma_f32_16x16x32_bf16 v[192:195], a[144:147], a[24:27], v[192:195]
 v_mfma_f32_16x16x32_bf16 v[192:195], a[140:143], a[8:11], v[192:195]
 v_mfma_f32_16x16x32_bf16 v[136:139], a[140:143], a[4:7], v[136:139]
 ds_read_b64_tr_b16 a[132:133], v4 offset:40960
 v_mfma_f32_16x16x32_bf16 v[136:139], a[144:147], a[20:23], v[136:139]
 ds_read_b64_tr_b16 a[134:135], v4 offset:41984
 s_waitcnt lgkmcnt(4)
 v_mfma_f32_16x16x32_bf16 v[80:83], a[144:147], a[16:19], v[80:83]
 buffer_load_dwordx4 a[196:199], v1, s[4:7], s26 offen offset:2048 sc1
 v_mfma_f32_16x16x32_bf16 v[80:83], a[140:143], a[0:3], v[80:83]
 v_mfma_f32_16x16x32_bf16 v[84:87], a[148:151], a[0:3], v[84:87]
 ds_read_b64_tr_b16 a[136:137], v4 offset:49152
 v_mfma_f32_16x16x32_bf16 v[84:87], a[152:155], a[16:19], v[84:87]
 ds_read_b64_tr_b16 a[138:139], v4 offset:50176
 v_mfma_f32_16x16x32_bf16 v[140:143], a[152:155], a[20:23], v[140:143]
 buffer_load_dwordx4 a[200:203], v1, s[4:7], s26 offen offset:3072 sc1
 v_mfma_f32_16x16x32_bf16 v[140:143], a[148:151], a[4:7], v[140:143]
 s_add_u32 s26, s22, 1245184
 v_mfma_f32_16x16x32_bf16 v[196:199], a[148:151], a[8:11], v[196:199]
 ds_read_b64_tr_b16 a[140:141], v4 offset:57344
 v_mfma_f32_16x16x32_bf16 v[196:199], a[152:155], a[24:27], v[196:199]
 ds_read_b64_tr_b16 a[142:143], v4 offset:58368
 s_waitcnt vmcnt(30) lgkmcnt(4)
 v_mfma_f32_16x16x32_bf16 v[252:255], a[152:155], a[28:31], v[252:255]
 v_mfma_f32_16x16x32_bf16 v[252:255], a[148:151], a[12:15], v[252:255]
 v_mfma_f32_16x16x32_bf16 v[200:203], a[128:131], a[44:47], v[200:203]
 ds_read_b64_tr_b16 a[144:145], v5 offset:32768
 s_mov_b32 s23, 21001216
 v_mfma_f32_16x16x32_bf16 v[200:203], a[132:135], a[60:63], v[200:203]
 ds_read_b64_tr_b16 a[146:147], v5 offset:33792
 v_mfma_f32_16x16x32_bf16 v[144:147], a[132:135], a[56:59], v[144:147]
 buffer_load_dwordx4 a[0:3], v2, s[4:7], s23 offen sc1
 v_mfma_f32_16x16x32_bf16 v[144:147], a[128:131], a[40:43], v[144:147]
 v_mfma_f32_16x16x32_bf16 v[88:91], a[128:131], a[36:39], v[88:91]
 ds_read_b64_tr_b16 a[148:149], v5 offset:40960
 v_mfma_f32_16x16x32_bf16 v[88:91], a[132:135], a[52:55], v[88:91]
 ds_read_b64_tr_b16 a[150:151], v5 offset:41984
 s_waitcnt lgkmcnt(4)
 v_mfma_f32_16x16x32_bf16 v[32:35], a[132:135], a[48:51], v[32:35]
 buffer_load_dwordx4 a[4:7], v3, s[4:7], s23 offen sc1
 v_mfma_f32_16x16x32_bf16 v[32:35], a[128:131], a[32:35], v[32:35]
 v_mfma_f32_16x16x32_bf16 v[36:39], a[136:139], a[32:35], v[36:39]
 ds_read_b64_tr_b16 a[152:153], v5 offset:49152
 s_bfe_u32 s0, s2, 0x20005
 v_mfma_f32_16x16x32_bf16 v[36:39], a[140:143], a[48:51], v[36:39]
 ds_read_b64_tr_b16 a[154:155], v5 offset:50176
 v_mfma_f32_16x16x32_bf16 v[92:95], a[140:143], a[52:55], v[92:95]
 s_and_b32 s3, s2, 1
 v_mfma_f32_16x16x32_bf16 v[92:95], a[136:139], a[36:39], v[92:95]
 buffer_load_dwordx4 a[8:11], v12, s[4:7], s23 offen sc1
 v_mfma_f32_16x16x32_bf16 v[148:151], a[136:139], a[40:43], v[148:151]
 ds_read_b64_tr_b16 a[128:129], v5 offset:57344
 v_mfma_f32_16x16x32_bf16 v[148:151], a[140:143], a[56:59], v[148:151]
 ds_read_b64_tr_b16 a[130:131], v5 offset:58368
 s_waitcnt lgkmcnt(4)
 v_mfma_f32_16x16x32_bf16 v[204:207], a[140:143], a[60:63], v[204:207]
 s_lshl2_add_u32 s0, s3, s0
 v_mfma_f32_16x16x32_bf16 v[204:207], a[136:139], a[44:47], v[204:207]
 s_lshl_b32 s0, s0, 8
 v_mfma_f32_16x16x32_bf16 v[208:211], a[144:147], a[44:47], v[208:211]
 ds_read_b64_tr_b16 a[132:133], v6 offset:32768
 v_mfma_f32_16x16x32_bf16 v[208:211], a[148:151], a[60:63], v[208:211]
 ds_read_b64_tr_b16 a[134:135], v6 offset:33792
 v_mfma_f32_16x16x32_bf16 v[152:155], a[148:151], a[56:59], v[152:155]
 buffer_load_dwordx4 a[12:15], v13, s[4:7], s23 offen sc1
 v_mfma_f32_16x16x32_bf16 v[152:155], a[144:147], a[40:43], v[152:155]
 s_lshl_b32 s31, s62, 11
 v_mfma_f32_16x16x32_bf16 v[96:99], a[144:147], a[36:39], v[96:99]
 ds_read_b64_tr_b16 a[136:137], v6 offset:40960
 s_add_u32 s31, s31, s0
 v_mfma_f32_16x16x32_bf16 v[96:99], a[148:151], a[52:55], v[96:99]
 ds_read_b64_tr_b16 a[138:139], v6 offset:41984
 s_waitcnt lgkmcnt(4)
 v_mfma_f32_16x16x32_bf16 v[40:43], a[148:151], a[48:51], v[40:43]
 v_mfma_f32_16x16x32_bf16 v[40:43], a[144:147], a[32:35], v[40:43]
 buffer_load_dwordx4 a[16:19], v2, s[4:7], s23 offen offset:2048 sc1
 v_mfma_f32_16x16x32_bf16 v[44:47], a[152:155], a[32:35], v[44:47]
 ds_read_b64_tr_b16 a[140:141], v6 offset:49152
 s_add_u32 s31, s31, 40222720
 v_mfma_f32_16x16x32_bf16 v[44:47], a[128:131], a[48:51], v[44:47]
 ds_read_b64_tr_b16 a[142:143], v6 offset:50176
 v_mfma_f32_16x16x32_bf16 v[100:103], a[128:131], a[52:55], v[100:103]
 s_add_u32 s33, s31, 16384
 v_mfma_f32_16x16x32_bf16 v[100:103], a[152:155], a[36:39], v[100:103]
 v_mfma_f32_16x16x32_bf16 v[156:159], a[152:155], a[40:43], v[156:159]
 ds_read_b64_tr_b16 a[144:145], v6 offset:57344
 s_lshr_b32 s29, s60, 1
 v_mfma_f32_16x16x32_bf16 v[156:159], a[128:131], a[56:59], v[156:159]
 ds_read_b64_tr_b16 a[146:147], v6 offset:58368
 s_waitcnt lgkmcnt(4)
 v_mfma_f32_16x16x32_bf16 v[212:215], a[128:131], a[60:63], v[212:215]
 buffer_load_dwordx4 a[20:23], v3, s[4:7], s23 offen offset:2048 sc1
 v_mfma_f32_16x16x32_bf16 v[212:215], a[152:155], a[44:47], v[212:215]
 s_lshl_b32 s29, s29, 11
 v_mfma_f32_16x16x32_bf16 v[216:219], a[132:135], a[44:47], v[216:219]
 ds_read_b64_tr_b16 a[148:149], v7 offset:32768
 v_mfma_f32_16x16x32_bf16 v[216:219], a[136:139], a[60:63], v[216:219]
 ds_read_b64_tr_b16 a[150:151], v7 offset:33792
 v_mfma_f32_16x16x32_bf16 v[160:163], a[136:139], a[56:59], v[160:163]
 buffer_load_dwordx4 a[24:27], v12, s[4:7], s23 offen offset:2048 sc1
 v_mfma_f32_16x16x32_bf16 v[160:163], a[132:135], a[40:43], v[160:163]
 s_add_u32 s29, s29, s0
 v_mfma_f32_16x16x32_bf16 v[104:107], a[132:135], a[36:39], v[104:107]
 ds_read_b64_tr_b16 a[152:153], v7 offset:40960
 s_add_u32 s29, s29, 40222720
 v_mfma_f32_16x16x32_bf16 v[104:107], a[136:139], a[52:55], v[104:107]
 ds_read_b64_tr_b16 a[154:155], v7 offset:41984
 s_waitcnt lgkmcnt(4)
 v_mfma_f32_16x16x32_bf16 v[48:51], a[136:139], a[48:51], v[48:51]
 v_mfma_f32_16x16x32_bf16 v[48:51], a[132:135], a[32:35], v[48:51]
 buffer_load_dwordx4 a[28:31], v13, s[4:7], s23 offen offset:2048 sc1
 v_mfma_f32_16x16x32_bf16 v[52:55], a[140:143], a[32:35], v[52:55]
 ds_read_b64_tr_b16 a[128:129], v7 offset:49152
 v_and_b32 v2, 0x7fff, v4
 v_mfma_f32_16x16x32_bf16 v[52:55], a[144:147], a[48:51], v[52:55]
 ds_read_b64_tr_b16 a[130:131], v7 offset:50176
 v_mfma_f32_16x16x32_bf16 v[108:111], a[144:147], a[52:55], v[108:111]
 v_and_b32 v3, 0x7fff, v5
 v_mfma_f32_16x16x32_bf16 v[108:111], a[140:143], a[36:39], v[108:111]
 v_and_b32 v12, 0x7fff, v6
 v_mfma_f32_16x16x32_bf16 v[164:167], a[140:143], a[40:43], v[164:167]
 ds_read_b64_tr_b16 a[132:133], v7 offset:57344
 v_and_b32 v13, 0x7fff, v7
 v_mfma_f32_16x16x32_bf16 v[164:167], a[144:147], a[56:59], v[164:167]
 ds_read_b64_tr_b16 a[134:135], v7 offset:58368
 s_waitcnt lgkmcnt(4)
 v_mfma_f32_16x16x32_bf16 v[220:223], a[144:147], a[60:63], v[220:223]
 buffer_load_dwordx4 a[204:207], v1, s[4:7], s26 offen sc1
 v_mfma_f32_16x16x32_bf16 v[220:223], a[140:143], a[44:47], v[220:223]
 v_add_u32 v7, 65536, v7
 s_add_u32 s28, s29, 16384
 v_mfma_f32_16x16x32_bf16 v[224:227], a[148:151], a[44:47], v[224:227]
 ds_read_b64_tr_b16 a[136:137], v4 offset:33280
 v_mfma_f32_16x16x32_bf16 v[224:227], a[152:155], a[60:63], v[224:227]
 ds_read_b64_tr_b16 a[138:139], v4 offset:34304
 v_mfma_f32_16x16x32_bf16 v[168:171], a[152:155], a[56:59], v[168:171]
 s_lshl2_add_u32 s32, s60, s16
 v_mfma_f32_16x16x32_bf16 v[168:171], a[148:151], a[40:43], v[168:171]
 buffer_load_dwordx4 a[208:211], v1, s[4:7], s26 offen offset:1024 sc1
 v_mfma_f32_16x16x32_bf16 v[112:115], a[148:151], a[36:39], v[112:115]
 ds_read_b64_tr_b16 a[140:141], v4 offset:41472
 s_lshl_b32 s32, s32, 1
 v_mfma_f32_16x16x32_bf16 v[112:115], a[152:155], a[52:55], v[112:115]
 ds_read_b64_tr_b16 a[142:143], v4 offset:42496
 s_waitcnt lgkmcnt(4)
 v_mfma_f32_16x16x32_bf16 v[56:59], a[152:155], a[48:51], v[56:59]
 v_mfma_f32_16x16x32_bf16 v[56:59], a[148:151], a[32:35], v[56:59]
 s_mul_i32 s3, s32, 114688
 v_mfma_f32_16x16x32_bf16 v[60:63], a[128:131], a[32:35], v[60:63]
 ds_read_b64_tr_b16 a[144:145], v4 offset:49664
 s_and_b32 s30, s61, 1
 v_mfma_f32_16x16x32_bf16 v[60:63], a[132:135], a[48:51], v[60:63]
 ds_read_b64_tr_b16 a[146:147], v4 offset:50688
 v_mfma_f32_16x16x32_bf16 v[116:119], a[132:135], a[52:55], v[116:119]
 buffer_load_dwordx4 a[212:215], v1, s[4:7], s26 offen offset:2048 sc1
 v_mfma_f32_16x16x32_bf16 v[116:119], a[128:131], a[36:39], v[116:119]
 v_mfma_f32_16x16x32_bf16 v[172:175], a[128:131], a[40:43], v[172:175]
 ds_read_b64_tr_b16 a[148:149], v4 offset:57856
 s_mul_i32 s30, s30, 57344
 v_mfma_f32_16x16x32_bf16 v[172:175], a[132:135], a[56:59], v[172:175]
 ds_read_b64_tr_b16 a[150:151], v4 offset:58880
 s_waitcnt lgkmcnt(4)
 v_mfma_f32_16x16x32_bf16 v[228:231], a[132:135], a[60:63], v[228:231]
 buffer_load_dwordx4 a[216:219], v1, s[4:7], s26 offen offset:3072 sc1
 v_mfma_f32_16x16x32_bf16 v[228:231], a[128:131], a[44:47], v[228:231]
 v_add_u32 v4, 65536, v4
 s_add_u32 s21, s22, 0
 s_add_u32 m0, s19, 32768
 v_mfma_f32_16x16x32_bf16 v[232:235], a[136:139], a[44:47], v[232:235]
 ds_read_b64_tr_b16 a[152:153], v5 offset:33280
 s_add_u32 s3, s3, s30
 v_mfma_f32_16x16x32_bf16 v[232:235], a[140:143], a[60:63], v[232:235]
 ds_read_b64_tr_b16 a[154:155], v5 offset:34304
 v_mfma_f32_16x16x32_bf16 v[176:179], a[140:143], a[56:59], v[176:179]
 v_mfma_f32_16x16x32_bf16 v[176:179], a[136:139], a[40:43], v[176:179]
 buffer_load_dwordx4 v1, s[4:7], s21 offen sc1 lds
 v_mfma_f32_16x16x32_bf16 v[120:123], a[136:139], a[36:39], v[120:123]
 ds_read_b64_tr_b16 a[128:129], v5 offset:41472
 s_add_u32 s3, s3, 25165824
 v_mfma_f32_16x16x32_bf16 v[120:123], a[140:143], a[52:55], v[120:123]
 ds_read_b64_tr_b16 a[130:131], v5 offset:42496
 s_waitcnt lgkmcnt(4)
 v_mfma_f32_16x16x32_bf16 v[64:67], a[140:143], a[48:51], v[64:67]
 v_add_u32 v8, s3, v1
 v_mfma_f32_16x16x32_bf16 v[64:67], a[136:139], a[32:35], v[64:67]
 v_mfma_f32_16x16x32_bf16 v[68:71], a[144:147], a[32:35], v[68:71]
 ds_read_b64_tr_b16 a[132:133], v5 offset:49664
 s_lshl_b32 s30, s32, 10
 v_mfma_f32_16x16x32_bf16 v[68:71], a[148:151], a[48:51], v[68:71]
 ds_read_b64_tr_b16 a[134:135], v5 offset:50688
 v_mfma_f32_16x16x32_bf16 v[124:127], a[148:151], a[52:55], v[124:127]
 buffer_load_dwordx4 v1, s[4:7], s21 offen offset:1024 sc1 lds
 v_mfma_f32_16x16x32_bf16 v[124:127], a[144:147], a[36:39], v[124:127]
 s_add_u32 s30, s30, 39878656
 v_mfma_f32_16x16x32_bf16 v[180:183], a[144:147], a[40:43], v[180:183]
 ds_read_b64_tr_b16 a[136:137], v5 offset:57856
 v_mfma_f32_16x16x32_bf16 v[180:183], a[148:151], a[56:59], v[180:183]
 ds_read_b64_tr_b16 a[138:139], v5 offset:58880
 s_waitcnt lgkmcnt(4)
 v_mfma_f32_16x16x32_bf16 v[236:239], a[148:151], a[60:63], v[236:239]
 v_add_u32 v9, 114688, v8
 v_mfma_f32_16x16x32_bf16 v[236:239], a[144:147], a[44:47], v[236:239]
 v_add_u32 v5, 65536, v5
 buffer_load_dwordx4 v1, s[4:7], s21 offen offset:2048 sc1 lds
 v_mfma_f32_16x16x32_bf16 v[240:243], a[152:155], a[44:47], v[240:243]
 ds_read_b64_tr_b16 a[140:141], v6 offset:33280
 v_add_u32 v10, 28672, v8
 v_mfma_f32_16x16x32_bf16 v[240:243], a[128:131], a[60:63], v[240:243]
 ds_read_b64_tr_b16 a[142:143], v6 offset:34304
 v_mfma_f32_16x16x32_bf16 v[184:187], a[128:131], a[56:59], v[184:187]
 v_mfma_f32_16x16x32_bf16 v[184:187], a[152:155], a[40:43], v[184:187]
 v_add_u32 v11, 143360, v8
 v_mfma_f32_16x16x32_bf16 v[128:131], a[152:155], a[36:39], v[128:131]
 ds_read_b64_tr_b16 a[144:145], v6 offset:41472
 v_mfma_f32_16x16x32_bf16 v[128:131], a[128:131], a[52:55], v[128:131]
 ds_read_b64_tr_b16 a[146:147], v6 offset:42496
 s_waitcnt lgkmcnt(4)
 v_mfma_f32_16x16x32_bf16 v[72:75], a[128:131], a[48:51], v[72:75]
 buffer_load_dwordx4 v1, s[4:7], s21 offen offset:3072 sc1 lds
 v_mfma_f32_16x16x32_bf16 v[72:75], a[152:155], a[32:35], v[72:75]
 s_add_u32 s21, s22, 393216
 s_add_u32 m0, s19, 49152
 v_mfma_f32_16x16x32_bf16 v[76:79], a[132:135], a[32:35], v[76:79]
 ds_read_b64_tr_b16 a[148:149], v6 offset:49664
 v_mfma_f32_16x16x32_bf16 v[76:79], a[136:139], a[48:51], v[76:79]
 ds_read_b64_tr_b16 a[150:151], v6 offset:50688
 v_mfma_f32_16x16x32_bf16 v[132:135], a[136:139], a[52:55], v[132:135]
 buffer_load_dwordx4 v1, s[4:7], s21 offen sc1 lds
 v_mfma_f32_16x16x32_bf16 v[132:135], a[132:135], a[36:39], v[132:135]
 v_mfma_f32_16x16x32_bf16 v[188:191], a[132:135], a[40:43], v[188:191]
 ds_read_b64_tr_b16 a[152:153], v6 offset:57856
 v_mfma_f32_16x16x32_bf16 v[188:191], a[136:139], a[56:59], v[188:191]
 ds_read_b64_tr_b16 a[154:155], v6 offset:58880
 s_waitcnt lgkmcnt(4)
 v_mfma_f32_16x16x32_bf16 v[244:247], a[136:139], a[60:63], v[244:247]
 v_mfma_f32_16x16x32_bf16 v[244:247], a[132:135], a[44:47], v[244:247]
 v_add_u32 v6, 65536, v6
 buffer_load_dwordx4 v1, s[4:7], s21 offen offset:1024 sc1 lds
 v_mfma_f32_16x16x32_bf16 v[248:251], a[140:143], a[44:47], v[248:251]
 s_waitcnt vmcnt(21)
 s_barrier
 ds_read_b64_tr_b16 a[128:129], v4
 v_mfma_f32_16x16x32_bf16 v[248:251], a[144:147], a[60:63], v[248:251]
 ds_read_b64_tr_b16 a[130:131], v4 offset:1024
 v_mfma_f32_16x16x32_bf16 v[192:195], a[144:147], a[56:59], v[192:195]
 v_mfma_f32_16x16x32_bf16 v[192:195], a[140:143], a[40:43], v[192:195]
 v_mfma_f32_16x16x32_bf16 v[136:139], a[140:143], a[36:39], v[136:139]
 ds_read_b64_tr_b16 a[132:133], v4 offset:8192
 v_mfma_f32_16x16x32_bf16 v[136:139], a[144:147], a[52:55], v[136:139]
 ds_read_b64_tr_b16 a[134:135], v4 offset:9216
 s_waitcnt lgkmcnt(4)
 v_mfma_f32_16x16x32_bf16 v[80:83], a[144:147], a[48:51], v[80:83]
 buffer_load_dwordx4 v1, s[4:7], s21 offen offset:2048 sc1 lds
 v_mfma_f32_16x16x32_bf16 v[80:83], a[140:143], a[32:35], v[80:83]
 v_mfma_f32_16x16x32_bf16 v[84:87], a[148:151], a[32:35], v[84:87]
 ds_read_b64_tr_b16 a[136:137], v2
 v_mfma_f32_16x16x32_bf16 v[84:87], a[152:155], a[48:51], v[84:87]
 ds_read_b64_tr_b16 a[138:139], v2 offset:1024
 v_mfma_f32_16x16x32_bf16 v[140:143], a[152:155], a[52:55], v[140:143]
 v_mfma_f32_16x16x32_bf16 v[140:143], a[148:151], a[36:39], v[140:143]
 buffer_load_dwordx4 v1, s[4:7], s21 offen offset:3072 sc1 lds
 v_mfma_f32_16x16x32_bf16 v[196:199], a[148:151], a[40:43], v[196:199]
 ds_read_b64_tr_b16 a[140:141], v2 offset:8192
 v_mfma_f32_16x16x32_bf16 v[196:199], a[152:155], a[56:59], v[196:199]
 ds_read_b64_tr_b16 a[142:143], v2 offset:9216
 s_waitcnt lgkmcnt(4)
 v_mfma_f32_16x16x32_bf16 v[252:255], a[152:155], a[60:63], v[252:255]
 v_mfma_f32_16x16x32_bf16 v[252:255], a[148:151], a[44:47], v[252:255]
 v_mfma_f32_16x16x32_bf16 v[200:203], a[128:131], a[76:79], v[200:203]
 ds_read_b64_tr_b16 a[144:145], v2 offset:16384
 s_add_u32 s21, s22, 458752
 s_add_u32 m0, s19, 65536
 v_mfma_f32_16x16x32_bf16 v[200:203], a[132:135], a[92:95], v[200:203]
 ds_read_b64_tr_b16 a[146:147], v2 offset:17408
 v_mfma_f32_16x16x32_bf16 v[144:147], a[132:135], a[88:91], v[144:147]
 buffer_load_dwordx4 v1, s[4:7], s21 offen sc1 lds
 v_mfma_f32_16x16x32_bf16 v[144:147], a[128:131], a[72:75], v[144:147]
 v_mfma_f32_16x16x32_bf16 v[88:91], a[128:131], a[68:71], v[88:91]
 ds_read_b64_tr_b16 a[148:149], v2 offset:24576
 v_mfma_f32_16x16x32_bf16 v[88:91], a[132:135], a[84:87], v[88:91]
 ds_read_b64_tr_b16 a[150:151], v2 offset:25600
 s_waitcnt vmcnt(13) lgkmcnt(4)
 v_mfma_f32_16x16x32_bf16 v[32:35], a[132:135], a[80:83], v[32:35]
 buffer_load_dwordx4 v1, s[4:7], s21 offen offset:1024 sc1 lds
 v_mfma_f32_16x16x32_bf16 v[32:35], a[128:131], a[64:67], v[32:35]
 v_mfma_f32_16x16x32_bf16 v[32:35], a[136:139], a[0:3], v[32:35]
 ds_read_b64_tr_b16 a[152:153], v4 offset:16384
 v_mfma_f32_16x16x32_bf16 v[32:35], a[140:143], a[16:19], v[32:35]
 ds_read_b64_tr_b16 a[154:155], v4 offset:17408
 v_mfma_f32_16x16x32_bf16 v[88:91], a[140:143], a[20:23], v[88:91]
 v_mfma_f32_16x16x32_bf16 v[88:91], a[136:139], a[4:7], v[88:91]
 buffer_load_dwordx4 v1, s[4:7], s21 offen offset:2048 sc1 lds
 v_mfma_f32_16x16x32_bf16 v[144:147], a[136:139], a[8:11], v[144:147]
 ds_read_b64_tr_b16 a[128:129], v4 offset:24576
 v_mfma_f32_16x16x32_bf16 v[144:147], a[140:143], a[24:27], v[144:147]
 ds_read_b64_tr_b16 a[130:131], v4 offset:25600
 s_waitcnt lgkmcnt(4)
 v_mfma_f32_16x16x32_bf16 v[200:203], a[140:143], a[28:31], v[200:203]
 v_mfma_f32_16x16x32_bf16 v[200:203], a[136:139], a[12:15], v[200:203]
 v_mfma_f32_16x16x32_bf16 v[204:207], a[144:147], a[12:15], v[204:207]
 ds_read_b64_tr_b16 a[132:133], v5
 v_mfma_f32_16x16x32_bf16 v[204:207], a[148:151], a[28:31], v[204:207]
 ds_read_b64_tr_b16 a[134:135], v5 offset:1024
 v_mfma_f32_16x16x32_bf16 v[148:151], a[148:151], a[24:27], v[148:151]
 buffer_load_dwordx4 v1, s[4:7], s21 offen offset:3072 sc1 lds
 v_mfma_f32_16x16x32_bf16 v[148:151], a[144:147], a[8:11], v[148:151]
 s_add_u32 s21, s22, 851968
 s_add_u32 m0, s19, 81920
 v_mfma_f32_16x16x32_bf16 v[92:95], a[144:147], a[4:7], v[92:95]
 ds_read_b64_tr_b16 a[136:137], v5 offset:8192
 v_mfma_f32_16x16x32_bf16 v[92:95], a[148:151], a[20:23], v[92:95]
 ds_read_b64_tr_b16 a[138:139], v5 offset:9216
 s_waitcnt lgkmcnt(4)
 v_mfma_f32_16x16x32_bf16 v[36:39], a[148:151], a[16:19], v[36:39]
 v_mfma_f32_16x16x32_bf16 v[36:39], a[144:147], a[0:3], v[36:39]
 buffer_load_dwordx4 v1, s[4:7], s21 offen sc1 lds
 v_mfma_f32_16x16x32_bf16 v[36:39], a[152:155], a[64:67], v[36:39]
 ds_read_b64_tr_b16 a[140:141], v3
 v_mfma_f32_16x16x32_bf16 v[36:39], a[128:131], a[80:83], v[36:39]
 ds_read_b64_tr_b16 a[142:143], v3 offset:1024
 v_mfma_f32_16x16x32_bf16 v[92:95], a[128:131], a[84:87], v[92:95]
 v_mfma_f32_16x16x32_bf16 v[92:95], a[152:155], a[68:71], v[92:95]
 buffer_load_dwordx4 v1, s[4:7], s21 offen offset:1024 sc1 lds
 v_mfma_f32_16x16x32_bf16 v[148:151], a[152:155], a[72:75], v[148:151]
 ds_read_b64_tr_b16 a[144:145], v3 offset:8192
 v_mfma_f32_16x16x32_bf16 v[148:151], a[128:131], a[88:91], v[148:151]
 ds_read_b64_tr_b16 a[146:147], v3 offset:9216
 s_waitcnt lgkmcnt(4)
 v_mfma_f32_16x16x32_bf16 v[204:207], a[128:131], a[92:95], v[204:207]
 v_mfma_f32_16x16x32_bf16 v[204:207], a[152:155], a[76:79], v[204:207]
 v_mfma_f32_16x16x32_bf16 v[208:211], a[132:135], a[76:79], v[208:211]
 ds_read_b64_tr_b16 a[148:149], v3 offset:16384
 v_mfma_f32_16x16x32_bf16 v[208:211], a[136:139], a[92:95], v[208:211]
 ds_read_b64_tr_b16 a[150:151], v3 offset:17408
 v_mfma_f32_16x16x32_bf16 v[152:155], a[136:139], a[88:91], v[152:155]
 buffer_load_dwordx4 v1, s[4:7], s21 offen offset:2048 sc1 lds
 v_mfma_f32_16x16x32_bf16 v[152:155], a[132:135], a[72:75], v[152:155]
 v_mfma_f32_16x16x32_bf16 v[96:99], a[132:135], a[68:71], v[96:99]
 ds_read_b64_tr_b16 a[152:153], v3 offset:24576
 v_mul_f32 v24, v32, v16
 v_mfma_f32_16x16x32_bf16 v[96:99], a[136:139], a[84:87], v[96:99]
 ds_read_b64_tr_b16 a[154:155], v3 offset:25600
 s_waitcnt lgkmcnt(4)
 v_mfma_f32_16x16x32_bf16 v[40:43], a[136:139], a[80:83], v[40:43]
 v_exp_f32 v24, v24
 v_mfma_f32_16x16x32_bf16 v[40:43], a[132:135], a[64:67], v[40:43]
 buffer_load_dwordx4 v1, s[4:7], s21 offen offset:3072 sc1 lds
 v_mfma_f32_16x16x32_bf16 v[40:43], a[140:143], a[0:3], v[40:43]
 ds_read_b64_tr_b16 a[128:129], v5 offset:16384
 s_add_u32 s21, s22, 1507328
 v_mfma_f32_16x16x32_bf16 v[40:43], a[144:147], a[16:19], v[40:43]
 ds_read_b64_tr_b16 a[130:131], v5 offset:17408
 v_mul_f32 v25, v33, v16
 v_mfma_f32_16x16x32_bf16 v[96:99], a[144:147], a[20:23], v[96:99]
 v_exp_f32 v25, v25
 v_mfma_f32_16x16x32_bf16 v[96:99], a[140:143], a[4:7], v[96:99]
 v_mul_f32 v26, v34, v16
 v_mul_f32 v27, v35, v16
 v_mfma_f32_16x16x32_bf16 v[152:155], a[140:143], a[8:11], v[152:155]
 ds_read_b64_tr_b16 a[132:133], v5 offset:24576
 v_mul_f32 v28, v88, v18
 v_mfma_f32_16x16x32_bf16 v[152:155], a[144:147], a[24:27], v[152:155]
 ds_read_b64_tr_b16 a[134:135], v5 offset:25600
 s_waitcnt lgkmcnt(4)
 v_mfma_f32_16x16x32_bf16 v[208:211], a[144:147], a[28:31], v[208:211]
 buffer_load_dwordx4 a[32:35], v1, s[4:7], s21 offen sc1
 v_mfma_f32_16x16x32_bf16 v[208:211], a[140:143], a[12:15], v[208:211]
 v_exp_f32 v26, v26
 v_mfma_f32_16x16x32_bf16 v[212:215], a[148:151], a[12:15], v[212:215]
 s_barrier
 ds_read_b64_tr_b16 a[136:137], v6
 v_mul_f32 v29, v89, v18
 v_mfma_f32_16x16x32_bf16 v[212:215], a[152:155], a[28:31], v[212:215]
 ds_read_b64_tr_b16 a[138:139], v6 offset:1024
 v_mul_f32 v30, v90, v18
 v_mfma_f32_16x16x32_bf16 v[156:159], a[152:155], a[24:27], v[156:159]
 v_exp_f32 v27, v27
 v_mfma_f32_16x16x32_bf16 v[156:159], a[148:151], a[8:11], v[156:159]
 buffer_load_dwordx4 a[36:39], v1, s[4:7], s21 offen offset:1024 sc1
 v_mfma_f32_16x16x32_bf16 v[100:103], a[148:151], a[4:7], v[100:103]
 ds_read_b64_tr_b16 a[140:141], v6 offset:8192
 v_mul_f32 v31, v91, v18
 v_mfma_f32_16x16x32_bf16 v[100:103], a[152:155], a[20:23], v[100:103]
 ds_read_b64_tr_b16 a[142:143], v6 offset:9216
 s_waitcnt lgkmcnt(4)
 v_mfma_f32_16x16x32_bf16 v[44:47], a[152:155], a[16:19], v[44:47]
 v_exp_f32 v28, v28
 v_mfma_f32_16x16x32_bf16 v[44:47], a[148:151], a[0:3], v[44:47]
 buffer_load_dwordx4 a[40:43], v1, s[4:7], s21 offen offset:2048 sc1
 v_mfma_f32_16x16x32_bf16 v[44:47], a[128:131], a[64:67], v[44:47]
 ds_read_b64_tr_b16 a[144:145], v12
 v_mul_f32 v32, v32, v36
 v_mfma_f32_16x16x32_bf16 v[44:47], a[132:135], a[80:83], v[44:47]
 ds_read_b64_tr_b16 a[146:147], v12 offset:1024
 v_mul_f32 v33, v33, v37
 v_mfma_f32_16x16x32_bf16 v[100:103], a[132:135], a[84:87], v[100:103]
 v_exp_f32 v29, v29
 v_mfma_f32_16x16x32_bf16 v[100:103], a[128:131], a[68:71], v[100:103]
 v_exp_f32 v30, v30
 v_mfma_f32_16x16x32_bf16 v[156:159], a[128:131], a[72:75], v[156:159]
 ds_read_b64_tr_b16 a[148:149], v12 offset:8192
 v_mul_f32 v34, v34, v38
 v_mfma_f32_16x16x32_bf16 v[156:159], a[132:135], a[88:91], v[156:159]
 ds_read_b64_tr_b16 a[150:151], v12 offset:9216
 s_waitcnt lgkmcnt(4)
 v_mfma_f32_16x16x32_bf16 v[212:215], a[132:135], a[92:95], v[212:215]
 buffer_load_dwordx4 a[44:47], v1, s[4:7], s21 offen offset:3072 sc1
 v_mfma_f32_16x16x32_bf16 v[212:215], a[128:131], a[76:79], v[212:215]
 s_add_u32 s21, s22, 1638400
 v_mfma_f32_16x16x32_bf16 v[216:219], a[136:139], a[76:79], v[216:219]
 ds_read_b64_tr_b16 a[152:153], v12 offset:16384
 v_mul_f32 v35, v35, v39
 v_mfma_f32_16x16x32_bf16 v[216:219], a[140:143], a[92:95], v[216:219]
 ds_read_b64_tr_b16 a[154:155], v12 offset:17408
 v_mul_f32 v88, v88, v92
 v_mfma_f32_16x16x32_bf16 v[160:163], a[140:143], a[88:91], v[160:163]
 v_exp_f32 v31, v31
 v_mfma_f32_16x16x32_bf16 v[160:163], a[136:139], a[72:75], v[160:163]
 buffer_load_dwordx4 a[48:51], v1, s[4:7], s21 offen sc1
 v_mfma_f32_16x16x32_bf16 v[104:107], a[136:139], a[68:71], v[104:107]
 ds_read_b64_tr_b16 a[128:129], v12 offset:24576
 v_mul_f32 v89, v89, v93
 v_mfma_f32_16x16x32_bf16 v[104:107], a[140:143], a[84:87], v[104:107]
 ds_read_b64_tr_b16 a[130:131], v12 offset:25600
 s_waitcnt lgkmcnt(4)
 v_mfma_f32_16x16x32_bf16 v[48:51], a[140:143], a[80:83], v[48:51]
 v_mul_f32 v90, v90, v94
 v_mul_f32 v91, v91, v95
 v_mfma_f32_16x16x32_bf16 v[48:51], a[136:139], a[64:67], v[48:51]
 v_add_f32 v36, 1.0, v24
 v_add_f32 v37, 1.0, v25
 v_mfma_f32_16x16x32_bf16 v[48:51], a[144:147], a[0:3], v[48:51]
 ds_read_b64_tr_b16 a[132:133], v6 offset:16384
 v_add_f32 v38, 1.0, v26
 v_mfma_f32_16x16x32_bf16 v[48:51], a[148:151], a[16:19], v[48:51]
 ds_read_b64_tr_b16 a[134:135], v6 offset:17408
 v_add_f32 v39, 1.0, v27
 v_mfma_f32_16x16x32_bf16 v[104:107], a[148:151], a[20:23], v[104:107]
 buffer_load_dwordx4 a[52:55], v1, s[4:7], s21 offen offset:1024 sc1
 v_mfma_f32_16x16x32_bf16 v[104:107], a[144:147], a[4:7], v[104:107]
 v_rcp_f32 v36, v36
 v_mfma_f32_16x16x32_bf16 v[160:163], a[144:147], a[8:11], v[160:163]
 ds_read_b64_tr_b16 a[136:137], v6 offset:24576
 v_add_f32 v92, 1.0, v28
 v_mfma_f32_16x16x32_bf16 v[160:163], a[148:151], a[24:27], v[160:163]
 ds_read_b64_tr_b16 a[138:139], v6 offset:25600
 s_waitcnt lgkmcnt(4)
 v_mfma_f32_16x16x32_bf16 v[216:219], a[148:151], a[28:31], v[216:219]
 v_rcp_f32 v37, v37
 v_mfma_f32_16x16x32_bf16 v[216:219], a[144:147], a[12:15], v[216:219]
 buffer_load_dwordx4 a[56:59], v1, s[4:7], s21 offen offset:2048 sc1
 v_mfma_f32_16x16x32_bf16 v[220:223], a[152:155], a[12:15], v[220:223]
 ds_read_b64_tr_b16 a[140:141], v7
 v_add_f32 v93, 1.0, v29
 v_mfma_f32_16x16x32_bf16 v[220:223], a[128:131], a[28:31], v[220:223]
 ds_read_b64_tr_b16 a[142:143], v7 offset:1024
 v_add_f32 v94, 1.0, v30
 v_mfma_f32_16x16x32_bf16 v[164:167], a[128:131], a[24:27], v[164:167]
 v_rcp_f32 v38, v38
 v_mfma_f32_16x16x32_bf16 v[164:167], a[152:155], a[8:11], v[164:167]
 buffer_load_dwordx4 a[60:63], v1, s[4:7], s21 offen offset:3072 sc1
 v_mfma_f32_16x16x32_bf16 v[108:111], a[152:155], a[4:7], v[108:111]
 ds_read_b64_tr_b16 a[144:145], v7 offset:8192
 s_add_u32 s21, s22, 917504
 s_add_u32 m0, s19, 98304
 v_mfma_f32_16x16x32_bf16 v[108:111], a[128:131], a[20:23], v[108:111]
 ds_read_b64_tr_b16 a[146:147], v7 offset:9216
 s_waitcnt lgkmcnt(4)
 v_mfma_f32_16x16x32_bf16 v[52:55], a[128:131], a[16:19], v[52:55]
 v_rcp_f32 v39, v39
 v_mfma_f32_16x16x32_bf16 v[52:55], a[152:155], a[0:3], v[52:55]
 v_rcp_f32 v92, v92
 v_mfma_f32_16x16x32_bf16 v[52:55], a[132:135], a[64:67], v[52:55]
 ds_read_b64_tr_b16 a[148:149], v13
 v_add_f32 v95, 1.0, v31
 v_mfma_f32_16x16x32_bf16 v[52:55], a[136:139], a[80:83], v[52:55]
 ds_read_b64_tr_b16 a[150:151], v13 offset:1024
 v_mul_f32 v32, v32, v36
 v_mfma_f32_16x16x32_bf16 v[108:111], a[136:139], a[84:87], v[108:111]
 buffer_load_dwordx4 v1, s[4:7], s21 offen sc1 lds
 v_mfma_f32_16x16x32_bf16 v[108:111], a[132:135], a[68:71], v[108:111]
 v_rcp_f32 v93, v93
 v_mfma_f32_16x16x32_bf16 v[164:167], a[132:135], a[72:75], v[164:167]
 ds_read_b64_tr_b16 a[152:153], v13 offset:8192
 v_mul_f32 v33, v33, v37
 v_mfma_f32_16x16x32_bf16 v[164:167], a[136:139], a[88:91], v[164:167]
 ds_read_b64_tr_b16 a[154:155], v13 offset:9216
 s_waitcnt lgkmcnt(4)
 v_mfma_f32_16x16x32_bf16 v[220:223], a[136:139], a[92:95], v[220:223]
 v_rcp_f32 v94, v94
 v_mfma_f32_16x16x32_bf16 v[220:223], a[132:135], a[76:79], v[220:223]
 buffer_load_dwordx4 v1, s[4:7], s21 offen offset:1024 sc1 lds
 v_mfma_f32_16x16x32_bf16 v[224:227], a[140:143], a[76:79], v[224:227]
 ds_read_b64_tr_b16 a[128:129], v13 offset:16384
 v_mul_f32 v34, v34, v38
 v_mfma_f32_16x16x32_bf16 v[224:227], a[144:147], a[92:95], v[224:227]
 ds_read_b64_tr_b16 a[130:131], v13 offset:17408
 v_mul_f32 v35, v35, v39
 v_mfma_f32_16x16x32_bf16 v[168:171], a[144:147], a[88:91], v[168:171]
 v_rcp_f32 v95, v95
 v_mfma_f32_16x16x32_bf16 v[168:171], a[140:143], a[72:75], v[168:171]
 v_mul_f32 v88, v88, v92
 v_mul_f32 v89, v89, v93
 v_mfma_f32_16x16x32_bf16 v[112:115], a[140:143], a[68:71], v[112:115]
 ds_read_b64_tr_b16 a[132:133], v13 offset:24576
 v_mul_f32 v90, v90, v94
 v_mfma_f32_16x16x32_bf16 v[112:115], a[144:147], a[84:87], v[112:115]
 ds_read_b64_tr_b16 a[134:135], v13 offset:25600
 s_waitcnt lgkmcnt(4)
 v_mfma_f32_16x16x32_bf16 v[56:59], a[144:147], a[80:83], v[56:59]
 buffer_load_dwordx4 v1, s[4:7], s21 offen offset:2048 sc1 lds
 v_mfma_f32_16x16x32_bf16 v[56:59], a[140:143], a[64:67], v[56:59]
 v_mul_f32 v91, v91, v95
 v_cvt_pk_bf16_f32 v36, v32, v33
 v_mfma_f32_16x16x32_bf16 v[56:59], a[148:151], a[0:3], v[56:59]
 ds_read_b64_tr_b16 a[136:137], v7 offset:16384
 v_cvt_pk_bf16_f32 v37, v34, v35
 v_mfma_f32_16x16x32_bf16 v[56:59], a[152:155], a[16:19], v[56:59]
 ds_read_b64_tr_b16 a[138:139], v7 offset:17408
 v_cvt_pk_bf16_f32 v38, v88, v89
 v_mfma_f32_16x16x32_bf16 v[112:115], a[152:155], a[20:23], v[112:115]
 v_cvt_pk_bf16_f32 v39, v90, v91
 v_mul_f32 v24, v144, v20
 v_mfma_f32_16x16x32_bf16 v[112:115], a[148:151], a[4:7], v[112:115]
 buffer_load_dwordx4 v1, s[4:7], s21 offen offset:3072 sc1 lds
 v_mfma_f32_16x16x32_bf16 v[168:171], a[148:151], a[8:11], v[168:171]
 ds_read_b64_tr_b16 a[140:141], v7 offset:24576
 s_add_u32 s21, s22, 1310720
 s_add_u32 m0, s19, 114688
 v_mfma_f32_16x16x32_bf16 v[168:171], a[152:155], a[24:27], v[168:171]
 ds_read_b64_tr_b16 a[142:143], v7 offset:25600
 s_waitcnt lgkmcnt(4)
 v_mfma_f32_16x16x32_bf16 v[224:227], a[152:155], a[28:31], v[224:227]
 v_permlane16_swap_b32 v36, v38
 v_mfma_f32_16x16x32_bf16 v[224:227], a[148:151], a[12:15], v[224:227]
 buffer_load_dwordx4 v1, s[4:7], s21 offen sc1 lds
 v_mfma_f32_16x16x32_bf16 v[228:231], a[128:131], a[12:15], v[228:231]
 ds_read_b64_tr_b16 a[144:145], v4 offset:512
 v_mul_f32 v25, v145, v20
 v_mfma_f32_16x16x32_bf16 v[228:231], a[132:135], a[28:31], v[228:231]
 ds_read_b64_tr_b16 a[146:147], v4 offset:1536
 v_mul_f32 v26, v146, v20
 v_mfma_f32_16x16x32_bf16 v[172:175], a[132:135], a[24:27], v[172:175]
 v_permlane16_swap_b32 v37, v39
 v_mfma_f32_16x16x32_bf16 v[172:175], a[128:131], a[8:11], v[172:175]
 buffer_store_dwordx4 v[36:39], v15, s[4:7], s34 offen sc1
 v_mfma_f32_16x16x32_bf16 v[116:119], a[128:131], a[4:7], v[116:119]
 ds_read_b64_tr_b16 a[148:149], v4 offset:8704
 v_mul_f32 v27, v147, v20
 v_mfma_f32_16x16x32_bf16 v[116:119], a[132:135], a[20:23], v[116:119]
 ds_read_b64_tr_b16 a[150:151], v4 offset:9728
 s_waitcnt lgkmcnt(4)
 v_mfma_f32_16x16x32_bf16 v[60:63], a[132:135], a[16:19], v[60:63]
 buffer_load_dwordx4 v1, s[4:7], s21 offen offset:1024 sc1 lds
 v_mfma_f32_16x16x32_bf16 v[60:63], a[128:131], a[0:3], v[60:63]
 v_exp_f32 v24, v24
 v_mfma_f32_16x16x32_bf16 v[60:63], a[136:139], a[64:67], v[60:63]
L_hop_17:
 s_cbranch_execz L_ret_7
 ds_read_b64_tr_b16 a[152:153], v2 offset:512
 s_add_u32 s34, s34, s27
 v_mfma_f32_16x16x32_bf16 v[60:63], a[140:143], a[80:83], v[60:63]
 ds_read_b64_tr_b16 a[154:155], v2 offset:1536
 v_mul_f32 v28, v200, v22
 v_mfma_f32_16x16x32_bf16 v[116:119], a[140:143], a[84:87], v[116:119]
 v_exp_f32 v25, v25
 v_mfma_f32_16x16x32_bf16 v[116:119], a[136:139], a[68:71], v[116:119]
 buffer_load_dwordx4 v1, s[4:7], s21 offen offset:2048 sc1 lds
 v_mfma_f32_16x16x32_bf16 v[172:175], a[136:139], a[72:75], v[172:175]
 ds_read_b64_tr_b16 a[128:129], v2 offset:8704
 v_mul_f32 v29, v201, v22
 v_mfma_f32_16x16x32_bf16 v[172:175], a[140:143], a[88:91], v[172:175]
 ds_read_b64_tr_b16 a[130:131], v2 offset:9728
 s_waitcnt lgkmcnt(4)
 v_mfma_f32_16x16x32_bf16 v[228:231], a[140:143], a[92:95], v[228:231]
 v_exp_f32 v26, v26
 v_mfma_f32_16x16x32_bf16 v[228:231], a[136:139], a[76:79], v[228:231]
 v_exp_f32 v27, v27
 v_mfma_f32_16x16x32_bf16 v[232:235], a[144:147], a[76:79], v[232:235]
 ds_read_b64_tr_b16 a[132:133], v2 offset:16896
 v_mul_f32 v30, v202, v22
 v_mfma_f32_16x16x32_bf16 v[232:235], a[148:151], a[92:95], v[232:235]
 ds_read_b64_tr_b16 a[134:135], v2 offset:17920
 v_mul_f32 v31, v203, v22
 v_mfma_f32_16x16x32_bf16 v[176:179], a[148:151], a[88:91], v[176:179]
 buffer_load_dwordx4 v1, s[4:7], s21 offen offset:3072 sc1 lds
 v_mfma_f32_16x16x32_bf16 v[176:179], a[144:147], a[72:75], v[176:179]
 v_exp_f32 v28, v28
 v_mfma_f32_16x16x32_bf16 v[120:123], a[144:147], a[68:71], v[120:123]
 ds_read_b64_tr_b16 a[136:137], v2 offset:25088
 v_mul_f32 v144, v144, v148
 v_mfma_f32_16x16x32_bf16 v[120:123], a[148:151], a[84:87], v[120:123]
 ds_read_b64_tr_b16 a[138:139], v2 offset:26112
 s_waitcnt lgkmcnt(4)
 v_mfma_f32_16x16x32_bf16 v[64:67], a[148:151], a[80:83], v[64:67]
 v_exp_f32 v29, v29
 v_mfma_f32_16x16x32_bf16 v[64:67], a[144:147], a[64:67], v[64:67]
 v_exp_f32 v30, v30
 v_mfma_f32_16x16x32_bf16 v[64:67], a[152:155], a[0:3], v[64:67]
 ds_read_b64_tr_b16 a[140:141], v4 offset:16896
 v_mul_f32 v145, v145, v149
 v_mfma_f32_16x16x32_bf16 v[64:67], a[128:131], a[16:19], v[64:67]
 ds_read_b64_tr_b16 a[142:143], v4 offset:17920
 v_mul_f32 v146, v146, v150
 v_mfma_f32_16x16x32_bf16 v[120:123], a[128:131], a[20:23], v[120:123]
 v_exp_f32 v31, v31
 v_mfma_f32_16x16x32_bf16 v[120:123], a[152:155], a[4:7], v[120:123]
 v_mul_f32 v147, v147, v151
 v_mul_f32 v200, v200, v204
 v_mfma_f32_16x16x32_bf16 v[176:179], a[152:155], a[8:11], v[176:179]
 ds_read_b64_tr_b16 a[144:145], v4 offset:25088
 v_mul_f32 v201, v201, v205
 v_mfma_f32_16x16x32_bf16 v[176:179], a[128:131], a[24:27], v[176:179]
 ds_read_b64_tr_b16 a[146:147], v4 offset:26112
 s_waitcnt lgkmcnt(4)
 v_mfma_f32_16x16x32_bf16 v[232:235], a[128:131], a[28:31], v[232:235]
 v_mul_f32 v202, v202, v206
 v_mul_f32 v203, v203, v207
 v_mfma_f32_16x16x32_bf16 v[232:235], a[152:155], a[12:15], v[232:235]
 v_add_f32 v148, 1.0, v24
 v_add_f32 v149, 1.0, v25
 v_mfma_f32_16x16x32_bf16 v[236:239], a[132:135], a[12:15], v[236:239]
 ds_read_b64_tr_b16 a[148:149], v5 offset:512
 v_add_f32 v150, 1.0, v26
 v_mfma_f32_16x16x32_bf16 v[236:239], a[136:139], a[28:31], v[236:239]
 ds_read_b64_tr_b16 a[150:151], v5 offset:1536
 v_add_f32 v151, 1.0, v27
 v_mfma_f32_16x16x32_bf16 v[180:183], a[136:139], a[24:27], v[180:183]
 v_rcp_f32 v148, v148
 v_mfma_f32_16x16x32_bf16 v[180:183], a[132:135], a[8:11], v[180:183]
 v_rcp_f32 v149, v149
 v_mfma_f32_16x16x32_bf16 v[124:127], a[132:135], a[4:7], v[124:127]
 ds_read_b64_tr_b16 a[152:153], v5 offset:8704
 v_add_f32 v204, 1.0, v28
 v_mfma_f32_16x16x32_bf16 v[124:127], a[136:139], a[20:23], v[124:127]
 ds_read_b64_tr_b16 a[154:155], v5 offset:9728
 s_waitcnt lgkmcnt(4)
 v_mfma_f32_16x16x32_bf16 v[68:71], a[136:139], a[16:19], v[68:71]
 v_rcp_f32 v150, v150
 v_mfma_f32_16x16x32_bf16 v[68:71], a[132:135], a[0:3], v[68:71]
 v_rcp_f32 v151, v151
 v_mfma_f32_16x16x32_bf16 v[68:71], a[140:143], a[64:67], v[68:71]
 ds_read_b64_tr_b16 a[128:129], v3 offset:512
 v_add_f32 v205, 1.0, v29
 v_mfma_f32_16x16x32_bf16 v[68:71], a[144:147], a[80:83], v[68:71]
 ds_read_b64_tr_b16 a[130:131], v3 offset:1536
 v_add_f32 v206, 1.0, v30
 v_mfma_f32_16x16x32_bf16 v[124:127], a[144:147], a[84:87], v[124:127]
 v_rcp_f32 v204, v204
 v_mfma_f32_16x16x32_bf16 v[124:127], a[140:143], a[68:71], v[124:127]
 v_rcp_f32 v205, v205
 v_mfma_f32_16x16x32_bf16 v[180:183], a[140:143], a[72:75], v[180:183]
 ds_read_b64_tr_b16 a[132:133], v3 offset:8704
 v_add_f32 v207, 1.0, v31
 v_mfma_f32_16x16x32_bf16 v[180:183], a[144:147], a[88:91], v[180:183]
 ds_read_b64_tr_b16 a[134:135], v3 offset:9728
 s_waitcnt lgkmcnt(4)
 v_mfma_f32_16x16x32_bf16 v[236:239], a[144:147], a[92:95], v[236:239]
 v_rcp_f32 v206, v206
 v_mfma_f32_16x16x32_bf16 v[236:239], a[140:143], a[76:79], v[236:239]
 v_rcp_f32 v207, v207
 v_mfma_f32_16x16x32_bf16 v[240:243], a[148:151], a[76:79], v[240:243]
 ds_read_b64_tr_b16 a[136:137], v3 offset:16896
 v_mul_f32 v144, v144, v148
 v_mfma_f32_16x16x32_bf16 v[240:243], a[152:155], a[92:95], v[240:243]
 ds_read_b64_tr_b16 a[138:139], v3 offset:17920
 v_mul_f32 v145, v145, v149
 v_mfma_f32_16x16x32_bf16 v[184:187], a[152:155], a[88:91], v[184:187]
 v_mul_f32 v146, v146, v150
 v_mul_f32 v147, v147, v151
 v_mfma_f32_16x16x32_bf16 v[184:187], a[148:151], a[72:75], v[184:187]
 v_mul_f32 v200, v200, v204
 v_mul_f32 v201, v201, v205
 v_mfma_f32_16x16x32_bf16 v[128:131], a[148:151], a[68:71], v[128:131]
 ds_read_b64_tr_b16 a[140:141], v3 offset:25088
 v_mul_f32 v202, v202, v206
 v_mfma_f32_16x16x32_bf16 v[128:131], a[152:155], a[84:87], v[128:131]
 ds_read_b64_tr_b16 a[142:143], v3 offset:26112
 s_waitcnt lgkmcnt(4)
 v_mfma_f32_16x16x32_bf16 v[72:75], a[152:155], a[80:83], v[72:75]
 v_mul_f32 v203, v203, v207
 v_cvt_pk_bf16_f32 v148, v144, v145
 v_mfma_f32_16x16x32_bf16 v[72:75], a[148:151], a[64:67], v[72:75]
 v_cvt_pk_bf16_f32 v149, v146, v147
 v_cvt_pk_bf16_f32 v150, v200, v201
 v_mfma_f32_16x16x32_bf16 v[72:75], a[128:131], a[0:3], v[72:75]
 ds_read_b64_tr_b16 a[144:145], v5 offset:16896
 v_cvt_pk_bf16_f32 v151, v202, v203
 v_mfma_f32_16x16x32_bf16 v[72:75], a[132:135], a[16:19], v[72:75]
 ds_read_b64_tr_b16 a[146:147], v5 offset:17920
 v_mul_f32 v24, v40, v16
 v_mfma_f32_16x16x32_bf16 v[128:131], a[132:135], a[20:23], v[128:131]
 v_permlane16_swap_b32 v148, v150
 v_mfma_f32_16x16x32_bf16 v[128:131], a[128:131], a[4:7], v[128:131]
 v_permlane16_swap_b32 v149, v151
 v_mfma_f32_16x16x32_bf16 v[184:187], a[128:131], a[8:11], v[184:187]
 ds_read_b64_tr_b16 a[148:149], v5 offset:25088
 v_mul_f32 v25, v41, v16
 v_mfma_f32_16x16x32_bf16 v[184:187], a[132:135], a[24:27], v[184:187]
 ds_read_b64_tr_b16 a[150:151], v5 offset:26112
 s_waitcnt lgkmcnt(4)
 v_mfma_f32_16x16x32_bf16 v[240:243], a[132:135], a[28:31], v[240:243]
 buffer_store_dwordx4 v[148:151], v15, s[4:7], s35 offen sc1
 v_mfma_f32_16x16x32_bf16 v[240:243], a[128:131], a[12:15], v[240:243]
 v_exp_f32 v24, v24
 v_mfma_f32_16x16x32_bf16 v[244:247], a[136:139], a[12:15], v[244:247]
 ds_read_b64_tr_b16 a[152:153], v6 offset:512
 s_add_u32 s35, s35, s27
 v_mfma_f32_16x16x32_bf16 v[244:247], a[140:143], a[28:31], v[244:247]
 ds_read_b64_tr_b16 a[154:155], v6 offset:1536
 v_mul_f32 v26, v42, v16
 v_mfma_f32_16x16x32_bf16 v[188:191], a[140:143], a[24:27], v[188:191]
 v_exp_f32 v25, v25
 v_mfma_f32_16x16x32_bf16 v[188:191], a[136:139], a[8:11], v[188:191]
 v_exp_f32 v26, v26
 v_mfma_f32_16x16x32_bf16 v[132:135], a[136:139], a[4:7], v[132:135]
 ds_read_b64_tr_b16 a[128:129], v6 offset:8704
 v_mul_f32 v27, v43, v16
 v_mfma_f32_16x16x32_bf16 v[132:135], a[140:143], a[20:23], v[132:135]
 ds_read_b64_tr_b16 a[130:131], v6 offset:9728
 s_waitcnt lgkmcnt(4)
 v_mfma_f32_16x16x32_bf16 v[76:79], a[140:143], a[16:19], v[76:79]
 v_exp_f32 v27, v27
 v_mfma_f32_16x16x32_bf16 v[76:79], a[136:139], a[0:3], v[76:79]
 v_mul_f32 v28, v96, v18
 v_mul_f32 v29, v97, v18
 v_mfma_f32_16x16x32_bf16 v[76:79], a[144:147], a[64:67], v[76:79]
 ds_read_b64_tr_b16 a[132:133], v12 offset:512
 v_mul_f32 v30, v98, v18
 v_mfma_f32_16x16x32_bf16 v[76:79], a[148:151], a[80:83], v[76:79]
 ds_read_b64_tr_b16 a[134:135], v12 offset:1536
 v_mul_f32 v31, v99, v18
 v_mfma_f32_16x16x32_bf16 v[132:135], a[148:151], a[84:87], v[132:135]
 v_exp_f32 v28, v28
 v_mfma_f32_16x16x32_bf16 v[132:135], a[144:147], a[68:71], v[132:135]
 v_exp_f32 v29, v29
 v_mfma_f32_16x16x32_bf16 v[188:191], a[144:147], a[72:75], v[188:191]
 ds_read_b64_tr_b16 a[136:137], v12 offset:8704
 v_mul_f32 v40, v40, v44
 v_mfma_f32_16x16x32_bf16 v[188:191], a[148:151], a[88:91], v[188:191]
 ds_read_b64_tr_b16 a[138:139], v12 offset:9728
 s_waitcnt lgkmcnt(4)
 v_mfma_f32_16x16x32_bf16 v[244:247], a[148:151], a[92:95], v[244:247]
 v_exp_f32 v30, v30
 v_mfma_f32_16x16x32_bf16 v[244:247], a[144:147], a[76:79], v[244:247]
 v_exp_f32 v31, v31
 v_mfma_f32_16x16x32_bf16 v[248:251], a[152:155], a[76:79], v[248:251]
 ds_read_b64_tr_b16 a[140:141], v12 offset:16896
 v_mul_f32 v41, v41, v45
 v_mfma_f32_16x16x32_bf16 v[248:251], a[128:131], a[92:95], v[248:251]
 ds_read_b64_tr_b16 a[142:143], v12 offset:17920
 v_mul_f32 v42, v42, v46
 v_mfma_f32_16x16x32_bf16 v[192:195], a[128:131], a[88:91], v[192:195]
 v_mul_f32 v43, v43, v47
 v_mul_f32 v96, v96, v100
 v_mfma_f32_16x16x32_bf16 v[192:195], a[152:155], a[72:75], v[192:195]
 v_mul_f32 v97, v97, v101
 v_mul_f32 v98, v98, v102
 v_mfma_f32_16x16x32_bf16 v[136:139], a[152:155], a[68:71], v[136:139]
 ds_read_b64_tr_b16 a[144:145], v12 offset:25088
 v_mul_f32 v99, v99, v103
 v_mfma_f32_16x16x32_bf16 v[136:139], a[128:131], a[84:87], v[136:139]
 ds_read_b64_tr_b16 a[146:147], v12 offset:26112
 s_waitcnt lgkmcnt(4)
 v_mfma_f32_16x16x32_bf16 v[80:83], a[128:131], a[80:83], v[80:83]
 v_add_f32 v44, 1.0, v24
 v_add_f32 v45, 1.0, v25
 v_mfma_f32_16x16x32_bf16 v[80:83], a[152:155], a[64:67], v[80:83]
 v_rcp_f32 v44, v44
 v_mfma_f32_16x16x32_bf16 v[80:83], a[132:135], a[0:3], v[80:83]
 ds_read_b64_tr_b16 a[148:149], v6 offset:16896
 v_add_f32 v46, 1.0, v26
 v_mfma_f32_16x16x32_bf16 v[80:83], a[136:139], a[16:19], v[80:83]
 ds_read_b64_tr_b16 a[150:151], v6 offset:17920
 v_add_f32 v47, 1.0, v27
 v_mfma_f32_16x16x32_bf16 v[136:139], a[136:139], a[20:23], v[136:139]
 v_rcp_f32 v45, v45
 v_mfma_f32_16x16x32_bf16 v[136:139], a[132:135], a[4:7], v[136:139]
 v_rcp_f32 v46, v46
 v_mfma_f32_16x16x32_bf16 v[192:195], a[132:135], a[8:11], v[192:195]
 ds_read_b64_tr_b16 a[152:153], v6 offset:25088
 v_add_f32 v100, 1.0, v28
 v_mfma_f32_16x16x32_bf16 v[192:195], a[136:139], a[24:27], v[192:195]
 ds_read_b64_tr_b16 a[154:155], v6 offset:26112
 s_waitcnt lgkmcnt(4)
 v_mfma_f32_16x16x32_bf16 v[248:251], a[136:139], a[28:31], v[248:251]
 v_rcp_f32 v47, v47
 v_mfma_f32_16x16x32_bf16 v[248:251], a[132:135], a[12:15], v[248:251]
 v_rcp_f32 v100, v100
 v_mfma_f32_16x16x32_bf16 v[252:255], a[140:143], a[12:15], v[252:255]
 v_add_f32 v101, 1.0, v29
 v_add_f32 v102, 1.0, v30
 v_mfma_f32_16x16x32_bf16 v[252:255], a[144:147], a[28:31], v[252:255]
 v_rcp_f32 v101, v101
 v_mfma_f32_16x16x32_bf16 v[196:199], a[144:147], a[24:27], v[196:199]
 v_rcp_f32 v102, v102
 v_mfma_f32_16x16x32_bf16 v[196:199], a[140:143], a[8:11], v[196:199]
 v_add_f32 v103, 1.0, v31
 v_mul_f32 v40, v40, v44
 v_mfma_f32_16x16x32_bf16 v[140:143], a[140:143], a[4:7], v[140:143]
 v_rcp_f32 v103, v103
 v_mfma_f32_16x16x32_bf16 v[140:143], a[144:147], a[20:23], v[140:143]
 s_waitcnt lgkmcnt(0)
 v_mul_f32 v41, v41, v45
 v_mfma_f32_16x16x32_bf16 v[84:87], a[144:147], a[16:19], v[84:87]
 v_mul_f32 v42, v42, v46
 v_mul_f32 v43, v43, v47
 v_mfma_f32_16x16x32_bf16 v[84:87], a[140:143], a[0:3], v[84:87]
 v_mul_f32 v96, v96, v100
 v_mul_f32 v97, v97, v101
 v_mfma_f32_16x16x32_bf16 v[84:87], a[148:151], a[64:67], v[84:87]
 v_mul_f32 v98, v98, v102
 v_mul_f32 v99, v99, v103
 v_mfma_f32_16x16x32_bf16 v[84:87], a[152:155], a[80:83], v[84:87]
 v_cvt_pk_bf16_f32 v44, v40, v41
 v_cvt_pk_bf16_f32 v45, v42, v43
 v_mfma_f32_16x16x32_bf16 v[140:143], a[152:155], a[84:87], v[140:143]
 v_cvt_pk_bf16_f32 v46, v96, v97
 v_cvt_pk_bf16_f32 v47, v98, v99
 v_mfma_f32_16x16x32_bf16 v[140:143], a[148:151], a[68:71], v[140:143]
 v_mfma_f32_16x16x32_bf16 v[196:199], a[148:151], a[72:75], v[196:199]
 v_permlane16_swap_b32 v44, v46
 v_mfma_f32_16x16x32_bf16 v[196:199], a[152:155], a[88:91], v[196:199]
 v_mfma_f32_16x16x32_bf16 v[252:255], a[152:155], a[92:95], v[252:255]
 v_permlane16_swap_b32 v45, v47
 v_mfma_f32_16x16x32_bf16 v[252:255], a[148:151], a[76:79], v[252:255]
 buffer_store_dwordx4 v[44:47], v15, s[4:7], s34 offen sc1
L_epi4:
 s_add_u32 s34, s34, s27
 v_mov_b32 v2, 1
 v_lshlrev_b32 v3, 8, v0
 v_mov_b32 v12, 0
 s_barrier
 v_pk_mul_f32 v[24:25], v[152:153], v[20:21] op_sel_hi:[1,0]
 v_pk_mul_f32 v[26:27], v[154:155], v[20:21] op_sel_hi:[1,0]
 v_pk_mul_f32 v[28:29], v[208:209], v[22:23] op_sel_hi:[1,0]
 v_pk_mul_f32 v[30:31], v[210:211], v[22:23] op_sel_hi:[1,0]
 v_exp_f32 v24, v24
 v_exp_f32 v25, v25
 v_exp_f32 v26, v26
 v_exp_f32 v27, v27
 v_exp_f32 v28, v28
 v_exp_f32 v29, v29
 v_exp_f32 v30, v30
 v_exp_f32 v31, v31
 v_pk_mul_f32 v[152:153], v[152:153], v[156:157]
 v_pk_mul_f32 v[154:155], v[154:155], v[158:159]
 v_pk_mul_f32 v[208:209], v[208:209], v[212:213]
 v_pk_mul_f32 v[210:211], v[210:211], v[214:215]
 v_pk_add_f32 v[24:25], v[24:25], 1.0 op_sel_hi:[1,0]
 v_pk_add_f32 v[26:27], v[26:27], 1.0 op_sel_hi:[1,0]
 v_pk_add_f32 v[28:29], v[28:29], 1.0 op_sel_hi:[1,0]
 v_pk_add_f32 v[30:31], v[30:31], 1.0 op_sel_hi:[1,0]
 v_rcp_f32 v24, v24
 v_rcp_f32 v25, v25
 v_rcp_f32 v26, v26
 v_rcp_f32 v27, v27
 v_rcp_f32 v28, v28
 v_rcp_f32 v29, v29
 v_rcp_f32 v30, v30
 v_rcp_f32 v31, v31
 v_pk_mul_f32 v[152:153], v[152:153], v[24:25]
 v_pk_mul_f32 v[154:155], v[154:155], v[26:27]
 v_pk_mul_f32 v[208:209], v[208:209], v[28:29]
 v_pk_mul_f32 v[210:211], v[210:211], v[30:31]
 v_cvt_pk_bf16_f32 v32, v152, v153
 v_cvt_pk_bf16_f32 v33, v154, v155
 v_cvt_pk_bf16_f32 v34, v208, v209
 v_cvt_pk_bf16_f32 v35, v210, v211
 v_pk_mul_f32 v[24:25], v[48:49], v[16:17] op_sel_hi:[1,0]
 v_pk_mul_f32 v[26:27], v[50:51], v[16:17] op_sel_hi:[1,0]
 v_pk_mul_f32 v[28:29], v[104:105], v[18:19] op_sel_hi:[1,0]
 v_pk_mul_f32 v[30:31], v[106:107], v[18:19] op_sel_hi:[1,0]
 v_permlane16_swap_b32 v32, v34
 v_permlane16_swap_b32 v33, v35
 buffer_store_dwordx4 v[32:35], v15, s[4:7], s35 offen sc1
 s_add_u32 s35, s35, s27
 v_exp_f32 v24, v24
 v_exp_f32 v25, v25
 v_exp_f32 v26, v26
 v_exp_f32 v27, v27
 v_exp_f32 v28, v28
 v_exp_f32 v29, v29
 v_exp_f32 v30, v30
 v_exp_f32 v31, v31
 s_add_u32 s21, s22, 1376256
 s_add_u32 m0, s19, 131072
 s_nop 0
 buffer_load_dwordx4 v1, s[4:7], s21 offen sc1 lds
 v_pk_mul_f32 v[48:49], v[48:49], v[52:53]
 v_pk_mul_f32 v[50:51], v[50:51], v[54:55]
 v_pk_mul_f32 v[104:105], v[104:105], v[108:109]
 v_pk_mul_f32 v[106:107], v[106:107], v[110:111]
 v_pk_add_f32 v[24:25], v[24:25], 1.0 op_sel_hi:[1,0]
 v_pk_add_f32 v[26:27], v[26:27], 1.0 op_sel_hi:[1,0]
 v_pk_add_f32 v[28:29], v[28:29], 1.0 op_sel_hi:[1,0]
 v_pk_add_f32 v[30:31], v[30:31], 1.0 op_sel_hi:[1,0]
 v_rcp_f32 v24, v24
 v_rcp_f32 v25, v25
 v_rcp_f32 v26, v26
 v_rcp_f32 v27, v27
 v_rcp_f32 v28, v28
 v_rcp_f32 v29, v29
 v_rcp_f32 v30, v30
 v_rcp_f32 v31, v31
 buffer_load_dwordx4 v1, s[4:7], s21 offen offset:1024 sc1 lds
 v_pk_mul_f32 v[48:49], v[48:49], v[24:25]
 v_pk_mul_f32 v[50:51], v[50:51], v[26:27]
 v_pk_mul_f32 v[104:105], v[104:105], v[28:29]
 v_pk_mul_f32 v[106:107], v[106:107], v[30:31]
 v_cvt_pk_bf16_f32 v4, v48, v49
 v_cvt_pk_bf16_f32 v5, v50, v51
 v_cvt_pk_bf16_f32 v6, v104, v105
 v_cvt_pk_bf16_f32 v7, v106, v107
 v_pk_mul_f32 v[24:25], v[160:161], v[20:21] op_sel_hi:[1,0]
 v_pk_mul_f32 v[26:27], v[162:163], v[20:21] op_sel_hi:[1,0]
 v_pk_mul_f32 v[28:29], v[216:217], v[22:23] op_sel_hi:[1,0]
 v_pk_mul_f32 v[30:31], v[218:219], v[22:23] op_sel_hi:[1,0]
 v_permlane16_swap_b32 v4, v6
 v_permlane16_swap_b32 v5, v7
 buffer_store_dwordx4 v[4:7], v15, s[4:7], s34 offen sc1
 s_add_u32 s34, s34, s27
 v_exp_f32 v24, v24
 v_exp_f32 v25, v25
 v_exp_f32 v26, v26
 v_exp_f32 v27, v27
 v_exp_f32 v28, v28
 v_exp_f32 v29, v29
 v_exp_f32 v30, v30
 v_exp_f32 v31, v31
 buffer_load_dwordx4 v1, s[4:7], s21 offen offset:2048 sc1 lds
 v_pk_mul_f32 v[160:161], v[160:161], v[164:165]
 v_pk_mul_f32 v[162:163], v[162:163], v[166:167]
 v_pk_mul_f32 v[216:217], v[216:217], v[220:221]
 v_pk_mul_f32 v[218:219], v[218:219], v[222:223]
 v_pk_add_f32 v[24:25], v[24:25], 1.0 op_sel_hi:[1,0]
 v_pk_add_f32 v[26:27], v[26:27], 1.0 op_sel_hi:[1,0]
 v_pk_add_f32 v[28:29], v[28:29], 1.0 op_sel_hi:[1,0]
 v_pk_add_f32 v[30:31], v[30:31], 1.0 op_sel_hi:[1,0]
 v_rcp_f32 v24, v24
 v_rcp_f32 v25, v25
 v_rcp_f32 v26, v26
 v_rcp_f32 v27, v27
 v_rcp_f32 v28, v28
 v_rcp_f32 v29, v29
 v_rcp_f32 v30, v30
 v_rcp_f32 v31, v31
 buffer_load_dwordx4 v1, s[4:7], s21 offen offset:3072 sc1 lds
 v_pk_mul_f32 v[160:161], v[160:161], v[24:25]
 v_pk_mul_f32 v[162:163], v[162:163], v[26:27]
 v_pk_mul_f32 v[216:217], v[216:217], v[28:29]
 v_pk_mul_f32 v[218:219], v[218:219], v[30:31]
 v_cvt_pk_bf16_f32 v32, v160, v161
 v_cvt_pk_bf16_f32 v33, v162, v163
 v_cvt_pk_bf16_f32 v34, v216, v217
 v_cvt_pk_bf16_f32 v35, v218, v219
 v_pk_mul_f32 v[24:25], v[56:57], v[16:17] op_sel_hi:[1,0]
 v_pk_mul_f32 v[26:27], v[58:59], v[16:17] op_sel_hi:[1,0]
 v_pk_mul_f32 v[28:29], v[112:113], v[18:19] op_sel_hi:[1,0]
 v_pk_mul_f32 v[30:31], v[114:115], v[18:19] op_sel_hi:[1,0]
 v_permlane16_swap_b32 v32, v34
 v_permlane16_swap_b32 v33, v35
 buffer_store_dwordx4 v[32:35], v15, s[4:7], s35 offen sc1
 s_add_u32 s35, s35, s27
 v_exp_f32 v24, v24
 v_exp_f32 v25, v25
 v_exp_f32 v26, v26
 v_exp_f32 v27, v27
 v_exp_f32 v28, v28
 v_exp_f32 v29, v29
 v_exp_f32 v30, v30
 v_exp_f32 v31, v31
 s_add_u32 s21, s22, 1769472
 s_add_u32 m0, s19, 147456
 s_nop 0
 buffer_load_dwordx4 v1, s[4:7], s21 offen sc1 lds
 v_pk_mul_f32 v[56:57], v[56:57], v[60:61]
 v_pk_mul_f32 v[58:59], v[58:59], v[62:63]
 v_pk_mul_f32 v[112:113], v[112:113], v[116:117]
 v_pk_mul_f32 v[114:115], v[114:115], v[118:119]
 v_pk_add_f32 v[24:25], v[24:25], 1.0 op_sel_hi:[1,0]
 v_pk_add_f32 v[26:27], v[26:27], 1.0 op_sel_hi:[1,0]
 v_pk_add_f32 v[28:29], v[28:29], 1.0 op_sel_hi:[1,0]
 v_pk_add_f32 v[30:31], v[30:31], 1.0 op_sel_hi:[1,0]
 v_rcp_f32 v24, v24
 v_rcp_f32 v25, v25
 v_rcp_f32 v26, v26
 v_rcp_f32 v27, v27
 v_rcp_f32 v28, v28
 v_rcp_f32 v29, v29
 v_rcp_f32 v30, v30
 v_rcp_f32 v31, v31
 buffer_load_dwordx4 v1, s[4:7], s21 offen offset:1024 sc1 lds
 v_pk_mul_f32 v[56:57], v[56:57], v[24:25]
 v_pk_mul_f32 v[58:59], v[58:59], v[26:27]
 v_pk_mul_f32 v[112:113], v[112:113], v[28:29]
 v_pk_mul_f32 v[114:115], v[114:115], v[30:31]
 v_cvt_pk_bf16_f32 v4, v56, v57
 v_cvt_pk_bf16_f32 v5, v58, v59
 v_cvt_pk_bf16_f32 v6, v112, v113
 v_cvt_pk_bf16_f32 v7, v114, v115
 v_pk_mul_f32 v[24:25], v[168:169], v[20:21] op_sel_hi:[1,0]
 v_pk_mul_f32 v[26:27], v[170:171], v[20:21] op_sel_hi:[1,0]
 v_pk_mul_f32 v[28:29], v[224:225], v[22:23] op_sel_hi:[1,0]
 v_pk_mul_f32 v[30:31], v[226:227], v[22:23] op_sel_hi:[1,0]
 v_permlane16_swap_b32 v4, v6
 v_permlane16_swap_b32 v5, v7
 buffer_store_dwordx4 v[4:7], v15, s[4:7], s34 offen sc1
 s_add_u32 s34, s34, s27
 s_waitcnt vmcnt(9)
 s_barrier
 s_cmp_lg_u32 s16, 0
 s_cbranch_scc1 L_arrived_38
 s_sub_u32 s67, s33, s0
 s_mov_b64 exec, 0xff
 buffer_atomic_add v2, v3, s[4:7], s67 offen sc1
 s_mov_b64 exec, -1
L_arrived_38:
 v_exp_f32 v24, v24
 v_exp_f32 v25, v25
 v_exp_f32 v26, v26
 v_exp_f32 v27, v27
 v_exp_f32 v28, v28
 v_exp_f32 v29, v29
 v_exp_f32 v30, v30
 v_exp_f32 v31, v31
 buffer_load_dwordx4 v1, s[4:7], s21 offen offset:2048 sc1 lds
 v_pk_mul_f32 v[168:169], v[168:169], v[172:173]
 v_pk_mul_f32 v[170:171], v[170:171], v[174:175]
 v_pk_mul_f32 v[224:225], v[224:225], v[228:229]
 v_pk_mul_f32 v[226:227], v[226:227], v[230:231]
 v_pk_add_f32 v[24:25], v[24:25], 1.0 op_sel_hi:[1,0]
 v_pk_add_f32 v[26:27], v[26:27], 1.0 op_sel_hi:[1,0]
 v_pk_add_f32 v[28:29], v[28:29], 1.0 op_sel_hi:[1,0]
 v_pk_add_f32 v[30:31], v[30:31], 1.0 op_sel_hi:[1,0]
 v_rcp_f32 v24, v24
 v_rcp_f32 v25, v25
 v_rcp_f32 v26, v26
 v_rcp_f32 v27, v27
 v_rcp_f32 v28, v28
 v_rcp_f32 v29, v29
 v_rcp_f32 v30, v30
 v_rcp_f32 v31, v31
 buffer_load_dwordx4 v1, s[4:7], s21 offen offset:3072 sc1 lds
 v_pk_mul_f32 v[168:169], v[168:169], v[24:25]
 v_pk_mul_f32 v[170:171], v[170:171], v[26:27]
 v_pk_mul_f32 v[224:225], v[224:225], v[28:29]
 v_pk_mul_f32 v[226:227], v[226:227], v[30:31]
 v_cvt_pk_bf16_f32 v32, v168, v169
 v_cvt_pk_bf16_f32 v33, v170, v171
 v_cvt_pk_bf16_f32 v34, v224, v225
 v_cvt_pk_bf16_f32 v35, v226, v227
 v_pk_mul_f32 v[24:25], v[64:65], v[16:17] op_sel_hi:[1,0]
 v_pk_mul_f32 v[26:27], v[66:67], v[16:17] op_sel_hi:[1,0]
 v_pk_mul_f32 v[28:29], v[120:121], v[18:19] op_sel_hi:[1,0]
 v_pk_mul_f32 v[30:31], v[122:123], v[18:19] op_sel_hi:[1,0]
 v_permlane16_swap_b32 v32, v34
 v_permlane16_swap_b32 v33, v35
 buffer_store_dwordx4 v[32:35], v15, s[4:7], s35 offen sc1
 s_add_u32 s35, s35, s27
 v_exp_f32 v24, v24
 v_exp_f32 v25, v25
 v_exp_f32 v26, v26
 v_exp_f32 v27, v27
 v_exp_f32 v28, v28
 v_exp_f32 v29, v29
 v_exp_f32 v30, v30
 v_exp_f32 v31, v31
 s_add_u32 s21, s22, 65536
 s_add_u32 m0, s19, 0
 s_nop 0
 buffer_load_dwordx4 v1, s[4:7], s21 offen sc1 lds
 v_pk_mul_f32 v[64:65], v[64:65], v[68:69]
 v_pk_mul_f32 v[66:67], v[66:67], v[70:71]
 v_pk_mul_f32 v[120:121], v[120:121], v[124:125]
 v_pk_mul_f32 v[122:123], v[122:123], v[126:127]
 v_pk_add_f32 v[24:25], v[24:25], 1.0 op_sel_hi:[1,0]
 v_pk_add_f32 v[26:27], v[26:27], 1.0 op_sel_hi:[1,0]
 v_pk_add_f32 v[28:29], v[28:29], 1.0 op_sel_hi:[1,0]
 v_pk_add_f32 v[30:31], v[30:31], 1.0 op_sel_hi:[1,0]
 v_rcp_f32 v24, v24
 v_rcp_f32 v25, v25
 v_rcp_f32 v26, v26
 v_rcp_f32 v27, v27
 v_rcp_f32 v28, v28
 v_rcp_f32 v29, v29
 v_rcp_f32 v30, v30
 v_rcp_f32 v31, v31
 buffer_load_dwordx4 v1, s[4:7], s21 offen offset:1024 sc1 lds
 v_pk_mul_f32 v[64:65], v[64:65], v[24:25]
 v_pk_mul_f32 v[66:67], v[66:67], v[26:27]
 v_pk_mul_f32 v[120:121], v[120:121], v[28:29]
 v_pk_mul_f32 v[122:123], v[122:123], v[30:31]
 v_cvt_pk_bf16_f32 v4, v64, v65
 v_cvt_pk_bf16_f32 v5, v66, v67
 v_cvt_pk_bf16_f32 v6, v120, v121
 v_cvt_pk_bf16_f32 v7, v122, v123
 v_pk_mul_f32 v[24:25], v[176:177], v[20:21] op_sel_hi:[1,0]
 v_pk_mul_f32 v[26:27], v[178:179], v[20:21] op_sel_hi:[1,0]
 v_pk_mul_f32 v[28:29], v[232:233], v[22:23] op_sel_hi:[1,0]
 v_pk_mul_f32 v[30:31], v[234:235], v[22:23] op_sel_hi:[1,0]
 v_permlane16_swap_b32 v4, v6
 v_permlane16_swap_b32 v5, v7
 buffer_store_dwordx4 v[4:7], v15, s[4:7], s34 offen sc1
 s_add_u32 s34, s34, s27
 v_exp_f32 v24, v24
 v_exp_f32 v25, v25
 v_exp_f32 v26, v26
 v_exp_f32 v27, v27
 v_exp_f32 v28, v28
 v_exp_f32 v29, v29
 v_exp_f32 v30, v30
 v_exp_f32 v31, v31
 buffer_load_dwordx4 v1, s[4:7], s21 offen offset:2048 sc1 lds
 v_pk_mul_f32 v[176:177], v[176:177], v[180:181]
 v_pk_mul_f32 v[178:179], v[178:179], v[182:183]
 v_pk_mul_f32 v[232:233], v[232:233], v[236:237]
 v_pk_mul_f32 v[234:235], v[234:235], v[238:239]
 v_pk_add_f32 v[24:25], v[24:25], 1.0 op_sel_hi:[1,0]
 v_pk_add_f32 v[26:27], v[26:27], 1.0 op_sel_hi:[1,0]
 v_pk_add_f32 v[28:29], v[28:29], 1.0 op_sel_hi:[1,0]
 v_pk_add_f32 v[30:31], v[30:31], 1.0 op_sel_hi:[1,0]
 v_rcp_f32 v24, v24
 v_rcp_f32 v25, v25
 v_rcp_f32 v26, v26
 v_rcp_f32 v27, v27
 v_rcp_f32 v28, v28
 v_rcp_f32 v29, v29
 v_rcp_f32 v30, v30
 v_rcp_f32 v31, v31
 buffer_load_dwordx4 v1, s[4:7], s21 offen offset:3072 sc1 lds
 v_pk_mul_f32 v[176:177], v[176:177], v[24:25]
 v_pk_mul_f32 v[178:179], v[178:179], v[26:27]
 v_pk_mul_f32 v[232:233], v[232:233], v[28:29]
 v_pk_mul_f32 v[234:235], v[234:235], v[30:31]
 v_cvt_pk_bf16_f32 v32, v176, v177
 v_cvt_pk_bf16_f32 v33, v178, v179
 v_cvt_pk_bf16_f32 v34, v232, v233
 v_cvt_pk_bf16_f32 v35, v234, v235
 v_pk_mul_f32 v[24:25], v[72:73], v[16:17] op_sel_hi:[1,0]
 v_pk_mul_f32 v[26:27], v[74:75], v[16:17] op_sel_hi:[1,0]
 v_pk_mul_f32 v[28:29], v[128:129], v[18:19] op_sel_hi:[1,0]
 v_pk_mul_f32 v[30:31], v[130:131], v[18:19] op_sel_hi:[1,0]
 s_cmp_lg_u32 s16, 0
 s_cbranch_scc1 L_look_39
 buffer_load_dword v13, v12, s[4:7], s28 offen sc1
L_look_39:
 v_permlane16_swap_b32 v32, v34
 v_permlane16_swap_b32 v33, v35
 buffer_store_dwordx4 v[32:35], v15, s[4:7], s35 offen sc1
 s_add_u32 s35, s35, s27
 v_exp_f32 v24, v24
 v_exp_f32 v25, v25
 v_exp_f32 v26, v26
 v_exp_f32 v27, v27
 v_exp_f32 v28, v28
 v_exp_f32 v29, v29
 v_exp_f32 v30, v30
 v_exp_f32 v31, v31
 s_add_u32 s21, s22, 131072
 s_add_u32 m0, s19, 16384
 s_nop 0
 buffer_load_dwordx4 v1, s[4:7], s21 offen sc1 lds
 v_pk_mul_f32 v[72:73], v[72:73], v[76:77]
 v_pk_mul_f32 v[74:75], v[74:75], v[78:79]
 v_pk_mul_f32 v[128:129], v[128:129], v[132:133]
 v_pk_mul_f32 v[130:131], v[130:131], v[134:135]
 v_pk_add_f32 v[24:25], v[24:25], 1.0 op_sel_hi:[1,0]
 v_pk_add_f32 v[26:27], v[26:27], 1.0 op_sel_hi:[1,0]
 v_pk_add_f32 v[28:29], v[28:29], 1.0 op_sel_hi:[1,0]
 v_pk_add_f32 v[30:31], v[30:31], 1.0 op_sel_hi:[1,0]
 v_rcp_f32 v24, v24
 v_rcp_f32 v25, v25
 v_rcp_f32 v26, v26
 v_rcp_f32 v27, v27
 v_rcp_f32 v28, v28
 v_rcp_f32 v29, v29
 v_rcp_f32 v30, v30
 v_rcp_f32 v31, v31
 buffer_load_dwordx4 v1, s[4:7], s21 offen offset:1024 sc1 lds
 v_pk_mul_f32 v[72:73], v[72:73], v[24:25]
 v_pk_mul_f32 v[74:75], v[74:75], v[26:27]
 v_pk_mul_f32 v[128:129], v[128:129], v[28:29]
 v_pk_mul_f32 v[130:131], v[130:131], v[30:31]
 v_cvt_pk_bf16_f32 v4, v72, v73
 v_cvt_pk_bf16_f32 v5, v74, v75
 v_cvt_pk_bf16_f32 v6, v128, v129
 v_cvt_pk_bf16_f32 v7, v130, v131
 v_pk_mul_f32 v[24:25], v[184:185], v[20:21] op_sel_hi:[1,0]
 v_pk_mul_f32 v[26:27], v[186:187], v[20:21] op_sel_hi:[1,0]
 v_pk_mul_f32 v[28:29], v[240:241], v[22:23] op_sel_hi:[1,0]
 v_pk_mul_f32 v[30:31], v[242:243], v[22:23] op_sel_hi:[1,0]
 v_permlane16_swap_b32 v4, v6
 v_permlane16_swap_b32 v5, v7
 buffer_store_dwordx4 v[4:7], v15, s[4:7], s34 offen sc1
 s_add_u32 s34, s34, s27
 v_exp_f32 v24, v24
 v_exp_f32 v25, v25
 v_exp_f32 v26, v26
 v_exp_f32 v27, v27
 v_exp_f32 v28, v28
 v_exp_f32 v29, v29
 v_exp_f32 v30, v30
 v_exp_f32 v31, v31
 buffer_load_dwordx4 v1, s[4:7], s21 offen offset:2048 sc1 lds
 v_pk_mul_f32 v[184:185], v[184:185], v[188:189]
 v_pk_mul_f32 v[186:187], v[186:187], v[190:191]
 v_pk_mul_f32 v[240:241], v[240:241], v[244:245]
 v_pk_mul_f32 v[242:243], v[242:243], v[246:247]
 v_pk_add_f32 v[24:25], v[24:25], 1.0 op_sel_hi:[1,0]
 v_pk_add_f32 v[26:27], v[26:27], 1.0 op_sel_hi:[1,0]
 v_pk_add_f32 v[28:29], v[28:29], 1.0 op_sel_hi:[1,0]
 v_pk_add_f32 v[30:31], v[30:31], 1.0 op_sel_hi:[1,0]
 v_rcp_f32 v24, v24
 v_rcp_f32 v25, v25
 v_rcp_f32 v26, v26
 v_rcp_f32 v27, v27
 v_rcp_f32 v28, v28
 v_rcp_f32 v29, v29
 v_rcp_f32 v30, v30
 v_rcp_f32 v31, v31
L_hop_18:
 s_cbranch_execz L_ret_8
 buffer_load_dwordx4 v1, s[4:7], s21 offen offset:3072 sc1 lds
 v_pk_mul_f32 v[184:185], v[184:185], v[24:25]
 v_pk_mul_f32 v[186:187], v[186:187], v[26:27]
 v_pk_mul_f32 v[240:241], v[240:241], v[28:29]
 v_pk_mul_f32 v[242:243], v[242:243], v[30:31]
 v_cvt_pk_bf16_f32 v32, v184, v185
 v_cvt_pk_bf16_f32 v33, v186, v187
 v_cvt_pk_bf16_f32 v34, v240, v241
 v_cvt_pk_bf16_f32 v35, v242, v243
 s_waitcnt vmcnt(6)
 v_cmp_gt_u32 vcc, 32, v13
 v_pk_mul_f32 v[24:25], v[80:81], v[16:17] op_sel_hi:[1,0]
 v_pk_mul_f32 v[26:27], v[82:83], v[16:17] op_sel_hi:[1,0]
 v_pk_mul_f32 v[28:29], v[136:137], v[18:19] op_sel_hi:[1,0]
 v_pk_mul_f32 v[30:31], v[138:139], v[18:19] op_sel_hi:[1,0]
 s_and_b32 s67, s1, vcc_lo
 s_cbranch_scc1 L_poll_40
L_polled_41:
 s_barrier
 s_mov_b32 s23, 0
 buffer_load_dwordx4 v[144:147], v8, s[4:7], s23 offen sc1
 buffer_load_dwordx4 v[148:151], v9, s[4:7], s23 offen sc1
 buffer_load_dwordx4 v[152:155], v10, s[4:7], s23 offen sc1
 buffer_load_dwordx4 v[156:159], v11, s[4:7], s23 offen sc1
 s_mov_b32 s23, 6144
 buffer_load_dwordx4 v[160:163], v8, s[4:7], s23 offen sc1
 buffer_load_dwordx4 v[164:167], v9, s[4:7], s23 offen sc1
 buffer_load_dwordx4 v[168:171], v10, s[4:7], s23 offen sc1
 buffer_load_dwordx4 v[172:175], v11, s[4:7], s23 offen sc1
 v_permlane16_swap_b32 v32, v34
 v_permlane16_swap_b32 v33, v35
 buffer_store_dwordx4 v[32:35], v15, s[4:7], s35 offen sc1
 s_add_u32 s35, s35, s27
 v_exp_f32 v24, v24
 v_exp_f32 v25, v25
 v_exp_f32 v26, v26
 v_exp_f32 v27, v27
 v_exp_f32 v28, v28
 v_exp_f32 v29, v29
 v_exp_f32 v30, v30
 v_exp_f32 v31, v31
 v_pk_mul_f32 v[80:81], v[80:81], v[84:85]
 v_pk_mul_f32 v[82:83], v[82:83], v[86:87]
 v_pk_mul_f32 v[136:137], v[136:137], v[140:141]
 v_pk_mul_f32 v[138:139], v[138:139], v[142:143]
 v_pk_add_f32 v[24:25], v[24:25], 1.0 op_sel_hi:[1,0]
 v_pk_add_f32 v[26:27], v[26:27], 1.0 op_sel_hi:[1,0]
 v_pk_add_f32 v[28:29], v[28:29], 1.0 op_sel_hi:[1,0]
 v_pk_add_f32 v[30:31], v[30:31], 1.0 op_sel_hi:[1,0]
 v_rcp_f32 v24, v24
 v_rcp_f32 v25, v25
 v_rcp_f32 v26, v26
 v_rcp_f32 v27, v27
 v_rcp_f32 v28, v28
 v_rcp_f32 v29, v29
 v_rcp_f32 v30, v30
 v_rcp_f32 v31, v31
 v_pk_mul_f32 v[80:81], v[80:81], v[24:25]
 v_pk_mul_f32 v[82:83], v[82:83], v[26:27]
 v_pk_mul_f32 v[136:137], v[136:137], v[28:29]
 v_pk_mul_f32 v[138:139], v[138:139], v[30:31]
 v_cvt_pk_bf16_f32 v4, v80, v81
 v_cvt_pk_bf16_f32 v5, v82, v83
 v_cvt_pk_bf16_f32 v6, v136, v137
 v_cvt_pk_bf16_f32 v7, v138, v139
 v_pk_mul_f32 v[24:25], v[192:193], v[20:21] op_sel_hi:[1,0]
 v_pk_mul_f32 v[26:27], v[194:195], v[20:21] op_sel_hi:[1,0]
 v_pk_mul_f32 v[28:29], v[248:249], v[22:23] op_sel_hi:[1,0]
 v_pk_mul_f32 v[30:31], v[250:251], v[22:23] op_sel_hi:[1,0]
 v_permlane16_swap_b32 v4, v6
 v_permlane16_swap_b32 v5, v7
 buffer_store_dwordx4 v[4:7], v15, s[4:7], s34 offen sc1
 s_add_u32 s34, s34, s27
 v_exp_f32 v24, v24
 v_exp_f32 v25, v25
 v_exp_f32 v26, v26
 v_exp_f32 v27, v27
 v_exp_f32 v28, v28
 v_exp_f32 v29, v29
 v_exp_f32 v30, v30
 v_exp_f32 v31, v31
 v_pk_mul_f32 v[192:193], v[192:193], v[196:197]
 v_pk_mul_f32 v[194:195], v[194:195], v[198:199]
 v_pk_mul_f32 v[248:249], v[248:249], v[252:253]
 v_pk_mul_f32 v[250:251], v[250:251], v[254:255]
 v_pk_add_f32 v[24:25], v[24:25], 1.0 op_sel_hi:[1,0]
 v_pk_add_f32 v[26:27], v[26:27], 1.0 op_sel_hi:[1,0]
 v_pk_add_f32 v[28:29], v[28:29], 1.0 op_sel_hi:[1,0]
 v_pk_add_f32 v[30:31], v[30:31], 1.0 op_sel_hi:[1,0]
 v_rcp_f32 v24, v24
 v_rcp_f32 v25, v25
 v_rcp_f32 v26, v26
 v_rcp_f32 v27, v27
 v_rcp_f32 v28, v28
 v_rcp_f32 v29, v29
 v_rcp_f32 v30, v30
 v_rcp_f32 v31, v31
 v_pk_mul_f32 v[192:193], v[192:193], v[24:25]
 v_pk_mul_f32 v[194:195], v[194:195], v[26:27]
 v_pk_mul_f32 v[248:249], v[248:249], v[28:29]
 v_pk_mul_f32 v[250:251], v[250:251], v[30:31]
 v_cvt_pk_bf16_f32 v32, v192, v193
 v_cvt_pk_bf16_f32 v33, v194, v195
 v_cvt_pk_bf16_f32 v34, v248, v249
 v_cvt_pk_bf16_f32 v35, v250, v251
 s_nop 0
 v_permlane16_swap_b32 v32, v34
 v_permlane16_swap_b32 v33, v35
 buffer_store_dwordx4 v[32:35], v15, s[4:7], s35 offen sc1
 s_add_u32 s35, s35, s27
 ds_read_b128 a[0:3], v1 offset:32768
 ds_read_b128 a[4:7], v1 offset:40960
 ds_read_b128 a[8:11], v1 offset:33792
 ds_read_b128 a[12:15], v1 offset:41984
 ds_read_b128 a[16:19], v1 offset:34816
 ds_read_b128 a[20:23], v1 offset:43008
 s_waitcnt vmcnt(7) lgkmcnt(5)
 v_mfma_f32_16x16x32_bf16 v[96:99], a[0:3], v[148:151], 0
 ds_read_b128 a[24:27], v1 offset:35840
 s_mov_b32 s23, 7168
 s_waitcnt lgkmcnt(5)
 v_mfma_f32_16x16x32_bf16 v[96:99], a[4:7], v[156:159], v[96:99]
 buffer_load_dwordx4 v[176:179], v8, s[4:7], s23 offen sc1
 v_mfma_f32_16x16x32_bf16 v[64:67], a[4:7], v[152:155], 0
 ds_read_b128 a[28:31], v1 offset:44032
 s_waitcnt lgkmcnt(4)
 v_mfma_f32_16x16x32_bf16 v[64:67], a[0:3], v[144:147], v[64:67]
 v_add_u32 v16, 0x10000, v1
 v_mfma_f32_16x16x32_bf16 v[68:71], a[8:11], v[144:147], 0
 ds_read_b128 a[0:3], v1 offset:36864
 v_mfma_f32_16x16x32_bf16 v[68:71], a[12:15], v[152:155], v[68:71]
 v_add_u32 v17, 0x20000, v1
 v_mfma_f32_16x16x32_bf16 v[100:103], a[12:15], v[156:159], 0
 ds_read_b128 a[4:7], v1 offset:45056
 s_waitcnt lgkmcnt(4)
 v_mfma_f32_16x16x32_bf16 v[100:103], a[8:11], v[148:151], v[100:103]
 buffer_load_dwordx4 v[180:183], v9, s[4:7], s23 offen sc1
 v_mfma_f32_16x16x32_bf16 v[104:107], a[16:19], v[148:151], 0
 ds_read_b128 a[8:11], v1 offset:37888
 v_mfma_f32_16x16x32_bf16 v[104:107], a[20:23], v[156:159], v[104:107]
 v_mfma_f32_16x16x32_bf16 v[72:75], a[20:23], v[152:155], 0
 ds_read_b128 a[12:15], v1 offset:46080
 s_waitcnt lgkmcnt(4)
 v_mfma_f32_16x16x32_bf16 v[72:75], a[16:19], v[144:147], v[72:75]
 v_lshlrev_b32 v23, 2, v0
 v_mfma_f32_16x16x32_bf16 v[76:79], a[24:27], v[144:147], 0
 ds_read_b128 a[16:19], v1 offset:38912
 v_mfma_f32_16x16x32_bf16 v[76:79], a[28:31], v[152:155], v[76:79]
 buffer_load_dwordx4 v[184:187], v10, s[4:7], s23 offen sc1
 v_mfma_f32_16x16x32_bf16 v[108:111], a[28:31], v[156:159], 0
 ds_read_b128 a[20:23], v1 offset:47104
 s_waitcnt lgkmcnt(4)
 v_mfma_f32_16x16x32_bf16 v[108:111], a[24:27], v[148:151], v[108:111]
 v_mfma_f32_16x16x32_bf16 v[112:115], a[0:3], v[148:151], 0
 ds_read_b128 a[24:27], v1 offset:39936
 v_add_u32 v18, s19, v1
 v_mfma_f32_16x16x32_bf16 v[112:115], a[4:7], v[156:159], v[112:115]
 v_mfma_f32_16x16x32_bf16 v[80:83], a[4:7], v[152:155], 0
 ds_read_b128 a[28:31], v1 offset:48128
 s_waitcnt lgkmcnt(4)
 v_mfma_f32_16x16x32_bf16 v[80:83], a[0:3], v[144:147], v[80:83]
 buffer_load_dwordx4 v[188:191], v11, s[4:7], s23 offen sc1
 v_mfma_f32_16x16x32_bf16 v[84:87], a[8:11], v[144:147], 0
 ds_read_b128 a[0:3], v1 offset:49152
 s_mov_b32 s23, 13312
 v_mfma_f32_16x16x32_bf16 v[84:87], a[12:15], v[152:155], v[84:87]
 v_mfma_f32_16x16x32_bf16 v[116:119], a[12:15], v[156:159], 0
 ds_read_b128 a[4:7], v1 offset:57344
 s_waitcnt lgkmcnt(4)
 v_mfma_f32_16x16x32_bf16 v[116:119], a[8:11], v[148:151], v[116:119]
 v_add_u32 v19, 0x10000, v18
 v_mfma_f32_16x16x32_bf16 v[120:123], a[16:19], v[148:151], 0
 ds_read_b128 a[8:11], v1 offset:50176
 v_mfma_f32_16x16x32_bf16 v[120:123], a[20:23], v[156:159], v[120:123]
 buffer_load_dwordx4 v[192:195], v8, s[4:7], s23 offen sc1
 v_mfma_f32_16x16x32_bf16 v[88:91], a[20:23], v[152:155], 0
 ds_read_b128 a[12:15], v1 offset:58368
 s_waitcnt lgkmcnt(4)
 v_mfma_f32_16x16x32_bf16 v[88:91], a[16:19], v[144:147], v[88:91]
 v_mfma_f32_16x16x32_bf16 v[92:95], a[24:27], v[144:147], 0
 ds_read_b128 a[16:19], v1 offset:51200
 v_add_u32 v21, 0x20000, v18
 v_mfma_f32_16x16x32_bf16 v[92:95], a[28:31], v[152:155], v[92:95]
 v_mfma_f32_16x16x32_bf16 v[124:127], a[28:31], v[156:159], 0
 ds_read_b128 a[20:23], v1 offset:59392
 s_waitcnt vmcnt(8) lgkmcnt(4)
 v_mfma_f32_16x16x32_bf16 v[124:127], a[24:27], v[148:151], v[124:127]
 v_mfma_f32_16x16x32_bf16 v[96:99], a[0:3], v[164:167], v[96:99]
 ds_read_b128 a[24:27], v1 offset:52224
 v_mfma_f32_16x16x32_bf16 v[96:99], a[4:7], v[172:175], v[96:99]
 buffer_load_dwordx4 v[196:199], v9, s[4:7], s23 offen sc1
 v_mfma_f32_16x16x32_bf16 v[64:67], a[4:7], v[168:171], v[64:67]
 ds_read_b128 a[28:31], v1 offset:60416
 s_waitcnt lgkmcnt(4)
 v_mfma_f32_16x16x32_bf16 v[64:67], a[0:3], v[160:163], v[64:67]
 v_mfma_f32_16x16x32_bf16 v[68:71], a[8:11], v[160:163], v[68:71]
 ds_read_b128 a[0:3], v1 offset:53248
 v_mfma_f32_16x16x32_bf16 v[68:71], a[12:15], v[168:171], v[68:71]
 v_mfma_f32_16x16x32_bf16 v[100:103], a[12:15], v[172:175], v[100:103]
 ds_read_b128 a[4:7], v1 offset:61440
 s_waitcnt lgkmcnt(4)
 v_mfma_f32_16x16x32_bf16 v[100:103], a[8:11], v[164:167], v[100:103]
 buffer_load_dwordx4 v[200:203], v10, s[4:7], s23 offen sc1
 v_mfma_f32_16x16x32_bf16 v[104:107], a[16:19], v[164:167], v[104:107]
 ds_read_b128 a[8:11], v1 offset:54272
 v_mfma_f32_16x16x32_bf16 v[104:107], a[20:23], v[172:175], v[104:107]
 v_mfma_f32_16x16x32_bf16 v[72:75], a[20:23], v[168:171], v[72:75]
 ds_read_b128 a[12:15], v1 offset:62464
 s_waitcnt lgkmcnt(4)
 v_mfma_f32_16x16x32_bf16 v[72:75], a[16:19], v[160:163], v[72:75]
 v_mfma_f32_16x16x32_bf16 v[76:79], a[24:27], v[160:163], v[76:79]
 ds_read_b128 a[16:19], v1 offset:55296
 v_mfma_f32_16x16x32_bf16 v[76:79], a[28:31], v[168:171], v[76:79]
 buffer_load_dwordx4 v[204:207], v11, s[4:7], s23 offen sc1
 v_mfma_f32_16x16x32_bf16 v[108:111], a[28:31], v[172:175], v[108:111]
 ds_read_b128 a[20:23], v1 offset:63488
 s_waitcnt lgkmcnt(4)
 v_mfma_f32_16x16x32_bf16 v[108:111], a[24:27], v[164:167], v[108:111]
 s_mov_b32 s23, 14336
 v_mfma_f32_16x16x32_bf16 v[112:115], a[0:3], v[164:167], v[112:115]
 ds_read_b128 a[24:27], v1 offset:56320
 v_mfma_f32_16x16x32_bf16 v[112:115], a[4:7], v[172:175], v[112:115]
 v_mfma_f32_16x16x32_bf16 v[80:83], a[4:7], v[168:171], v[80:83]
 ds_read_b128 a[28:31], v1 offset:64512
 s_waitcnt lgkmcnt(4)
 v_mfma_f32_16x16x32_bf16 v[80:83], a[0:3], v[160:163], v[80:83]
 buffer_load_dwordx4 v[208:211], v8, s[4:7], s23 offen sc1
 v_mfma_f32_16x16x32_bf16 v[84:87], a[8:11], v[160:163], v[84:87]
 s_waitcnt vmcnt(9)
 s_barrier
 s_cmp_lg_u32 s16, 0
 s_cbranch_scc1 L_arrived_42
 s_sub_u32 s67, s31, s0
 s_mov_b64 exec, 0xff
 buffer_atomic_add v2, v3, s[4:7], s67 offen sc1
 s_mov_b64 exec, -1
L_arrived_42:
 ds_read_b128 a[0:3], v16
 v_mfma_f32_16x16x32_bf16 v[84:87], a[12:15], v[168:171], v[84:87]
 v_mfma_f32_16x16x32_bf16 v[116:119], a[12:15], v[172:175], v[116:119]
 ds_read_b128 a[4:7], v16 offset:8192
 s_waitcnt lgkmcnt(4)
 v_mfma_f32_16x16x32_bf16 v[116:119], a[8:11], v[164:167], v[116:119]
 v_mfma_f32_16x16x32_bf16 v[120:123], a[16:19], v[164:167], v[120:123]
 ds_read_b128 a[8:11], v16 offset:1024
 v_mfma_f32_16x16x32_bf16 v[120:123], a[20:23], v[172:175], v[120:123]
 buffer_load_dwordx4 v[212:215], v9, s[4:7], s23 offen sc1
 v_mfma_f32_16x16x32_bf16 v[88:91], a[20:23], v[168:171], v[88:91]
 ds_read_b128 a[12:15], v16 offset:9216
 s_waitcnt lgkmcnt(4)
 v_mfma_f32_16x16x32_bf16 v[88:91], a[16:19], v[160:163], v[88:91]
 v_mfma_f32_16x16x32_bf16 v[92:95], a[24:27], v[160:163], v[92:95]
 ds_read_b128 a[16:19], v16 offset:2048
 v_mfma_f32_16x16x32_bf16 v[92:95], a[28:31], v[168:171], v[92:95]
 v_mfma_f32_16x16x32_bf16 v[124:127], a[28:31], v[172:175], v[124:127]
 ds_read_b128 a[20:23], v16 offset:10240
 s_waitcnt vmcnt(6) lgkmcnt(4)
 v_mfma_f32_16x16x32_bf16 v[124:127], a[24:27], v[164:167], v[124:127]
 v_mfma_f32_16x16x32_bf16 v[96:99], a[0:3], v[180:183], v[96:99]
 ds_read_b128 a[24:27], v16 offset:3072
 v_mfma_f32_16x16x32_bf16 v[96:99], a[4:7], v[188:191], v[96:99]
 buffer_load_dwordx4 v[216:219], v10, s[4:7], s23 offen sc1
 v_mfma_f32_16x16x32_bf16 v[64:67], a[4:7], v[184:187], v[64:67]
 ds_read_b128 a[28:31], v16 offset:11264
 s_waitcnt lgkmcnt(4)
 v_mfma_f32_16x16x32_bf16 v[64:67], a[0:3], v[176:179], v[64:67]
 v_mfma_f32_16x16x32_bf16 v[68:71], a[8:11], v[176:179], v[68:71]
 ds_read_b128 a[0:3], v16 offset:4096
 v_mfma_f32_16x16x32_bf16 v[68:71], a[12:15], v[184:187], v[68:71]
 buffer_load_dwordx4 v[220:223], v11, s[4:7], s23 offen sc1
 v_mfma_f32_16x16x32_bf16 v[100:103], a[12:15], v[188:191], v[100:103]
 ds_read_b128 a[4:7], v16 offset:12288
 s_waitcnt lgkmcnt(4)
 v_mfma_f32_16x16x32_bf16 v[100:103], a[8:11], v[180:183], v[100:103]
 s_mov_b32 s23, 20480
 v_mfma_f32_16x16x32_bf16 v[104:107], a[16:19], v[180:183], v[104:107]
 ds_read_b128 a[8:11], v16 offset:5120
 v_mfma_f32_16x16x32_bf16 v[104:107], a[20:23], v[188:191], v[104:107]
 buffer_load_dwordx4 v[224:227], v8, s[4:7], s23 offen sc1
 v_mfma_f32_16x16x32_bf16 v[72:75], a[20:23], v[184:187], v[72:75]
 ds_read_b128 a[12:15], v16 offset:13312
 s_waitcnt lgkmcnt(4)
 v_mfma_f32_16x16x32_bf16 v[72:75], a[16:19], v[176:179], v[72:75]
 v_mfma_f32_16x16x32_bf16 v[76:79], a[24:27], v[176:179], v[76:79]
 ds_read_b128 a[16:19], v16 offset:6144
 v_mfma_f32_16x16x32_bf16 v[76:79], a[28:31], v[184:187], v[76:79]
 buffer_load_dwordx4 v[228:231], v9, s[4:7], s23 offen sc1
 v_mfma_f32_16x16x32_bf16 v[108:111], a[28:31], v[188:191], v[108:111]
 ds_read_b128 a[20:23], v16 offset:14336
 s_waitcnt lgkmcnt(4)
 v_mfma_f32_16x16x32_bf16 v[108:111], a[24:27], v[180:183], v[108:111]
 v_mfma_f32_16x16x32_bf16 v[112:115], a[0:3], v[180:183], v[112:115]
 ds_read_b128 a[24:27], v16 offset:7168
 v_mfma_f32_16x16x32_bf16 v[112:115], a[4:7], v[188:191], v[112:115]
 v_mfma_f32_16x16x32_bf16 v[80:83], a[4:7], v[184:187], v[80:83]
 ds_read_b128 a[28:31], v16 offset:15360
 s_waitcnt lgkmcnt(4)
 v_mfma_f32_16x16x32_bf16 v[80:83], a[0:3], v[176:179], v[80:83]
 buffer_load_dwordx4 v[232:235], v10, s[4:7], s23 offen sc1
 v_mfma_f32_16x16x32_bf16 v[84:87], a[8:11], v[176:179], v[84:87]
 ds_read_b128 a[0:3], v16 offset:16384
 v_mfma_f32_16x16x32_bf16 v[84:87], a[12:15], v[184:187], v[84:87]
 v_mfma_f32_16x16x32_bf16 v[116:119], a[12:15], v[188:191], v[116:119]
 ds_read_b128 a[4:7], v16 offset:24576
 s_waitcnt lgkmcnt(4)
 v_mfma_f32_16x16x32_bf16 v[116:119], a[8:11], v[180:183], v[116:119]
 buffer_load_dword v40, v23, s[4:7], s30 offen sc1
 v_mfma_f32_16x16x32_bf16 v[120:123], a[16:19], v[180:183], v[120:123]
 ds_read_b128 a[8:11], v16 offset:17408
 v_mfma_f32_16x16x32_bf16 v[120:123], a[20:23], v[188:191], v[120:123]
 v_mfma_f32_16x16x32_bf16 v[88:91], a[20:23], v[184:187], v[88:91]
 ds_read_b128 a[12:15], v16 offset:25600
 s_waitcnt lgkmcnt(4)
 v_mfma_f32_16x16x32_bf16 v[88:91], a[16:19], v[176:179], v[88:91]
 buffer_load_dword v41, v23, s[4:7], s30 offen offset:256 sc1
 v_mfma_f32_16x16x32_bf16 v[92:95], a[24:27], v[176:179], v[92:95]
 ds_read_b128 a[16:19], v16 offset:18432
 v_mfma_f32_16x16x32_bf16 v[92:95], a[28:31], v[184:187], v[92:95]
 v_mfma_f32_16x16x32_bf16 v[124:127], a[28:31], v[188:191], v[124:127]
 ds_read_b128 a[20:23], v16 offset:26624
 s_waitcnt vmcnt(9) lgkmcnt(4)
 v_mfma_f32_16x16x32_bf16 v[124:127], a[24:27], v[180:183], v[124:127]
 v_mfma_f32_16x16x32_bf16 v[96:99], a[0:3], v[196:199], v[96:99]
 ds_read_b128 a[24:27], v16 offset:19456
 v_mfma_f32_16x16x32_bf16 v[96:99], a[4:7], v[204:207], v[96:99]
 buffer_load_dwordx4 v[236:239], v11, s[4:7], s23 offen sc1
 s_add_u32 s21, s22, 196608
 s_add_u32 m0, s19, 32768
 s_mov_b32 s23, 21504
 v_mfma_f32_16x16x32_bf16 v[64:67], a[4:7], v[200:203], v[64:67]
 ds_read_b128 a[28:31], v16 offset:27648
 s_waitcnt lgkmcnt(4)
 v_mfma_f32_16x16x32_bf16 v[64:67], a[0:3], v[192:195], v[64:67]
 buffer_load_dwordx4 v1, s[4:7], s21 offen sc1 lds
 v_mfma_f32_16x16x32_bf16 v[68:71], a[8:11], v[192:195], v[68:71]
 ds_read_b128 a[0:3], v16 offset:20480
 v_mfma_f32_16x16x32_bf16 v[68:71], a[12:15], v[200:203], v[68:71]
 buffer_load_dwordx4 v[240:243], v8, s[4:7], s23 offen sc1
 v_mfma_f32_16x16x32_bf16 v[100:103], a[12:15], v[204:207], v[100:103]
 ds_read_b128 a[4:7], v16 offset:28672
 s_waitcnt lgkmcnt(4)
 v_mfma_f32_16x16x32_bf16 v[100:103], a[8:11], v[196:199], v[100:103]
 v_mfma_f32_16x16x32_bf16 v[104:107], a[16:19], v[196:199], v[104:107]
 ds_read_b128 a[8:11], v16 offset:21504
 v_mfma_f32_16x16x32_bf16 v[104:107], a[20:23], v[204:207], v[104:107]
 buffer_load_dwordx4 v1, s[4:7], s21 offen offset:1024 sc1 lds
 v_mfma_f32_16x16x32_bf16 v[72:75], a[20:23], v[200:203], v[72:75]
 ds_read_b128 a[12:15], v16 offset:29696
 s_waitcnt lgkmcnt(4)
 v_mfma_f32_16x16x32_bf16 v[72:75], a[16:19], v[192:195], v[72:75]
 buffer_load_dwordx4 v[244:247], v9, s[4:7], s23 offen sc1
 v_mfma_f32_16x16x32_bf16 v[76:79], a[24:27], v[192:195], v[76:79]
 ds_read_b128 a[16:19], v16 offset:22528
 v_mfma_f32_16x16x32_bf16 v[76:79], a[28:31], v[200:203], v[76:79]
 v_mfma_f32_16x16x32_bf16 v[108:111], a[28:31], v[204:207], v[108:111]
 ds_read_b128 a[20:23], v16 offset:30720
 s_waitcnt lgkmcnt(4)
 v_mfma_f32_16x16x32_bf16 v[108:111], a[24:27], v[196:199], v[108:111]
 buffer_load_dwordx4 v1, s[4:7], s21 offen offset:2048 sc1 lds
 v_mfma_f32_16x16x32_bf16 v[112:115], a[0:3], v[196:199], v[112:115]
 ds_read_b128 a[24:27], v16 offset:23552
 v_mfma_f32_16x16x32_bf16 v[112:115], a[4:7], v[204:207], v[112:115]
 buffer_load_dwordx4 v[248:251], v10, s[4:7], s23 offen sc1
 v_mfma_f32_16x16x32_bf16 v[80:83], a[4:7], v[200:203], v[80:83]
 ds_read_b128 a[28:31], v16 offset:31744
 s_waitcnt lgkmcnt(4)
 v_mfma_f32_16x16x32_bf16 v[80:83], a[0:3], v[192:195], v[80:83]
 v_mfma_f32_16x16x32_bf16 v[84:87], a[8:11], v[192:195], v[84:87]
 s_barrier
 ds_read_b128 a[0:3], v16 offset:32768
 v_mfma_f32_16x16x32_bf16 v[84:87], a[12:15], v[200:203], v[84:87]
 buffer_load_dwordx4 v1, s[4:7], s21 offen offset:3072 sc1 lds
 v_mfma_f32_16x16x32_bf16 v[116:119], a[12:15], v[204:207], v[116:119]
 ds_read_b128 a[4:7], v16 offset:40960
 s_waitcnt lgkmcnt(4)
 v_mfma_f32_16x16x32_bf16 v[116:119], a[8:11], v[196:199], v[116:119]
 buffer_load_dwordx4 v[252:255], v11, s[4:7], s23 offen sc1
 v_mfma_f32_16x16x32_bf16 v[120:123], a[16:19], v[196:199], v[120:123]
 ds_read_b128 a[8:11], v16 offset:33792
 v_mfma_f32_16x16x32_bf16 v[120:123], a[20:23], v[204:207], v[120:123]
 v_mfma_f32_16x16x32_bf16 v[88:91], a[20:23], v[200:203], v[88:91]
 ds_read_b128 a[12:15], v16 offset:41984
 s_waitcnt lgkmcnt(4)
 v_mfma_f32_16x16x32_bf16 v[88:91], a[16:19], v[192:195], v[88:91]
 buffer_load_dword v42, v23, s[4:7], s30 offen offset:512 sc1
 v_mfma_f32_16x16x32_bf16 v[92:95], a[24:27], v[192:195], v[92:95]
 ds_read_b128 a[16:19], v16 offset:34816
 v_mfma_f32_16x16x32_bf16 v[92:95], a[28:31], v[200:203], v[92:95]
 buffer_load_dword v43, v23, s[4:7], s30 offen offset:768 sc1
 v_mfma_f32_16x16x32_bf16 v[124:127], a[28:31], v[204:207], v[124:127]
 ds_read_b128 a[20:23], v16 offset:43008
 s_waitcnt vmcnt(16) lgkmcnt(4)
 v_mfma_f32_16x16x32_bf16 v[124:127], a[24:27], v[196:199], v[124:127]
 v_mfma_f32_16x16x32_bf16 v[96:99], a[0:3], v[212:215], v[96:99]
 ds_read_b128 a[24:27], v16 offset:35840
 s_cmp_lg_u32 s16, 0
 s_cbranch_scc1 L_look_43
 buffer_load_dword v13, v12, s[4:7], s29 offen sc1
L_look_43:
 v_mfma_f32_16x16x32_bf16 v[96:99], a[4:7], v[220:223], v[96:99]
 s_mov_b32 s23, 27648
 v_mfma_f32_16x16x32_bf16 v[64:67], a[4:7], v[216:219], v[64:67]
 ds_read_b128 a[28:31], v16 offset:44032
 s_waitcnt lgkmcnt(4)
 v_mfma_f32_16x16x32_bf16 v[64:67], a[0:3], v[208:211], v[64:67]
 s_add_u32 s21, s22, 262144
 s_add_u32 m0, s19, 49152
 v_mfma_f32_16x16x32_bf16 v[68:71], a[8:11], v[208:211], v[68:71]
 ds_read_b128 a[0:3], v16 offset:36864
 v_mfma_f32_16x16x32_bf16 v[68:71], a[12:15], v[216:219], v[68:71]
 v_mfma_f32_16x16x32_bf16 v[100:103], a[12:15], v[220:223], v[100:103]
 ds_read_b128 a[4:7], v16 offset:45056
 s_waitcnt lgkmcnt(4)
 v_mfma_f32_16x16x32_bf16 v[100:103], a[8:11], v[212:215], v[100:103]
 v_mfma_f32_16x16x32_bf16 v[104:107], a[16:19], v[212:215], v[104:107]
 ds_read_b128 a[8:11], v16 offset:37888
 v_mfma_f32_16x16x32_bf16 v[104:107], a[20:23], v[220:223], v[104:107]
 buffer_load_dwordx4 v[128:131], v8, s[4:7], s23 offen sc1
 v_mfma_f32_16x16x32_bf16 v[72:75], a[20:23], v[216:219], v[72:75]
 ds_read_b128 a[12:15], v16 offset:46080
 s_waitcnt lgkmcnt(4)
 v_mfma_f32_16x16x32_bf16 v[72:75], a[16:19], v[208:211], v[72:75]
 buffer_load_dwordx4 v1, s[4:7], s21 offen sc1 lds
 v_mfma_f32_16x16x32_bf16 v[76:79], a[24:27], v[208:211], v[76:79]
 ds_read_b128 a[16:19], v16 offset:38912
 v_mfma_f32_16x16x32_bf16 v[76:79], a[28:31], v[216:219], v[76:79]
 buffer_load_dwordx4 v[132:135], v9, s[4:7], s23 offen sc1
 v_mfma_f32_16x16x32_bf16 v[108:111], a[28:31], v[220:223], v[108:111]
 ds_read_b128 a[20:23], v16 offset:47104
 s_waitcnt lgkmcnt(4)
 v_mfma_f32_16x16x32_bf16 v[108:111], a[24:27], v[212:215], v[108:111]
 ds_write_b128 v19, a[96:99]
 v_mfma_f32_16x16x32_bf16 v[112:115], a[0:3], v[212:215], v[112:115]
 v_mfma_f32_16x16x32_bf16 v[112:115], a[4:7], v[220:223], v[112:115]
 buffer_load_dwordx4 v[136:139], v10, s[4:7], s23 offen sc1
 v_mfma_f32_16x16x32_bf16 v[80:83], a[4:7], v[216:219], v[80:83]
 ds_read_b128 a[24:27], v16 offset:39936
 s_waitcnt lgkmcnt(4)
 v_mfma_f32_16x16x32_bf16 v[80:83], a[0:3], v[208:211], v[80:83]
 ds_read_b128 a[28:31], v16 offset:48128
 v_mfma_f32_16x16x32_bf16 v[84:87], a[8:11], v[208:211], v[84:87]
 ds_read_b128 a[0:3], v16 offset:49152
 v_mfma_f32_16x16x32_bf16 v[84:87], a[12:15], v[216:219], v[84:87]
 buffer_load_dwordx4 v1, s[4:7], s21 offen offset:1024 sc1 lds
 v_mfma_f32_16x16x32_bf16 v[116:119], a[12:15], v[220:223], v[116:119]
 ds_read_b128 a[4:7], v16 offset:57344
 s_waitcnt lgkmcnt(5)
 v_mfma_f32_16x16x32_bf16 v[116:119], a[8:11], v[212:215], v[116:119]
 buffer_load_dwordx4 v[140:143], v11, s[4:7], s23 offen sc1
 v_mfma_f32_16x16x32_bf16 v[120:123], a[16:19], v[212:215], v[120:123]
 ds_read_b128 a[8:11], v16 offset:50176
 v_mfma_f32_16x16x32_bf16 v[120:123], a[20:23], v[220:223], v[120:123]
 ds_write_b128 v19, a[100:103] offset:1024
 v_mfma_f32_16x16x32_bf16 v[88:91], a[20:23], v[216:219], v[88:91]
 s_waitcnt lgkmcnt(4)
 v_mfma_f32_16x16x32_bf16 v[88:91], a[16:19], v[208:211], v[88:91]
 buffer_load_dword v44, v23, s[4:7], s30 offen offset:1024 sc1
 v_mfma_f32_16x16x32_bf16 v[92:95], a[24:27], v[208:211], v[92:95]
 ds_read_b128 a[12:15], v16 offset:58368
 v_mfma_f32_16x16x32_bf16 v[92:95], a[28:31], v[216:219], v[92:95]
 buffer_load_dword v45, v23, s[4:7], s30 offen offset:1280 sc1
 v_mfma_f32_16x16x32_bf16 v[124:127], a[28:31], v[220:223], v[124:127]
 ds_read_b128 a[16:19], v16 offset:51200
 s_waitcnt vmcnt(18) lgkmcnt(4)
 v_mfma_f32_16x16x32_bf16 v[124:127], a[24:27], v[212:215], v[124:127]
 ds_read_b128 a[20:23], v16 offset:59392
 v_mfma_f32_16x16x32_bf16 v[96:99], a[0:3], v[228:231], v[96:99]
 ds_read_b128 a[24:27], v16 offset:52224
 v_mfma_f32_16x16x32_bf16 v[96:99], a[4:7], v[236:239], v[96:99]
 buffer_load_dwordx4 v1, s[4:7], s21 offen offset:2048 sc1 lds
 v_mfma_f32_16x16x32_bf16 v[64:67], a[4:7], v[232:235], v[64:67]
 ds_read_b128 a[28:31], v16 offset:60416
 s_waitcnt lgkmcnt(4)
 v_mfma_f32_16x16x32_bf16 v[64:67], a[0:3], v[224:227], v[64:67]
 v_mfma_f32_16x16x32_bf16 v[68:71], a[8:11], v[224:227], v[68:71]
 ds_read_b128 a[0:3], v16 offset:53248
 v_mfma_f32_16x16x32_bf16 v[68:71], a[12:15], v[232:235], v[68:71]
 ds_write_b128 v19, a[104:107] offset:2048
 v_mfma_f32_16x16x32_bf16 v[100:103], a[12:15], v[236:239], v[100:103]
 s_waitcnt lgkmcnt(4)
 v_mfma_f32_16x16x32_bf16 v[100:103], a[8:11], v[228:231], v[100:103]
 v_mfma_f32_16x16x32_bf16 v[104:107], a[16:19], v[228:231], v[104:107]
 ds_read_b128 a[4:7], v16 offset:61440
 v_mfma_f32_16x16x32_bf16 v[104:107], a[20:23], v[236:239], v[104:107]
 ds_read_b128 a[8:11], v16 offset:54272
 v_mfma_f32_16x16x32_bf16 v[72:75], a[20:23], v[232:235], v[72:75]
 ds_read_b128 a[12:15], v16 offset:62464
 s_waitcnt lgkmcnt(5)
 v_mfma_f32_16x16x32_bf16 v[72:75], a[16:19], v[224:227], v[72:75]
 buffer_load_dwordx4 v1, s[4:7], s21 offen offset:3072 sc1 lds
 v_mfma_f32_16x16x32_bf16 v[76:79], a[24:27], v[224:227], v[76:79]
 ds_read_b128 a[16:19], v16 offset:55296
 v_mfma_f32_16x16x32_bf16 v[76:79], a[28:31], v[232:235], v[76:79]
 v_mfma_f32_16x16x32_bf16 v[108:111], a[28:31], v[236:239], v[108:111]
 ds_read_b128 a[20:23], v16 offset:63488
 s_waitcnt lgkmcnt(4)
 v_mfma_f32_16x16x32_bf16 v[108:111], a[24:27], v[228:231], v[108:111]
 v_mfma_f32_16x16x32_bf16 v[112:115], a[0:3], v[228:231], v[112:115]
 ds_read_b128 a[24:27], v16 offset:56320
 v_mfma_f32_16x16x32_bf16 v[112:115], a[4:7], v[236:239], v[112:115]
 s_waitcnt vmcnt(10)
 v_cmp_gt_u32 vcc, 32, v13
 ds_write_b128 v19, a[108:111] offset:3072
 v_mfma_f32_16x16x32_bf16 v[80:83], a[4:7], v[232:235], v[80:83]
 s_waitcnt lgkmcnt(4)
 v_mfma_f32_16x16x32_bf16 v[80:83], a[0:3], v[224:227], v[80:83]
 v_mfma_f32_16x16x32_bf16 v[84:87], a[8:11], v[224:227], v[84:87]
 ds_read_b128 a[28:31], v16 offset:64512
 v_mfma_f32_16x16x32_bf16 v[84:87], a[12:15], v[232:235], v[84:87]
 buffer_load_dword v46, v23, s[4:7], s30 offen offset:1536 sc1
 v_mfma_f32_16x16x32_bf16 v[116:119], a[12:15], v[236:239], v[116:119]
 s_and_b32 s67, s1, vcc_lo
 s_cbranch_scc1 L_poll_44
L_polled_45:
 s_barrier
 ds_read_b128 a[0:3], v17
 s_waitcnt lgkmcnt(4)
 v_mfma_f32_16x16x32_bf16 v[116:119], a[8:11], v[228:231], v[116:119]
 ds_read_b128 a[4:7], v17 offset:8192
 v_mfma_f32_16x16x32_bf16 v[120:123], a[16:19], v[228:231], v[120:123]
 ds_read_b128 a[8:11], v17 offset:1024
 v_mfma_f32_16x16x32_bf16 v[120:123], a[20:23], v[236:239], v[120:123]
 v_mfma_f32_16x16x32_bf16 v[88:91], a[20:23], v[232:235], v[88:91]
 ds_read_b128 a[12:15], v17 offset:9216
 s_waitcnt lgkmcnt(4)
 v_mfma_f32_16x16x32_bf16 v[88:91], a[16:19], v[224:227], v[88:91]
 buffer_load_dword v47, v23, s[4:7], s30 offen offset:1792 sc1
 v_mfma_f32_16x16x32_bf16 v[92:95], a[24:27], v[224:227], v[92:95]
 ds_read_b128 a[16:19], v17 offset:2048
 v_mfma_f32_16x16x32_bf16 v[92:95], a[28:31], v[232:235], v[92:95]
 v_mfma_f32_16x16x32_bf16 v[124:127], a[28:31], v[236:239], v[124:127]
 ds_read_b128 a[20:23], v17 offset:10240
 s_waitcnt lgkmcnt(4)
 v_mfma_f32_16x16x32_bf16 v[124:127], a[24:27], v[228:231], v[124:127]
 v_mfma_f32_16x16x32_bf16 v[96:99], a[0:3], v[244:247], v[96:99]
 ds_read_b128 a[24:27], v17 offset:3072
 s_mov_b32 s23, 1024
 v_mfma_f32_16x16x32_bf16 v[96:99], a[4:7], v[252:255], v[96:99]
 s_add_u32 s21, s22, 524288
 s_add_u32 m0, s19, 81920
 v_mfma_f32_16x16x32_bf16 v[64:67], a[4:7], v[248:251], v[64:67]
 ds_read_b128 a[28:31], v17 offset:11264
 s_waitcnt lgkmcnt(4)
 v_mfma_f32_16x16x32_bf16 v[64:67], a[0:3], v[240:243], v[64:67]
 v_mfma_f32_16x16x32_bf16 v[68:71], a[8:11], v[240:243], v[68:71]
 ds_read_b128 a[0:3], v17 offset:4096
 v_mfma_f32_16x16x32_bf16 v[68:71], a[12:15], v[248:251], v[68:71]
 buffer_load_dwordx4 v[144:147], v8, s[4:7], s23 offen sc1
 v_mfma_f32_16x16x32_bf16 v[100:103], a[12:15], v[252:255], v[100:103]
 ds_read_b128 a[4:7], v17 offset:12288
 s_waitcnt lgkmcnt(4)
 v_mfma_f32_16x16x32_bf16 v[100:103], a[8:11], v[244:247], v[100:103]
 buffer_load_dwordx4 v1, s[4:7], s21 offen sc1 lds
 v_mfma_f32_16x16x32_bf16 v[104:107], a[16:19], v[244:247], v[104:107]
 ds_read_b128 a[8:11], v17 offset:5120
 v_mfma_f32_16x16x32_bf16 v[104:107], a[20:23], v[252:255], v[104:107]
 v_mfma_f32_16x16x32_bf16 v[72:75], a[20:23], v[248:251], v[72:75]
 ds_read_b128 a[12:15], v17 offset:13312
 s_waitcnt lgkmcnt(4)
 v_mfma_f32_16x16x32_bf16 v[72:75], a[16:19], v[240:243], v[72:75]
 buffer_load_dwordx4 v[148:151], v9, s[4:7], s23 offen sc1
 v_mfma_f32_16x16x32_bf16 v[76:79], a[24:27], v[240:243], v[76:79]
 ds_read_b128 a[16:19], v17 offset:6144
 v_mfma_f32_16x16x32_bf16 v[76:79], a[28:31], v[248:251], v[76:79]
 ds_write_b128 v19, a[112:115] offset:32768
 v_mfma_f32_16x16x32_bf16 v[108:111], a[28:31], v[252:255], v[108:111]
 s_waitcnt lgkmcnt(4)
 v_mfma_f32_16x16x32_bf16 v[108:111], a[24:27], v[244:247], v[108:111]
 v_mfma_f32_16x16x32_bf16 v[112:115], a[0:3], v[244:247], v[112:115]
 ds_read_b128 a[20:23], v17 offset:14336
 v_mfma_f32_16x16x32_bf16 v[112:115], a[4:7], v[252:255], v[112:115]
 buffer_load_dwordx4 v[152:155], v10, s[4:7], s23 offen sc1
 v_mfma_f32_16x16x32_bf16 v[80:83], a[4:7], v[248:251], v[80:83]
 ds_read_b128 a[24:27], v17 offset:7168
 s_waitcnt lgkmcnt(4)
 v_mfma_f32_16x16x32_bf16 v[80:83], a[0:3], v[240:243], v[80:83]
L_hop_19:
 s_cbranch_execz L_ret_9
 buffer_load_dwordx4 v1, s[4:7], s21 offen offset:1024 sc1 lds
 v_mfma_f32_16x16x32_bf16 v[84:87], a[8:11], v[240:243], v[84:87]
 ds_read_b128 a[28:31], v17 offset:15360
 v_mfma_f32_16x16x32_bf16 v[84:87], a[12:15], v[248:251], v[84:87]
 ds_read_b128 a[0:3], v17 offset:16384
 v_mfma_f32_16x16x32_bf16 v[116:119], a[12:15], v[252:255], v[116:119]
 ds_read_b128 a[4:7], v17 offset:24576
 s_waitcnt lgkmcnt(4)
 v_mfma_f32_16x16x32_bf16 v[116:119], a[8:11], v[244:247], v[116:119]
 buffer_load_dwordx4 v[156:159], v11, s[4:7], s23 offen sc1
 v_mfma_f32_16x16x32_bf16 v[120:123], a[16:19], v[244:247], v[120:123]
 ds_read_b128 a[8:11], v17 offset:17408
 v_mfma_f32_16x16x32_bf16 v[120:123], a[20:23], v[252:255], v[120:123]
 ds_write_b128 v19, a[116:119] offset:33792
 v_mfma_f32_16x16x32_bf16 v[88:91], a[20:23], v[248:251], v[88:91]
 s_waitcnt lgkmcnt(4)
 v_mfma_f32_16x16x32_bf16 v[88:91], a[16:19], v[240:243], v[88:91]
 s_mov_b32 s23, 2048
 v_mfma_f32_16x16x32_bf16 v[92:95], a[24:27], v[240:243], v[92:95]
 ds_read_b128 a[12:15], v17 offset:25600
 v_mfma_f32_16x16x32_bf16 v[92:95], a[28:31], v[248:251], v[92:95]
 buffer_load_dwordx4 v[160:163], v8, s[4:7], s23 offen sc1
 v_mfma_f32_16x16x32_bf16 v[124:127], a[28:31], v[252:255], v[124:127]
 ds_read_b128 a[16:19], v17 offset:18432
 s_waitcnt vmcnt(13) lgkmcnt(4)
 v_mfma_f32_16x16x32_bf16 v[124:127], a[24:27], v[244:247], v[124:127]
 ds_read_b128 a[20:23], v17 offset:26624
 v_mfma_f32_16x16x32_bf16 v[96:99], a[0:3], v[132:135], v[96:99]
 ds_read_b128 a[24:27], v17 offset:19456
 v_mfma_f32_16x16x32_bf16 v[96:99], a[4:7], v[140:143], v[96:99]
 buffer_load_dwordx4 v[164:167], v9, s[4:7], s23 offen sc1
 v_mfma_f32_16x16x32_bf16 v[64:67], a[4:7], v[136:139], v[64:67]
 ds_read_b128 a[28:31], v17 offset:27648
 s_waitcnt lgkmcnt(4)
 v_mfma_f32_16x16x32_bf16 v[64:67], a[0:3], v[128:131], v[64:67]
 buffer_load_dwordx4 v1, s[4:7], s21 offen offset:2048 sc1 lds
 v_mfma_f32_16x16x32_bf16 v[68:71], a[8:11], v[128:131], v[68:71]
 ds_read_b128 a[0:3], v17 offset:20480
 v_mfma_f32_16x16x32_bf16 v[68:71], a[12:15], v[136:139], v[68:71]
 v_mfma_f32_16x16x32_bf16 v[100:103], a[12:15], v[140:143], v[100:103]
 ds_read_b128 a[4:7], v17 offset:28672
 s_waitcnt lgkmcnt(4)
 v_mfma_f32_16x16x32_bf16 v[100:103], a[8:11], v[132:135], v[100:103]
 buffer_load_dwordx4 v[168:171], v10, s[4:7], s23 offen sc1
 v_mfma_f32_16x16x32_bf16 v[104:107], a[16:19], v[132:135], v[104:107]
 ds_read_b128 a[8:11], v17 offset:21504
 v_mfma_f32_16x16x32_bf16 v[104:107], a[20:23], v[140:143], v[104:107]
 v_mfma_f32_16x16x32_bf16 v[72:75], a[20:23], v[136:139], v[72:75]
 ds_read_b128 a[12:15], v17 offset:29696
 s_waitcnt lgkmcnt(4)
 v_mfma_f32_16x16x32_bf16 v[72:75], a[16:19], v[128:131], v[72:75]
 ds_write_b128 v19, a[120:123] offset:34816
 v_mfma_f32_16x16x32_bf16 v[76:79], a[24:27], v[128:131], v[76:79]
 v_mfma_f32_16x16x32_bf16 v[76:79], a[28:31], v[136:139], v[76:79]
 v_mfma_f32_16x16x32_bf16 v[108:111], a[28:31], v[140:143], v[108:111]
 ds_read_b128 a[16:19], v17 offset:22528
 s_waitcnt lgkmcnt(4)
 v_mfma_f32_16x16x32_bf16 v[108:111], a[24:27], v[132:135], v[108:111]
 buffer_load_dwordx4 v[172:175], v11, s[4:7], s23 offen sc1
 v_mfma_f32_16x16x32_bf16 v[112:115], a[0:3], v[132:135], v[112:115]
 ds_read_b128 a[20:23], v17 offset:30720
 v_mfma_f32_16x16x32_bf16 v[112:115], a[4:7], v[140:143], v[112:115]
 buffer_load_dwordx4 v1, s[4:7], s21 offen offset:3072 sc1 lds
 v_mfma_f32_16x16x32_bf16 v[80:83], a[4:7], v[136:139], v[80:83]
 ds_read_b128 a[24:27], v17 offset:23552
 s_waitcnt lgkmcnt(4)
 v_mfma_f32_16x16x32_bf16 v[80:83], a[0:3], v[128:131], v[80:83]
 ds_read_b128 a[28:31], v17 offset:31744
 s_mov_b32 s23, 3072
 v_mfma_f32_16x16x32_bf16 v[84:87], a[8:11], v[128:131], v[84:87]
 s_barrier
 ds_read_b128 a[0:3], v1
 v_mfma_f32_16x16x32_bf16 v[84:87], a[12:15], v[136:139], v[84:87]
 ds_write_b128 v19, a[124:127] offset:35840
 v_mfma_f32_16x16x32_bf16 v[116:119], a[12:15], v[140:143], v[116:119]
 s_waitcnt lgkmcnt(4)
 v_mfma_f32_16x16x32_bf16 v[116:119], a[8:11], v[132:135], v[116:119]
 v_mfma_f32_16x16x32_bf16 v[120:123], a[16:19], v[132:135], v[120:123]
 ds_read_b128 a[4:7], v1 offset:8192
 v_mfma_f32_16x16x32_bf16 v[120:123], a[20:23], v[140:143], v[120:123]
 buffer_load_dwordx4 v[176:179], v8, s[4:7], s23 offen sc1
 v_mfma_f32_16x16x32_bf16 v[88:91], a[20:23], v[136:139], v[88:91]
 ds_read_b128 a[8:11], v1 offset:1024
 s_waitcnt lgkmcnt(4)
 v_mfma_f32_16x16x32_bf16 v[88:91], a[16:19], v[128:131], v[88:91]
 ds_read_b128 a[12:15], v1 offset:9216
 v_mfma_f32_16x16x32_bf16 v[92:95], a[24:27], v[128:131], v[92:95]
 ds_read_b128 a[16:19], v1 offset:2048
 v_mfma_f32_16x16x32_bf16 v[92:95], a[28:31], v[136:139], v[92:95]
 buffer_load_dwordx4 v[180:183], v9, s[4:7], s23 offen sc1
 v_mfma_f32_16x16x32_bf16 v[124:127], a[28:31], v[140:143], v[124:127]
 ds_read_b128 a[20:23], v1 offset:10240
 s_waitcnt vmcnt(8) lgkmcnt(4)
 v_mfma_f32_16x16x32_bf16 v[124:127], a[24:27], v[132:135], v[124:127]
 v_mfma_f32_16x16x32_bf16 v[96:99], a[0:3], v[148:151], v[96:99]
 ds_read_b128 a[24:27], v1 offset:3072
 v_mfma_f32_16x16x32_bf16 v[96:99], a[4:7], v[156:159], v[96:99]
 buffer_load_dwordx4 v[184:187], v10, s[4:7], s23 offen sc1
 s_add_u32 s21, s22, 655360
 s_add_u32 m0, s19, 114688
 v_mfma_f32_16x16x32_bf16 v[64:67], a[4:7], v[152:155], v[64:67]
 ds_read_b128 a[28:31], v1 offset:11264
 s_waitcnt lgkmcnt(4)
 v_mfma_f32_16x16x32_bf16 v[64:67], a[0:3], v[144:147], v[64:67]
 buffer_load_dwordx4 v[188:191], v11, s[4:7], s23 offen sc1
 v_mfma_f32_16x16x32_bf16 v[68:71], a[8:11], v[144:147], v[68:71]
 ds_read_b128 a[0:3], v1 offset:4096
 v_mfma_f32_16x16x32_bf16 v[68:71], a[12:15], v[152:155], v[68:71]
 v_mfma_f32_16x16x32_bf16 v[100:103], a[12:15], v[156:159], v[100:103]
 ds_read_b128 a[4:7], v1 offset:12288
 s_waitcnt lgkmcnt(4)
 v_mfma_f32_16x16x32_bf16 v[100:103], a[8:11], v[148:151], v[100:103]
 buffer_load_dwordx4 v1, s[4:7], s21 offen sc1 lds
 v_mfma_f32_16x16x32_bf16 v[104:107], a[16:19], v[148:151], v[104:107]
 ds_read_b128 a[8:11], v1 offset:5120
 s_mov_b32 s23, 4096
 v_mfma_f32_16x16x32_bf16 v[104:107], a[20:23], v[156:159], v[104:107]
 v_mfma_f32_16x16x32_bf16 v[72:75], a[20:23], v[152:155], v[72:75]
 ds_read_b128 a[12:15], v1 offset:13312
 s_waitcnt lgkmcnt(4)
 v_mfma_f32_16x16x32_bf16 v[72:75], a[16:19], v[144:147], v[72:75]
 ds_write_b128 v21, a[156:159]
 v_mfma_f32_16x16x32_bf16 v[76:79], a[24:27], v[144:147], v[76:79]
 v_mfma_f32_16x16x32_bf16 v[76:79], a[28:31], v[152:155], v[76:79]
 v_mfma_f32_16x16x32_bf16 v[108:111], a[28:31], v[156:159], v[108:111]
 ds_read_b128 a[16:19], v1 offset:6144
 s_waitcnt lgkmcnt(4)
 v_mfma_f32_16x16x32_bf16 v[108:111], a[24:27], v[148:151], v[108:111]
 buffer_load_dwordx4 v[192:195], v8, s[4:7], s23 offen sc1
 v_mfma_f32_16x16x32_bf16 v[112:115], a[0:3], v[148:151], v[112:115]
 ds_read_b128 a[20:23], v1 offset:14336
 v_mfma_f32_16x16x32_bf16 v[112:115], a[4:7], v[156:159], v[112:115]
 buffer_load_dwordx4 v1, s[4:7], s21 offen offset:1024 sc1 lds
 v_mfma_f32_16x16x32_bf16 v[80:83], a[4:7], v[152:155], v[80:83]
 ds_read_b128 a[24:27], v1 offset:7168
 s_waitcnt lgkmcnt(4)
 v_mfma_f32_16x16x32_bf16 v[80:83], a[0:3], v[144:147], v[80:83]
 ds_read_b128 a[28:31], v1 offset:15360
 v_mfma_f32_16x16x32_bf16 v[84:87], a[8:11], v[144:147], v[84:87]
 ds_read_b128 a[0:3], v1 offset:16384
 v_mfma_f32_16x16x32_bf16 v[84:87], a[12:15], v[152:155], v[84:87]
 buffer_load_dwordx4 v[196:199], v9, s[4:7], s23 offen sc1
 v_mfma_f32_16x16x32_bf16 v[116:119], a[12:15], v[156:159], v[116:119]
 ds_read_b128 a[4:7], v1 offset:24576
 s_waitcnt lgkmcnt(4)
 v_mfma_f32_16x16x32_bf16 v[116:119], a[8:11], v[148:151], v[116:119]
 v_mfma_f32_16x16x32_bf16 v[120:123], a[16:19], v[148:151], v[120:123]
 ds_read_b128 a[8:11], v1 offset:17408
 v_mfma_f32_16x16x32_bf16 v[120:123], a[20:23], v[156:159], v[120:123]
 ds_write_b128 v21, a[160:163] offset:1024
 v_mfma_f32_16x16x32_bf16 v[88:91], a[20:23], v[152:155], v[88:91]
 s_waitcnt lgkmcnt(4)
 v_mfma_f32_16x16x32_bf16 v[88:91], a[16:19], v[144:147], v[88:91]
 v_mfma_f32_16x16x32_bf16 v[92:95], a[24:27], v[144:147], v[92:95]
 ds_read_b128 a[12:15], v1 offset:25600
 v_mfma_f32_16x16x32_bf16 v[92:95], a[28:31], v[152:155], v[92:95]
 buffer_load_dwordx4 v[200:203], v10, s[4:7], s23 offen sc1
 v_mfma_f32_16x16x32_bf16 v[124:127], a[28:31], v[156:159], v[124:127]
 ds_read_b128 a[16:19], v1 offset:18432
 s_waitcnt vmcnt(10) lgkmcnt(4)
 v_mfma_f32_16x16x32_bf16 v[124:127], a[24:27], v[148:151], v[124:127]
 ds_read_b128 a[20:23], v1 offset:26624
 v_mfma_f32_16x16x32_bf16 v[96:99], a[0:3], v[164:167], v[96:99]
 ds_read_b128 a[24:27], v1 offset:19456
 v_mfma_f32_16x16x32_bf16 v[96:99], a[4:7], v[172:175], v[96:99]
 buffer_load_dwordx4 v[204:207], v11, s[4:7], s23 offen sc1
 v_mfma_f32_16x16x32_bf16 v[64:67], a[4:7], v[168:171], v[64:67]
 ds_read_b128 a[28:31], v1 offset:27648
 s_waitcnt lgkmcnt(4)
 v_mfma_f32_16x16x32_bf16 v[64:67], a[0:3], v[160:163], v[64:67]
 buffer_load_dwordx4 v1, s[4:7], s21 offen offset:2048 sc1 lds
 v_mfma_f32_16x16x32_bf16 v[68:71], a[8:11], v[160:163], v[68:71]
 ds_read_b128 a[0:3], v1 offset:20480
 s_mov_b32 s23, 5120
 v_mfma_f32_16x16x32_bf16 v[68:71], a[12:15], v[168:171], v[68:71]
 v_mfma_f32_16x16x32_bf16 v[100:103], a[12:15], v[172:175], v[100:103]
 ds_read_b128 a[4:7], v1 offset:28672
 s_waitcnt lgkmcnt(4)
 v_mfma_f32_16x16x32_bf16 v[100:103], a[8:11], v[164:167], v[100:103]
 ds_write_b128 v21, a[164:167] offset:2048
 v_mfma_f32_16x16x32_bf16 v[104:107], a[16:19], v[164:167], v[104:107]
 v_mfma_f32_16x16x32_bf16 v[104:107], a[20:23], v[172:175], v[104:107]
 v_mfma_f32_16x16x32_bf16 v[72:75], a[20:23], v[168:171], v[72:75]
 ds_read_b128 a[8:11], v1 offset:21504
 s_waitcnt lgkmcnt(4)
 v_mfma_f32_16x16x32_bf16 v[72:75], a[16:19], v[160:163], v[72:75]
 buffer_load_dwordx4 v[208:211], v8, s[4:7], s23 offen sc1
 v_mfma_f32_16x16x32_bf16 v[76:79], a[24:27], v[160:163], v[76:79]
 ds_read_b128 a[12:15], v1 offset:29696
 v_mfma_f32_16x16x32_bf16 v[76:79], a[28:31], v[168:171], v[76:79]
 ds_read_b128 a[16:19], v1 offset:22528
 v_mfma_f32_16x16x32_bf16 v[108:111], a[28:31], v[172:175], v[108:111]
 ds_read_b128 a[20:23], v1 offset:30720
 s_waitcnt lgkmcnt(5)
 v_mfma_f32_16x16x32_bf16 v[108:111], a[24:27], v[164:167], v[108:111]
 buffer_load_dwordx4 v1, s[4:7], s21 offen offset:3072 sc1 lds
 v_mfma_f32_16x16x32_bf16 v[112:115], a[0:3], v[164:167], v[112:115]
 ds_read_b128 a[24:27], v1 offset:23552
 v_mfma_f32_16x16x32_bf16 v[112:115], a[4:7], v[172:175], v[112:115]
 buffer_load_dwordx4 v[212:215], v9, s[4:7], s23 offen sc1
 v_mfma_f32_16x16x32_bf16 v[80:83], a[4:7], v[168:171], v[80:83]
 ds_read_b128 a[28:31], v1 offset:31744
 s_waitcnt lgkmcnt(4)
 v_mfma_f32_16x16x32_bf16 v[80:83], a[0:3], v[160:163], v[80:83]
 v_mfma_f32_16x16x32_bf16 v[84:87], a[8:11], v[160:163], v[84:87]
 s_barrier
 ds_read_b128 a[0:3], v1 offset:32768
 v_mfma_f32_16x16x32_bf16 v[84:87], a[12:15], v[168:171], v[84:87]
 ds_write_b128 v21, a[168:171] offset:3072
 v_mfma_f32_16x16x32_bf16 v[116:119], a[12:15], v[172:175], v[116:119]
 s_waitcnt lgkmcnt(4)
 v_mfma_f32_16x16x32_bf16 v[116:119], a[8:11], v[164:167], v[116:119]
 v_mfma_f32_16x16x32_bf16 v[120:123], a[16:19], v[164:167], v[120:123]
 ds_read_b128 a[4:7], v1 offset:40960
 v_mfma_f32_16x16x32_bf16 v[120:123], a[20:23], v[172:175], v[120:123]
 buffer_load_dwordx4 v[216:219], v10, s[4:7], s23 offen sc1
 v_mfma_f32_16x16x32_bf16 v[88:91], a[20:23], v[168:171], v[88:91]
 ds_read_b128 a[8:11], v1 offset:33792
 s_waitcnt lgkmcnt(4)
 v_mfma_f32_16x16x32_bf16 v[88:91], a[16:19], v[160:163], v[88:91]
 ds_read_b128 a[12:15], v1 offset:41984
 v_mfma_f32_16x16x32_bf16 v[92:95], a[24:27], v[160:163], v[92:95]
 ds_read_b128 a[16:19], v1 offset:34816
 v_mfma_f32_16x16x32_bf16 v[92:95], a[28:31], v[168:171], v[92:95]
 buffer_load_dwordx4 v[220:223], v11, s[4:7], s23 offen sc1
 v_mfma_f32_16x16x32_bf16 v[124:127], a[28:31], v[172:175], v[124:127]
 ds_read_b128 a[20:23], v1 offset:43008
 s_waitcnt vmcnt(12) lgkmcnt(4)
 v_mfma_f32_16x16x32_bf16 v[124:127], a[24:27], v[164:167], v[124:127]
 v_mfma_f32_16x16x32_bf16 v[96:99], a[0:3], v[180:183], v[96:99]
 ds_read_b128 a[24:27], v1 offset:35840
 s_mov_b32 s23, 8192
 v_mfma_f32_16x16x32_bf16 v[96:99], a[4:7], v[188:191], v[96:99]
 s_add_u32 s21, s22, 786432
 s_add_u32 m0, s19, 147456
 v_mfma_f32_16x16x32_bf16 v[64:67], a[4:7], v[184:187], v[64:67]
 ds_read_b128 a[28:31], v1 offset:44032
 s_waitcnt lgkmcnt(4)
 v_mfma_f32_16x16x32_bf16 v[64:67], a[0:3], v[176:179], v[64:67]
 v_mfma_f32_16x16x32_bf16 v[68:71], a[8:11], v[176:179], v[68:71]
 ds_read_b128 a[0:3], v1 offset:36864
 v_mfma_f32_16x16x32_bf16 v[68:71], a[12:15], v[184:187], v[68:71]
 buffer_load_dwordx4 v[224:227], v8, s[4:7], s23 offen sc1
 v_mfma_f32_16x16x32_bf16 v[100:103], a[12:15], v[188:191], v[100:103]
 ds_read_b128 a[4:7], v1 offset:45056
 s_waitcnt lgkmcnt(4)
 v_mfma_f32_16x16x32_bf16 v[100:103], a[8:11], v[180:183], v[100:103]
 buffer_load_dwordx4 v1, s[4:7], s21 offen sc1 lds
 v_mfma_f32_16x16x32_bf16 v[104:107], a[16:19], v[180:183], v[104:107]
 ds_read_b128 a[8:11], v1 offset:37888
 v_mfma_f32_16x16x32_bf16 v[104:107], a[20:23], v[188:191], v[104:107]
 v_mfma_f32_16x16x32_bf16 v[72:75], a[20:23], v[184:187], v[72:75]
 ds_read_b128 a[12:15], v1 offset:46080
 s_waitcnt lgkmcnt(4)
 v_mfma_f32_16x16x32_bf16 v[72:75], a[16:19], v[176:179], v[72:75]
 buffer_load_dwordx4 v[228:231], v9, s[4:7], s23 offen sc1
 v_mfma_f32_16x16x32_bf16 v[76:79], a[24:27], v[176:179], v[76:79]
 ds_read_b128 a[16:19], v1 offset:38912
 v_mfma_f32_16x16x32_bf16 v[76:79], a[28:31], v[184:187], v[76:79]
 v_mfma_f32_16x16x32_bf16 v[108:111], a[28:31], v[188:191], v[108:111]
 ds_read_b128 a[20:23], v1 offset:47104
 s_waitcnt lgkmcnt(4)
 v_mfma_f32_16x16x32_bf16 v[108:111], a[24:27], v[180:183], v[108:111]
 ds_write_b128 v18, a[172:175]
 v_mfma_f32_16x16x32_bf16 v[112:115], a[0:3], v[180:183], v[112:115]
 v_mfma_f32_16x16x32_bf16 v[112:115], a[4:7], v[188:191], v[112:115]
 v_mfma_f32_16x16x32_bf16 v[80:83], a[4:7], v[184:187], v[80:83]
 ds_read_b128 a[24:27], v1 offset:39936
 s_waitcnt lgkmcnt(4)
 v_mfma_f32_16x16x32_bf16 v[80:83], a[0:3], v[176:179], v[80:83]
 buffer_load_dwordx4 v[232:235], v10, s[4:7], s23 offen sc1
 v_mfma_f32_16x16x32_bf16 v[84:87], a[8:11], v[176:179], v[84:87]
 ds_read_b128 a[28:31], v1 offset:48128
 v_mfma_f32_16x16x32_bf16 v[84:87], a[12:15], v[184:187], v[84:87]
 buffer_load_dwordx4 v1, s[4:7], s21 offen offset:1024 sc1 lds
 v_mfma_f32_16x16x32_bf16 v[116:119], a[12:15], v[188:191], v[116:119]
 ds_read_b128 a[0:3], v1 offset:49152
 s_waitcnt lgkmcnt(4)
 v_mfma_f32_16x16x32_bf16 v[116:119], a[8:11], v[180:183], v[116:119]
 ds_read_b128 a[4:7], v1 offset:57344
 v_mfma_f32_16x16x32_bf16 v[120:123], a[16:19], v[180:183], v[120:123]
 ds_read_b128 a[8:11], v1 offset:50176
 v_mfma_f32_16x16x32_bf16 v[120:123], a[20:23], v[188:191], v[120:123]
 buffer_load_dwordx4 v[236:239], v11, s[4:7], s23 offen sc1
 v_mfma_f32_16x16x32_bf16 v[88:91], a[20:23], v[184:187], v[88:91]
 ds_read_b128 a[12:15], v1 offset:58368
 s_waitcnt lgkmcnt(4)
 v_mfma_f32_16x16x32_bf16 v[88:91], a[16:19], v[176:179], v[88:91]
 v_mfma_f32_16x16x32_bf16 v[92:95], a[24:27], v[176:179], v[92:95]
 ds_read_b128 a[16:19], v1 offset:51200
 v_mfma_f32_16x16x32_bf16 v[92:95], a[28:31], v[184:187], v[92:95]
 ds_write_b128 v18, a[176:179] offset:1024
 v_mfma_f32_16x16x32_bf16 v[124:127], a[28:31], v[188:191], v[124:127]
 s_waitcnt vmcnt(12) lgkmcnt(4)
 v_mfma_f32_16x16x32_bf16 v[124:127], a[24:27], v[180:183], v[124:127]
 v_mfma_f32_16x16x32_bf16 v[96:99], a[0:3], v[196:199], v[96:99]
 ds_read_b128 a[20:23], v1 offset:59392
 s_mov_b32 s23, 9216
 v_mfma_f32_16x16x32_bf16 v[96:99], a[4:7], v[204:207], v[96:99]
 buffer_load_dwordx4 v1, s[4:7], s21 offen offset:2048 sc1 lds
 v_mfma_f32_16x16x32_bf16 v[64:67], a[4:7], v[200:203], v[64:67]
 ds_read_b128 a[24:27], v1 offset:52224
 s_waitcnt lgkmcnt(4)
 v_mfma_f32_16x16x32_bf16 v[64:67], a[0:3], v[192:195], v[64:67]
 ds_read_b128 a[28:31], v1 offset:60416
 v_add_f32 v40, v40, v41
 v_mfma_f32_16x16x32_bf16 v[68:71], a[8:11], v[192:195], v[68:71]
 ds_read_b128 a[0:3], v1 offset:53248
 v_mfma_f32_16x16x32_bf16 v[68:71], a[12:15], v[200:203], v[68:71]
 buffer_load_dwordx4 v[240:243], v8, s[4:7], s23 offen sc1
 v_mfma_f32_16x16x32_bf16 v[100:103], a[12:15], v[204:207], v[100:103]
 ds_read_b128 a[4:7], v1 offset:61440
 s_waitcnt lgkmcnt(4)
 v_mfma_f32_16x16x32_bf16 v[100:103], a[8:11], v[196:199], v[100:103]
 v_add_f32 v42, v42, v43
 v_mfma_f32_16x16x32_bf16 v[104:107], a[16:19], v[196:199], v[104:107]
 ds_read_b128 a[8:11], v1 offset:54272
 v_mfma_f32_16x16x32_bf16 v[104:107], a[20:23], v[204:207], v[104:107]
 ds_write_b128 v18, a[180:183] offset:2048
 v_mfma_f32_16x16x32_bf16 v[72:75], a[20:23], v[200:203], v[72:75]
 s_waitcnt lgkmcnt(4)
 v_mfma_f32_16x16x32_bf16 v[72:75], a[16:19], v[192:195], v[72:75]
 v_add_f32 v40, v40, v42
 v_mfma_f32_16x16x32_bf16 v[76:79], a[24:27], v[192:195], v[76:79]
 ds_read_b128 a[12:15], v1 offset:62464
 v_mfma_f32_16x16x32_bf16 v[76:79], a[28:31], v[200:203], v[76:79]
 buffer_load_dwordx4 v[244:247], v9, s[4:7], s23 offen sc1
 v_mfma_f32_16x16x32_bf16 v[108:111], a[28:31], v[204:207], v[108:111]
 ds_read_b128 a[16:19], v1 offset:55296
 s_waitcnt lgkmcnt(4)
 v_mfma_f32_16x16x32_bf16 v[108:111], a[24:27], v[196:199], v[108:111]
 ds_read_b128 a[20:23], v1 offset:63488
 v_mov_b32 v26, v40
 v_mfma_f32_16x16x32_bf16 v[112:115], a[0:3], v[196:199], v[112:115]
 ds_read_b128 a[24:27], v1 offset:56320
 v_mfma_f32_16x16x32_bf16 v[112:115], a[4:7], v[204:207], v[112:115]
 buffer_load_dwordx4 v1, s[4:7], s21 offen offset:3072 sc1 lds
 v_mfma_f32_16x16x32_bf16 v[80:83], a[4:7], v[200:203], v[80:83]
 ds_read_b128 a[28:31], v1 offset:64512
 s_waitcnt lgkmcnt(4)
 v_mfma_f32_16x16x32_bf16 v[80:83], a[0:3], v[192:195], v[80:83]
 v_permlane16_swap_b32 v40, v26
 v_mfma_f32_16x16x32_bf16 v[84:87], a[8:11], v[192:195], v[84:87]
 s_barrier
 ds_read_b128 a[0:3], v16
 v_mfma_f32_16x16x32_bf16 v[84:87], a[12:15], v[200:203], v[84:87]
 buffer_load_dwordx4 v[248:251], v10, s[4:7], s23 offen sc1
 v_mfma_f32_16x16x32_bf16 v[116:119], a[12:15], v[204:207], v[116:119]
 ds_read_b128 a[4:7], v16 offset:8192
 s_waitcnt lgkmcnt(4)
 v_mfma_f32_16x16x32_bf16 v[116:119], a[8:11], v[196:199], v[116:119]
 v_add_f32 v40, v40, v26
 v_mfma_f32_16x16x32_bf16 v[120:123], a[16:19], v[196:199], v[120:123]
 ds_read_b128 a[8:11], v16 offset:1024
 v_mfma_f32_16x16x32_bf16 v[120:123], a[20:23], v[204:207], v[120:123]
 ds_write_b128 v18, a[184:187] offset:3072
 v_mfma_f32_16x16x32_bf16 v[88:91], a[20:23], v[200:203], v[88:91]
 s_waitcnt lgkmcnt(4)
 v_mfma_f32_16x16x32_bf16 v[88:91], a[16:19], v[192:195], v[88:91]
 v_mfma_f32_16x16x32_bf16 v[92:95], a[24:27], v[192:195], v[92:95]
 ds_read_b128 a[12:15], v16 offset:9216
 v_mfma_f32_16x16x32_bf16 v[92:95], a[28:31], v[200:203], v[92:95]
 buffer_load_dwordx4 v[252:255], v11, s[4:7], s23 offen sc1
 v_mfma_f32_16x16x32_bf16 v[124:127], a[28:31], v[204:207], v[124:127]
 ds_read_b128 a[16:19], v16 offset:2048
 s_waitcnt vmcnt(12) lgkmcnt(4)
 v_mfma_f32_16x16x32_bf16 v[124:127], a[24:27], v[196:199], v[124:127]
 ds_read_b128 a[20:23], v16 offset:10240
 v_mov_b32 v26, v40
 v_mfma_f32_16x16x32_bf16 v[96:99], a[0:3], v[212:215], v[96:99]
 ds_read_b128 a[24:27], v16 offset:3072
 s_mov_b32 s23, 10240
 v_mfma_f32_16x16x32_bf16 v[96:99], a[4:7], v[220:223], v[96:99]
 s_add_u32 s21, s22, 1048576
 s_add_u32 m0, s19, 16384
 v_mfma_f32_16x16x32_bf16 v[64:67], a[4:7], v[216:219], v[64:67]
 ds_read_b128 a[28:31], v16 offset:11264
 s_waitcnt lgkmcnt(4)
 v_mfma_f32_16x16x32_bf16 v[64:67], a[0:3], v[208:211], v[64:67]
 v_permlane32_swap_b32 v40, v26
 v_mfma_f32_16x16x32_bf16 v[68:71], a[8:11], v[208:211], v[68:71]
 ds_read_b128 a[0:3], v16 offset:4096
 v_mfma_f32_16x16x32_bf16 v[68:71], a[12:15], v[216:219], v[68:71]
 buffer_load_dwordx4 v[128:131], v8, s[4:7], s23 offen sc1
 v_mfma_f32_16x16x32_bf16 v[100:103], a[12:15], v[220:223], v[100:103]
 ds_read_b128 a[4:7], v16 offset:12288
 s_waitcnt lgkmcnt(4)
 v_mfma_f32_16x16x32_bf16 v[100:103], a[8:11], v[212:215], v[100:103]
 buffer_load_dwordx4 v1, s[4:7], s21 offen sc1 lds
 v_mfma_f32_16x16x32_bf16 v[104:107], a[16:19], v[212:215], v[104:107]
 ds_read_b128 a[8:11], v16 offset:5120
 v_mfma_f32_16x16x32_bf16 v[104:107], a[20:23], v[220:223], v[104:107]
 v_add_f32 v40, v40, v26
 v_mfma_f32_16x16x32_bf16 v[72:75], a[20:23], v[216:219], v[72:75]
 ds_read_b128 a[12:15], v16 offset:13312
 s_waitcnt lgkmcnt(4)
 v_mfma_f32_16x16x32_bf16 v[72:75], a[16:19], v[208:211], v[72:75]
 buffer_load_dwordx4 v[132:135], v9, s[4:7], s23 offen sc1
 v_mfma_f32_16x16x32_bf16 v[76:79], a[24:27], v[208:211], v[76:79]
 ds_read_b128 a[16:19], v16 offset:6144
 v_mfma_f32_16x16x32_bf16 v[76:79], a[28:31], v[216:219], v[76:79]
 v_mov_b32 v26, 0x3727c5ac
 v_mfma_f32_16x16x32_bf16 v[108:111], a[28:31], v[220:223], v[108:111]
 ds_read_b128 a[20:23], v16 offset:14336
 s_waitcnt lgkmcnt(4)
 v_mfma_f32_16x16x32_bf16 v[108:111], a[24:27], v[212:215], v[108:111]
 ds_write_b128 v18, a[188:191] offset:32768
 v_mfma_f32_16x16x32_bf16 v[112:115], a[0:3], v[212:215], v[112:115]
 v_mfma_f32_16x16x32_bf16 v[112:115], a[4:7], v[220:223], v[112:115]
 v_fmac_f32 v26, 0x3a800000, v40
 v_mfma_f32_16x16x32_bf16 v[80:83], a[4:7], v[216:219], v[80:83]
 ds_read_b128 a[24:27], v16 offset:7168
 s_waitcnt lgkmcnt(4)
 v_mfma_f32_16x16x32_bf16 v[80:83], a[0:3], v[208:211], v[80:83]
 buffer_load_dwordx4 v[136:139], v10, s[4:7], s23 offen sc1
 v_mfma_f32_16x16x32_bf16 v[84:87], a[8:11], v[208:211], v[84:87]
 ds_read_b128 a[28:31], v16 offset:15360
 v_mfma_f32_16x16x32_bf16 v[84:87], a[12:15], v[216:219], v[84:87]
 buffer_load_dwordx4 v1, s[4:7], s21 offen offset:1024 sc1 lds
 v_mfma_f32_16x16x32_bf16 v[116:119], a[12:15], v[220:223], v[116:119]
 ds_read_b128 a[0:3], v16 offset:16384
 s_waitcnt lgkmcnt(4)
 v_mfma_f32_16x16x32_bf16 v[116:119], a[8:11], v[212:215], v[116:119]
 ds_read_b128 a[4:7], v16 offset:24576
 v_rcp_f32 v26, v26
 v_mfma_f32_16x16x32_bf16 v[120:123], a[16:19], v[212:215], v[120:123]
 ds_read_b128 a[8:11], v16 offset:17408
 v_mfma_f32_16x16x32_bf16 v[120:123], a[20:23], v[220:223], v[120:123]
 buffer_load_dwordx4 v[140:143], v11, s[4:7], s23 offen sc1
 v_mfma_f32_16x16x32_bf16 v[88:91], a[20:23], v[216:219], v[88:91]
 ds_read_b128 a[12:15], v16 offset:25600
 s_waitcnt lgkmcnt(4)
 v_mfma_f32_16x16x32_bf16 v[88:91], a[16:19], v[208:211], v[88:91]
 v_mfma_f32_16x16x32_bf16 v[92:95], a[24:27], v[208:211], v[92:95]
 ds_read_b128 a[16:19], v16 offset:18432
 v_mfma_f32_16x16x32_bf16 v[92:95], a[28:31], v[216:219], v[92:95]
 ds_write_b128 v18, a[192:195] offset:33792
 v_mfma_f32_16x16x32_bf16 v[124:127], a[28:31], v[220:223], v[124:127]
 s_waitcnt vmcnt(12) lgkmcnt(4)
 v_mfma_f32_16x16x32_bf16 v[124:127], a[24:27], v[212:215], v[124:127]
 v_add_f32 v44, v44, v45
 v_mfma_f32_16x16x32_bf16 v[96:99], a[0:3], v[228:231], v[96:99]
 ds_read_b128 a[20:23], v16 offset:26624
 s_mov_b32 s23, 11264
 v_mfma_f32_16x16x32_bf16 v[96:99], a[4:7], v[236:239], v[96:99]
 buffer_load_dwordx4 v1, s[4:7], s21 offen offset:2048 sc1 lds
 v_mfma_f32_16x16x32_bf16 v[64:67], a[4:7], v[232:235], v[64:67]
 ds_read_b128 a[24:27], v16 offset:19456
 s_waitcnt lgkmcnt(4)
 v_mfma_f32_16x16x32_bf16 v[64:67], a[0:3], v[224:227], v[64:67]
 ds_read_b128 a[28:31], v16 offset:27648
 v_add_f32 v46, v46, v47
 v_mfma_f32_16x16x32_bf16 v[68:71], a[8:11], v[224:227], v[68:71]
 ds_read_b128 a[0:3], v16 offset:20480
 v_mfma_f32_16x16x32_bf16 v[68:71], a[12:15], v[232:235], v[68:71]
 buffer_load_dwordx4 v[144:147], v8, s[4:7], s23 offen sc1
 v_mfma_f32_16x16x32_bf16 v[100:103], a[12:15], v[236:239], v[100:103]
 ds_read_b128 a[4:7], v16 offset:28672
 s_waitcnt lgkmcnt(4)
 v_mfma_f32_16x16x32_bf16 v[100:103], a[8:11], v[228:231], v[100:103]
 v_add_f32 v44, v44, v46
 v_mfma_f32_16x16x32_bf16 v[104:107], a[16:19], v[228:231], v[104:107]
 ds_read_b128 a[8:11], v16 offset:21504
 v_mfma_f32_16x16x32_bf16 v[104:107], a[20:23], v[236:239], v[104:107]
 ds_write_b128 v18, a[196:199] offset:34816
 v_mfma_f32_16x16x32_bf16 v[72:75], a[20:23], v[232:235], v[72:75]
 s_waitcnt lgkmcnt(4)
 v_mfma_f32_16x16x32_bf16 v[72:75], a[16:19], v[224:227], v[72:75]
 v_mov_b32 v28, v44
 v_mfma_f32_16x16x32_bf16 v[76:79], a[24:27], v[224:227], v[76:79]
 ds_read_b128 a[12:15], v16 offset:29696
 v_mfma_f32_16x16x32_bf16 v[76:79], a[28:31], v[232:235], v[76:79]
 buffer_load_dwordx4 v[148:151], v9, s[4:7], s23 offen sc1
 v_mfma_f32_16x16x32_bf16 v[108:111], a[28:31], v[236:239], v[108:111]
 ds_read_b128 a[16:19], v16 offset:22528
 s_waitcnt lgkmcnt(4)
 v_mfma_f32_16x16x32_bf16 v[108:111], a[24:27], v[228:231], v[108:111]
 ds_read_b128 a[20:23], v16 offset:30720
 v_permlane16_swap_b32 v44, v28
 v_mfma_f32_16x16x32_bf16 v[112:115], a[0:3], v[228:231], v[112:115]
 ds_read_b128 a[24:27], v16 offset:23552
 v_mfma_f32_16x16x32_bf16 v[112:115], a[4:7], v[236:239], v[112:115]
 buffer_load_dwordx4 v1, s[4:7], s21 offen offset:3072 sc1 lds
 v_mfma_f32_16x16x32_bf16 v[80:83], a[4:7], v[232:235], v[80:83]
 ds_read_b128 a[28:31], v16 offset:31744
 s_waitcnt lgkmcnt(4)
 v_mfma_f32_16x16x32_bf16 v[80:83], a[0:3], v[224:227], v[80:83]
 v_add_f32 v44, v44, v28
 v_mfma_f32_16x16x32_bf16 v[84:87], a[8:11], v[224:227], v[84:87]
 s_barrier
 ds_read_b128 a[0:3], v16 offset:32768
 v_mfma_f32_16x16x32_bf16 v[84:87], a[12:15], v[232:235], v[84:87]
 buffer_load_dwordx4 v[152:155], v10, s[4:7], s23 offen sc1
 v_mfma_f32_16x16x32_bf16 v[116:119], a[12:15], v[236:239], v[116:119]
 ds_read_b128 a[4:7], v16 offset:40960
 s_waitcnt lgkmcnt(4)
 v_mfma_f32_16x16x32_bf16 v[116:119], a[8:11], v[228:231], v[116:119]
 v_mfma_f32_16x16x32_bf16 v[120:123], a[16:19], v[228:231], v[120:123]
 ds_read_b128 a[8:11], v16 offset:33792
 v_mfma_f32_16x16x32_bf16 v[120:123], a[20:23], v[236:239], v[120:123]
 ds_write_b128 v18, a[200:203] offset:35840
 v_mfma_f32_16x16x32_bf16 v[88:91], a[20:23], v[232:235], v[88:91]
 s_waitcnt lgkmcnt(4)
 v_mfma_f32_16x16x32_bf16 v[88:91], a[16:19], v[224:227], v[88:91]
 v_mov_b32 v28, v44
 v_mfma_f32_16x16x32_bf16 v[92:95], a[24:27], v[224:227], v[92:95]
 ds_read_b128 a[12:15], v16 offset:41984
 v_mfma_f32_16x16x32_bf16 v[92:95], a[28:31], v[232:235], v[92:95]
 buffer_load_dwordx4 v[156:159], v11, s[4:7], s23 offen sc1
 v_mfma_f32_16x16x32_bf16 v[124:127], a[28:31], v[236:239], v[124:127]
 ds_read_b128 a[16:19], v16 offset:34816
 s_waitcnt vmcnt(12) lgkmcnt(4)
 v_mfma_f32_16x16x32_bf16 v[124:127], a[24:27], v[228:231], v[124:127]
 ds_read_b128 a[20:23], v16 offset:43008
 v_permlane32_swap_b32 v44, v28
 v_mfma_f32_16x16x32_bf16 v[96:99], a[0:3], v[244:247], v[96:99]
 ds_read_b128 a[24:27], v16 offset:35840
 s_mov_b32 s23, 12288
 v_mfma_f32_16x16x32_bf16 v[96:99], a[4:7], v[252:255], v[96:99]
 s_add_u32 s21, s22, 1179648
 s_add_u32 m0, s19, 49152
 v_mfma_f32_16x16x32_bf16 v[64:67], a[4:7], v[248:251], v[64:67]
 ds_read_b128 a[28:31], v16 offset:44032
 s_waitcnt lgkmcnt(4)
 v_mfma_f32_16x16x32_bf16 v[64:67], a[0:3], v[240:243], v[64:67]
 v_add_f32 v44, v44, v28
 v_mfma_f32_16x16x32_bf16 v[68:71], a[8:11], v[240:243], v[68:71]
 ds_read_b128 a[0:3], v16 offset:36864
 v_mfma_f32_16x16x32_bf16 v[68:71], a[12:15], v[248:251], v[68:71]
 buffer_load_dwordx4 v[160:163], v8, s[4:7], s23 offen sc1
 v_mfma_f32_16x16x32_bf16 v[100:103], a[12:15], v[252:255], v[100:103]
 ds_read_b128 a[4:7], v16 offset:45056
 s_waitcnt lgkmcnt(4)
 v_mfma_f32_16x16x32_bf16 v[100:103], a[8:11], v[244:247], v[100:103]
 buffer_load_dwordx4 v1, s[4:7], s21 offen sc1 lds
 v_mfma_f32_16x16x32_bf16 v[104:107], a[16:19], v[244:247], v[104:107]
 ds_read_b128 a[8:11], v16 offset:37888
 v_mfma_f32_16x16x32_bf16 v[104:107], a[20:23], v[252:255], v[104:107]
 v_mov_b32 v28, 0x3727c5ac
 v_mfma_f32_16x16x32_bf16 v[72:75], a[20:23], v[248:251], v[72:75]
 ds_read_b128 a[12:15], v16 offset:46080
 s_waitcnt lgkmcnt(4)
 v_mfma_f32_16x16x32_bf16 v[72:75], a[16:19], v[240:243], v[72:75]
 buffer_load_dwordx4 v[164:167], v9, s[4:7], s23 offen sc1
 v_mfma_f32_16x16x32_bf16 v[76:79], a[24:27], v[240:243], v[76:79]
 ds_read_b128 a[16:19], v16 offset:38912
 v_mfma_f32_16x16x32_bf16 v[76:79], a[28:31], v[248:251], v[76:79]
 ds_write_b128 v19, a[204:207]
 v_mfma_f32_16x16x32_bf16 v[108:111], a[28:31], v[252:255], v[108:111]
 s_waitcnt lgkmcnt(4)
 v_mfma_f32_16x16x32_bf16 v[108:111], a[24:27], v[244:247], v[108:111]
 v_fmac_f32 v28, 0x3a800000, v44
 v_mfma_f32_16x16x32_bf16 v[112:115], a[0:3], v[244:247], v[112:115]
 ds_read_b128 a[20:23], v16 offset:47104
 v_mfma_f32_16x16x32_bf16 v[112:115], a[4:7], v[252:255], v[112:115]
L_hop_20:
 s_cbranch_execz L_ret_10
 buffer_load_dwordx4 v[168:171], v10, s[4:7], s23 offen sc1
 v_mfma_f32_16x16x32_bf16 v[80:83], a[4:7], v[248:251], v[80:83]
 ds_read_b128 a[24:27], v16 offset:39936
 s_waitcnt lgkmcnt(4)
 v_mfma_f32_16x16x32_bf16 v[80:83], a[0:3], v[240:243], v[80:83]
 buffer_load_dwordx4 v1, s[4:7], s21 offen offset:1024 sc1 lds
 v_mfma_f32_16x16x32_bf16 v[84:87], a[8:11], v[240:243], v[84:87]
 ds_read_b128 a[28:31], v16 offset:48128
 v_mfma_f32_16x16x32_bf16 v[84:87], a[12:15], v[248:251], v[84:87]
 ds_read_b128 a[0:3], v16 offset:49152
 v_rcp_f32 v28, v28
 v_mfma_f32_16x16x32_bf16 v[116:119], a[12:15], v[252:255], v[116:119]
 ds_read_b128 a[4:7], v16 offset:57344
 s_waitcnt lgkmcnt(4)
 v_mfma_f32_16x16x32_bf16 v[116:119], a[8:11], v[244:247], v[116:119]
 buffer_load_dwordx4 v[172:175], v11, s[4:7], s23 offen sc1
 v_mfma_f32_16x16x32_bf16 v[120:123], a[16:19], v[244:247], v[120:123]
 ds_read_b128 a[8:11], v16 offset:50176
 v_mfma_f32_16x16x32_bf16 v[120:123], a[20:23], v[252:255], v[120:123]
 ds_write_b128 v19, a[208:211] offset:1024
 v_mfma_f32_16x16x32_bf16 v[88:91], a[20:23], v[248:251], v[88:91]
 s_waitcnt lgkmcnt(4)
 v_mfma_f32_16x16x32_bf16 v[88:91], a[16:19], v[240:243], v[88:91]
 s_mov_b32 s23, 15360
 v_mfma_f32_16x16x32_bf16 v[92:95], a[24:27], v[240:243], v[92:95]
 ds_read_b128 a[12:15], v16 offset:58368
 v_mfma_f32_16x16x32_bf16 v[92:95], a[28:31], v[248:251], v[92:95]
 buffer_load_dwordx4 v[176:179], v8, s[4:7], s23 offen sc1
 v_mfma_f32_16x16x32_bf16 v[124:127], a[28:31], v[252:255], v[124:127]
 ds_read_b128 a[16:19], v16 offset:51200
 s_waitcnt vmcnt(13) lgkmcnt(4)
 v_mfma_f32_16x16x32_bf16 v[124:127], a[24:27], v[244:247], v[124:127]
 ds_read_b128 a[20:23], v16 offset:59392
 v_mfma_f32_16x16x32_bf16 v[96:99], a[0:3], v[132:135], v[96:99]
 ds_read_b128 a[24:27], v16 offset:52224
 v_and_b32 v22, 15, v0
 v_mfma_f32_16x16x32_bf16 v[96:99], a[4:7], v[140:143], v[96:99]
 buffer_load_dwordx4 v[180:183], v9, s[4:7], s23 offen sc1
 v_mfma_f32_16x16x32_bf16 v[64:67], a[4:7], v[136:139], v[64:67]
 ds_read_b128 a[28:31], v16 offset:60416
 s_waitcnt lgkmcnt(4)
 v_mfma_f32_16x16x32_bf16 v[64:67], a[0:3], v[128:131], v[64:67]
 buffer_load_dwordx4 v1, s[4:7], s21 offen offset:2048 sc1 lds
 v_mfma_f32_16x16x32_bf16 v[68:71], a[8:11], v[128:131], v[68:71]
 ds_read_b128 a[0:3], v16 offset:53248
 v_lshlrev_b32 v24, 7, v22
 v_mfma_f32_16x16x32_bf16 v[68:71], a[12:15], v[136:139], v[68:71]
 v_mfma_f32_16x16x32_bf16 v[100:103], a[12:15], v[140:143], v[100:103]
 ds_read_b128 a[4:7], v16 offset:61440
 s_waitcnt lgkmcnt(4)
 v_mfma_f32_16x16x32_bf16 v[100:103], a[8:11], v[132:135], v[100:103]
 buffer_load_dwordx4 v[184:187], v10, s[4:7], s23 offen sc1
 v_mfma_f32_16x16x32_bf16 v[104:107], a[16:19], v[132:135], v[104:107]
 ds_read_b128 a[8:11], v16 offset:54272
 v_bfe_u32 v25, v0, 4, 1
 v_mfma_f32_16x16x32_bf16 v[104:107], a[20:23], v[140:143], v[104:107]
 v_lshl_add_u32 v24, v25, 3, v24
 v_mfma_f32_16x16x32_bf16 v[72:75], a[20:23], v[136:139], v[72:75]
 ds_read_b128 a[12:15], v16 offset:62464
 s_waitcnt lgkmcnt(4)
 v_mfma_f32_16x16x32_bf16 v[72:75], a[16:19], v[128:131], v[72:75]
 ds_write_b128 v19, a[212:215] offset:2048
 v_mfma_f32_16x16x32_bf16 v[76:79], a[24:27], v[128:131], v[76:79]
 v_mfma_f32_16x16x32_bf16 v[76:79], a[28:31], v[136:139], v[76:79]
 v_add_u32 v24, s19, v24
 v_mfma_f32_16x16x32_bf16 v[108:111], a[28:31], v[140:143], v[108:111]
 ds_read_b128 a[16:19], v16 offset:55296
 s_waitcnt lgkmcnt(4)
 v_mfma_f32_16x16x32_bf16 v[108:111], a[24:27], v[132:135], v[108:111]
 buffer_load_dwordx4 v[188:191], v11, s[4:7], s23 offen sc1
 v_mfma_f32_16x16x32_bf16 v[112:115], a[0:3], v[132:135], v[112:115]
 ds_read_b128 a[20:23], v16 offset:63488
 v_mfma_f32_16x16x32_bf16 v[112:115], a[4:7], v[140:143], v[112:115]
 buffer_load_dwordx4 v1, s[4:7], s21 offen offset:3072 sc1 lds
 v_mfma_f32_16x16x32_bf16 v[80:83], a[4:7], v[136:139], v[80:83]
 ds_read_b128 a[24:27], v16 offset:56320
 s_waitcnt lgkmcnt(4)
 v_mfma_f32_16x16x32_bf16 v[80:83], a[0:3], v[128:131], v[80:83]
 ds_read_b128 a[28:31], v16 offset:64512
 s_mov_b32 s23, 16384
 v_mfma_f32_16x16x32_bf16 v[84:87], a[8:11], v[128:131], v[84:87]
 s_barrier
 ds_read_b128 a[0:3], v17
 v_add_u32 v24, 16384, v24
 v_mfma_f32_16x16x32_bf16 v[84:87], a[12:15], v[136:139], v[84:87]
 ds_write_b128 v19, a[216:219] offset:3072
 v_mfma_f32_16x16x32_bf16 v[116:119], a[12:15], v[140:143], v[116:119]
 s_waitcnt lgkmcnt(4)
 v_mfma_f32_16x16x32_bf16 v[116:119], a[8:11], v[132:135], v[116:119]
 v_and_b32 v22, 7, v0
 v_mfma_f32_16x16x32_bf16 v[120:123], a[16:19], v[132:135], v[120:123]
 ds_read_b128 a[4:7], v17 offset:8192
 v_mfma_f32_16x16x32_bf16 v[120:123], a[20:23], v[140:143], v[120:123]
 buffer_load_dwordx4 v[192:195], v8, s[4:7], s23 offen sc1
 v_mfma_f32_16x16x32_bf16 v[88:91], a[20:23], v[136:139], v[88:91]
 ds_read_b128 a[8:11], v17 offset:1024
 s_waitcnt lgkmcnt(4)
 v_mfma_f32_16x16x32_bf16 v[88:91], a[16:19], v[128:131], v[88:91]
 ds_read_b128 a[12:15], v17 offset:9216
 v_lshrrev_b32 v25, 5, v0
 v_mfma_f32_16x16x32_bf16 v[92:95], a[24:27], v[128:131], v[92:95]
 ds_read_b128 a[16:19], v17 offset:2048
 v_xor_b32 v25, v25, v22
 v_mfma_f32_16x16x32_bf16 v[92:95], a[28:31], v[136:139], v[92:95]
 buffer_load_dwordx4 v[196:199], v9, s[4:7], s23 offen sc1
 v_mfma_f32_16x16x32_bf16 v[124:127], a[28:31], v[140:143], v[124:127]
 ds_read_b128 a[20:23], v17 offset:10240
 s_waitcnt vmcnt(14) lgkmcnt(4)
 v_mfma_f32_16x16x32_bf16 v[124:127], a[24:27], v[132:135], v[124:127]
 v_mfma_f32_16x16x32_bf16 v[96:99], a[0:3], v[148:151], v[96:99]
 ds_read_b128 a[24:27], v17 offset:3072
 v_xor_b32 v20, 0, v25
 v_mfma_f32_16x16x32_bf16 v[96:99], a[4:7], v[156:159], v[96:99]
 buffer_load_dwordx4 v[200:203], v10, s[4:7], s23 offen sc1
 s_add_u32 s21, s22, 1441792
 s_add_u32 m0, s19, 81920
 v_mfma_f32_16x16x32_bf16 v[64:67], a[4:7], v[152:155], v[64:67]
 ds_read_b128 a[28:31], v17 offset:11264
 s_waitcnt lgkmcnt(4)
 v_mfma_f32_16x16x32_bf16 v[64:67], a[0:3], v[144:147], v[64:67]
 buffer_load_dwordx4 v[204:207], v11, s[4:7], s23 offen sc1
 v_mfma_f32_16x16x32_bf16 v[68:71], a[8:11], v[144:147], v[68:71]
 ds_read_b128 a[0:3], v17 offset:4096
 v_mfma_f32_16x16x32_bf16 v[68:71], a[12:15], v[152:155], v[68:71]
 v_lshl_add_u32 v4, v20, 4, v24
 v_mfma_f32_16x16x32_bf16 v[100:103], a[12:15], v[156:159], v[100:103]
 ds_read_b128 a[4:7], v17 offset:12288
 s_waitcnt lgkmcnt(4)
 v_mfma_f32_16x16x32_bf16 v[100:103], a[8:11], v[148:151], v[100:103]
 buffer_load_dwordx4 v1, s[4:7], s21 offen sc1 lds
 v_mfma_f32_16x16x32_bf16 v[104:107], a[16:19], v[148:151], v[104:107]
 ds_read_b128 a[8:11], v17 offset:5120
 s_mov_b32 s23, 17408
 v_mfma_f32_16x16x32_bf16 v[104:107], a[20:23], v[156:159], v[104:107]
 v_xor_b32 v20, 2, v25
 v_mfma_f32_16x16x32_bf16 v[72:75], a[20:23], v[152:155], v[72:75]
 ds_read_b128 a[12:15], v17 offset:13312
 s_waitcnt lgkmcnt(4)
 v_mfma_f32_16x16x32_bf16 v[72:75], a[16:19], v[144:147], v[72:75]
 ds_write_b128 v19, a[32:35] offset:32768
 v_mfma_f32_16x16x32_bf16 v[76:79], a[24:27], v[144:147], v[76:79]
 v_mfma_f32_16x16x32_bf16 v[76:79], a[28:31], v[152:155], v[76:79]
 v_lshl_add_u32 v5, v20, 4, v24
 v_mfma_f32_16x16x32_bf16 v[108:111], a[28:31], v[156:159], v[108:111]
 ds_read_b128 a[16:19], v17 offset:6144
 s_waitcnt lgkmcnt(4)
 v_mfma_f32_16x16x32_bf16 v[108:111], a[24:27], v[148:151], v[108:111]
 buffer_load_dwordx4 v[208:211], v8, s[4:7], s23 offen sc1
 v_mfma_f32_16x16x32_bf16 v[112:115], a[0:3], v[148:151], v[112:115]
 ds_read_b128 a[20:23], v17 offset:14336
 v_mfma_f32_16x16x32_bf16 v[112:115], a[4:7], v[156:159], v[112:115]
 buffer_load_dwordx4 v1, s[4:7], s21 offen offset:1024 sc1 lds
 v_mfma_f32_16x16x32_bf16 v[80:83], a[4:7], v[152:155], v[80:83]
 ds_read_b128 a[24:27], v17 offset:7168
 s_waitcnt lgkmcnt(4)
 v_mfma_f32_16x16x32_bf16 v[80:83], a[0:3], v[144:147], v[80:83]
 ds_read_b128 a[28:31], v17 offset:15360
 v_xor_b32 v20, 4, v25
 v_mfma_f32_16x16x32_bf16 v[84:87], a[8:11], v[144:147], v[84:87]
 ds_read_b128 a[0:3], v17 offset:16384
 v_lshl_add_u32 v6, v20, 4, v24
 v_mfma_f32_16x16x32_bf16 v[84:87], a[12:15], v[152:155], v[84:87]
 buffer_load_dwordx4 v[212:215], v9, s[4:7], s23 offen sc1
 v_mfma_f32_16x16x32_bf16 v[116:119], a[12:15], v[156:159], v[116:119]
 ds_read_b128 a[4:7], v17 offset:24576
 s_waitcnt lgkmcnt(4)
 v_mfma_f32_16x16x32_bf16 v[116:119], a[8:11], v[148:151], v[116:119]
 v_mfma_f32_16x16x32_bf16 v[120:123], a[16:19], v[148:151], v[120:123]
 ds_read_b128 a[8:11], v17 offset:17408
 v_xor_b32 v20, 6, v25
 v_mfma_f32_16x16x32_bf16 v[120:123], a[20:23], v[156:159], v[120:123]
 ds_write_b128 v19, a[36:39] offset:33792
 v_mfma_f32_16x16x32_bf16 v[88:91], a[20:23], v[152:155], v[88:91]
 s_waitcnt lgkmcnt(4)
 v_mfma_f32_16x16x32_bf16 v[88:91], a[16:19], v[144:147], v[88:91]
 v_lshl_add_u32 v7, v20, 4, v24
 v_mfma_f32_16x16x32_bf16 v[92:95], a[24:27], v[144:147], v[92:95]
 ds_read_b128 a[12:15], v17 offset:25600
 v_mfma_f32_16x16x32_bf16 v[92:95], a[28:31], v[152:155], v[92:95]
 buffer_load_dwordx4 v[216:219], v10, s[4:7], s23 offen sc1
 v_mfma_f32_16x16x32_bf16 v[124:127], a[28:31], v[156:159], v[124:127]
 ds_read_b128 a[16:19], v17 offset:18432
 s_waitcnt vmcnt(15) lgkmcnt(4)
 v_mfma_f32_16x16x32_bf16 v[124:127], a[24:27], v[148:151], v[124:127]
 ds_read_b128 a[20:23], v17 offset:26624
 v_lshrrev_b32 v25, 3, v0
 v_mfma_f32_16x16x32_bf16 v[96:99], a[0:3], v[164:167], v[96:99]
 ds_read_b128 a[24:27], v17 offset:19456
 v_mfma_f32_16x16x32_bf16 v[96:99], a[4:7], v[172:175], v[96:99]
 buffer_load_dwordx4 v[220:223], v11, s[4:7], s23 offen sc1
 v_mfma_f32_16x16x32_bf16 v[64:67], a[4:7], v[168:171], v[64:67]
 ds_read_b128 a[28:31], v17 offset:27648
 s_waitcnt lgkmcnt(4)
 v_mfma_f32_16x16x32_bf16 v[64:67], a[0:3], v[160:163], v[64:67]
 buffer_load_dwordx4 v1, s[4:7], s21 offen offset:2048 sc1 lds
 v_mfma_f32_16x16x32_bf16 v[68:71], a[8:11], v[160:163], v[68:71]
 ds_read_b128 a[0:3], v17 offset:20480
 s_mov_b32 s23, 18432
 v_mfma_f32_16x16x32_bf16 v[68:71], a[12:15], v[168:171], v[68:71]
 v_xor_b32 v24, v25, v22
 v_mfma_f32_16x16x32_bf16 v[100:103], a[12:15], v[172:175], v[100:103]
 ds_read_b128 a[4:7], v17 offset:28672
 s_waitcnt lgkmcnt(4)
 v_mfma_f32_16x16x32_bf16 v[100:103], a[8:11], v[164:167], v[100:103]
 ds_write_b128 v19, a[40:43] offset:34816
 v_mfma_f32_16x16x32_bf16 v[104:107], a[16:19], v[164:167], v[104:107]
 v_lshlrev_b32 v24, 4, v24
 v_mfma_f32_16x16x32_bf16 v[104:107], a[20:23], v[172:175], v[104:107]
 v_mfma_f32_16x16x32_bf16 v[72:75], a[20:23], v[168:171], v[72:75]
 ds_read_b128 a[8:11], v17 offset:21504
 s_waitcnt lgkmcnt(4)
 v_mfma_f32_16x16x32_bf16 v[72:75], a[16:19], v[160:163], v[72:75]
 buffer_load_dwordx4 v[224:227], v8, s[4:7], s23 offen sc1
 v_mfma_f32_16x16x32_bf16 v[76:79], a[24:27], v[160:163], v[76:79]
 ds_read_b128 a[12:15], v17 offset:29696
 v_lshl_add_u32 v24, v25, 7, v24
 v_mfma_f32_16x16x32_bf16 v[76:79], a[28:31], v[168:171], v[76:79]
 ds_read_b128 a[16:19], v17 offset:22528
 v_mfma_f32_16x16x32_bf16 v[108:111], a[28:31], v[172:175], v[108:111]
 ds_read_b128 a[20:23], v17 offset:30720
 s_waitcnt lgkmcnt(5)
 v_mfma_f32_16x16x32_bf16 v[108:111], a[24:27], v[164:167], v[108:111]
 buffer_load_dwordx4 v1, s[4:7], s21 offen offset:3072 sc1 lds
 v_mfma_f32_16x16x32_bf16 v[112:115], a[0:3], v[164:167], v[112:115]
 ds_read_b128 a[24:27], v17 offset:23552
 v_add_u32 v24, s19, v24
 v_mfma_f32_16x16x32_bf16 v[112:115], a[4:7], v[172:175], v[112:115]
 buffer_load_dwordx4 v[228:231], v9, s[4:7], s23 offen sc1
 v_mfma_f32_16x16x32_bf16 v[80:83], a[4:7], v[168:171], v[80:83]
 ds_read_b128 a[28:31], v17 offset:31744
 s_waitcnt lgkmcnt(4)
 v_mfma_f32_16x16x32_bf16 v[80:83], a[0:3], v[160:163], v[80:83]
 v_add_u32 v14, 16384, v24
 v_mfma_f32_16x16x32_bf16 v[84:87], a[8:11], v[160:163], v[84:87]
 s_barrier
 ds_read_b128 a[0:3], v1
 v_mfma_f32_16x16x32_bf16 v[84:87], a[12:15], v[168:171], v[84:87]
 ds_write_b128 v19, a[44:47] offset:35840
 v_mfma_f32_16x16x32_bf16 v[116:119], a[12:15], v[172:175], v[116:119]
 s_waitcnt lgkmcnt(4)
 v_mfma_f32_16x16x32_bf16 v[116:119], a[8:11], v[164:167], v[116:119]
 v_lshlrev_b32 v22, 4, v22
 v_mfma_f32_16x16x32_bf16 v[120:123], a[16:19], v[164:167], v[120:123]
 ds_read_b128 a[4:7], v1 offset:8192
 v_lshl_add_u32 v20, v25, 11, v22
 v_mfma_f32_16x16x32_bf16 v[120:123], a[20:23], v[172:175], v[120:123]
 buffer_load_dwordx4 v[232:235], v10, s[4:7], s23 offen sc1
 v_mfma_f32_16x16x32_bf16 v[88:91], a[20:23], v[168:171], v[88:91]
 ds_read_b128 a[8:11], v1 offset:1024
 s_waitcnt lgkmcnt(4)
 v_mfma_f32_16x16x32_bf16 v[88:91], a[16:19], v[160:163], v[88:91]
 ds_read_b128 a[12:15], v1 offset:9216
 v_mfma_f32_16x16x32_bf16 v[92:95], a[24:27], v[160:163], v[92:95]
 ds_read_b128 a[16:19], v1 offset:2048
 s_mov_b32 s8, s50
 v_mfma_f32_16x16x32_bf16 v[92:95], a[28:31], v[168:171], v[92:95]
 buffer_load_dwordx4 v[236:239], v11, s[4:7], s23 offen sc1
 v_mfma_f32_16x16x32_bf16 v[124:127], a[28:31], v[172:175], v[124:127]
 ds_read_b128 a[20:23], v1 offset:10240
 s_waitcnt vmcnt(17) lgkmcnt(4)
 v_mfma_f32_16x16x32_bf16 v[124:127], a[24:27], v[164:167], v[124:127]
 v_mfma_f32_16x16x32_bf16 v[96:99], a[0:3], v[180:183], v[96:99]
 ds_read_b128 a[24:27], v1 offset:3072
 s_mov_b32 s23, 19456
 v_mfma_f32_16x16x32_bf16 v[96:99], a[4:7], v[188:191], v[96:99]
 s_add_u32 s21, s22, 1572864
 s_add_u32 m0, s19, 114688
 v_mfma_f32_16x16x32_bf16 v[64:67], a[4:7], v[184:187], v[64:67]
 ds_read_b128 a[28:31], v1 offset:11264
 s_waitcnt lgkmcnt(4)
 v_mfma_f32_16x16x32_bf16 v[64:67], a[0:3], v[176:179], v[64:67]
 s_mov_b32 s9, s51
 v_mfma_f32_16x16x32_bf16 v[68:71], a[8:11], v[176:179], v[68:71]
 ds_read_b128 a[0:3], v1 offset:4096
 s_mov_b32 s10, 0x400000
 v_mfma_f32_16x16x32_bf16 v[68:71], a[12:15], v[184:187], v[68:71]
 buffer_load_dwordx4 v[240:243], v8, s[4:7], s23 offen sc1
 v_mfma_f32_16x16x32_bf16 v[100:103], a[12:15], v[188:191], v[100:103]
 ds_read_b128 a[4:7], v1 offset:12288
 s_waitcnt lgkmcnt(4)
 v_mfma_f32_16x16x32_bf16 v[100:103], a[8:11], v[180:183], v[100:103]
 buffer_load_dwordx4 v1, s[4:7], s21 offen sc1 lds
 v_mfma_f32_16x16x32_bf16 v[104:107], a[16:19], v[180:183], v[104:107]
 ds_read_b128 a[8:11], v1 offset:5120
 v_mfma_f32_16x16x32_bf16 v[104:107], a[20:23], v[188:191], v[104:107]
 s_mov_b32 s11, 0x20000
 v_mfma_f32_16x16x32_bf16 v[72:75], a[20:23], v[184:187], v[72:75]
 ds_read_b128 a[12:15], v1 offset:13312
 s_waitcnt lgkmcnt(4)
 v_mfma_f32_16x16x32_bf16 v[72:75], a[16:19], v[176:179], v[72:75]
 buffer_load_dwordx4 v[244:247], v9, s[4:7], s23 offen sc1
 v_mfma_f32_16x16x32_bf16 v[76:79], a[24:27], v[176:179], v[76:79]
 ds_read_b128 a[16:19], v1 offset:6144
 s_lshl_b32 s34, s32, 15
 v_mfma_f32_16x16x32_bf16 v[76:79], a[28:31], v[184:187], v[76:79]
 ds_write_b128 v21, a[48:51]
 v_mfma_f32_16x16x32_bf16 v[108:111], a[28:31], v[188:191], v[108:111]
 s_waitcnt lgkmcnt(4)
 v_mfma_f32_16x16x32_bf16 v[108:111], a[24:27], v[180:183], v[108:111]
 v_mfma_f32_16x16x32_bf16 v[112:115], a[0:3], v[180:183], v[112:115]
 ds_read_b128 a[20:23], v1 offset:14336
 s_lshl_b32 s3, s61, 7
 v_mfma_f32_16x16x32_bf16 v[112:115], a[4:7], v[188:191], v[112:115]
 buffer_load_dwordx4 v[248:251], v10, s[4:7], s23 offen sc1
 v_mfma_f32_16x16x32_bf16 v[80:83], a[4:7], v[184:187], v[80:83]
 ds_read_b128 a[24:27], v1 offset:7168
 s_waitcnt lgkmcnt(4)
 v_mfma_f32_16x16x32_bf16 v[80:83], a[0:3], v[176:179], v[80:83]
 buffer_load_dwordx4 v1, s[4:7], s21 offen offset:1024 sc1 lds
 v_mfma_f32_16x16x32_bf16 v[84:87], a[8:11], v[176:179], v[84:87]
 ds_read_b128 a[28:31], v1 offset:15360
 v_mfma_f32_16x16x32_bf16 v[84:87], a[12:15], v[184:187], v[84:87]
 ds_read_b128 a[0:3], v1 offset:16384
 s_add_u32 s34, s34, s3
 v_mfma_f32_16x16x32_bf16 v[116:119], a[12:15], v[188:191], v[116:119]
 ds_read_b128 a[4:7], v1 offset:24576
 s_waitcnt lgkmcnt(4)
 v_mfma_f32_16x16x32_bf16 v[116:119], a[8:11], v[180:183], v[116:119]
 buffer_load_dwordx4 v[252:255], v11, s[4:7], s23 offen sc1
 v_mfma_f32_16x16x32_bf16 v[120:123], a[16:19], v[180:183], v[120:123]
 ds_read_b128 a[8:11], v1 offset:17408
 s_xor_b32 s24, s61, 1
 v_mfma_f32_16x16x32_bf16 v[120:123], a[20:23], v[188:191], v[120:123]
 ds_write_b128 v21, a[52:55] offset:1024
 v_mfma_f32_16x16x32_bf16 v[88:91], a[20:23], v[184:187], v[88:91]
 s_waitcnt lgkmcnt(4)
 v_mfma_f32_16x16x32_bf16 v[88:91], a[16:19], v[176:179], v[88:91]
 s_mov_b32 s23, 22528
 v_mfma_f32_16x16x32_bf16 v[92:95], a[24:27], v[176:179], v[92:95]
 ds_read_b128 a[12:15], v1 offset:25600
 v_mfma_f32_16x16x32_bf16 v[92:95], a[28:31], v[184:187], v[92:95]
 buffer_load_dwordx4 v[128:131], v8, s[4:7], s23 offen sc1
 v_mfma_f32_16x16x32_bf16 v[124:127], a[28:31], v[188:191], v[124:127]
 ds_read_b128 a[16:19], v1 offset:18432
 s_waitcnt vmcnt(19) lgkmcnt(4)
 v_mfma_f32_16x16x32_bf16 v[124:127], a[24:27], v[180:183], v[124:127]
 ds_read_b128 a[20:23], v1 offset:26624
 s_lshl4_add_u32 s24, s60, s24
 v_mfma_f32_16x16x32_bf16 v[96:99], a[0:3], v[196:199], v[96:99]
 ds_read_b128 a[24:27], v1 offset:19456
 v_mfma_f32_16x16x32_bf16 v[96:99], a[4:7], v[204:207], v[96:99]
 buffer_load_dwordx4 v[132:135], v9, s[4:7], s23 offen sc1
 v_mfma_f32_16x16x32_bf16 v[64:67], a[4:7], v[200:203], v[64:67]
 ds_read_b128 a[28:31], v1 offset:27648
 s_waitcnt lgkmcnt(4)
 v_mfma_f32_16x16x32_bf16 v[64:67], a[0:3], v[192:195], v[64:67]
 buffer_load_dwordx4 v1, s[4:7], s21 offen offset:2048 sc1 lds
 v_mfma_f32_16x16x32_bf16 v[68:71], a[8:11], v[192:195], v[68:71]
 ds_read_b128 a[0:3], v1 offset:20480
 s_lshl2_add_u32 s24, s24, s16
 v_mfma_f32_16x16x32_bf16 v[68:71], a[12:15], v[200:203], v[68:71]
 s_lshl_b32 s24, s24, 13
 v_mfma_f32_16x16x32_bf16 v[100:103], a[12:15], v[204:207], v[100:103]
 ds_read_b128 a[4:7], v1 offset:28672
 s_waitcnt lgkmcnt(4)
 v_mfma_f32_16x16x32_bf16 v[100:103], a[8:11], v[196:199], v[100:103]
 buffer_load_dwordx4 v[136:139], v10, s[4:7], s23 offen sc1
 v_mfma_f32_16x16x32_bf16 v[104:107], a[16:19], v[196:199], v[104:107]
 ds_read_b128 a[8:11], v1 offset:21504
 v_mfma_f32_16x16x32_bf16 v[104:107], a[20:23], v[204:207], v[104:107]
 s_add_u32 s24, s24, 41943040
 v_mfma_f32_16x16x32_bf16 v[72:75], a[20:23], v[200:203], v[72:75]
 ds_read_b128 a[12:15], v1 offset:29696
 s_waitcnt lgkmcnt(4)
 v_mfma_f32_16x16x32_bf16 v[72:75], a[16:19], v[192:195], v[72:75]
 ds_write_b128 v21, a[56:59] offset:2048
 v_mfma_f32_16x16x32_bf16 v[76:79], a[24:27], v[192:195], v[76:79]
 s_xor_b32 s26, s61, 0
 v_mfma_f32_16x16x32_bf16 v[76:79], a[28:31], v[200:203], v[76:79]
 v_mfma_f32_16x16x32_bf16 v[108:111], a[28:31], v[204:207], v[108:111]
 ds_read_b128 a[16:19], v1 offset:22528
 s_waitcnt lgkmcnt(4)
 v_mfma_f32_16x16x32_bf16 v[108:111], a[24:27], v[196:199], v[108:111]
 buffer_load_dwordx4 v[140:143], v11, s[4:7], s23 offen sc1
 v_mfma_f32_16x16x32_bf16 v[112:115], a[0:3], v[196:199], v[112:115]
 ds_read_b128 a[20:23], v1 offset:30720
 s_lshl4_add_u32 s26, s60, s26
 v_mfma_f32_16x16x32_bf16 v[112:115], a[4:7], v[204:207], v[112:115]
 buffer_load_dwordx4 v1, s[4:7], s21 offen offset:3072 sc1 lds
 v_mfma_f32_16x16x32_bf16 v[80:83], a[4:7], v[200:203], v[80:83]
 ds_read_b128 a[24:27], v1 offset:23552
 s_waitcnt lgkmcnt(4)
 v_mfma_f32_16x16x32_bf16 v[80:83], a[0:3], v[192:195], v[80:83]
 ds_read_b128 a[28:31], v1 offset:31744
 s_mov_b32 s23, 23552
 v_mfma_f32_16x16x32_bf16 v[84:87], a[8:11], v[192:195], v[84:87]
 s_barrier
 ds_read_b128 a[0:3], v1 offset:32768
 v_mfma_f32_16x16x32_bf16 v[84:87], a[12:15], v[200:203], v[84:87]
 ds_write_b128 v21, a[60:63] offset:3072
 v_mfma_f32_16x16x32_bf16 v[116:119], a[12:15], v[204:207], v[116:119]
 s_waitcnt lgkmcnt(4)
 v_mfma_f32_16x16x32_bf16 v[116:119], a[8:11], v[196:199], v[116:119]
 s_lshl2_add_u32 s26, s26, s16
 v_mfma_f32_16x16x32_bf16 v[120:123], a[16:19], v[196:199], v[120:123]
 ds_read_b128 a[4:7], v1 offset:40960
 s_lshl_b32 s26, s26, 13
 v_mfma_f32_16x16x32_bf16 v[120:123], a[20:23], v[204:207], v[120:123]
 buffer_load_dwordx4 v[144:147], v8, s[4:7], s23 offen sc1
 v_mfma_f32_16x16x32_bf16 v[88:91], a[20:23], v[200:203], v[88:91]
 ds_read_b128 a[8:11], v1 offset:33792
 s_waitcnt lgkmcnt(4)
 v_mfma_f32_16x16x32_bf16 v[88:91], a[16:19], v[192:195], v[88:91]
 ds_read_b128 a[12:15], v1 offset:41984
 v_mfma_f32_16x16x32_bf16 v[92:95], a[24:27], v[192:195], v[92:95]
 ds_read_b128 a[16:19], v1 offset:34816
 s_add_u32 s26, s26, 41943040
 v_mfma_f32_16x16x32_bf16 v[92:95], a[28:31], v[200:203], v[92:95]
 buffer_load_dwordx4 v[148:151], v9, s[4:7], s23 offen sc1
 v_mfma_f32_16x16x32_bf16 v[124:127], a[28:31], v[204:207], v[124:127]
 ds_read_b128 a[20:23], v1 offset:43008
 s_waitcnt vmcnt(20) lgkmcnt(4)
 v_mfma_f32_16x16x32_bf16 v[124:127], a[24:27], v[196:199], v[124:127]
 v_mfma_f32_16x16x32_bf16 v[96:99], a[0:3], v[212:215], v[96:99]
 ds_read_b128 a[24:27], v1 offset:35840
 v_mfma_f32_16x16x32_bf16 v[96:99], a[4:7], v[220:223], v[96:99]
 buffer_load_dwordx4 v[152:155], v10, s[4:7], s23 offen sc1
 s_add_u32 s21, s22, 1703936
 s_add_u32 m0, s19, 147456
 v_mfma_f32_16x16x32_bf16 v[64:67], a[4:7], v[216:219], v[64:67]
 ds_read_b128 a[28:31], v1 offset:44032
 s_waitcnt lgkmcnt(4)
 v_mfma_f32_16x16x32_bf16 v[64:67], a[0:3], v[208:211], v[64:67]
 buffer_load_dwordx4 v[156:159], v11, s[4:7], s23 offen sc1
 v_mfma_f32_16x16x32_bf16 v[68:71], a[8:11], v[208:211], v[68:71]
 ds_read_b128 a[0:3], v1 offset:36864
 v_mfma_f32_16x16x32_bf16 v[68:71], a[12:15], v[216:219], v[68:71]
 v_accvgpr_read_b32 v32, a224
 v_mfma_f32_16x16x32_bf16 v[100:103], a[12:15], v[220:223], v[100:103]
 ds_read_b128 a[4:7], v1 offset:45056
 s_waitcnt lgkmcnt(4)
 v_mfma_f32_16x16x32_bf16 v[100:103], a[8:11], v[212:215], v[100:103]
 buffer_load_dwordx4 v1, s[4:7], s21 offen sc1 lds
 v_mfma_f32_16x16x32_bf16 v[104:107], a[16:19], v[212:215], v[104:107]
 ds_read_b128 a[8:11], v1 offset:37888
 s_mov_b32 s23, 24576
 v_mfma_f32_16x16x32_bf16 v[104:107], a[20:23], v[220:223], v[104:107]
 v_accvgpr_read_b32 v33, a225
 v_mfma_f32_16x16x32_bf16 v[72:75], a[20:23], v[216:219], v[72:75]
 ds_read_b128 a[12:15], v1 offset:46080
 s_waitcnt lgkmcnt(4)
 v_mfma_f32_16x16x32_bf16 v[72:75], a[16:19], v[208:211], v[72:75]
 buffer_load_dwordx4 v1, s[4:7], s21 offen offset:1024 sc1 lds
 v_mfma_f32_16x16x32_bf16 v[76:79], a[24:27], v[208:211], v[76:79]
 ds_read_b128 a[16:19], v1 offset:38912
 v_mfma_f32_16x16x32_bf16 v[76:79], a[28:31], v[216:219], v[76:79]
 v_mfma_f32_16x16x32_bf16 v[108:111], a[28:31], v[220:223], v[108:111]
 ds_read_b128 a[20:23], v1 offset:47104
 s_waitcnt lgkmcnt(4)
 v_mfma_f32_16x16x32_bf16 v[108:111], a[24:27], v[212:215], v[108:111]
 buffer_load_dwordx4 v[160:163], v8, s[4:7], s23 offen sc1
 v_mfma_f32_16x16x32_bf16 v[112:115], a[0:3], v[212:215], v[112:115]
 ds_read_b128 a[24:27], v1 offset:39936
 v_mfma_f32_16x16x32_bf16 v[112:115], a[4:7], v[220:223], v[112:115]
 buffer_load_dwordx4 v1, s[4:7], s21 offen offset:2048 sc1 lds
 v_mfma_f32_16x16x32_bf16 v[80:83], a[4:7], v[216:219], v[80:83]
 ds_read_b128 a[28:31], v1 offset:48128
 s_waitcnt lgkmcnt(4)
 v_mfma_f32_16x16x32_bf16 v[80:83], a[0:3], v[208:211], v[80:83]
 v_accvgpr_read_b32 v34, a226
 v_mfma_f32_16x16x32_bf16 v[84:87], a[8:11], v[208:211], v[84:87]
 ds_read_b128 a[0:3], v1 offset:49152
 v_mfma_f32_16x16x32_bf16 v[84:87], a[12:15], v[216:219], v[84:87]
 buffer_load_dwordx4 v[164:167], v9, s[4:7], s23 offen sc1
 v_mfma_f32_16x16x32_bf16 v[116:119], a[12:15], v[220:223], v[116:119]
 ds_read_b128 a[4:7], v1 offset:57344
 s_waitcnt lgkmcnt(4)
 v_mfma_f32_16x16x32_bf16 v[116:119], a[8:11], v[212:215], v[116:119]
 v_mfma_f32_16x16x32_bf16 v[120:123], a[16:19], v[212:215], v[120:123]
 ds_read_b128 a[8:11], v1 offset:50176
 v_mfma_f32_16x16x32_bf16 v[120:123], a[20:23], v[220:223], v[120:123]
 buffer_load_dwordx4 v1, s[4:7], s21 offen offset:3072 sc1 lds
 v_mfma_f32_16x16x32_bf16 v[88:91], a[20:23], v[216:219], v[88:91]
 ds_read_b128 a[12:15], v1 offset:58368
 s_waitcnt lgkmcnt(4)
 v_mfma_f32_16x16x32_bf16 v[88:91], a[16:19], v[208:211], v[88:91]
 v_accvgpr_read_b32 v35, a227
 v_mfma_f32_16x16x32_bf16 v[92:95], a[24:27], v[208:211], v[92:95]
 ds_read_b128 a[16:19], v1 offset:51200
 v_mfma_f32_16x16x32_bf16 v[92:95], a[28:31], v[216:219], v[92:95]
 buffer_load_dwordx4 v[168:171], v10, s[4:7], s23 offen sc1
 v_mfma_f32_16x16x32_bf16 v[124:127], a[28:31], v[220:223], v[124:127]
 ds_read_b128 a[20:23], v1 offset:59392
 s_waitcnt vmcnt(23) lgkmcnt(4)
 v_mfma_f32_16x16x32_bf16 v[124:127], a[24:27], v[212:215], v[124:127]
 v_mfma_f32_16x16x32_bf16 v[96:99], a[0:3], v[228:231], v[96:99]
 ds_read_b128 a[24:27], v1 offset:52224
 v_mfma_f32_16x16x32_bf16 v[96:99], a[4:7], v[236:239], v[96:99]
 buffer_load_dwordx4 v[172:175], v11, s[4:7], s23 offen sc1
 s_mov_b32 s23, 25600
 v_mfma_f32_16x16x32_bf16 v[64:67], a[4:7], v[232:235], v[64:67]
 ds_read_b128 a[28:31], v1 offset:60416
 s_waitcnt lgkmcnt(4)
 v_mfma_f32_16x16x32_bf16 v[64:67], a[0:3], v[224:227], v[64:67]
 buffer_load_dwordx4 v[176:179], v8, s[4:7], s23 offen sc1
 v_mfma_f32_16x16x32_bf16 v[68:71], a[8:11], v[224:227], v[68:71]
 ds_read_b128 a[0:3], v1 offset:53248
 v_mfma_f32_16x16x32_bf16 v[68:71], a[12:15], v[232:235], v[68:71]
 v_accvgpr_read_b32 v36, a228
 v_mfma_f32_16x16x32_bf16 v[100:103], a[12:15], v[236:239], v[100:103]
 ds_read_b128 a[4:7], v1 offset:61440
 s_waitcnt lgkmcnt(4)
 v_mfma_f32_16x16x32_bf16 v[100:103], a[8:11], v[228:231], v[100:103]
 buffer_load_dwordx4 v[180:183], v9, s[4:7], s23 offen sc1
 v_mfma_f32_16x16x32_bf16 v[104:107], a[16:19], v[228:231], v[104:107]
 ds_read_b128 a[8:11], v1 offset:54272
 v_mfma_f32_16x16x32_bf16 v[104:107], a[20:23], v[236:239], v[104:107]
 v_accvgpr_read_b32 v37, a229
 v_mfma_f32_16x16x32_bf16 v[72:75], a[20:23], v[232:235], v[72:75]
 ds_read_b128 a[12:15], v1 offset:62464
 s_waitcnt lgkmcnt(4)
 v_mfma_f32_16x16x32_bf16 v[72:75], a[16:19], v[224:227], v[72:75]
 buffer_load_dwordx4 v[184:187], v10, s[4:7], s23 offen sc1
 v_mfma_f32_16x16x32_bf16 v[76:79], a[24:27], v[224:227], v[76:79]
 ds_read_b128 a[16:19], v1 offset:55296
 v_mfma_f32_16x16x32_bf16 v[76:79], a[28:31], v[232:235], v[76:79]
 v_mfma_f32_16x16x32_bf16 v[108:111], a[28:31], v[236:239], v[108:111]
 ds_read_b128 a[20:23], v1 offset:63488
 s_waitcnt lgkmcnt(4)
 v_mfma_f32_16x16x32_bf16 v[108:111], a[24:27], v[228:231], v[108:111]
 buffer_load_dwordx4 v[188:191], v11, s[4:7], s23 offen sc1
 v_mfma_f32_16x16x32_bf16 v[112:115], a[0:3], v[228:231], v[112:115]
 ds_read_b128 a[24:27], v1 offset:56320
 s_mov_b32 s23, 26624
 v_mfma_f32_16x16x32_bf16 v[112:115], a[4:7], v[236:239], v[112:115]
 buffer_load_dwordx4 v[192:195], v8, s[4:7], s23 offen sc1
 v_mfma_f32_16x16x32_bf16 v[80:83], a[4:7], v[232:235], v[80:83]
 ds_read_b128 a[28:31], v1 offset:64512
 s_waitcnt lgkmcnt(4)
 v_mfma_f32_16x16x32_bf16 v[80:83], a[0:3], v[224:227], v[80:83]
 v_accvgpr_read_b32 v38, a230
 v_mfma_f32_16x16x32_bf16 v[84:87], a[8:11], v[224:227], v[84:87]
 s_barrier
 ds_read_b128 a[0:3], v16 offset:4096
 v_mfma_f32_16x16x32_bf16 v[84:87], a[12:15], v[232:235], v[84:87]
 buffer_load_dwordx4 v[196:199], v9, s[4:7], s23 offen sc1
 v_mfma_f32_16x16x32_bf16 v[116:119], a[12:15], v[236:239], v[116:119]
 ds_read_b128 a[4:7], v16 offset:12288
 s_waitcnt lgkmcnt(4)
 v_mfma_f32_16x16x32_bf16 v[116:119], a[8:11], v[228:231], v[116:119]
 v_mfma_f32_16x16x32_bf16 v[120:123], a[16:19], v[228:231], v[120:123]
 ds_read_b128 a[8:11], v16 offset:5120
 v_mfma_f32_16x16x32_bf16 v[120:123], a[20:23], v[236:239], v[120:123]
 buffer_load_dwordx4 v[200:203], v10, s[4:7], s23 offen sc1
 v_mfma_f32_16x16x32_bf16 v[88:91], a[20:23], v[232:235], v[88:91]
 ds_read_b128 a[12:15], v16 offset:13312
 s_waitcnt lgkmcnt(4)
 v_mfma_f32_16x16x32_bf16 v[88:91], a[16:19], v[224:227], v[88:91]
 v_accvgpr_read_b32 v39, a231
 v_mfma_f32_16x16x32_bf16 v[92:95], a[24:27], v[224:227], v[92:95]
 ds_read_b128 a[16:19], v16 offset:6144
 v_mfma_f32_16x16x32_bf16 v[92:95], a[28:31], v[232:235], v[92:95]
 buffer_load_dwordx4 v[204:207], v11, s[4:7], s23 offen sc1
 v_mfma_f32_16x16x32_bf16 v[124:127], a[28:31], v[236:239], v[124:127]
 ds_read_b128 a[20:23], v16 offset:14336
 s_waitcnt vmcnt(26) lgkmcnt(4)
 v_mfma_f32_16x16x32_bf16 v[124:127], a[24:27], v[228:231], v[124:127]
L_hop_21:
 s_cbranch_execz L_ret_11
 v_mfma_f32_16x16x32_bf16 v[112:115], a[0:3], v[244:247], v[112:115]
 ds_read_b128 a[24:27], v16 offset:7168
 v_mfma_f32_16x16x32_bf16 v[112:115], a[4:7], v[252:255], v[112:115]
 v_accvgpr_read_b32 v40, a232
 v_mfma_f32_16x16x32_bf16 v[80:83], a[4:7], v[248:251], v[80:83]
 ds_read_b128 a[28:31], v16 offset:15360
 s_waitcnt lgkmcnt(4)
 v_mfma_f32_16x16x32_bf16 v[80:83], a[0:3], v[240:243], v[80:83]
 v_mfma_f32_16x16x32_bf16 v[84:87], a[8:11], v[240:243], v[84:87]
 ds_read_b128 a[0:3], v16 offset:20480
 v_mfma_f32_16x16x32_bf16 v[84:87], a[12:15], v[248:251], v[84:87]
 v_accvgpr_read_b32 v41, a233
 v_mfma_f32_16x16x32_bf16 v[116:119], a[12:15], v[252:255], v[116:119]
 ds_read_b128 a[4:7], v16 offset:28672
 s_waitcnt lgkmcnt(4)
 v_mfma_f32_16x16x32_bf16 v[116:119], a[8:11], v[244:247], v[116:119]
 v_accvgpr_read_b32 v42, a234
 v_mfma_f32_16x16x32_bf16 v[120:123], a[16:19], v[244:247], v[120:123]
 ds_read_b128 a[8:11], v16 offset:21504
 v_mfma_f32_16x16x32_bf16 v[120:123], a[20:23], v[252:255], v[120:123]
 v_mfma_f32_16x16x32_bf16 v[88:91], a[20:23], v[248:251], v[88:91]
 ds_read_b128 a[12:15], v16 offset:29696
 s_waitcnt lgkmcnt(4)
 v_mfma_f32_16x16x32_bf16 v[88:91], a[16:19], v[240:243], v[88:91]
 v_accvgpr_read_b32 v43, a235
 v_mfma_f32_16x16x32_bf16 v[92:95], a[24:27], v[240:243], v[92:95]
 ds_read_b128 a[16:19], v16 offset:22528
 v_mfma_f32_16x16x32_bf16 v[92:95], a[28:31], v[248:251], v[92:95]
 v_mfma_f32_16x16x32_bf16 v[124:127], a[28:31], v[252:255], v[124:127]
 ds_read_b128 a[20:23], v16 offset:30720
 s_waitcnt vmcnt(21) lgkmcnt(4)
 v_mfma_f32_16x16x32_bf16 v[124:127], a[24:27], v[244:247], v[124:127]
 v_accvgpr_read_b32 v44, a236
 v_mfma_f32_16x16x32_bf16 v[112:115], a[0:3], v[132:135], v[112:115]
 ds_read_b128 a[24:27], v16 offset:23552
 v_mfma_f32_16x16x32_bf16 v[112:115], a[4:7], v[140:143], v[112:115]
 v_mfma_f32_16x16x32_bf16 v[80:83], a[4:7], v[136:139], v[80:83]
 ds_read_b128 a[28:31], v16 offset:31744
 s_waitcnt lgkmcnt(4)
 v_mfma_f32_16x16x32_bf16 v[80:83], a[0:3], v[128:131], v[80:83]
 v_accvgpr_read_b32 v45, a237
 v_mfma_f32_16x16x32_bf16 v[84:87], a[8:11], v[128:131], v[84:87]
 s_waitcnt vmcnt(10)
 s_barrier
 ds_read_b128 a[0:3], v16 offset:36864
 v_mfma_f32_16x16x32_bf16 v[84:87], a[12:15], v[136:139], v[84:87]
 v_accvgpr_read_b32 v46, a238
 v_mfma_f32_16x16x32_bf16 v[116:119], a[12:15], v[140:143], v[116:119]
 ds_read_b128 a[4:7], v16 offset:45056
 s_waitcnt lgkmcnt(4)
 v_mfma_f32_16x16x32_bf16 v[116:119], a[8:11], v[132:135], v[116:119]
 v_mfma_f32_16x16x32_bf16 v[120:123], a[16:19], v[132:135], v[120:123]
 ds_read_b128 a[8:11], v16 offset:37888
 v_mfma_f32_16x16x32_bf16 v[120:123], a[20:23], v[140:143], v[120:123]
 v_accvgpr_read_b32 v47, a239
 v_mfma_f32_16x16x32_bf16 v[88:91], a[20:23], v[136:139], v[88:91]
 ds_read_b128 a[12:15], v16 offset:46080
 s_waitcnt lgkmcnt(4)
 v_mfma_f32_16x16x32_bf16 v[88:91], a[16:19], v[128:131], v[88:91]
 v_mfma_f32_16x16x32_bf16 v[92:95], a[24:27], v[128:131], v[92:95]
 ds_read_b128 a[16:19], v16 offset:38912
 v_mfma_f32_16x16x32_bf16 v[92:95], a[28:31], v[136:139], v[92:95]
 v_accvgpr_read_b32 v48, a240
 v_mfma_f32_16x16x32_bf16 v[124:127], a[28:31], v[140:143], v[124:127]
 ds_read_b128 a[20:23], v16 offset:47104
 s_waitcnt lgkmcnt(4)
 v_mfma_f32_16x16x32_bf16 v[124:127], a[24:27], v[132:135], v[124:127]
 v_mfma_f32_16x16x32_bf16 v[112:115], a[0:3], v[148:151], v[112:115]
 ds_read_b128 a[24:27], v16 offset:39936
 v_mfma_f32_16x16x32_bf16 v[112:115], a[4:7], v[156:159], v[112:115]
 v_accvgpr_read_b32 v49, a241
 v_mfma_f32_16x16x32_bf16 v[80:83], a[4:7], v[152:155], v[80:83]
 ds_read_b128 a[28:31], v16 offset:48128
 s_waitcnt lgkmcnt(4)
 v_mfma_f32_16x16x32_bf16 v[80:83], a[0:3], v[144:147], v[80:83]
 v_mfma_f32_16x16x32_bf16 v[84:87], a[8:11], v[144:147], v[84:87]
 ds_read_b128 a[0:3], v16 offset:53248
 v_mfma_f32_16x16x32_bf16 v[84:87], a[12:15], v[152:155], v[84:87]
 v_accvgpr_read_b32 v50, a242
 v_mfma_f32_16x16x32_bf16 v[116:119], a[12:15], v[156:159], v[116:119]
 ds_read_b128 a[4:7], v16 offset:61440
 s_waitcnt lgkmcnt(4)
 v_mfma_f32_16x16x32_bf16 v[116:119], a[8:11], v[148:151], v[116:119]
 v_accvgpr_read_b32 v51, a243
 v_mfma_f32_16x16x32_bf16 v[120:123], a[16:19], v[148:151], v[120:123]
 ds_read_b128 a[8:11], v16 offset:54272
 v_mfma_f32_16x16x32_bf16 v[120:123], a[20:23], v[156:159], v[120:123]
 v_mfma_f32_16x16x32_bf16 v[88:91], a[20:23], v[152:155], v[88:91]
 ds_read_b128 a[12:15], v16 offset:62464
 s_waitcnt lgkmcnt(4)
 v_mfma_f32_16x16x32_bf16 v[88:91], a[16:19], v[144:147], v[88:91]
 v_accvgpr_read_b32 v52, a244
 v_mfma_f32_16x16x32_bf16 v[92:95], a[24:27], v[144:147], v[92:95]
 ds_read_b128 a[16:19], v16 offset:55296
 v_mfma_f32_16x16x32_bf16 v[92:95], a[28:31], v[152:155], v[92:95]
 v_mfma_f32_16x16x32_bf16 v[124:127], a[28:31], v[156:159], v[124:127]
 ds_read_b128 a[20:23], v16 offset:63488
 s_waitcnt vmcnt(8) lgkmcnt(4)
 v_mfma_f32_16x16x32_bf16 v[124:127], a[24:27], v[148:151], v[124:127]
 v_accvgpr_read_b32 v53, a245
 v_mfma_f32_16x16x32_bf16 v[112:115], a[0:3], v[164:167], v[112:115]
 ds_read_b128 a[24:27], v16 offset:56320
 v_mfma_f32_16x16x32_bf16 v[112:115], a[4:7], v[172:175], v[112:115]
 v_mfma_f32_16x16x32_bf16 v[80:83], a[4:7], v[168:171], v[80:83]
 ds_read_b128 a[28:31], v16 offset:64512
 s_waitcnt lgkmcnt(4)
 v_mfma_f32_16x16x32_bf16 v[80:83], a[0:3], v[160:163], v[80:83]
 v_accvgpr_read_b32 v54, a246
 v_mfma_f32_16x16x32_bf16 v[84:87], a[8:11], v[160:163], v[84:87]
 ds_read_b128 a[0:3], v17 offset:4096
 v_mfma_f32_16x16x32_bf16 v[84:87], a[12:15], v[168:171], v[84:87]
 v_accvgpr_read_b32 v55, a247
 v_mfma_f32_16x16x32_bf16 v[116:119], a[12:15], v[172:175], v[116:119]
 ds_read_b128 a[4:7], v17 offset:12288
 s_waitcnt lgkmcnt(4)
 v_mfma_f32_16x16x32_bf16 v[116:119], a[8:11], v[164:167], v[116:119]
 v_mfma_f32_16x16x32_bf16 v[120:123], a[16:19], v[164:167], v[120:123]
 ds_read_b128 a[8:11], v17 offset:5120
 v_mfma_f32_16x16x32_bf16 v[120:123], a[20:23], v[172:175], v[120:123]
 v_accvgpr_read_b32 v56, a248
 v_mfma_f32_16x16x32_bf16 v[88:91], a[20:23], v[168:171], v[88:91]
 ds_read_b128 a[12:15], v17 offset:13312
 s_waitcnt lgkmcnt(4)
 v_mfma_f32_16x16x32_bf16 v[88:91], a[16:19], v[160:163], v[88:91]
 v_mfma_f32_16x16x32_bf16 v[92:95], a[24:27], v[160:163], v[92:95]
 ds_read_b128 a[16:19], v17 offset:6144
 v_mfma_f32_16x16x32_bf16 v[92:95], a[28:31], v[168:171], v[92:95]
 v_accvgpr_read_b32 v57, a249
 v_mfma_f32_16x16x32_bf16 v[124:127], a[28:31], v[172:175], v[124:127]
 ds_read_b128 a[20:23], v17 offset:14336
 s_waitcnt vmcnt(4) lgkmcnt(4)
 v_mfma_f32_16x16x32_bf16 v[124:127], a[24:27], v[164:167], v[124:127]
 v_mfma_f32_16x16x32_bf16 v[112:115], a[0:3], v[180:183], v[112:115]
 ds_read_b128 a[24:27], v17 offset:7168
 v_mfma_f32_16x16x32_bf16 v[112:115], a[4:7], v[188:191], v[112:115]
 v_accvgpr_read_b32 v58, a250
 v_mfma_f32_16x16x32_bf16 v[80:83], a[4:7], v[184:187], v[80:83]
 ds_read_b128 a[28:31], v17 offset:15360
 s_waitcnt lgkmcnt(4)
 v_mfma_f32_16x16x32_bf16 v[80:83], a[0:3], v[176:179], v[80:83]
 v_mfma_f32_16x16x32_bf16 v[84:87], a[8:11], v[176:179], v[84:87]
 ds_read_b128 a[0:3], v17 offset:20480
 v_mfma_f32_16x16x32_bf16 v[84:87], a[12:15], v[184:187], v[84:87]
 v_accvgpr_read_b32 v59, a251
 v_mfma_f32_16x16x32_bf16 v[116:119], a[12:15], v[188:191], v[116:119]
 ds_read_b128 a[4:7], v17 offset:28672
 s_waitcnt lgkmcnt(4)
 v_mfma_f32_16x16x32_bf16 v[116:119], a[8:11], v[180:183], v[116:119]
 v_accvgpr_read_b32 v60, a252
 v_mfma_f32_16x16x32_bf16 v[120:123], a[16:19], v[180:183], v[120:123]
 ds_read_b128 a[8:11], v17 offset:21504
 v_mfma_f32_16x16x32_bf16 v[120:123], a[20:23], v[188:191], v[120:123]
 v_mfma_f32_16x16x32_bf16 v[88:91], a[20:23], v[184:187], v[88:91]
 ds_read_b128 a[12:15], v17 offset:29696
 s_waitcnt lgkmcnt(4)
 v_mfma_f32_16x16x32_bf16 v[88:91], a[16:19], v[176:179], v[88:91]
 v_accvgpr_read_b32 v61, a253
 v_mfma_f32_16x16x32_bf16 v[92:95], a[24:27], v[176:179], v[92:95]
 ds_read_b128 a[16:19], v17 offset:22528
 v_mfma_f32_16x16x32_bf16 v[92:95], a[28:31], v[184:187], v[92:95]
 v_mfma_f32_16x16x32_bf16 v[124:127], a[28:31], v[188:191], v[124:127]
 ds_read_b128 a[20:23], v17 offset:30720
 s_waitcnt vmcnt(0) lgkmcnt(4)
 v_mfma_f32_16x16x32_bf16 v[124:127], a[24:27], v[180:183], v[124:127]
 v_accvgpr_read_b32 v62, a254
 v_mfma_f32_16x16x32_bf16 v[112:115], a[0:3], v[196:199], v[112:115]
 ds_read_b128 a[24:27], v17 offset:23552
 v_mfma_f32_16x16x32_bf16 v[112:115], a[4:7], v[204:207], v[112:115]
 v_mfma_f32_16x16x32_bf16 v[80:83], a[4:7], v[200:203], v[80:83]
 ds_read_b128 a[28:31], v17 offset:31744
 s_waitcnt lgkmcnt(4)
 v_mfma_f32_16x16x32_bf16 v[80:83], a[0:3], v[192:195], v[80:83]
 v_accvgpr_read_b32 v63, a255
 v_mfma_f32_16x16x32_bf16 v[84:87], a[8:11], v[192:195], v[84:87]
 ds_read_b128 a[0:3], v16
 v_mfma_f32_16x16x32_bf16 v[84:87], a[12:15], v[200:203], v[84:87]
 v_mfma_f32_16x16x32_bf16 v[116:119], a[12:15], v[204:207], v[116:119]
 ds_read_b128 a[4:7], v16 offset:8192
 s_waitcnt lgkmcnt(4)
 v_mfma_f32_16x16x32_bf16 v[116:119], a[8:11], v[196:199], v[116:119]
 v_mfma_f32_16x16x32_bf16 v[120:123], a[16:19], v[196:199], v[120:123]
 ds_read_b128 a[8:11], v16 offset:1024
 v_cvt_pk_bf16_f32 v80, v80, v81
 v_mfma_f32_16x16x32_bf16 v[120:123], a[20:23], v[204:207], v[120:123]
 v_cvt_pk_bf16_f32 v81, v82, v83
 v_min_u32 v80, -2, v80
 v_mfma_f32_16x16x32_bf16 v[88:91], a[20:23], v[200:203], v[88:91]
 ds_read_b128 a[12:15], v16 offset:9216
 s_waitcnt lgkmcnt(4)
 v_mfma_f32_16x16x32_bf16 v[88:91], a[16:19], v[192:195], v[88:91]
 v_cvt_pk_bf16_f32 v82, v112, v113
 v_cvt_pk_bf16_f32 v83, v114, v115
 v_mfma_f32_16x16x32_bf16 v[92:95], a[24:27], v[192:195], v[92:95]
 ds_read_b128 a[16:19], v16 offset:2048
 v_min_u32 v81, -2, v81
 v_mfma_f32_16x16x32_bf16 v[92:95], a[28:31], v[200:203], v[92:95]
 v_min_u32 v82, -2, v82
 v_min_u32 v83, -2, v83
 v_mfma_f32_16x16x32_bf16 v[124:127], a[28:31], v[204:207], v[124:127]
 ds_read_b128 a[20:23], v16 offset:10240
 s_waitcnt lgkmcnt(4)
 v_mfma_f32_16x16x32_bf16 v[124:127], a[24:27], v[196:199], v[124:127]
 buffer_store_dwordx4 v[80:83], v1, s[4:7], s24 offen sc1
 v_mfma_f32_16x16x32_bf16 v[96:99], a[0:3], v[244:247], v[96:99]
 ds_read_b128 a[24:27], v16 offset:3072
 v_cvt_pk_bf16_f32 v84, v84, v85
 v_mfma_f32_16x16x32_bf16 v[96:99], a[4:7], v[252:255], v[96:99]
 v_cvt_pk_bf16_f32 v85, v86, v87
 v_min_u32 v84, -2, v84
 v_mfma_f32_16x16x32_bf16 v[64:67], a[4:7], v[248:251], v[64:67]
 ds_read_b128 a[28:31], v16 offset:11264
 s_waitcnt lgkmcnt(4)
 v_mfma_f32_16x16x32_bf16 v[64:67], a[0:3], v[240:243], v[64:67]
 v_cvt_pk_bf16_f32 v86, v116, v117
 v_cvt_pk_bf16_f32 v87, v118, v119
 v_mfma_f32_16x16x32_bf16 v[68:71], a[8:11], v[240:243], v[68:71]
 ds_read_b128 a[0:3], v16 offset:16384
 v_min_u32 v85, -2, v85
 v_mfma_f32_16x16x32_bf16 v[68:71], a[12:15], v[248:251], v[68:71]
 v_min_u32 v86, -2, v86
 v_min_u32 v87, -2, v87
 v_mfma_f32_16x16x32_bf16 v[100:103], a[12:15], v[252:255], v[100:103]
 ds_read_b128 a[4:7], v16 offset:24576
 s_waitcnt lgkmcnt(4)
 v_mfma_f32_16x16x32_bf16 v[100:103], a[8:11], v[244:247], v[100:103]
 buffer_store_dwordx4 v[84:87], v1, s[4:7], s24 offen offset:1024 sc1
 v_mfma_f32_16x16x32_bf16 v[104:107], a[16:19], v[244:247], v[104:107]
 ds_read_b128 a[8:11], v16 offset:17408
 v_cvt_pk_bf16_f32 v88, v88, v89
 v_mfma_f32_16x16x32_bf16 v[104:107], a[20:23], v[252:255], v[104:107]
 v_cvt_pk_bf16_f32 v89, v90, v91
 v_min_u32 v88, -2, v88
 v_mfma_f32_16x16x32_bf16 v[72:75], a[20:23], v[248:251], v[72:75]
 ds_read_b128 a[12:15], v16 offset:25600
 s_waitcnt lgkmcnt(4)
 v_mfma_f32_16x16x32_bf16 v[72:75], a[16:19], v[240:243], v[72:75]
 v_cvt_pk_bf16_f32 v90, v120, v121
 v_cvt_pk_bf16_f32 v91, v122, v123
 v_mfma_f32_16x16x32_bf16 v[76:79], a[24:27], v[240:243], v[76:79]
 ds_read_b128 a[16:19], v16 offset:18432
 v_min_u32 v89, -2, v89
 v_mfma_f32_16x16x32_bf16 v[76:79], a[28:31], v[248:251], v[76:79]
 v_min_u32 v90, -2, v90
 v_min_u32 v91, -2, v91
 v_mfma_f32_16x16x32_bf16 v[108:111], a[28:31], v[252:255], v[108:111]
 ds_read_b128 a[20:23], v16 offset:26624
 s_waitcnt lgkmcnt(4)
 v_mfma_f32_16x16x32_bf16 v[108:111], a[24:27], v[244:247], v[108:111]
 buffer_store_dwordx4 v[88:91], v1, s[4:7], s24 offen offset:2048 sc1
 v_mfma_f32_16x16x32_bf16 v[96:99], a[0:3], v[132:135], v[96:99]
 ds_read_b128 a[24:27], v16 offset:19456
 v_cvt_pk_bf16_f32 v92, v92, v93
 v_mfma_f32_16x16x32_bf16 v[96:99], a[4:7], v[140:143], v[96:99]
 v_cvt_pk_bf16_f32 v93, v94, v95
 v_min_u32 v92, -2, v92
 v_mfma_f32_16x16x32_bf16 v[64:67], a[4:7], v[136:139], v[64:67]
 ds_read_b128 a[28:31], v16 offset:27648
 s_waitcnt lgkmcnt(4)
 v_mfma_f32_16x16x32_bf16 v[64:67], a[0:3], v[128:131], v[64:67]
 v_cvt_pk_bf16_f32 v94, v124, v125
 v_cvt_pk_bf16_f32 v95, v126, v127
 v_mfma_f32_16x16x32_bf16 v[68:71], a[8:11], v[128:131], v[68:71]
 ds_read_b128 a[0:3], v16 offset:32768
 v_min_u32 v93, -2, v93
 v_mfma_f32_16x16x32_bf16 v[68:71], a[12:15], v[136:139], v[68:71]
 v_min_u32 v94, -2, v94
 v_min_u32 v95, -2, v95
 v_mfma_f32_16x16x32_bf16 v[100:103], a[12:15], v[140:143], v[100:103]
 ds_read_b128 a[4:7], v16 offset:40960
 s_waitcnt lgkmcnt(4)
 v_mfma_f32_16x16x32_bf16 v[100:103], a[8:11], v[132:135], v[100:103]
 buffer_store_dwordx4 v[92:95], v1, s[4:7], s24 offen offset:3072 sc1
 v_mfma_f32_16x16x32_bf16 v[104:107], a[16:19], v[132:135], v[104:107]
 ds_read_b128 a[8:11], v16 offset:33792
 v_mfma_f32_16x16x32_bf16 v[104:107], a[20:23], v[140:143], v[104:107]
 v_mfma_f32_16x16x32_bf16 v[72:75], a[20:23], v[136:139], v[72:75]
 ds_read_b128 a[12:15], v16 offset:41984
 s_waitcnt lgkmcnt(4)
 v_mfma_f32_16x16x32_bf16 v[72:75], a[16:19], v[128:131], v[72:75]
 v_mfma_f32_16x16x32_bf16 v[76:79], a[24:27], v[128:131], v[76:79]
 ds_read_b128 a[16:19], v16 offset:34816
 v_mfma_f32_16x16x32_bf16 v[76:79], a[28:31], v[136:139], v[76:79]
 v_mfma_f32_16x16x32_bf16 v[108:111], a[28:31], v[140:143], v[108:111]
 ds_read_b128 a[20:23], v16 offset:43008
 s_waitcnt lgkmcnt(4)
 v_mfma_f32_16x16x32_bf16 v[108:111], a[24:27], v[132:135], v[108:111]
 v_mfma_f32_16x16x32_bf16 v[96:99], a[0:3], v[148:151], v[96:99]
 ds_read_b128 a[24:27], v16 offset:35840
 v_mfma_f32_16x16x32_bf16 v[96:99], a[4:7], v[156:159], v[96:99]
 v_mfma_f32_16x16x32_bf16 v[64:67], a[4:7], v[152:155], v[64:67]
 ds_read_b128 a[28:31], v16 offset:44032
 s_waitcnt lgkmcnt(4)
 v_mfma_f32_16x16x32_bf16 v[64:67], a[0:3], v[144:147], v[64:67]
 v_mfma_f32_16x16x32_bf16 v[68:71], a[8:11], v[144:147], v[68:71]
 ds_read_b128 a[0:3], v16 offset:49152
 v_mfma_f32_16x16x32_bf16 v[68:71], a[12:15], v[152:155], v[68:71]
 v_mfma_f32_16x16x32_bf16 v[100:103], a[12:15], v[156:159], v[100:103]
 ds_read_b128 a[4:7], v16 offset:57344
 s_waitcnt lgkmcnt(4)
 v_mfma_f32_16x16x32_bf16 v[100:103], a[8:11], v[148:151], v[100:103]
 v_mfma_f32_16x16x32_bf16 v[104:107], a[16:19], v[148:151], v[104:107]
 ds_read_b128 a[8:11], v16 offset:50176
 v_mfma_f32_16x16x32_bf16 v[104:107], a[20:23], v[156:159], v[104:107]
 v_mfma_f32_16x16x32_bf16 v[72:75], a[20:23], v[152:155], v[72:75]
 ds_read_b128 a[12:15], v16 offset:58368
 s_waitcnt lgkmcnt(4)
 v_mfma_f32_16x16x32_bf16 v[72:75], a[16:19], v[144:147], v[72:75]
 v_mfma_f32_16x16x32_bf16 v[76:79], a[24:27], v[144:147], v[76:79]
 ds_read_b128 a[16:19], v16 offset:51200
 v_mfma_f32_16x16x32_bf16 v[76:79], a[28:31], v[152:155], v[76:79]
 v_mfma_f32_16x16x32_bf16 v[108:111], a[28:31], v[156:159], v[108:111]
 ds_read_b128 a[20:23], v16 offset:59392
 s_waitcnt lgkmcnt(4)
 v_mfma_f32_16x16x32_bf16 v[108:111], a[24:27], v[148:151], v[108:111]
 v_mfma_f32_16x16x32_bf16 v[96:99], a[0:3], v[164:167], v[96:99]
 ds_read_b128 a[24:27], v16 offset:52224
 v_mfma_f32_16x16x32_bf16 v[96:99], a[4:7], v[172:175], v[96:99]
 v_mfma_f32_16x16x32_bf16 v[64:67], a[4:7], v[168:171], v[64:67]
 ds_read_b128 a[28:31], v16 offset:60416
 s_waitcnt lgkmcnt(4)
 v_mfma_f32_16x16x32_bf16 v[64:67], a[0:3], v[160:163], v[64:67]
 v_mfma_f32_16x16x32_bf16 v[68:71], a[8:11], v[160:163], v[68:71]
 ds_read_b128 a[0:3], v17
 v_mfma_f32_16x16x32_bf16 v[68:71], a[12:15], v[168:171], v[68:71]
 v_mfma_f32_16x16x32_bf16 v[100:103], a[12:15], v[172:175], v[100:103]
 ds_read_b128 a[4:7], v17 offset:8192
 s_waitcnt lgkmcnt(4)
 v_mfma_f32_16x16x32_bf16 v[100:103], a[8:11], v[164:167], v[100:103]
 v_mfma_f32_16x16x32_bf16 v[104:107], a[16:19], v[164:167], v[104:107]
 ds_read_b128 a[8:11], v17 offset:1024
 v_mfma_f32_16x16x32_bf16 v[104:107], a[20:23], v[172:175], v[104:107]
 v_mfma_f32_16x16x32_bf16 v[72:75], a[20:23], v[168:171], v[72:75]
 ds_read_b128 a[12:15], v17 offset:9216
 s_waitcnt lgkmcnt(4)
 v_mfma_f32_16x16x32_bf16 v[72:75], a[16:19], v[160:163], v[72:75]
 v_mfma_f32_16x16x32_bf16 v[76:79], a[24:27], v[160:163], v[76:79]
 ds_read_b128 a[16:19], v17 offset:2048
 v_mfma_f32_16x16x32_bf16 v[76:79], a[28:31], v[168:171], v[76:79]
 v_mfma_f32_16x16x32_bf16 v[108:111], a[28:31], v[172:175], v[108:111]
 ds_read_b128 a[20:23], v17 offset:10240
 s_waitcnt lgkmcnt(4)
 v_mfma_f32_16x16x32_bf16 v[108:111], a[24:27], v[164:167], v[108:111]
 v_mfma_f32_16x16x32_bf16 v[96:99], a[0:3], v[180:183], v[96:99]
 ds_read_b128 a[24:27], v17 offset:3072
 v_mfma_f32_16x16x32_bf16 v[96:99], a[4:7], v[188:191], v[96:99]
 v_mfma_f32_16x16x32_bf16 v[64:67], a[4:7], v[184:187], v[64:67]
 ds_read_b128 a[28:31], v17 offset:11264
 s_waitcnt lgkmcnt(4)
 v_mfma_f32_16x16x32_bf16 v[64:67], a[0:3], v[176:179], v[64:67]
 v_mfma_f32_16x16x32_bf16 v[68:71], a[8:11], v[176:179], v[68:71]
 ds_read_b128 a[0:3], v17 offset:16384
 v_mfma_f32_16x16x32_bf16 v[68:71], a[12:15], v[184:187], v[68:71]
 v_mfma_f32_16x16x32_bf16 v[100:103], a[12:15], v[188:191], v[100:103]
 ds_read_b128 a[4:7], v17 offset:24576
 s_waitcnt lgkmcnt(4)
 v_mfma_f32_16x16x32_bf16 v[100:103], a[8:11], v[180:183], v[100:103]
 v_mfma_f32_16x16x32_bf16 v[104:107], a[16:19], v[180:183], v[104:107]
 ds_read_b128 a[8:11], v17 offset:17408
 v_mfma_f32_16x16x32_bf16 v[104:107], a[20:23], v[188:191], v[104:107]
 v_mfma_f32_16x16x32_bf16 v[72:75], a[20:23], v[184:187], v[72:75]
 ds_read_b128 a[12:15], v17 offset:25600
 s_waitcnt lgkmcnt(4)
 v_mfma_f32_16x16x32_bf16 v[72:75], a[16:19], v[176:179], v[72:75]
 v_mfma_f32_16x16x32_bf16 v[76:79], a[24:27], v[176:179], v[76:79]
 ds_read_b128 a[16:19], v17 offset:18432
 v_mfma_f32_16x16x32_bf16 v[76:79], a[28:31], v[184:187], v[76:79]
 v_mfma_f32_16x16x32_bf16 v[108:111], a[28:31], v[188:191], v[108:111]
 ds_read_b128 a[20:23], v17 offset:26624
 s_waitcnt lgkmcnt(4)
 v_mfma_f32_16x16x32_bf16 v[108:111], a[24:27], v[180:183], v[108:111]
 v_mfma_f32_16x16x32_bf16 v[96:99], a[0:3], v[196:199], v[96:99]
 ds_read_b128 a[24:27], v17 offset:19456
 v_mfma_f32_16x16x32_bf16 v[96:99], a[4:7], v[204:207], v[96:99]
 v_mfma_f32_16x16x32_bf16 v[64:67], a[4:7], v[200:203], v[64:67]
 ds_read_b128 a[28:31], v17 offset:27648
 s_waitcnt lgkmcnt(4)
 v_mfma_f32_16x16x32_bf16 v[64:67], a[0:3], v[192:195], v[64:67]
 v_mfma_f32_16x16x32_bf16 v[68:71], a[8:11], v[192:195], v[68:71]
 v_mfma_f32_16x16x32_bf16 v[68:71], a[12:15], v[200:203], v[68:71]
 v_mfma_f32_16x16x32_bf16 v[100:103], a[12:15], v[204:207], v[100:103]
 s_waitcnt lgkmcnt(2)
 v_mfma_f32_16x16x32_bf16 v[100:103], a[8:11], v[196:199], v[100:103]
 v_mfma_f32_16x16x32_bf16 v[104:107], a[16:19], v[196:199], v[104:107]
 v_mfma_f32_16x16x32_bf16 v[104:107], a[20:23], v[204:207], v[104:107]
 v_mfma_f32_16x16x32_bf16 v[72:75], a[20:23], v[200:203], v[72:75]
 s_waitcnt lgkmcnt(0)
 v_mfma_f32_16x16x32_bf16 v[72:75], a[16:19], v[192:195], v[72:75]
 v_mfma_f32_16x16x32_bf16 v[76:79], a[24:27], v[192:195], v[76:79]
 v_mfma_f32_16x16x32_bf16 v[76:79], a[28:31], v[200:203], v[76:79]
 v_mfma_f32_16x16x32_bf16 v[108:111], a[28:31], v[204:207], v[108:111]
 v_mfma_f32_16x16x32_bf16 v[108:111], a[24:27], v[196:199], v[108:111]
 buffer_load_dwordx4 v[112:115], v1, s[4:7], s26 offen sc1
 buffer_load_dwordx4 v[116:119], v1, s[4:7], s26 offen offset:1024 sc1
 buffer_load_dwordx4 v[120:123], v1, s[4:7], s26 offen offset:2048 sc1
 buffer_load_dwordx4 v[124:127], v1, s[4:7], s26 offen offset:3072 sc1
 v_pk_fma_f32 v[64:65], v[64:65], v[26:27], v[32:33] op_sel_hi:[1,0,1]
 v_pk_fma_f32 v[66:67], v[66:67], v[26:27], v[34:35] op_sel_hi:[1,0,1]
 v_pk_fma_f32 v[96:97], v[96:97], v[28:29], v[48:49] op_sel_hi:[1,0,1]
 v_pk_fma_f32 v[98:99], v[98:99], v[28:29], v[50:51] op_sel_hi:[1,0,1]
 v_pk_fma_f32 v[68:69], v[68:69], v[26:27], v[36:37] op_sel_hi:[1,0,1]
 v_pk_fma_f32 v[70:71], v[70:71], v[26:27], v[38:39] op_sel_hi:[1,0,1]
 v_pk_fma_f32 v[100:101], v[100:101], v[28:29], v[52:53] op_sel_hi:[1,0,1]
 v_pk_fma_f32 v[102:103], v[102:103], v[28:29], v[54:55] op_sel_hi:[1,0,1]
 v_pk_fma_f32 v[72:73], v[72:73], v[26:27], v[40:41] op_sel_hi:[1,0,1]
 v_pk_fma_f32 v[74:75], v[74:75], v[26:27], v[42:43] op_sel_hi:[1,0,1]
 v_pk_fma_f32 v[104:105], v[104:105], v[28:29], v[56:57] op_sel_hi:[1,0,1]
 v_pk_fma_f32 v[106:107], v[106:107], v[28:29], v[58:59] op_sel_hi:[1,0,1]
 v_pk_fma_f32 v[76:77], v[76:77], v[26:27], v[44:45] op_sel_hi:[1,0,1]
 v_pk_fma_f32 v[78:79], v[78:79], v[26:27], v[46:47] op_sel_hi:[1,0,1]
 v_pk_fma_f32 v[108:109], v[108:109], v[28:29], v[60:61] op_sel_hi:[1,0,1]
 v_pk_fma_f32 v[110:111], v[110:111], v[28:29], v[62:63] op_sel_hi:[1,0,1]
 s_mov_b32 s67, 400000
L_look_47:
 s_waitcnt vmcnt(3)
 v_max3_u32 v22, v112, v113, v113
 v_max3_u32 v22, v114, v115, v22
 s_waitcnt vmcnt(2)
 v_max3_u32 v22, v116, v117, v22
 v_max3_u32 v22, v118, v119, v22
 s_waitcnt vmcnt(1)
 v_max3_u32 v22, v120, v121, v22
 v_max3_u32 v22, v122, v123, v22
 s_waitcnt vmcnt(0)
 v_max3_u32 v22, v124, v125, v22
 v_max3_u32 v22, v126, v127, v22
 v_cmp_eq_u32 vcc, -1, v22
 s_sub_u32 s67, s67, 1
 s_cmp_eq_u32 s67, 0
 s_cbranch_vccz L_have_48
 s_cbranch_scc1 L_have_48
 buffer_load_dwordx4 v[112:115], v1, s[4:7], s26 offen sc1
 buffer_load_dwordx4 v[116:119], v1, s[4:7], s26 offen offset:1024 sc1
 buffer_load_dwordx4 v[120:123], v1, s[4:7], s26 offen offset:2048 sc1
 buffer_load_dwordx4 v[124:127], v1, s[4:7], s26 offen offset:3072 sc1
 s_waitcnt vmcnt(0)
 s_branch L_look_47
L_have_48:
 v_lshlrev_b32 v48, 16, v112
 v_and_b32 v49, s64, v112
 v_lshlrev_b32 v50, 16, v113
 v_and_b32 v51, s64, v113
 v_lshlrev_b32 v52, 16, v114
 v_and_b32 v53, s64, v114
 v_lshlrev_b32 v54, 16, v115
 v_and_b32 v55, s64, v115
 v_pk_fma_f32 v[64:65], v[48:49], v[26:27], v[64:65] op_sel_hi:[1,0,1]
 v_pk_fma_f32 v[66:67], v[50:51], v[26:27], v[66:67] op_sel_hi:[1,0,1]
 v_pk_fma_f32 v[96:97], v[52:53], v[28:29], v[96:97] op_sel_hi:[1,0,1]
 v_pk_fma_f32 v[98:99], v[54:55], v[28:29], v[98:99] op_sel_hi:[1,0,1]
 v_cvt_pk_bf16_f32 v32, v64, v65
 v_cvt_pk_bf16_f32 v33, v66, v67
 v_cvt_pk_bf16_f32 v34, v96, v97
 v_cvt_pk_bf16_f32 v35, v98, v99
 ds_write_b64 v4, v[32:33]
 ds_write_b64 v4, v[34:35] offset:2048
 v_lshlrev_b32 v48, 16, v116
 v_and_b32 v49, s64, v116
 v_lshlrev_b32 v50, 16, v117
 v_and_b32 v51, s64, v117
 v_lshlrev_b32 v52, 16, v118
 v_and_b32 v53, s64, v118
 v_lshlrev_b32 v54, 16, v119
 v_and_b32 v55, s64, v119
 v_pk_fma_f32 v[68:69], v[48:49], v[26:27], v[68:69] op_sel_hi:[1,0,1]
 v_pk_fma_f32 v[70:71], v[50:51], v[26:27], v[70:71] op_sel_hi:[1,0,1]
 v_pk_fma_f32 v[100:101], v[52:53], v[28:29], v[100:101] op_sel_hi:[1,0,1]
 v_pk_fma_f32 v[102:103], v[54:55], v[28:29], v[102:103] op_sel_hi:[1,0,1]
 v_cvt_pk_bf16_f32 v36, v68, v69
 v_cvt_pk_bf16_f32 v37, v70, v71
 v_cvt_pk_bf16_f32 v38, v100, v101
 v_cvt_pk_bf16_f32 v39, v102, v103
 ds_write_b64 v5, v[36:37]
 ds_write_b64 v5, v[38:39] offset:2048
 v_lshlrev_b32 v48, 16, v120
 v_and_b32 v49, s64, v120
 v_lshlrev_b32 v50, 16, v121
 v_and_b32 v51, s64, v121
 v_lshlrev_b32 v52, 16, v122
 v_and_b32 v53, s64, v122
 v_lshlrev_b32 v54, 16, v123
 v_and_b32 v55, s64, v123
 v_pk_fma_f32 v[72:73], v[48:49], v[26:27], v[72:73] op_sel_hi:[1,0,1]
 v_pk_fma_f32 v[74:75], v[50:51], v[26:27], v[74:75] op_sel_hi:[1,0,1]
 v_pk_fma_f32 v[104:105], v[52:53], v[28:29], v[104:105] op_sel_hi:[1,0,1]
 v_pk_fma_f32 v[106:107], v[54:55], v[28:29], v[106:107] op_sel_hi:[1,0,1]
 v_cvt_pk_bf16_f32 v40, v72, v73
 v_cvt_pk_bf16_f32 v41, v74, v75
 v_cvt_pk_bf16_f32 v42, v104, v105
 v_cvt_pk_bf16_f32 v43, v106, v107
 ds_write_b64 v6, v[40:41]
 ds_write_b64 v6, v[42:43] offset:2048
 v_lshlrev_b32 v48, 16, v124
 v_and_b32 v49, s64, v124
 v_lshlrev_b32 v50, 16, v125
 v_and_b32 v51, s64, v125
 v_lshlrev_b32 v52, 16, v126
 v_and_b32 v53, s64, v126
 v_lshlrev_b32 v54, 16, v127
 v_and_b32 v55, s64, v127
 v_pk_fma_f32 v[76:77], v[48:49], v[26:27], v[76:77] op_sel_hi:[1,0,1]
 v_pk_fma_f32 v[78:79], v[50:51], v[26:27], v[78:79] op_sel_hi:[1,0,1]
 v_pk_fma_f32 v[108:109], v[52:53], v[28:29], v[108:109] op_sel_hi:[1,0,1]
 v_pk_fma_f32 v[110:111], v[54:55], v[28:29], v[110:111] op_sel_hi:[1,0,1]
 v_cvt_pk_bf16_f32 v44, v76, v77
 v_cvt_pk_bf16_f32 v45, v78, v79
 v_cvt_pk_bf16_f32 v46, v108, v109
 v_cvt_pk_bf16_f32 v47, v110, v111
 ds_write_b64 v7, v[44:45]
 ds_write_b64 v7, v[46:47] offset:2048
 ds_read_b128 v[48:51], v14
 ds_read_b128 v[52:55], v14 offset:1024
 ds_read_b128 v[56:59], v14 offset:2048
 ds_read_b128 v[60:63], v14 offset:3072
 s_waitcnt lgkmcnt(3)
 buffer_store_dwordx4 v[48:51], v20, s[8:11], s34 offen sc1
 s_add_u32 s34, s34, 16384
 s_waitcnt lgkmcnt(2)
 buffer_store_dwordx4 v[52:55], v20, s[8:11], s34 offen sc1
 s_add_u32 s34, s34, 16384
 s_waitcnt lgkmcnt(1)
 buffer_store_dwordx4 v[56:59], v20, s[8:11], s34 offen sc1
 s_add_u32 s34, s34, 16384
 s_waitcnt lgkmcnt(0)
 buffer_store_dwordx4 v[60:63], v20, s[8:11], s34 offen sc1
L_end_1:
 s_endpgm
L_hotend:
 s_waitcnt vmcnt(0) lgkmcnt(0)
L_poll_6:
 s_mov_b32 s67, 400000
 s_mov_b64 exec, 0x3
L_spin_49:
 buffer_load_dword v84, v95, s[56:59], 0 offen sc1
 s_waitcnt vmcnt(0)
 v_cmp_gt_u32 vcc, 1, v84
 s_nop 1
 s_cbranch_vccz L_spun_50
 s_sleep 2
 s_sub_u32 s67, s67, 1
 s_cmp_lg_u32 s67, 0
 s_cbranch_scc1 L_spin_49
L_spun_50:
 s_mov_b64 exec, -1
 s_branch L_polled_7
 s_waitcnt vmcnt(0) lgkmcnt(0)
L_poll_14:
 s_mov_b32 s67, 400000
 s_mov_b64 exec, 0x1
L_spin_51:
 buffer_load_dword v207, v214, s[4:7], s32 offen sc1
 s_waitcnt vmcnt(0)
 v_cmp_gt_u32 vcc, 16, v207
 s_nop 1
 s_cbranch_vccz L_spun_52
 s_sleep 2
 s_sub_u32 s67, s67, 1
 s_cmp_lg_u32 s67, 0
 s_cbranch_scc1 L_spin_51
L_spun_52:
 s_mov_b64 exec, -1
 s_branch L_polled_15
 s_waitcnt vmcnt(0) lgkmcnt(0)
L_poll_17:
 s_mov_b32 s67, 400000
 s_mov_b64 exec, 0xffff
L_spin_53:
 buffer_load_dword v207, v213, s[4:7], s28 offen sc1
 s_waitcnt vmcnt(0)
 v_cmp_gt_u32 vcc, 16, v207
 s_nop 1
 s_cbranch_vccz L_spun_54
 s_sleep 2
 s_sub_u32 s67, s67, 1
 s_cmp_lg_u32 s67, 0
 s_cbranch_scc1 L_spin_53
L_spun_54:
 s_mov_b64 exec, -1
 s_branch L_polled_18
 s_waitcnt vmcnt(0) lgkmcnt(0)
L_exact_19:
 s_waitcnt vmcnt(0) lgkmcnt(0)
 s_nop 15
 v_mov_b32 v112, 0
 v_mov_b32 v113, 0
 v_mov_b32 v114, 0
 v_mov_b32 v115, 0
 v_mov_b32 v116, 0
 v_mov_b32 v117, 0
 v_mov_b32 v118, 0
 v_mov_b32 v119, 0
 v_mov_b32 v120, 0
 v_mov_b32 v121, 0
 v_mov_b32 v122, 0
 v_mov_b32 v123, 0
 v_mov_b32 v124, 0
 v_mov_b32 v125, 0
 v_mov_b32 v126, 0
 v_mov_b32 v127, 0
 v_mov_b32 v128, 0
 v_mov_b32 v129, 0
 v_mov_b32 v130, 0
 v_mov_b32 v131, 0
 v_mov_b32 v132, 0
 v_mov_b32 v133, 0
 v_mov_b32 v134, 0
 v_mov_b32 v135, 0
 v_mov_b32 v136, 0
 v_mov_b32 v137, 0
 v_mov_b32 v138, 0
 v_mov_b32 v139, 0
 v_mov_b32 v140, 0
 v_mov_b32 v141, 0
 v_mov_b32 v142, 0
 v_mov_b32 v143, 0
 v_mov_b32 v144, 0
 v_mov_b32 v145, 0
 v_mov_b32 v146, 0
 v_mov_b32 v147, 0
 v_mov_b32 v148, 0
 v_mov_b32 v149, 0
 v_mov_b32 v150, 0
 v_mov_b32 v151, 0
 v_mov_b32 v157, 0xff7fffff
 v_mov_b32 v158, 0xff7fffff
 s_and_b32 s3, s31, 0xffffefff
 s_mov_b32 s67, 64
L_exloop_55:
 buffer_load_dwordx4 v[32:35], v206, s[4:7], s3 offen sc1
 buffer_load_dwordx4 v[36:39], v206, s[4:7], s3 offen offset:1024 sc1
 buffer_load_dwordx4 v[40:43], v1, s[4:7], s3 offen offset:2048 sc1
 buffer_load_dwordx4 v[44:47], v1, s[4:7], s3 offen offset:3072 sc1
 s_waitcnt vmcnt(3)
 v_mfma_f32_32x32x16_bf16 v[64:79], v[32:35], v[16:19], 0
 s_waitcnt vmcnt(2)
 v_mfma_f32_32x32x16_bf16 v[64:79], v[36:39], v[20:23], v[64:79]
 s_nop 11
 v_max3_f32 v6, v64, v65, v157
 v_max3_f32 v6, v6, v66, v67
 v_max3_f32 v6, v6, v68, v69
 v_max3_f32 v6, v6, v70, v71
 v_max3_f32 v6, v6, v72, v73
 v_max3_f32 v6, v6, v74, v75
 v_max3_f32 v6, v6, v76, v77
 v_max3_f32 v6, v6, v78, v79
 v_mov_b32 v7, v6
 s_nop 1
 v_permlane32_swap_b32 v6, v7
 v_max_f32 v6, v6, v7
 v_sub_f32 v159, v157, v6
 v_exp_f32 v159, v159
 v_mov_b32 v157, v6
 v_sub_f32 v64, v64, v6
 v_sub_f32 v65, v65, v6
 v_sub_f32 v66, v66, v6
 v_sub_f32 v67, v67, v6
 v_sub_f32 v68, v68, v6
 v_sub_f32 v69, v69, v6
 v_sub_f32 v70, v70, v6
 v_sub_f32 v71, v71, v6
 v_sub_f32 v72, v72, v6
 v_sub_f32 v73, v73, v6
 v_sub_f32 v74, v74, v6
 v_sub_f32 v75, v75, v6
 v_sub_f32 v76, v76, v6
 v_sub_f32 v77, v77, v6
 v_sub_f32 v78, v78, v6
 v_sub_f32 v79, v79, v6
 v_exp_f32 v96, v64
 v_exp_f32 v97, v65
 v_exp_f32 v98, v66
 v_exp_f32 v99, v67
 v_exp_f32 v100, v68
 v_exp_f32 v101, v69
 v_exp_f32 v102, v70
 v_exp_f32 v103, v71
 v_exp_f32 v104, v72
 v_exp_f32 v105, v73
 v_exp_f32 v106, v74
 v_exp_f32 v107, v75
 v_exp_f32 v108, v76
 v_exp_f32 v109, v77
 v_exp_f32 v110, v78
 v_exp_f32 v111, v79
 v_mul_f32 v112, v112, v159
 v_mul_f32 v113, v113, v159
 v_mul_f32 v114, v114, v159
 v_mul_f32 v115, v115, v159
 v_mul_f32 v116, v116, v159
 v_mul_f32 v117, v117, v159
 v_mul_f32 v118, v118, v159
 v_mul_f32 v119, v119, v159
 v_mul_f32 v120, v120, v159
 v_mul_f32 v121, v121, v159
 v_mul_f32 v122, v122, v159
 v_mul_f32 v123, v123, v159
 v_mul_f32 v124, v124, v159
 v_mul_f32 v125, v125, v159
 v_mul_f32 v126, v126, v159
 v_mul_f32 v127, v127, v159
 v_mul_f32 v144, v144, v159
 v_mul_f32 v145, v145, v159
 v_mul_f32 v146, v146, v159
 v_mul_f32 v147, v147, v159
 s_waitcnt vmcnt(1)
 v_smfmac_f32_32x32x32_bf16 v[112:127], v[40:43], v[96:103], v156
 s_waitcnt vmcnt(0)
 v_smfmac_f32_32x32x32_bf16 v[112:127], v[44:47], v[104:111], v156
 v_smfmac_f32_16x16x64_bf16 v[144:147], v[152:155], v[96:103], v156
 v_smfmac_f32_16x16x64_bf16 v[144:147], v[152:155], v[104:111], v156
 v_mfma_f32_32x32x16_bf16 v[80:95], v[32:35], v[24:27], 0
 v_mfma_f32_32x32x16_bf16 v[80:95], v[36:39], v[28:31], v[80:95]
 s_nop 11
 v_max3_f32 v6, v80, v81, v158
 v_max3_f32 v6, v6, v82, v83
 v_max3_f32 v6, v6, v84, v85
 v_max3_f32 v6, v6, v86, v87
 v_max3_f32 v6, v6, v88, v89
 v_max3_f32 v6, v6, v90, v91
 v_max3_f32 v6, v6, v92, v93
 v_max3_f32 v6, v6, v94, v95
 v_mov_b32 v7, v6
 s_nop 1
 v_permlane32_swap_b32 v6, v7
 v_max_f32 v6, v6, v7
 v_sub_f32 v159, v158, v6
 v_exp_f32 v159, v159
 v_mov_b32 v158, v6
 v_sub_f32 v80, v80, v6
 v_sub_f32 v81, v81, v6
 v_sub_f32 v82, v82, v6
 v_sub_f32 v83, v83, v6
 v_sub_f32 v84, v84, v6
 v_sub_f32 v85, v85, v6
 v_sub_f32 v86, v86, v6
 v_sub_f32 v87, v87, v6
 v_sub_f32 v88, v88, v6
 v_sub_f32 v89, v89, v6
 v_sub_f32 v90, v90, v6
 v_sub_f32 v91, v91, v6
 v_sub_f32 v92, v92, v6
 v_sub_f32 v93, v93, v6
 v_sub_f32 v94, v94, v6
 v_sub_f32 v95, v95, v6
 v_exp_f32 v224, v80
 v_exp_f32 v225, v81
 v_exp_f32 v226, v82
 v_exp_f32 v227, v83
 v_exp_f32 v228, v84
 v_exp_f32 v229, v85
 v_exp_f32 v230, v86
 v_exp_f32 v231, v87
 v_exp_f32 v232, v88
 v_exp_f32 v233, v89
 v_exp_f32 v234, v90
 v_exp_f32 v235, v91
 v_exp_f32 v236, v92
 v_exp_f32 v237, v93
 v_exp_f32 v238, v94
 v_exp_f32 v239, v95
 v_mul_f32 v128, v128, v159
 v_mul_f32 v129, v129, v159
 v_mul_f32 v130, v130, v159
 v_mul_f32 v131, v131, v159
 v_mul_f32 v132, v132, v159
 v_mul_f32 v133, v133, v159
 v_mul_f32 v134, v134, v159
 v_mul_f32 v135, v135, v159
 v_mul_f32 v136, v136, v159
 v_mul_f32 v137, v137, v159
 v_mul_f32 v138, v138, v159
 v_mul_f32 v139, v139, v159
 v_mul_f32 v140, v140, v159
 v_mul_f32 v141, v141, v159
 v_mul_f32 v142, v142, v159
 v_mul_f32 v143, v143, v159
 v_mul_f32 v148, v148, v159
 v_mul_f32 v149, v149, v159
 v_mul_f32 v150, v150, v159
 v_mul_f32 v151, v151, v159
 v_smfmac_f32_32x32x32_bf16 v[128:143], v[40:43], v[224:231], v156
 v_smfmac_f32_32x32x32_bf16 v[128:143], v[44:47], v[232:239], v156
 v_smfmac_f32_16x16x64_bf16 v[148:151], v[152:155], v[224:231], v156
 v_smfmac_f32_16x16x64_bf16 v[148:151], v[152:155], v[232:239], v156
 s_nop 15
 s_add_u32 s3, s3, 4096
 s_sub_u32 s67, s67, 1
 s_cmp_lg_u32 s67, 0
 s_cbranch_scc1 L_exloop_55
 v_rcp_f32 v4, v144
 s_nop 0
 v_pk_mul_f32 v[112:113], v[112:113], v[4:5] op_sel_hi:[1,0]
 v_pk_mul_f32 v[114:115], v[114:115], v[4:5] op_sel_hi:[1,0]
 v_pk_mul_f32 v[116:117], v[116:117], v[4:5] op_sel_hi:[1,0]
 v_pk_mul_f32 v[118:119], v[118:119], v[4:5] op_sel_hi:[1,0]
 v_cvt_pk_bf16_f32 v64, v112, v113
 v_cvt_pk_bf16_f32 v65, v114, v115
 v_cvt_pk_bf16_f32 v66, v116, v117
 v_cvt_pk_bf16_f32 v67, v118, v119
 buffer_store_dwordx4 v[64:67], v9, s[4:7], s33 offen sc1
 v_pk_mul_f32 v[120:121], v[120:121], v[4:5] op_sel_hi:[1,0]
 v_pk_mul_f32 v[122:123], v[122:123], v[4:5] op_sel_hi:[1,0]
 v_pk_mul_f32 v[124:125], v[124:125], v[4:5] op_sel_hi:[1,0]
 v_pk_mul_f32 v[126:127], v[126:127], v[4:5] op_sel_hi:[1,0]
 v_cvt_pk_bf16_f32 v68, v120, v121
 v_cvt_pk_bf16_f32 v69, v122, v123
 v_cvt_pk_bf16_f32 v70, v124, v125
 v_cvt_pk_bf16_f32 v71, v126, v127
 buffer_store_dwordx4 v[68:71], v9, s[4:7], s33 offen offset:1024 sc1
 v_rcp_f32 v4, v148
 s_nop 0
 v_pk_mul_f32 v[128:129], v[128:129], v[4:5] op_sel_hi:[1,0]
 v_pk_mul_f32 v[130:131], v[130:131], v[4:5] op_sel_hi:[1,0]
 v_pk_mul_f32 v[132:133], v[132:133], v[4:5] op_sel_hi:[1,0]
 v_pk_mul_f32 v[134:135], v[134:135], v[4:5] op_sel_hi:[1,0]
 v_cvt_pk_bf16_f32 v80, v128, v129
 v_cvt_pk_bf16_f32 v81, v130, v131
 v_cvt_pk_bf16_f32 v82, v132, v133
 v_cvt_pk_bf16_f32 v83, v134, v135
 buffer_store_dwordx4 v[80:83], v9, s[4:7], s34 offen sc1
 v_pk_mul_f32 v[136:137], v[136:137], v[4:5] op_sel_hi:[1,0]
 v_pk_mul_f32 v[138:139], v[138:139], v[4:5] op_sel_hi:[1,0]
 v_pk_mul_f32 v[140:141], v[140:141], v[4:5] op_sel_hi:[1,0]
 v_pk_mul_f32 v[142:143], v[142:143], v[4:5] op_sel_hi:[1,0]
 v_cvt_pk_bf16_f32 v84, v136, v137
 v_cvt_pk_bf16_f32 v85, v138, v139
 v_cvt_pk_bf16_f32 v86, v140, v141
 v_cvt_pk_bf16_f32 v87, v142, v143
 buffer_store_dwordx4 v[84:87], v9, s[4:7], s34 offen offset:1024 sc1
 s_waitcnt vmcnt(0)
 s_branch L_exacted_20
 s_waitcnt vmcnt(0) lgkmcnt(0)
L_poll_34:
 s_mov_b32 s67, 400000
 s_mov_b64 exec, 0xffff
L_spin_56:
 buffer_load_dword v17, v16, s[4:7], s33 offen sc1
 s_waitcnt vmcnt(0)
 v_cmp_gt_u32 vcc, 16, v17
 s_nop 1
 s_cbranch_vccz L_spun_57
 s_sleep 2
 s_sub_u32 s67, s67, 1
 s_cmp_lg_u32 s67, 0
 s_cbranch_scc1 L_spin_56
L_spun_57:
 s_mov_b64 exec, -1
 s_branch L_polled_35
 s_waitcnt vmcnt(0) lgkmcnt(0)
L_poll_36:
 s_mov_b32 s67, 400000
 s_mov_b64 exec, 0x1
L_spin_58:
 buffer_load_dword v31, v30, s[4:7], s65 offen sc1
 s_waitcnt vmcnt(0)
 v_cmp_gt_u32 vcc, 32, v31
 s_nop 1
 s_cbranch_vccz L_spun_59
 s_sleep 2
 s_sub_u32 s67, s67, 1
 s_cmp_lg_u32 s67, 0
 s_cbranch_scc1 L_spin_58
L_spun_59:
 s_mov_b64 exec, -1
 s_branch L_polled_37
 s_waitcnt vmcnt(0) lgkmcnt(0)
L_poll_40:
 s_mov_b32 s67, 400000
 s_mov_b64 exec, 0x1
L_spin_60:
 buffer_load_dword v13, v12, s[4:7], s28 offen sc1
 s_waitcnt vmcnt(0)
 v_cmp_gt_u32 vcc, 32, v13
 s_nop 1
 s_cbranch_vccz L_spun_61
 s_sleep 2
 s_sub_u32 s67, s67, 1
 s_cmp_lg_u32 s67, 0
 s_cbranch_scc1 L_spin_60
L_spun_61:
 s_mov_b64 exec, -1
 s_branch L_polled_41
 s_waitcnt vmcnt(0) lgkmcnt(0)
L_poll_44:
 s_mov_b32 s67, 400000
 s_mov_b64 exec, 0x1
L_spin_62:
 buffer_load_dword v13, v12, s[4:7], s29 offen sc1
 s_waitcnt vmcnt(0)
 v_cmp_gt_u32 vcc, 32, v13
 s_nop 1
 s_cbranch_vccz L_spun_63
 s_sleep 2
 s_sub_u32 s67, s67, 1
 s_cmp_lg_u32 s67, 0
 s_cbranch_scc1 L_spin_62
L_spun_63:
 s_mov_b64 exec, -1
 s_branch L_polled_45
L_codeend:
 s_endpgm
.section .rodata,"a"
.p2align 6
.amdhsa_kernel sequential_preLN__softmax_full_mha__glu_gated_swiglu__prompt_kernel
  .amdhsa_next_free_vgpr 512
  .amdhsa_next_free_sgpr 102
  .amdhsa_accum_offset 256
  .amdhsa_group_segment_fixed_size 0
  .amdhsa_kernarg_size 80
  .amdhsa_user_sgpr_count 2
  .amdhsa_user_sgpr_kernarg_segment_ptr 1
  .amdhsa_system_sgpr_workgroup_id_x 1
  .amdhsa_float_denorm_mode_32 3
.end_amdhsa_kernel
```
